```python
import torch

def _softmax(x, axis=-1):
    return torch.softmax(x, dim=axis)

def _gelu(x):
    return torch.nn.functional.gelu(x, approximate='tanh')

def _silu(x):
    return torch.nn.functional.silu(x)

def _sigmoid(x):
    return torch.sigmoid(x)

def _layernorm(x, axis=-1, eps=1e-05):
    m = x.mean(dim=axis, keepdim=True)
    v = x.var(dim=axis, keepdim=True, unbiased=False)
    return (x - m) / torch.sqrt(v + eps)

def _scatter_add(tgt, idx, src, axis=0):
    return tgt.clone().index_add_(axis, idx, src)

def _segment_sum(src, seg, n):
    out = torch.zeros((n,) + src.shape[1:], dtype=src.dtype)
    return out.index_add_(0, seg, src)

def _pad(x, pw):
    flat = tuple((v for pair in reversed(pw) for v in pair))
    return torch.nn.functional.pad(x, flat)
kernel_name = 'adaLN_cond__gqa_block_cached__glu_gated_bilinear__prompt'

def setup_inputs():

    _w = lambda a: (lambda t: t.to(torch.bfloat16) if t.is_floating_point() else t)(torch.as_tensor(a))

    def _A_setup():
        B, Sq, D = (1, 2048, 512)
        Hq, Hkv, Sk, Dh = (32, 32, 2048, 128)
        assert Hq % Hkv == 0, (Hq, Hkv)
        return {'x': _w((lambda *s: torch.randn(*s, dtype=torch.bfloat16) * 0.05)(B, Sq, D)), 'k_cache': _w((lambda *s: torch.randn(*s, dtype=torch.bfloat16) * 0.8)(B, Hkv, Sk, Dh)), 'v_cache': _w((lambda *s: torch.randn(*s, dtype=torch.bfloat16) * 3.2)(B, Hkv, Sk, Dh)), 'wq': _w((lambda *s: torch.randn(*s, dtype=torch.bfloat16) * 0.8)(D, Hq * Dh) * D ** (-0.5)), 'wo': _w((lambda *s: torch.randn(*s, dtype=torch.bfloat16) * 3.2)(Hq * Dh, D) * (Hq * Dh) ** (-0.5))}
    _A_in = _A_setup()

    def _B_setup():
        B, S, D, F = (1, 2048, 512, 1376)
        return {'x': _w((lambda *s: torch.randn(*s, dtype=torch.bfloat16) * 0.05)(B, S, D)), 'w_gate': _w((lambda *s: torch.randn(*s, dtype=torch.bfloat16) * 3.2)(D, F) * D ** (-0.5)), 'w_up': _w((lambda *s: torch.randn(*s, dtype=torch.bfloat16) * 3.2)(D, F) * D ** (-0.5)), 'w_down': _w((lambda *s: torch.randn(*s, dtype=torch.bfloat16) * 3.2)(F, D) * F ** (-0.5))}
    _B_in = _B_setup()
    return {'A_x': _A_in['x'], 'A_k_cache': _A_in['k_cache'], 'A_v_cache': _A_in['v_cache'], 'A_wq': _A_in['wq'], 'A_wo': _A_in['wo'], 'B_x': _B_in['x'], 'B_w_gate': _B_in['w_gate'], 'B_w_up': _B_in['w_up'], 'B_w_down': _B_in['w_down'], 'c': _w((lambda *s: torch.randn(*s, dtype=torch.bfloat16) * 0.4)(1, 512) * 8.0), 'w_mod': _w((lambda *s: torch.randn(*s, dtype=torch.bfloat16) * 0.4)(512, 6 * 512) * 512 ** (-0.5) * 8.0)}

def reference(A_x, A_k_cache, A_v_cache, A_wq, A_wo, B_x, B_w_gate, B_w_up, B_w_down, c, w_mod):

    def _A_ref(x, k_cache, v_cache, wq, wo):
        B, Sq, D = x.shape
        Hq, Dh = (32, 128)
        Hkv = k_cache.shape[1]
        rep = Hq // Hkv
        q = (lambda x, *d: x.permute(*d))((x @ wq).reshape(B, Sq, Hq, Dh), 0, 2, 1, 3)
        k = (lambda x, n, axis: torch.repeat_interleave(x, n, dim=axis))(k_cache, rep, axis=1)
        v = (lambda x, n, axis: torch.repeat_interleave(x, n, dim=axis))(v_cache, rep, axis=1)
        scores = torch.einsum('bhqd,bhkd->bhqk', q, k) * Dh ** (-0.5)
        p = _softmax(scores, axis=-1)
        o = torch.einsum('bhqk,bhkd->bhqd', p, v)
        return (lambda x, *d: x.permute(*d))(o, 0, 2, 1, 3).reshape(B, Sq, Hq * Dh) @ wo

    def _B_ref(x, w_gate, w_up, w_down):
        g = torch.einsum('bsd,df->bsf', x, w_gate)
        u = torch.einsum('bsd,df->bsf', x, w_up)
        h = g * u
        return torch.einsum('bsf,fd->bsd', h, w_down)
    x = A_x
    mod = (_silu(c) @ w_mod).reshape(c.shape[0], 6, 1, -1)
    sa, ca, ga, sb, cb, gb = (mod[:, 0].clone(), mod[:, 1].clone(), mod[:, 2].clone(), mod[:, 3].clone(), mod[:, 4].clone(), mod[:, 5].clone())
    h = _layernorm(x, axis=-1) * (1 + ca) + sa
    x = x + ga * _A_ref(h, A_k_cache, A_v_cache, A_wq, A_wo)
    h = _layernorm(x, axis=-1) * (1 + cb) + sb
    x = x + gb * _B_ref(h, B_w_gate, B_w_up, B_w_down)
    return x
```

```asm
; @launch grid=(256,1,1) block=(256,1,1) lds=163840
.amdgcn_target "amdgcn-amd-amdhsa--gfx950"
.text
.globl adaLN_cond__gqa_block_cached__glu_gated_bilinear__prompt_kernel
.p2align 8
.type adaLN_cond__gqa_block_cached__glu_gated_bilinear__prompt_kernel,@function
adaLN_cond__gqa_block_cached__glu_gated_bilinear__prompt_kernel:
    s_cmp_ge_u32 s2, 256
    s_cbranch_scc1 L_end_main_kernel
    s_load_dwordx8 s[4:11], s[0:1], 0
    s_load_dwordx2 s[72:73], s[0:1], 104
    s_load_dwordx2 s[12:13], s[0:1], 32
    s_load_dwordx4 s[64:67], s[0:1], 48
    s_load_dwordx2 s[68:69], s[0:1], 64
    s_load_dwordx2 s[70:71], s[0:1], 88
    s_load_dwordx2 s[82:83], s[0:1], 72
    s_load_dwordx2 s[84:85], s[0:1], 80
    s_load_dwordx2 s[86:87], s[0:1], 96
    s_and_b32 s58, s2, 7
    s_bfe_u32 s14, s2, 0x20003
    s_lshr_b32 s57, s2, 5
    s_lshl_b32 s56, s58, 2
    s_add_u32 s56, s56, s14
    v_mov_b32 v21, v0
    v_lshrrev_b32 v1, 6, v0
    v_and_b32 v0, 63, v0
    v_readfirstlane_b32 s15, v1
    v_lshlrev_b32 v20, 4, v0
    v_lshlrev_b32 v54, 4, v21
    s_cmp_lg_u32 s15, 3
    s_cbranch_scc1 L_ncp_main_kernel
    s_getpc_b64 s[16:17]
L_pc_self_main_kernel:
    s_add_u32 s16, s16, adaLN_cond__gqa_block_cached__glu_gated_bilinear__prompt_kernel-L_pc_self_main_kernel
    s_addc_u32 s17, s17, -1
    s_and_b32 s17, s17, 0xffff
    s_mov_b32 s18, L_hot_end-adaLN_cond__gqa_block_cached__glu_gated_bilinear__prompt_kernel
    s_mov_b32 s19, 0x20000
    v_lshlrev_b32 v2, 7, v0
    s_bfe_u32 s40, s2, 0x30003
    s_lshl_b32 s40, s40, 13
    buffer_load_dword v36, v2, s[16:19], 0 offen
    buffer_load_dword v36, v2, s[16:19], s40 offen
L_ncp_main_kernel:
    s_lshl_b32 s88, s15, 8
    s_add_u32 s88, s88, s2
    s_cmp_ge_u32 s88, 192
    s_cbranch_scc1 L_m1_main_kernel
    v_lshrrev_b32 v6, 3, v0
    v_and_b32 v7, 7, v0
    v_bfe_u32 v8, v0, 4, 2
    v_lshlrev_b32 v8, 1, v8
    v_xor_b32 v7, v7, v8
    v_mul_u32_u24 v6, 6144, v6
    v_lshl_add_u32 v144, v7, 4, v6
    v_add_u32 v145, 48128, v144
    v_add_u32 v146, 96256, v144
    v_add_u32 v147, 144384, v144
    s_and_b32 s36, s2, 3
    s_lshr_b32 s37, s2, 2
    s_mul_i32 s39, s36, 786432
    s_lshl_b32 s40, s37, 7
    s_add_u32 s39, s39, s40
    s_lshl_b32 s40, s36, 8
    v_lshl_add_u32 v2, v0, 2, s40
    s_waitcnt lgkmcnt(0)
    s_mov_b32 s16, s84
    s_and_b32 s17, s85, 0xffff
    s_mov_b32 s18, 3145728
    s_mov_b32 s19, 0x20000
    s_mov_b32 m0, 8192
    s_mov_b32 s20, s82
    s_and_b32 s21, s83, 0xffff
    s_mov_b32 s22, 1024
    s_mov_b32 s23, 0x20000
    buffer_load_dword v148, v2, s[20:23], 0 offen
    buffer_load_dwordx4 v144, s[16:19], s39 offen offset:0 nt lds
    buffer_load_dwordx4 v145, s[16:19], s39 offen offset:1024 nt lds
    buffer_load_dwordx4 v146, s[16:19], s39 offen offset:2048 nt lds
    buffer_load_dwordx4 v147, s[16:19], s39 offen offset:3072 nt lds
    s_mov_b32 m0, 12288
    s_add_u32 s39, s39, 196608
    buffer_load_dwordx4 v144, s[16:19], s39 offen offset:0 nt lds
    buffer_load_dwordx4 v145, s[16:19], s39 offen offset:1024 nt lds
    buffer_load_dwordx4 v146, s[16:19], s39 offen offset:2048 nt lds
    buffer_load_dwordx4 v147, s[16:19], s39 offen offset:3072 nt lds
    s_mov_b32 m0, 16384
    s_add_u32 s39, s39, 196608
    buffer_load_dwordx4 v144, s[16:19], s39 offen offset:0 nt lds
    buffer_load_dwordx4 v145, s[16:19], s39 offen offset:1024 nt lds
    buffer_load_dwordx4 v146, s[16:19], s39 offen offset:2048 nt lds
    buffer_load_dwordx4 v147, s[16:19], s39 offen offset:3072 nt lds
    s_mov_b32 m0, 20480
    s_add_u32 s39, s39, 196608
    buffer_load_dwordx4 v144, s[16:19], s39 offen offset:0 nt lds
    buffer_load_dwordx4 v145, s[16:19], s39 offen offset:1024 nt lds
    buffer_load_dwordx4 v146, s[16:19], s39 offen offset:2048 nt lds
    buffer_load_dwordx4 v147, s[16:19], s39 offen offset:3072 nt lds
L_m1_main_kernel:
    v_and_b32 v48, 7, v21
    v_lshrrev_b32 v49, 5, v21
    v_bfe_u32 v50, v21, 3, 2
    v_lshlrev_b32 v52, 12, v49
    v_lshl_add_u32 v52, v50, 8, v52
    v_lshl_add_u32 v52, v48, 4, v52
    v_lshlrev_b32 v53, 7, v49
    v_lshl_add_u32 v53, v50, 4, v53
    v_lshrrev_b32 v51, 1, v53
    v_lshl_add_u32 v51, v48, 10, v51
    s_lshl_b32 s41, s57, 5
    s_add_u32 s41, s41, s56
    s_lshl_b32 s40, s41, 13
    s_waitcnt lgkmcnt(0)
    s_add_u32 s60, s4, s40
    s_addc_u32 s61, s5, 0
    s_and_b32 s61, s61, 0xffff
    s_mov_b32 s62, 8192
    s_mov_b32 s63, 0x20000
    buffer_load_dwordx2 v[56:57], v51, s[60:63], 0 offen offset:0
    buffer_load_dwordx2 v[58:59], v51, s[60:63], 0 offen offset:32
    buffer_load_dwordx2 v[60:61], v51, s[60:63], 0 offen offset:512
    buffer_load_dwordx2 v[62:63], v51, s[60:63], 0 offen offset:544
    s_add_u32 s52, s72, 0
    s_addc_u32 s53, s73, 0
    s_and_b32 s53, s53, 0xffff
    s_mov_b32 s54, 196608
    s_mov_b32 s55, 0x20000
    s_cmp_ge_u32 s88, 192
    s_cbranch_scc1 L_m2_main_kernel
    v_mov_b32 v4, 0
    v_mov_b32 v5, 0
    v_mov_b32 v6, 0
    v_mov_b32 v7, 0
    s_lshl_b32 s41, s2, 10
    s_add_u32 s41, s41, 131072
    v_add_u32 v2, s41, v20
    buffer_store_dwordx4 v[4:7], v2, s[52:55], 0 offen sc1
    v_lshrrev_b32 v149, 2, v0
    v_and_b32 v150, 3, v0
    v_lshlrev_b32 v150, 3, v150
    v_lshl_add_u32 v150, v149, 7, v150
    v_bfe_u32 v149, v0, 3, 2
    v_add_u32 v150, 8192, v150
    v_xor_b32 v151, 0, v149
    v_lshl_add_u32 v152, v151, 5, v150
    v_xor_b32 v151, 1, v149
    v_lshl_add_u32 v153, v151, 5, v150
    v_xor_b32 v151, 2, v149
    v_lshl_add_u32 v154, v151, 5, v150
    v_xor_b32 v151, 3, v149
    v_lshl_add_u32 v155, v151, 5, v150
    s_mul_i32 s40, s36, 12288
    s_lshl_b32 s41, s37, 8
    s_add_u32 s40, s40, s41
    s_add_u32 s40, s40, 16384
    v_lshrrev_b32 v149, 4, v0
    v_lshlrev_b32 v150, 2, v0
    v_lshlrev_b32 v151, 3, v149
    v_lshlrev_b32 v149, 4, v149
    v_and_b32 v156, 15, v0
    s_waitcnt vmcnt(21)
    v_and_b32 v157, 0xffff0000, v148
    v_lshlrev_b32 v148, 16, v148
    v_mul_f32 v158, 0xbfb8aa3b, v148
    v_mul_f32 v159, 0xbfb8aa3b, v157
    v_exp_f32 v158, v158
    v_exp_f32 v159, v159
    v_cmp_eq_u32 vcc, 0, v156
    v_add_f32 v158, 1.0, v158
    v_add_f32 v159, 1.0, v159
    v_rcp_f32 v160, v158
    v_rcp_f32 v161, v159
    s_nop 0
    v_fma_f32 v158, -v158, v160, 1.0
    v_fma_f32 v159, -v159, v161, 1.0
    v_fmac_f32 v160, v158, v160
    v_fmac_f32 v161, v159, v161
    v_mul_f32 v148, v148, v160
    v_mul_f32 v157, v157, v161
    v_cvt_pk_bf16_f32 v148, v148, v157
    ds_write_b32 v150, v148 offset:24576
    s_waitcnt lgkmcnt(0)
    ds_read_b64 v[160:161], v151 offset:24576
    ds_read_b64 v[162:163], v151 offset:24608
    ds_read_b64 v[164:165], v151 offset:24640
    ds_read_b64 v[166:167], v151 offset:24672
    ds_read_b64 v[168:169], v151 offset:24704
    ds_read_b64 v[170:171], v151 offset:24736
    ds_read_b64 v[172:173], v151 offset:24768
    ds_read_b64 v[174:175], v151 offset:24800
    s_waitcnt vmcnt(17)
    ds_read_b64_tr_b16 v[176:177], v152 offset:0
    ds_read_b64_tr_b16 v[178:179], v152 offset:2048
    ds_read_b64_tr_b16 v[180:181], v153 offset:0
    ds_read_b64_tr_b16 v[182:183], v153 offset:2048
    ds_read_b64_tr_b16 v[184:185], v154 offset:0
    ds_read_b64_tr_b16 v[186:187], v154 offset:2048
    ds_read_b64_tr_b16 v[188:189], v155 offset:0
    ds_read_b64_tr_b16 v[190:191], v155 offset:2048
    s_waitcnt vmcnt(13)
    ds_read_b64_tr_b16 v[192:193], v152 offset:4096
    ds_read_b64_tr_b16 v[194:195], v152 offset:6144
    ds_read_b64_tr_b16 v[196:197], v153 offset:4096
    ds_read_b64_tr_b16 v[198:199], v153 offset:6144
    ds_read_b64_tr_b16 v[200:201], v154 offset:4096
    ds_read_b64_tr_b16 v[202:203], v154 offset:6144
    ds_read_b64_tr_b16 v[204:205], v155 offset:4096
    ds_read_b64_tr_b16 v[206:207], v155 offset:6144
    s_waitcnt vmcnt(9)
    ds_read_b64_tr_b16 v[208:209], v152 offset:8192
    ds_read_b64_tr_b16 v[210:211], v152 offset:10240
    ds_read_b64_tr_b16 v[212:213], v153 offset:8192
    ds_read_b64_tr_b16 v[214:215], v153 offset:10240
    ds_read_b64_tr_b16 v[216:217], v154 offset:8192
    ds_read_b64_tr_b16 v[218:219], v154 offset:10240
    ds_read_b64_tr_b16 v[220:221], v155 offset:8192
    ds_read_b64_tr_b16 v[222:223], v155 offset:10240
    s_waitcnt vmcnt(5)
    ds_read_b64_tr_b16 v[224:225], v152 offset:12288
    ds_read_b64_tr_b16 v[226:227], v152 offset:14336
    ds_read_b64_tr_b16 v[228:229], v153 offset:12288
    ds_read_b64_tr_b16 v[230:231], v153 offset:14336
    ds_read_b64_tr_b16 v[232:233], v154 offset:12288
    ds_read_b64_tr_b16 v[234:235], v154 offset:14336
    ds_read_b64_tr_b16 v[236:237], v155 offset:12288
    ds_read_b64_tr_b16 v[238:239], v155 offset:14336
    s_waitcnt lgkmcnt(8)
    v_mfma_f32_16x16x32_bf16 v[112:115], v[176:179], v[160:163], 0
    v_mfma_f32_16x16x32_bf16 v[116:119], v[180:183], v[160:163], 0
    v_mfma_f32_16x16x32_bf16 v[120:123], v[184:187], v[160:163], 0
    v_mfma_f32_16x16x32_bf16 v[124:127], v[188:191], v[160:163], 0
    v_mfma_f32_16x16x32_bf16 v[112:115], v[192:195], v[164:167], v[112:115]
    v_mfma_f32_16x16x32_bf16 v[116:119], v[196:199], v[164:167], v[116:119]
    v_mfma_f32_16x16x32_bf16 v[120:123], v[200:203], v[164:167], v[120:123]
    v_mfma_f32_16x16x32_bf16 v[124:127], v[204:207], v[164:167], v[124:127]
    v_mfma_f32_16x16x32_bf16 v[112:115], v[208:211], v[168:171], v[112:115]
    v_mfma_f32_16x16x32_bf16 v[116:119], v[212:215], v[168:171], v[116:119]
    v_mfma_f32_16x16x32_bf16 v[120:123], v[216:219], v[168:171], v[120:123]
    v_mfma_f32_16x16x32_bf16 v[124:127], v[220:223], v[168:171], v[124:127]
    s_waitcnt lgkmcnt(0)
    v_mfma_f32_16x16x32_bf16 v[112:115], v[224:227], v[172:175], v[112:115]
    v_mfma_f32_16x16x32_bf16 v[116:119], v[228:231], v[172:175], v[116:119]
    v_mfma_f32_16x16x32_bf16 v[120:123], v[232:235], v[172:175], v[120:123]
    v_mfma_f32_16x16x32_bf16 v[124:127], v[236:239], v[172:175], v[124:127]
    s_nop 7
    s_and_saveexec_b64 s[42:43], vcc
    buffer_store_dwordx4 v[112:115], v149, s[52:55], s40 offen offset:0 sc1
    buffer_store_dwordx4 v[116:119], v149, s[52:55], s40 offen offset:64 sc1
    buffer_store_dwordx4 v[120:123], v149, s[52:55], s40 offen offset:128 sc1
    buffer_store_dwordx4 v[124:127], v149, s[52:55], s40 offen offset:192 sc1
    s_mov_b64 exec, -1
    s_waitcnt vmcnt(5)
L_m2_main_kernel:
    v_lshrrev_b32 v1, 4, v0
    v_and_b32 v2, 15, v0
    v_lshlrev_b32 v3, 1, v1
    v_xor_b32 v18, v3, v2
    v_xor_b32 v19, 8, v18
    s_lshl_b32 s40, s15, 3
    v_add_u32 v37, s40, v1
    v_lshlrev_b32 v2, 13, v37
    v_lshl_add_u32 v248, v18, 4, v2
    v_lshl_add_u32 v249, v19, 4, v2
    v_add_u32 v249, 31744, v249
    s_lshl_b32 s48, s15, 11
    s_mul_i32 s50, s14, 0
    s_mul_i32 s49, s57, 1
    s_add_u32 s49, s49, s50
    s_mul_i32 s50, s58, 2
    s_add_u32 s49, s49, s50
    s_and_b32 s49, s49, 15
    s_mov_b32 s50, s49
    s_lshl_b32 s59, s57, 2
    s_add_u32 s59, s59, s15
    s_lshl_b32 s41, s56, 8
    s_getreg_b32 s90, hwreg(HW_REG_XCC_ID, 0, 4)
    s_lshl_b32 s90, 1, s90
    s_lshl_b32 s91, s57, 3
    s_add_u32 s91, s91, s58
    s_lshl_b32 s91, s91, 7
    s_add_u32 s91, s91, 163844
    v_mov_b32 v55, s90
    s_add_u32 s24, s10, s41
    s_addc_u32 s25, s11, 0
    s_and_b32 s25, s25, 0xffff
    s_mov_b32 s26, 4186368
    s_mov_b32 s27, 0x20000
    s_lshl_b32 s41, s57, 5
    s_add_u32 s41, s41, s56
    s_lshr_b32 s76, s41, 3
    s_lshl_b32 s74, s76, 16
    s_bfe_u32 s40, s41, 0x20001
    s_lshl_b32 s40, s40, 10
    s_add_u32 s74, s74, s40
    s_and_b32 s40, s41, 1
    s_lshl_b32 s40, s40, 7
    s_add_u32 s74, s74, s40
    s_mov_b32 s75, 32768
    s_lshl_b32 s76, s76, 10
    s_add_u32 s77, s76, 131072
    s_lshl_b32 s45, s58, 7
    s_lshl_b32 s78, s57, 12
    s_add_u32 s78, s78, s45
    s_add_u32 s78, s78, 131072
    s_add_u32 s32, s74, 1048576
    s_add_u32 s32, s72, s32
    s_addc_u32 s33, s73, 0
    s_and_b32 s33, s33, 0xffff
    s_mov_b32 s34, 65536
    s_mov_b32 s35, 0x20000
    s_lshl_b32 s40, s59, 16
    s_add_u32 s28, s40, 1048576
    s_add_u32 s28, s72, s28
    s_addc_u32 s29, s73, 0
    s_and_b32 s29, s29, 0xffff
    s_mov_b32 s30, 65536
    s_mov_b32 s31, 0x20000
    s_lshl_b32 s40, s15, 16
    v_subrev_u32 v38, s40, v248
    v_subrev_u32 v39, s40, v249
    s_sub_u32 s79, s15, 1
    s_cmp_eq_u32 s15, 0
    s_cbranch_scc1 L_w0_main_kernel
    s_add_u32 m0, s48, 32768
    s_mul_i32 s43, s49, 262144
    buffer_load_dwordx4 v248, s[24:27], s43 offen  lds
    s_add_u32 s49, s49, 1
    s_and_b32 s49, s49, 15
    buffer_load_dwordx4 v249, s[24:27], s43 offen offset:1024  lds
    s_add_u32 m0, s48, 40960
    s_mul_i32 s43, s49, 262144
    buffer_load_dwordx4 v248, s[24:27], s43 offen  lds
    s_add_u32 s49, s49, 1
    s_and_b32 s49, s49, 15
    buffer_load_dwordx4 v249, s[24:27], s43 offen offset:1024  lds
    s_add_u32 m0, s48, 49152
    s_mul_i32 s43, s49, 262144
    buffer_load_dwordx4 v248, s[24:27], s43 offen  lds
    s_add_u32 s49, s49, 1
    s_and_b32 s49, s49, 15
    buffer_load_dwordx4 v249, s[24:27], s43 offen offset:1024  lds
    s_lshl_b32 s40, s79, 13
    s_add_u32 m0, s40, 32768
    s_add_u32 s40, s79, s50
    s_and_b32 s40, s40, 15
    s_lshl_b32 s40, s40, 18
    buffer_load_dwordx4 v38, s[24:27], s40 offen  lds
    buffer_load_dwordx4 v39, s[24:27], s40 offen offset:1024  lds
    s_add_u32 s79, s79, 3
    s_waitcnt vmcnt(8)
    s_branch L_xw_main_kernel
L_w0_main_kernel:
    s_cmp_lt_u32 s2, 192
    s_cbranch_scc1 L_xw_main_kernel
    s_waitcnt vmcnt(0)
L_xw_main_kernel:
    v_mov_b32 v96, 0
    v_mov_b32 v97, 0
    v_mov_b32 v99, 0x3f803f80
    v_dot2c_f32_bf16 v96, v56, v99
    v_dot2c_f32_bf16 v97, v56, v56
    v_dot2c_f32_bf16 v96, v57, v99
    v_dot2c_f32_bf16 v97, v57, v57
    v_dot2c_f32_bf16 v96, v58, v99
    v_dot2c_f32_bf16 v97, v58, v58
    v_dot2c_f32_bf16 v96, v59, v99
    v_dot2c_f32_bf16 v97, v59, v59
    v_dot2c_f32_bf16 v96, v60, v99
    v_dot2c_f32_bf16 v97, v60, v60
    v_dot2c_f32_bf16 v96, v61, v99
    v_dot2c_f32_bf16 v97, v61, v61
    v_dot2c_f32_bf16 v96, v62, v99
    v_dot2c_f32_bf16 v97, v62, v62
    v_dot2c_f32_bf16 v96, v63, v99
    v_dot2c_f32_bf16 v97, v63, v63
    s_lshl_b32 s40, s15, 3
    v_bfe_u32 v98, v0, 4, 1
    v_lshl_add_u32 v98, v98, 2, s40
    v_add_f32_dpp v96, v96, v96 row_ror:8 row_mask:0xf bank_mask:0xf
    v_add_f32_dpp v97, v97, v97 row_ror:8 row_mask:0xf bank_mask:0xf
    v_lshl_add_u32 v98, v48, 5, v98
    s_nop 0
    v_permlane16_swap_b32 v96, v97
    v_add_f32 v96, v96, v97
    v_mov_b32 v97, v96
    s_nop 1
    v_permlane32_swap_b32 v96, v97
    v_add_f32 v96, v96, v97
    ds_write_b32 v98, v96 offset:4096
    s_lshr_b32 s40, s15, 1
    v_cvt_f32_u32 v110, s40
    s_mov_b32 s44, 0x3e0293ee
    v_lshlrev_b32 v96, 5, v48
    v_mul_f32 v110, s44, v110
    s_mov_b32 s20, s86
    s_and_b32 s21, s87, 0xffff
    s_movk_i32 s22, 256
    s_mov_b32 s23, 0x20000
    s_cmp_ge_u32 s88, 64
    s_cbranch_scc1 L_a2_main_kernel
    s_mov_b64 exec, 1
    v_mov_b32 v1, 1
    s_waitcnt vmcnt(0)
    buffer_atomic_add v1, off, s[20:23], 0 sc0 sc1
    s_waitcnt vmcnt(0)
    v_readfirstlane_b32 s41, v1
    s_cmp_lg_u32 s41, 63
    s_cbranch_scc1 L_m3_main_kernel
    buffer_store_dword v1, off, s[20:23], 0 offset:128 sc1
L_m3_main_kernel:
    s_mov_b64 exec, -1
L_a2_main_kernel:
    s_cmp_ge_u32 s2, 64
    s_cbranch_scc1 L_wm3A
    s_cmp_lg_u32 s15, 1
    s_cbranch_scc1 L_wm1A
    s_call_b64 s[46:47], L_stub0
    s_call_b64 s[46:47], L_stub3
    s_call_b64 s[46:47], L_stub6
    s_call_b64 s[46:47], L_stub9
L_wm1A:
    s_cmp_lg_u32 s15, 2
    s_cbranch_scc1 L_wm2A
    s_call_b64 s[46:47], L_stub1
    s_call_b64 s[46:47], L_stub4
    s_call_b64 s[46:47], L_stub7
    s_call_b64 s[46:47], L_stub10
L_wm2A:
    s_cmp_lg_u32 s15, 3
    s_cbranch_scc1 L_wm3A
    s_call_b64 s[46:47], L_stub2
    s_call_b64 s[46:47], L_stub5
    s_call_b64 s[46:47], L_stub8
    s_call_b64 s[46:47], L_stub11
L_wm3A:
    s_waitcnt lgkmcnt(0)
    s_barrier
    ds_read_b128 v[100:103], v96 offset:4096
    ds_read_b128 v[104:107], v96 offset:4112
    s_cmp_eq_u32 s15, 0
    s_cbranch_scc1 L_a0_main_kernel
    s_add_u32 m0, s48, 57344
    s_mul_i32 s43, s49, 262144
    buffer_load_dwordx4 v248, s[24:27], s43 offen  lds
    s_add_u32 s49, s49, 1
    s_and_b32 s49, s49, 15
    buffer_load_dwordx4 v249, s[24:27], s43 offen offset:1024  lds
    s_add_u32 m0, s48, 65536
    s_mul_i32 s43, s49, 262144
    buffer_load_dwordx4 v248, s[24:27], s43 offen  lds
    s_add_u32 s49, s49, 1
    s_and_b32 s49, s49, 15
    buffer_load_dwordx4 v249, s[24:27], s43 offen offset:1024  lds
    s_add_u32 m0, s48, 73728
    s_mul_i32 s43, s49, 262144
    buffer_load_dwordx4 v248, s[24:27], s43 offen  lds
    s_add_u32 s49, s49, 1
    s_and_b32 s49, s49, 15
    buffer_load_dwordx4 v249, s[24:27], s43 offen offset:1024  lds
    s_lshl_b32 s40, s79, 13
    s_add_u32 m0, s40, 32768
    s_add_u32 s40, s79, s50
    s_and_b32 s40, s40, 15
    s_lshl_b32 s40, s40, 18
    buffer_load_dwordx4 v38, s[24:27], s40 offen  lds
    buffer_load_dwordx4 v39, s[24:27], s40 offen offset:1024  lds
    s_add_u32 s79, s79, 3
    s_add_u32 m0, s48, 81920
    s_mul_i32 s43, s49, 262144
    buffer_load_dwordx4 v248, s[24:27], s43 offen  lds
    s_add_u32 s49, s49, 1
    s_and_b32 s49, s49, 15
    buffer_load_dwordx4 v249, s[24:27], s43 offen offset:1024  lds
    s_add_u32 m0, s48, 90112
    s_mul_i32 s43, s49, 262144
    buffer_load_dwordx4 v248, s[24:27], s43 offen  lds
    s_add_u32 s49, s49, 1
    s_and_b32 s49, s49, 15
    buffer_load_dwordx4 v249, s[24:27], s43 offen offset:1024  lds
    s_add_u32 m0, s48, 98304
    s_mul_i32 s43, s49, 262144
    buffer_load_dwordx4 v248, s[24:27], s43 offen  lds
    s_add_u32 s49, s49, 1
    s_and_b32 s49, s49, 15
    buffer_load_dwordx4 v249, s[24:27], s43 offen offset:1024  lds
    s_lshl_b32 s40, s79, 13
    s_add_u32 m0, s40, 32768
    s_add_u32 s40, s79, s50
    s_and_b32 s40, s40, 15
    s_lshl_b32 s40, s40, 18
    buffer_load_dwordx4 v38, s[24:27], s40 offen  lds
    buffer_load_dwordx4 v39, s[24:27], s40 offen offset:1024  lds
    s_add_u32 s79, s79, 3
L_a0_main_kernel:
    s_add_u32 s49, s50, 9
    s_and_b32 s49, s49, 15
    v_lshlrev_b32 v80, 16, v56
    v_and_b32 v81, 0xffff0000, v56
    v_lshlrev_b32 v82, 16, v57
    v_and_b32 v83, 0xffff0000, v57
    v_lshlrev_b32 v84, 16, v58
    v_and_b32 v85, 0xffff0000, v58
    v_lshlrev_b32 v86, 16, v59
    v_and_b32 v87, 0xffff0000, v59
    v_lshlrev_b32 v88, 16, v60
    v_and_b32 v89, 0xffff0000, v60
    v_lshlrev_b32 v90, 16, v61
    v_and_b32 v91, 0xffff0000, v61
    v_lshlrev_b32 v92, 16, v62
    v_and_b32 v93, 0xffff0000, v62
    v_lshlrev_b32 v94, 16, v63
    v_and_b32 v95, 0xffff0000, v63
    s_waitcnt lgkmcnt(0)
    v_add_f32 v100, v100, v102
    v_add_f32 v101, v101, v103
    v_add_f32 v104, v104, v106
    v_add_f32 v105, v105, v107
    s_mov_b32 s40, 0x3b000000
    v_add_f32 v100, v100, v104
    v_add_f32 v101, v101, v105
    v_mul_f32 v108, s40, v100
    v_mul_f32 v100, v108, v108
    v_fma_f32 v100, v101, s40, -v100
    v_max_f32 v100, 0, v100
    v_add_f32 v100, 0x3727c5ac, v100
    v_rsq_f32 v109, v100
    s_nop 0
    v_mul_f32 v108, v108, v109
    v_fma_f32 v80, v80, v109, -v108
    v_fma_f32 v81, v81, v109, -v108
    v_fma_f32 v82, v82, v109, -v108
    v_fma_f32 v83, v83, v109, -v108
    v_fma_f32 v84, v84, v109, -v108
    v_fma_f32 v85, v85, v109, -v108
    v_fma_f32 v86, v86, v109, -v108
    v_fma_f32 v87, v87, v109, -v108
    v_fma_f32 v88, v88, v109, -v108
    v_fma_f32 v89, v89, v109, -v108
    v_fma_f32 v90, v90, v109, -v108
    v_fma_f32 v91, v91, v109, -v108
    v_fma_f32 v92, v92, v109, -v108
    v_fma_f32 v93, v93, v109, -v108
    v_fma_f32 v94, v94, v109, -v108
    v_fma_f32 v95, v95, v109, -v108
    s_mov_b64 s[100:101], s[86:87]
    s_lshl_b32 s40, s15, 10
    s_add_u32 s40, s40, s78
    s_mov_b32 s83, s40
    s_add_u32 s84, s72, s40
    s_addc_u32 s85, s73, 0
    v_bfe_u32 v38, v0, 2, 3
    v_and_b32 v39, 3, v0
    v_lshlrev_b32 v39, 3, v39
    v_lshl_add_u32 v39, v38, 8, v39
    v_lshrrev_b32 v40, 5, v0
    v_lshl_add_u32 v39, v40, 11, v39
    v_add_u32 v39, 32768, v39
    v_xor_b32 v40, 0, v38
    v_lshl_add_u32 v240, v40, 5, v39
    v_xor_b32 v40, 1, v38
    v_lshl_add_u32 v241, v40, 5, v39
    v_xor_b32 v40, 2, v38
    v_lshl_add_u32 v242, v40, 5, v39
    v_xor_b32 v40, 3, v38
    v_lshl_add_u32 v243, v40, 5, v39
    v_xor_b32 v40, 4, v38
    v_lshl_add_u32 v244, v40, 5, v39
    v_xor_b32 v40, 5, v38
    v_lshl_add_u32 v245, v40, 5, v39
    v_xor_b32 v40, 6, v38
    v_lshl_add_u32 v246, v40, 5, v39
    v_xor_b32 v40, 7, v38
    v_lshl_add_u32 v247, v40, 5, v39
    s_lshl_b32 s40, s56, 19
    s_add_u32 s16, s6, s40
    s_addc_u32 s17, s7, 0
    s_and_b32 s17, s17, 0xffff
    s_mov_b32 s18, 524288
    s_mov_b32 s19, 0x20000
    s_add_u32 s20, s8, s40
    s_addc_u32 s21, s9, 0
    s_and_b32 s21, s21, 0xffff
    s_mov_b32 s22, 524288
    s_mov_b32 s23, 0x20000
    s_lshl_b32 s37, s15, 12
    s_mov_b32 s39, 0x3f000000
    v_lshlrev_b32 v2, 10, v37
    v_lshl_add_u32 v44, v18, 4, v2
    v_lshl_add_u32 v45, v19, 4, v2
    s_mul_i32 s40, s58, 1
    s_mul_i32 s41, s57, 1
    s_add_u32 s40, s40, s41
    s_and_b32 s40, s40, 3
    s_lshl_b32 s40, s40, 6
    v_xor_b32 v44, s40, v44
    v_xor_b32 v45, s40, v45
    v_add_u32 v45, 3072, v45
    v_lshrrev_b32 v3, 4, v0
    v_lshl_add_u32 v2, v3, 8, s37
    v_lshl_add_u32 v18, v18, 4, v2
    v_lshl_add_u32 v19, v19, 4, v2
    v_xor_b32 v3, v3, v0
    v_and_b32 v3, 15, v3
    v_and_b32 v1, 15, v0
    v_lshlrev_b32 v1, 8, v1
    v_xor_b32 v4, 0, v3
    v_lshl_add_u32 v16, v4, 4, v2
    v_lshl_add_u32 v4, v4, 4, v1
    v_xor_b32 v5, 4, v3
    v_lshl_add_u32 v17, v5, 4, v2
    v_lshl_add_u32 v5, v5, 4, v1
    v_xor_b32 v6, 8, v3
    v_lshl_add_u32 v41, v6, 4, v2
    v_lshl_add_u32 v6, v6, 4, v1
    v_xor_b32 v7, 12, v3
    v_lshl_add_u32 v42, v7, 4, v2
    v_lshl_add_u32 v7, v7, 4, v1
    v_bfe_u32 v38, v0, 2, 3
    v_and_b32 v39, 3, v0
    v_lshlrev_b32 v39, 3, v39
    v_lshl_add_u32 v39, v38, 8, v39
    v_lshrrev_b32 v40, 5, v0
    v_lshl_add_u32 v39, v40, 11, v39
    v_xor_b32 v40, 0, v38
    v_lshl_add_u32 v8, v40, 5, v39
    v_xor_b32 v40, 1, v38
    v_lshl_add_u32 v9, v40, 5, v39
    v_xor_b32 v40, 2, v38
    v_lshl_add_u32 v10, v40, 5, v39
    v_xor_b32 v40, 3, v38
    v_lshl_add_u32 v11, v40, 5, v39
    v_xor_b32 v40, 4, v38
    v_lshl_add_u32 v12, v40, 5, v39
    v_xor_b32 v40, 5, v38
    v_lshl_add_u32 v13, v40, 5, v39
    v_xor_b32 v40, 6, v38
    v_lshl_add_u32 v14, v40, 5, v39
    v_xor_b32 v40, 7, v38
    v_lshl_add_u32 v15, v40, 5, v39
    v_mov_b32 v24, 0x3f803f80
    v_mov_b32 v25, 0x3f803f80
    v_mov_b32 v26, 0x3f803f80
    v_mov_b32 v27, 0x3f803f80
    v_lshrrev_b32 v2, 4, v0
    v_xor_b32 v2, v2, v0
    v_and_b32 v2, 2, v2
    v_cmp_eq_u32 vcc, 0, v2
    v_and_b32 v3, 1, v0
    v_mul_u32_u24 v3, 0xaaaa, v3
    v_add_u32 v250, 0x4444, v3
    v_cndmask_b32 v24, 0, v24, vcc
    v_cndmask_b32 v25, 0, v25, vcc
    v_cndmask_b32 v26, 0, v26, vcc
    v_cndmask_b32 v27, 0, v27, vcc
    s_lshl_b32 s40, s58, 19
    s_lshl_b32 s41, s14, 8
    s_add_u32 s40, s40, s41
    s_add_u32 s96, s12, s40
    s_addc_u32 s97, s13, 0
    s_and_b32 s97, s97, 0xffff
    s_mov_b32 s98, 523520
    s_mov_b32 s99, 0x20000
    s_add_u32 s51, s48, 65536
    s_lshr_b32 s78, s2, 3
    s_mul_i32 s79, s58, 31
    s_add_u32 s79, s79, s78
    s_mul_i32 s40, s58, 23095
    s_lshr_b32 s40, s40, 13
    s_lshr_b32 s40, s58, 1
    s_mul_i32 s40, s40, 11
    s_add_u32 s40, s40, 1
    s_lshr_b32 s40, s40, 1
    s_lshl_b32 s40, s40, 7
    s_mul_i32 s41, s78, 44032
    s_add_u32 s40, s40, s41
    s_and_b32 s42, s15, 1
    s_mul_i32 s41, s42, 0
    s_add_u32 s40, s40, s41
    s_add_u32 s40, s40, 0
    s_cmp_eq_u32 s15, 1
    s_cselect_b32 s88, s66, s64
    s_cselect_b32 s89, s67, s65
    s_mul_i32 s41, s2, 5504
    s_mul_i32 s43, s42, 4096
    s_add_u32 s41, s41, s43
    s_cmp_ge_u32 s15, 2
    s_cselect_b32 s60, s68, s88
    s_cselect_b32 s61, s69, s89
    s_movk_i32 s88, 11008
    s_cselect_b32 s88, 2048, s88
    s_movk_i32 s89, 2752
    s_cselect_b32 s89, 512, s89
    v_lshrrev_b32 v2, 4, v0
    v_and_b32 v3, 15, v0
    v_mul_u32_u24 v2, s89, v2
    v_mul_u32_u24 v3, 56, v3
    v_add_u32 v43, v3, v2
    s_cselect_b32 s80, s41, s40
    s_cselect_b32 s81, 12, 8
    s_cselect_b32 s86, 10, 4
    s_mov_b32 s87, 1409024
    s_cselect_b32 s87, 1409024, s87
    s_and_b32 s61, s61, 0xffff
    s_mov_b32 s62, 0
    s_mov_b32 s63, 0x20000
    s_cmp_lt_u32 s2, 64
    s_cbranch_scc1 L_wm3B
    s_cmp_lg_u32 s15, 1
    s_cbranch_scc1 L_wm1B
    s_call_b64 s[46:47], L_stub0
    s_call_b64 s[46:47], L_stub3
    s_call_b64 s[46:47], L_stub6
    s_call_b64 s[46:47], L_stub9
L_wm1B:
    s_cmp_lg_u32 s15, 2
    s_cbranch_scc1 L_wm2B
    s_call_b64 s[46:47], L_stub1
    s_call_b64 s[46:47], L_stub4
    s_call_b64 s[46:47], L_stub7
    s_call_b64 s[46:47], L_stub10
L_wm2B:
    s_cmp_lg_u32 s15, 3
    s_cbranch_scc1 L_wm3B
    s_call_b64 s[46:47], L_stub2
    s_call_b64 s[46:47], L_stub5
    s_call_b64 s[46:47], L_stub8
    s_call_b64 s[46:47], L_stub11
L_wm3B:
    v_mov_b32 v2, 0
    s_cmp_lg_u32 s15, 0
    s_cbranch_scc1 L_gd_main_kernel
    s_mov_b32 s41, 0
L_go_main_kernel:
    global_load_dword v1, v2, s[100:101] offset:128 sc1
    s_add_u32 s41, s41, 1
    s_waitcnt vmcnt(0)
    v_cmp_ne_u32 vcc, 0, v1
    s_cbranch_vccnz L_gd_main_kernel
    s_sleep 1
    s_cmp_lt_u32 s41, 0x80000
    s_cbranch_scc1 L_go_main_kernel
L_gd_main_kernel:
    s_barrier
    s_mov_b32 s42, 16384
    buffer_load_dwordx4 v[64:67], v54, s[52:55], s42 offen sc1
    s_mov_b32 s42, 28672
    buffer_load_dwordx4 v[68:71], v54, s[52:55], s42 offen sc1
    s_mov_b32 s42, 40960
    buffer_load_dwordx4 v[72:75], v54, s[52:55], s42 offen sc1
    s_mov_b32 s42, 53248
    buffer_load_dwordx4 v[76:79], v54, s[52:55], s42 offen sc1
    s_waitcnt vmcnt(0)
    v_add_f32 v64, v64, v68
    v_add_f32 v72, v72, v76
    v_add_f32 v65, v65, v69
    v_add_f32 v73, v73, v77
    v_add_f32 v66, v66, v70
    v_add_f32 v74, v74, v78
    v_add_f32 v67, v67, v71
    v_add_f32 v75, v75, v79
    v_add_f32 v64, v64, v72
    v_add_f32 v65, v65, v73
    v_add_f32 v66, v66, v74
    v_add_f32 v67, v67, v75
    v_cvt_pk_bf16_f32 v68, v64, v65
    v_cvt_pk_bf16_f32 v69, v66, v67
    v_lshlrev_b32 v64, 16, v68
    v_and_b32 v65, 0xffff0000, v68
    v_lshlrev_b32 v66, 16, v69
    v_and_b32 v67, 0xffff0000, v69
    v_fma_f32 v64, v64, s44, v110
    v_fma_f32 v65, v65, s44, v110
    v_fma_f32 v66, v66, s44, v110
    v_fma_f32 v67, v67, s44, v110
    ds_write_b128 v54, v[64:67]
    s_cmp_lg_u32 s15, 0
    s_cbranch_scc1 L_noid_main_kernel
    s_mov_b64 exec, 1
    buffer_atomic_or v55, off, s[52:55], s91 sc1
    s_lshl_b32 s40, s14, 2
    s_add_u32 s40, s40, s91
    s_add_u32 s40, s40, 16412
    v_mov_b32 v1, 0
    buffer_store_dword v1, off, s[52:55], s40 sc1
    s_mov_b64 exec, -1
L_noid_main_kernel:
    s_waitcnt lgkmcnt(0)
    s_barrier
    ds_read_b128 v[112:115], v53 offset:0
    ds_read_b128 v[128:131], v53 offset:2048
    ds_read_b128 v[116:119], v53 offset:64
    ds_read_b128 v[132:135], v53 offset:2112
    ds_read_b128 v[120:123], v53 offset:1024
    ds_read_b128 v[136:139], v53 offset:3072
    ds_read_b128 v[124:127], v53 offset:1088
    ds_read_b128 v[140:143], v53 offset:3136
    s_waitcnt lgkmcnt(4)
    v_fmac_f32 v112, v80, v128
    v_fmac_f32 v113, v81, v129
    v_fmac_f32 v114, v82, v130
    v_fmac_f32 v115, v83, v131
    v_fmac_f32 v116, v84, v132
    v_fmac_f32 v117, v85, v133
    v_fmac_f32 v118, v86, v134
    v_fmac_f32 v119, v87, v135
    v_cvt_pk_bf16_f32 v56, v112, v113
    v_cvt_pk_bf16_f32 v57, v114, v115
    v_cvt_pk_bf16_f32 v58, v116, v117
    v_cvt_pk_bf16_f32 v59, v118, v119
    buffer_store_dwordx4 v[56:59], v52, s[32:35], 0 offen sc1
    s_waitcnt lgkmcnt(0)
    v_fmac_f32 v120, v88, v136
    v_fmac_f32 v121, v89, v137
    v_fmac_f32 v122, v90, v138
    v_fmac_f32 v123, v91, v139
    v_fmac_f32 v124, v92, v140
    v_fmac_f32 v125, v93, v141
    v_fmac_f32 v126, v94, v142
    v_fmac_f32 v127, v95, v143
    v_cvt_pk_bf16_f32 v60, v120, v121
    v_cvt_pk_bf16_f32 v61, v122, v123
    v_cvt_pk_bf16_f32 v62, v124, v125
    v_cvt_pk_bf16_f32 v63, v126, v127
    buffer_store_dwordx4 v[60:63], v52, s[32:35], s75 offen sc1
    v_lshlrev_b32 v3, 7, v0
    v_mov_b32 v1, 1
    s_waitcnt vmcnt(0)
    s_barrier
    s_cmp_lg_u32 s15, 0
    s_cbranch_scc1 L_sig1
    s_mov_b64 exec, 255
    buffer_atomic_add v1, v3, s[52:55], s77 offen sc1
    s_mov_b64 exec, -1
L_sig1:
    s_branch L_al
.p2align 12
L_stub0:
    s_setpc_b64 s[46:47]
L_al:
    ds_read_b64_tr_b16 v[48:49], v240 offset:0
    ds_read_b64_tr_b16 v[50:51], v240 offset:4096
    ds_read_b64_tr_b16 v[52:53], v241 offset:0
    ds_read_b64_tr_b16 v[54:55], v241 offset:4096
    ds_read_b64_tr_b16 v[56:57], v242 offset:0
    ds_read_b64_tr_b16 v[58:59], v242 offset:4096
    ds_read_b64_tr_b16 v[60:61], v243 offset:0
    ds_read_b64_tr_b16 v[62:63], v243 offset:4096
    ds_read_b64_tr_b16 v[64:65], v244 offset:0
    ds_read_b64_tr_b16 v[66:67], v244 offset:4096
    ds_read_b64_tr_b16 v[68:69], v245 offset:0
    ds_read_b64_tr_b16 v[70:71], v245 offset:4096
    ds_read_b64_tr_b16 v[72:73], v246 offset:0
    ds_read_b64_tr_b16 v[74:75], v246 offset:4096
    ds_read_b64_tr_b16 v[76:77], v247 offset:0
    ds_read_b64_tr_b16 v[78:79], v247 offset:4096
    s_lshl_b32 s40, s59, 19
    s_lshl_b32 s41, s56, 14
    s_add_u32 s41, s40, s41
    s_add_u32 s32, s41, 4194304
    s_add_u32 s32, s72, s32
    s_addc_u32 s33, s73, 0
    s_and_b32 s33, s33, 0xffff
    s_mov_b32 s34, 16384
    s_mov_b32 s35, 0x20000
    v_lshlrev_b32 v2, 10, v0
    s_mov_b32 s40, 0
    s_mov_b64 exec, 1
    v_mov_b32 v36, 0
    buffer_atomic_add v36, v2, s[52:55], s83 offen sc0 sc1
    s_sleep 4
    v_mov_b32 v254, 0
    buffer_atomic_add v254, v2, s[52:55], s83 offen sc0 sc1
L_poll2:
    s_waitcnt vmcnt(1)
    v_cmp_gt_u32 vcc, 8, v36
    s_cbranch_vccz L_wt2
    v_mov_b32 v36, 0
    buffer_atomic_add v36, v2, s[52:55], s83 offen sc0 sc1
    s_waitcnt vmcnt(1)
    v_cmp_gt_u32 vcc, 8, v254
    s_cbranch_vccz L_wt2
    v_mov_b32 v254, 0
    buffer_atomic_add v254, v2, s[52:55], s83 offen sc0 sc1
    s_add_u32 s40, s40, 1
    s_cmp_lt_u32 s40, 0x40000
    s_cbranch_scc1 L_poll2
L_wt2:
    s_mov_b64 exec, -1
    s_lshl_b32 s44, s50, 12
    buffer_load_dwordx4 a[0:3], v20, s[28:31], s44 offen offset:0 sc1
    s_add_u32 s50, s50, 1
    s_and_b32 s50, s50, 15
    buffer_load_dwordx4 a[4:7], v20, s[28:31], s44 offen offset:1024 sc1
    buffer_load_dwordx4 a[8:11], v20, s[28:31], s44 offen offset:2048 sc1
    buffer_load_dwordx4 a[12:15], v20, s[28:31], s44 offen offset:3072 sc1
    s_lshl_b32 s44, s50, 12
    buffer_load_dwordx4 a[16:19], v20, s[28:31], s44 offen offset:0 sc1
    s_add_u32 s50, s50, 1
    s_and_b32 s50, s50, 15
    buffer_load_dwordx4 a[20:23], v20, s[28:31], s44 offen offset:1024 sc1
    buffer_load_dwordx4 a[24:27], v20, s[28:31], s44 offen offset:2048 sc1
    buffer_load_dwordx4 a[28:31], v20, s[28:31], s44 offen offset:3072 sc1
    s_waitcnt vmcnt(4) lgkmcnt(0)
    v_mfma_f32_16x16x32_bf16 v[112:115], v[48:51], a[0:3], 0
    ds_read_b64_tr_b16 v[80:81], v240 offset:8192
    ds_read_b64_tr_b16 v[82:83], v240 offset:12288
    v_mfma_f32_16x16x32_bf16 v[144:147], v[48:51], a[4:7], 0
    ds_read_b64_tr_b16 v[84:85], v241 offset:8192
    ds_read_b64_tr_b16 v[86:87], v241 offset:12288
    v_mfma_f32_16x16x32_bf16 v[176:179], v[48:51], a[8:11], 0
    s_lshl_b32 s44, s50, 12
    buffer_load_dwordx4 a[32:35], v20, s[28:31], s44 offen offset:0 sc1
    v_mfma_f32_16x16x32_bf16 v[208:211], v[48:51], a[12:15], 0
    v_mfma_f32_16x16x32_bf16 v[212:215], v[52:55], a[12:15], 0
    s_add_u32 s50, s50, 1
    ds_read_b64_tr_b16 v[88:89], v242 offset:8192
    ds_read_b64_tr_b16 v[90:91], v242 offset:12288
    v_mfma_f32_16x16x32_bf16 v[180:183], v[52:55], a[8:11], 0
    s_and_b32 s50, s50, 15
    buffer_load_dwordx4 a[36:39], v20, s[28:31], s44 offen offset:1024 sc1
    v_mfma_f32_16x16x32_bf16 v[148:151], v[52:55], a[4:7], 0
    v_mfma_f32_16x16x32_bf16 v[116:119], v[52:55], a[0:3], 0
    ds_read_b64_tr_b16 v[92:93], v243 offset:8192
    ds_read_b64_tr_b16 v[94:95], v243 offset:12288
    v_mfma_f32_16x16x32_bf16 v[120:123], v[56:59], a[0:3], 0
    ds_read_b64_tr_b16 v[96:97], v244 offset:8192
    ds_read_b64_tr_b16 v[98:99], v244 offset:12288
    v_mfma_f32_16x16x32_bf16 v[152:155], v[56:59], a[4:7], 0
    buffer_load_dwordx4 a[40:43], v20, s[28:31], s44 offen offset:2048 sc1
    v_mfma_f32_16x16x32_bf16 v[184:187], v[56:59], a[8:11], 0
    v_mfma_f32_16x16x32_bf16 v[216:219], v[56:59], a[12:15], 0
    ds_read_b64_tr_b16 v[100:101], v245 offset:8192
    ds_read_b64_tr_b16 v[102:103], v245 offset:12288
    v_mfma_f32_16x16x32_bf16 v[220:223], v[60:63], a[12:15], 0
    ds_read_b64_tr_b16 v[104:105], v246 offset:8192
    ds_read_b64_tr_b16 v[106:107], v246 offset:12288
    v_mfma_f32_16x16x32_bf16 v[188:191], v[60:63], a[8:11], 0
    buffer_load_dwordx4 a[44:47], v20, s[28:31], s44 offen offset:3072 sc1
    v_mfma_f32_16x16x32_bf16 v[156:159], v[60:63], a[4:7], 0
    v_mfma_f32_16x16x32_bf16 v[124:127], v[60:63], a[0:3], 0
    ds_read_b64_tr_b16 v[108:109], v247 offset:8192
    ds_read_b64_tr_b16 v[110:111], v247 offset:12288
    v_mfma_f32_16x16x32_bf16 v[128:131], v[64:67], a[0:3], 0
    v_mfma_f32_16x16x32_bf16 v[160:163], v[64:67], a[4:7], 0
    s_lshl_b32 s44, s50, 12
    buffer_load_dwordx4 a[48:51], v20, s[28:31], s44 offen offset:0 sc1
    v_mfma_f32_16x16x32_bf16 v[192:195], v[64:67], a[8:11], 0
    v_mfma_f32_16x16x32_bf16 v[224:227], v[64:67], a[12:15], 0
    s_add_u32 s50, s50, 1
    v_mfma_f32_16x16x32_bf16 v[228:231], v[68:71], a[12:15], 0
    s_and_b32 s50, s50, 15
    buffer_load_dwordx4 a[52:55], v20, s[28:31], s44 offen offset:1024 sc1
    v_mfma_f32_16x16x32_bf16 v[196:199], v[68:71], a[8:11], 0
    v_mfma_f32_16x16x32_bf16 v[164:167], v[68:71], a[4:7], 0
    v_mfma_f32_16x16x32_bf16 v[132:135], v[68:71], a[0:3], 0
    v_mfma_f32_16x16x32_bf16 v[136:139], v[72:75], a[0:3], 0
    buffer_load_dwordx4 a[56:59], v20, s[28:31], s44 offen offset:2048 sc1
    v_mfma_f32_16x16x32_bf16 v[168:171], v[72:75], a[4:7], 0
    v_mfma_f32_16x16x32_bf16 v[200:203], v[72:75], a[8:11], 0
    v_mfma_f32_16x16x32_bf16 v[232:235], v[72:75], a[12:15], 0
    v_mfma_f32_16x16x32_bf16 v[236:239], v[76:79], a[12:15], 0
    buffer_load_dwordx4 a[60:63], v20, s[28:31], s44 offen offset:3072 sc1
    v_mfma_f32_16x16x32_bf16 v[204:207], v[76:79], a[8:11], 0
    v_mfma_f32_16x16x32_bf16 v[172:175], v[76:79], a[4:7], 0
    v_mfma_f32_16x16x32_bf16 v[140:143], v[76:79], a[0:3], 0
    s_waitcnt vmcnt(8) lgkmcnt(0)
    v_mfma_f32_16x16x32_bf16 v[112:115], v[80:83], a[16:19], v[112:115]
    ds_read_b64_tr_b16 v[48:49], v240 offset:16384
    ds_read_b64_tr_b16 v[50:51], v240 offset:20480
    v_mfma_f32_16x16x32_bf16 v[144:147], v[80:83], a[20:23], v[144:147]
    ds_read_b64_tr_b16 v[52:53], v240 offset:24576
    ds_read_b64_tr_b16 v[54:55], v240 offset:28672
    v_mfma_f32_16x16x32_bf16 v[176:179], v[80:83], a[24:27], v[176:179]
    s_lshl_b32 s44, s50, 12
    buffer_load_dwordx4 a[64:67], v20, s[28:31], s44 offen offset:0 sc1
    v_mfma_f32_16x16x32_bf16 v[208:211], v[80:83], a[28:31], v[208:211]
    v_mfma_f32_16x16x32_bf16 v[212:215], v[84:87], a[28:31], v[212:215]
    s_add_u32 s50, s50, 1
    ds_read_b64_tr_b16 v[56:57], v241 offset:16384
    ds_read_b64_tr_b16 v[58:59], v241 offset:20480
    v_mfma_f32_16x16x32_bf16 v[180:183], v[84:87], a[24:27], v[180:183]
    s_and_b32 s50, s50, 15
    buffer_load_dwordx4 a[68:71], v20, s[28:31], s44 offen offset:1024 sc1
    v_mfma_f32_16x16x32_bf16 v[148:151], v[84:87], a[20:23], v[148:151]
    v_mfma_f32_16x16x32_bf16 v[116:119], v[84:87], a[16:19], v[116:119]
    ds_read_b64_tr_b16 v[60:61], v241 offset:24576
    ds_read_b64_tr_b16 v[62:63], v241 offset:28672
    v_mfma_f32_16x16x32_bf16 v[120:123], v[88:91], a[16:19], v[120:123]
    buffer_load_dwordx4 a[72:75], v20, s[28:31], s44 offen offset:2048 sc1
    v_mfma_f32_16x16x32_bf16 v[152:155], v[88:91], a[20:23], v[152:155]
    v_mfma_f32_16x16x32_bf16 v[184:187], v[88:91], a[24:27], v[184:187]
    ds_read_b64_tr_b16 v[64:65], v242 offset:16384
    ds_read_b64_tr_b16 v[66:67], v242 offset:20480
    v_mfma_f32_16x16x32_bf16 v[216:219], v[88:91], a[28:31], v[216:219]
    buffer_load_dwordx4 a[76:79], v20, s[28:31], s44 offen offset:3072 sc1
    v_mfma_f32_16x16x32_bf16 v[220:223], v[92:95], a[28:31], v[220:223]
    v_mfma_f32_16x16x32_bf16 v[188:191], v[92:95], a[24:27], v[188:191]
    ds_read_b64_tr_b16 v[68:69], v242 offset:24576
    ds_read_b64_tr_b16 v[70:71], v242 offset:28672
    v_mfma_f32_16x16x32_bf16 v[156:159], v[92:95], a[20:23], v[156:159]
    s_lshl_b32 s44, s50, 12
    buffer_load_dwordx4 a[80:83], v20, s[28:31], s44 offen offset:0 sc1
    v_mfma_f32_16x16x32_bf16 v[124:127], v[92:95], a[16:19], v[124:127]
    v_mfma_f32_16x16x32_bf16 v[128:131], v[96:99], a[16:19], v[128:131]
    s_add_u32 s50, s50, 1
    ds_read_b64_tr_b16 v[72:73], v243 offset:16384
    ds_read_b64_tr_b16 v[74:75], v243 offset:20480
    v_mfma_f32_16x16x32_bf16 v[160:163], v[96:99], a[20:23], v[160:163]
    s_and_b32 s50, s50, 15
    buffer_load_dwordx4 a[84:87], v20, s[28:31], s44 offen offset:1024 sc1
    v_mfma_f32_16x16x32_bf16 v[192:195], v[96:99], a[24:27], v[192:195]
    v_mfma_f32_16x16x32_bf16 v[224:227], v[96:99], a[28:31], v[224:227]
    ds_read_b64_tr_b16 v[76:77], v243 offset:24576
    ds_read_b64_tr_b16 v[78:79], v243 offset:28672
    v_mfma_f32_16x16x32_bf16 v[228:231], v[100:103], a[28:31], v[228:231]
    buffer_load_dwordx4 a[88:91], v20, s[28:31], s44 offen offset:2048 sc1
    v_mfma_f32_16x16x32_bf16 v[196:199], v[100:103], a[24:27], v[196:199]
    v_mfma_f32_16x16x32_bf16 v[164:167], v[100:103], a[20:23], v[164:167]
    v_mfma_f32_16x16x32_bf16 v[132:135], v[100:103], a[16:19], v[132:135]
    buffer_load_dwordx4 a[92:95], v20, s[28:31], s44 offen offset:3072 sc1
    v_mfma_f32_16x16x32_bf16 v[136:139], v[104:107], a[16:19], v[136:139]
    v_mfma_f32_16x16x32_bf16 v[168:171], v[104:107], a[20:23], v[168:171]
    s_add_u32 m0, s48, 106496
    v_mfma_f32_16x16x32_bf16 v[200:203], v[104:107], a[24:27], v[200:203]
    s_mul_i32 s43, s49, 262144
    buffer_load_dwordx4 v248, s[24:27], s43 offen  lds
    v_mfma_f32_16x16x32_bf16 v[232:235], v[104:107], a[28:31], v[232:235]
    v_mfma_f32_16x16x32_bf16 v[236:239], v[108:111], a[28:31], v[236:239]
    s_add_u32 s49, s49, 1
    v_mfma_f32_16x16x32_bf16 v[204:207], v[108:111], a[24:27], v[204:207]
    s_and_b32 s49, s49, 15
    buffer_load_dwordx4 v249, s[24:27], s43 offen offset:1024  lds
    v_mfma_f32_16x16x32_bf16 v[172:175], v[108:111], a[20:23], v[172:175]
    v_mfma_f32_16x16x32_bf16 v[140:143], v[108:111], a[16:19], v[140:143]
    s_waitcnt vmcnt(10) lgkmcnt(0)
    v_mfma_f32_16x16x32_bf16 v[112:115], v[48:51], a[32:35], v[112:115]
    ds_read_b64_tr_b16 v[80:81], v244 offset:16384
    v_mfma_f32_16x16x32_bf16 v[112:115], v[52:55], a[48:51], v[112:115]
    ds_read_b64_tr_b16 v[82:83], v244 offset:20480
    v_mfma_f32_16x16x32_bf16 v[144:147], v[52:55], a[52:55], v[144:147]
    s_lshl_b32 s44, s50, 12
    buffer_load_dwordx4 a[96:99], v20, s[28:31], s44 offen offset:0 sc1
    v_mfma_f32_16x16x32_bf16 v[144:147], v[48:51], a[36:39], v[144:147]
    v_mfma_f32_16x16x32_bf16 v[176:179], v[48:51], a[40:43], v[176:179]
    ds_read_b64_tr_b16 v[84:85], v244 offset:24576
    v_mfma_f32_16x16x32_bf16 v[176:179], v[52:55], a[56:59], v[176:179]
    ds_read_b64_tr_b16 v[86:87], v244 offset:28672
    v_mfma_f32_16x16x32_bf16 v[208:211], v[52:55], a[60:63], v[208:211]
    s_add_u32 s50, s50, 1
    ds_read_b64_tr_b16 v[88:89], v245 offset:16384
    v_mfma_f32_16x16x32_bf16 v[208:211], v[48:51], a[44:47], v[208:211]
    s_and_b32 s50, s50, 15
    buffer_load_dwordx4 a[100:103], v20, s[28:31], s44 offen offset:1024 sc1
    v_mfma_f32_16x16x32_bf16 v[212:215], v[56:59], a[44:47], v[212:215]
    v_mfma_f32_16x16x32_bf16 v[212:215], v[60:63], a[60:63], v[212:215]
    ds_read_b64_tr_b16 v[90:91], v245 offset:20480
    v_mfma_f32_16x16x32_bf16 v[180:183], v[60:63], a[56:59], v[180:183]
    ds_read_b64_tr_b16 v[92:93], v245 offset:24576
    v_mfma_f32_16x16x32_bf16 v[180:183], v[56:59], a[40:43], v[180:183]
    ds_read_b64_tr_b16 v[94:95], v245 offset:28672
    v_mfma_f32_16x16x32_bf16 v[148:151], v[56:59], a[36:39], v[148:151]
    buffer_load_dwordx4 a[104:107], v20, s[28:31], s44 offen offset:2048 sc1
    v_mfma_f32_16x16x32_bf16 v[148:151], v[60:63], a[52:55], v[148:151]
    v_mfma_f32_16x16x32_bf16 v[116:119], v[60:63], a[48:51], v[116:119]
    ds_read_b64_tr_b16 v[96:97], v246 offset:16384
    v_mfma_f32_16x16x32_bf16 v[116:119], v[56:59], a[32:35], v[116:119]
    ds_read_b64_tr_b16 v[98:99], v246 offset:20480
    v_mfma_f32_16x16x32_bf16 v[120:123], v[64:67], a[32:35], v[120:123]
    ds_read_b64_tr_b16 v[100:101], v246 offset:24576
    v_mfma_f32_16x16x32_bf16 v[120:123], v[68:71], a[48:51], v[120:123]
    buffer_load_dwordx4 a[108:111], v20, s[28:31], s44 offen offset:3072 sc1
    v_mfma_f32_16x16x32_bf16 v[152:155], v[68:71], a[52:55], v[152:155]
    v_mfma_f32_16x16x32_bf16 v[152:155], v[64:67], a[36:39], v[152:155]
    ds_read_b64_tr_b16 v[102:103], v246 offset:28672
    v_mfma_f32_16x16x32_bf16 v[184:187], v[64:67], a[40:43], v[184:187]
    ds_read_b64_tr_b16 v[104:105], v247 offset:16384
    v_mfma_f32_16x16x32_bf16 v[184:187], v[68:71], a[56:59], v[184:187]
    s_add_u32 m0, s48, 114688
    ds_read_b64_tr_b16 v[106:107], v247 offset:20480
    v_mfma_f32_16x16x32_bf16 v[216:219], v[68:71], a[60:63], v[216:219]
    s_mul_i32 s43, s49, 262144
    buffer_load_dwordx4 v248, s[24:27], s43 offen  lds
    v_mfma_f32_16x16x32_bf16 v[216:219], v[64:67], a[44:47], v[216:219]
    v_mfma_f32_16x16x32_bf16 v[220:223], v[72:75], a[44:47], v[220:223]
    ds_read_b64_tr_b16 v[108:109], v247 offset:24576
    v_mfma_f32_16x16x32_bf16 v[220:223], v[76:79], a[60:63], v[220:223]
    ds_read_b64_tr_b16 v[110:111], v247 offset:28672
    v_mfma_f32_16x16x32_bf16 v[188:191], v[76:79], a[56:59], v[188:191]
    s_add_u32 s49, s49, 1
    v_mfma_f32_16x16x32_bf16 v[188:191], v[72:75], a[40:43], v[188:191]
    s_and_b32 s49, s49, 15
    buffer_load_dwordx4 v249, s[24:27], s43 offen offset:1024  lds
    v_mfma_f32_16x16x32_bf16 v[156:159], v[72:75], a[36:39], v[156:159]
    v_mfma_f32_16x16x32_bf16 v[156:159], v[76:79], a[52:55], v[156:159]
    v_mfma_f32_16x16x32_bf16 v[124:127], v[76:79], a[48:51], v[124:127]
    v_mfma_f32_16x16x32_bf16 v[124:127], v[72:75], a[32:35], v[124:127]
    s_waitcnt vmcnt(16) lgkmcnt(0)
    v_mfma_f32_16x16x32_bf16 v[128:131], v[80:83], a[32:35], v[128:131]
    ds_read_b64_tr_b16 v[48:49], v240 offset:32768
    v_mfma_f32_16x16x32_bf16 v[128:131], v[84:87], a[48:51], v[128:131]
    ds_read_b64_tr_b16 v[50:51], v240 offset:36864
    v_mfma_f32_16x16x32_bf16 v[160:163], v[84:87], a[52:55], v[160:163]
    s_lshl_b32 s44, s50, 12
    buffer_load_dwordx4 a[112:115], v20, s[28:31], s44 offen offset:0 sc1
    v_mfma_f32_16x16x32_bf16 v[160:163], v[80:83], a[36:39], v[160:163]
    v_mfma_f32_16x16x32_bf16 v[192:195], v[80:83], a[40:43], v[192:195]
    ds_read_b64_tr_b16 v[52:53], v240 offset:40960
    v_mfma_f32_16x16x32_bf16 v[192:195], v[84:87], a[56:59], v[192:195]
    ds_read_b64_tr_b16 v[54:55], v240 offset:45056
    v_mfma_f32_16x16x32_bf16 v[224:227], v[84:87], a[60:63], v[224:227]
    s_add_u32 s50, s50, 1
    ds_read_b64_tr_b16 v[56:57], v241 offset:32768
    v_mfma_f32_16x16x32_bf16 v[224:227], v[80:83], a[44:47], v[224:227]
    s_and_b32 s50, s50, 15
    buffer_load_dwordx4 a[116:119], v20, s[28:31], s44 offen offset:1024 sc1
    v_mfma_f32_16x16x32_bf16 v[228:231], v[88:91], a[44:47], v[228:231]
    v_mfma_f32_16x16x32_bf16 v[228:231], v[92:95], a[60:63], v[228:231]
    ds_read_b64_tr_b16 v[58:59], v241 offset:36864
    v_mfma_f32_16x16x32_bf16 v[196:199], v[92:95], a[56:59], v[196:199]
    ds_read_b64_tr_b16 v[60:61], v241 offset:40960
    v_mfma_f32_16x16x32_bf16 v[196:199], v[88:91], a[40:43], v[196:199]
    ds_read_b64_tr_b16 v[62:63], v241 offset:45056
    v_mfma_f32_16x16x32_bf16 v[164:167], v[88:91], a[36:39], v[164:167]
    buffer_load_dwordx4 a[120:123], v20, s[28:31], s44 offen offset:2048 sc1
    v_mfma_f32_16x16x32_bf16 v[164:167], v[92:95], a[52:55], v[164:167]
    v_mfma_f32_16x16x32_bf16 v[132:135], v[92:95], a[48:51], v[132:135]
    ds_read_b64_tr_b16 v[64:65], v242 offset:32768
    v_mfma_f32_16x16x32_bf16 v[132:135], v[88:91], a[32:35], v[132:135]
    ds_read_b64_tr_b16 v[66:67], v242 offset:36864
    v_mfma_f32_16x16x32_bf16 v[136:139], v[96:99], a[32:35], v[136:139]
    ds_read_b64_tr_b16 v[68:69], v242 offset:40960
    v_mfma_f32_16x16x32_bf16 v[136:139], v[100:103], a[48:51], v[136:139]
    buffer_load_dwordx4 a[124:127], v20, s[28:31], s44 offen offset:3072 sc1
    v_mfma_f32_16x16x32_bf16 v[168:171], v[100:103], a[52:55], v[168:171]
    v_mfma_f32_16x16x32_bf16 v[168:171], v[96:99], a[36:39], v[168:171]
    ds_read_b64_tr_b16 v[70:71], v242 offset:45056
    v_mfma_f32_16x16x32_bf16 v[200:203], v[96:99], a[40:43], v[200:203]
    ds_read_b64_tr_b16 v[72:73], v243 offset:32768
    v_mfma_f32_16x16x32_bf16 v[200:203], v[100:103], a[56:59], v[200:203]
    s_add_u32 m0, s48, 122880
    ds_read_b64_tr_b16 v[74:75], v243 offset:36864
    v_mfma_f32_16x16x32_bf16 v[232:235], v[100:103], a[60:63], v[232:235]
    s_mul_i32 s43, s49, 262144
    buffer_load_dwordx4 v248, s[24:27], s43 offen  lds
    v_mfma_f32_16x16x32_bf16 v[232:235], v[96:99], a[44:47], v[232:235]
    v_mfma_f32_16x16x32_bf16 v[236:239], v[104:107], a[44:47], v[236:239]
    ds_read_b64_tr_b16 v[76:77], v243 offset:40960
    v_mfma_f32_16x16x32_bf16 v[236:239], v[108:111], a[60:63], v[236:239]
    ds_read_b64_tr_b16 v[78:79], v243 offset:45056
    v_mfma_f32_16x16x32_bf16 v[204:207], v[108:111], a[56:59], v[204:207]
    s_add_u32 s49, s49, 1
    v_mfma_f32_16x16x32_bf16 v[204:207], v[104:107], a[40:43], v[204:207]
    s_and_b32 s49, s49, 15
    buffer_load_dwordx4 v249, s[24:27], s43 offen offset:1024  lds
    v_mfma_f32_16x16x32_bf16 v[172:175], v[104:107], a[36:39], v[172:175]
    v_mfma_f32_16x16x32_bf16 v[172:175], v[108:111], a[52:55], v[172:175]
    v_mfma_f32_16x16x32_bf16 v[140:143], v[108:111], a[48:51], v[140:143]
    v_mfma_f32_16x16x32_bf16 v[140:143], v[104:107], a[32:35], v[140:143]
    s_waitcnt vmcnt(14) lgkmcnt(0)
    v_mfma_f32_16x16x32_bf16 v[112:115], v[48:51], a[64:67], v[112:115]
    ds_read_b64_tr_b16 v[80:81], v244 offset:32768
    v_mfma_f32_16x16x32_bf16 v[112:115], v[52:55], a[80:83], v[112:115]
    ds_read_b64_tr_b16 v[82:83], v244 offset:36864
    v_mfma_f32_16x16x32_bf16 v[144:147], v[52:55], a[84:87], v[144:147]
    s_lshl_b32 s44, s50, 12
    buffer_load_dwordx4 a[128:131], v20, s[28:31], s44 offen offset:0 sc1
    v_mfma_f32_16x16x32_bf16 v[144:147], v[48:51], a[68:71], v[144:147]
    v_mfma_f32_16x16x32_bf16 v[176:179], v[48:51], a[72:75], v[176:179]
    ds_read_b64_tr_b16 v[84:85], v244 offset:40960
    v_mfma_f32_16x16x32_bf16 v[176:179], v[52:55], a[88:91], v[176:179]
    ds_read_b64_tr_b16 v[86:87], v244 offset:45056
    v_mfma_f32_16x16x32_bf16 v[208:211], v[52:55], a[92:95], v[208:211]
    s_add_u32 s50, s50, 1
    ds_read_b64_tr_b16 v[88:89], v245 offset:32768
    v_mfma_f32_16x16x32_bf16 v[208:211], v[48:51], a[76:79], v[208:211]
    s_and_b32 s50, s50, 15
    buffer_load_dwordx4 a[132:135], v20, s[28:31], s44 offen offset:1024 sc1
    v_mfma_f32_16x16x32_bf16 v[212:215], v[56:59], a[76:79], v[212:215]
    v_mfma_f32_16x16x32_bf16 v[212:215], v[60:63], a[92:95], v[212:215]
    ds_read_b64_tr_b16 v[90:91], v245 offset:36864
    v_mfma_f32_16x16x32_bf16 v[180:183], v[60:63], a[88:91], v[180:183]
    ds_read_b64_tr_b16 v[92:93], v245 offset:40960
    v_mfma_f32_16x16x32_bf16 v[180:183], v[56:59], a[72:75], v[180:183]
    ds_read_b64_tr_b16 v[94:95], v245 offset:45056
    v_mfma_f32_16x16x32_bf16 v[148:151], v[56:59], a[68:71], v[148:151]
    buffer_load_dwordx4 a[136:139], v20, s[28:31], s44 offen offset:2048 sc1
    v_mfma_f32_16x16x32_bf16 v[148:151], v[60:63], a[84:87], v[148:151]
    v_mfma_f32_16x16x32_bf16 v[116:119], v[60:63], a[80:83], v[116:119]
    ds_read_b64_tr_b16 v[96:97], v246 offset:32768
    v_mfma_f32_16x16x32_bf16 v[116:119], v[56:59], a[64:67], v[116:119]
    ds_read_b64_tr_b16 v[98:99], v246 offset:36864
    v_mfma_f32_16x16x32_bf16 v[120:123], v[64:67], a[64:67], v[120:123]
    ds_read_b64_tr_b16 v[100:101], v246 offset:40960
    v_mfma_f32_16x16x32_bf16 v[120:123], v[68:71], a[80:83], v[120:123]
    buffer_load_dwordx4 a[140:143], v20, s[28:31], s44 offen offset:3072 sc1
    v_mfma_f32_16x16x32_bf16 v[152:155], v[68:71], a[84:87], v[152:155]
    v_mfma_f32_16x16x32_bf16 v[152:155], v[64:67], a[68:71], v[152:155]
    ds_read_b64_tr_b16 v[102:103], v246 offset:45056
    v_mfma_f32_16x16x32_bf16 v[184:187], v[64:67], a[72:75], v[184:187]
    ds_read_b64_tr_b16 v[104:105], v247 offset:32768
    v_mfma_f32_16x16x32_bf16 v[184:187], v[68:71], a[88:91], v[184:187]
    s_add_u32 m0, s48, 131072
    ds_read_b64_tr_b16 v[106:107], v247 offset:36864
    v_mfma_f32_16x16x32_bf16 v[216:219], v[68:71], a[92:95], v[216:219]
    s_mul_i32 s43, s49, 262144
    buffer_load_dwordx4 v248, s[24:27], s43 offen  lds
    v_mfma_f32_16x16x32_bf16 v[216:219], v[64:67], a[76:79], v[216:219]
    v_mfma_f32_16x16x32_bf16 v[220:223], v[72:75], a[76:79], v[220:223]
    ds_read_b64_tr_b16 v[108:109], v247 offset:40960
    v_mfma_f32_16x16x32_bf16 v[220:223], v[76:79], a[92:95], v[220:223]
    ds_read_b64_tr_b16 v[110:111], v247 offset:45056
    v_mfma_f32_16x16x32_bf16 v[188:191], v[76:79], a[88:91], v[188:191]
    s_add_u32 s49, s49, 1
    v_mfma_f32_16x16x32_bf16 v[188:191], v[72:75], a[72:75], v[188:191]
    s_and_b32 s49, s49, 15
    buffer_load_dwordx4 v249, s[24:27], s43 offen offset:1024  lds
    v_mfma_f32_16x16x32_bf16 v[156:159], v[72:75], a[68:71], v[156:159]
    v_mfma_f32_16x16x32_bf16 v[156:159], v[76:79], a[84:87], v[156:159]
    v_mfma_f32_16x16x32_bf16 v[124:127], v[76:79], a[80:83], v[124:127]
    v_mfma_f32_16x16x32_bf16 v[124:127], v[72:75], a[64:67], v[124:127]
    s_waitcnt vmcnt(20) lgkmcnt(0)
    v_mfma_f32_16x16x32_bf16 v[128:131], v[80:83], a[64:67], v[128:131]
    ds_read_b64_tr_b16 v[48:49], v240 offset:49152
    v_mfma_f32_16x16x32_bf16 v[128:131], v[84:87], a[80:83], v[128:131]
    ds_read_b64_tr_b16 v[50:51], v240 offset:53248
    v_mfma_f32_16x16x32_bf16 v[160:163], v[84:87], a[84:87], v[160:163]
    s_lshl_b32 s44, s50, 12
    buffer_load_dwordx4 a[144:147], v20, s[28:31], s44 offen offset:0 sc1
    v_mfma_f32_16x16x32_bf16 v[160:163], v[80:83], a[68:71], v[160:163]
    v_mfma_f32_16x16x32_bf16 v[192:195], v[80:83], a[72:75], v[192:195]
    ds_read_b64_tr_b16 v[52:53], v240 offset:57344
    v_mfma_f32_16x16x32_bf16 v[192:195], v[84:87], a[88:91], v[192:195]
    ds_read_b64_tr_b16 v[54:55], v240 offset:61440
    v_mfma_f32_16x16x32_bf16 v[224:227], v[84:87], a[92:95], v[224:227]
    s_add_u32 s50, s50, 1
    ds_read_b64_tr_b16 v[56:57], v241 offset:49152
    v_mfma_f32_16x16x32_bf16 v[224:227], v[80:83], a[76:79], v[224:227]
    s_and_b32 s50, s50, 15
    buffer_load_dwordx4 a[148:151], v20, s[28:31], s44 offen offset:1024 sc1
    v_mfma_f32_16x16x32_bf16 v[228:231], v[88:91], a[76:79], v[228:231]
    v_mfma_f32_16x16x32_bf16 v[228:231], v[92:95], a[92:95], v[228:231]
    ds_read_b64_tr_b16 v[58:59], v241 offset:53248
    v_mfma_f32_16x16x32_bf16 v[196:199], v[92:95], a[88:91], v[196:199]
    ds_read_b64_tr_b16 v[60:61], v241 offset:57344
    v_mfma_f32_16x16x32_bf16 v[196:199], v[88:91], a[72:75], v[196:199]
    ds_read_b64_tr_b16 v[62:63], v241 offset:61440
    v_mfma_f32_16x16x32_bf16 v[164:167], v[88:91], a[68:71], v[164:167]
    buffer_load_dwordx4 a[152:155], v20, s[28:31], s44 offen offset:2048 sc1
    v_mfma_f32_16x16x32_bf16 v[164:167], v[92:95], a[84:87], v[164:167]
    v_mfma_f32_16x16x32_bf16 v[132:135], v[92:95], a[80:83], v[132:135]
    ds_read_b64_tr_b16 v[64:65], v242 offset:49152
    v_mfma_f32_16x16x32_bf16 v[132:135], v[88:91], a[64:67], v[132:135]
    ds_read_b64_tr_b16 v[66:67], v242 offset:53248
    v_mfma_f32_16x16x32_bf16 v[136:139], v[96:99], a[64:67], v[136:139]
    ds_read_b64_tr_b16 v[68:69], v242 offset:57344
    v_mfma_f32_16x16x32_bf16 v[136:139], v[100:103], a[80:83], v[136:139]
    buffer_load_dwordx4 a[156:159], v20, s[28:31], s44 offen offset:3072 sc1
    v_mfma_f32_16x16x32_bf16 v[168:171], v[100:103], a[84:87], v[168:171]
    v_mfma_f32_16x16x32_bf16 v[168:171], v[96:99], a[68:71], v[168:171]
    ds_read_b64_tr_b16 v[70:71], v242 offset:61440
    v_mfma_f32_16x16x32_bf16 v[200:203], v[96:99], a[72:75], v[200:203]
    ds_read_b64_tr_b16 v[72:73], v243 offset:49152
    v_mfma_f32_16x16x32_bf16 v[200:203], v[100:103], a[88:91], v[200:203]
    s_add_u32 m0, s48, 139264
    ds_read_b64_tr_b16 v[74:75], v243 offset:53248
    v_mfma_f32_16x16x32_bf16 v[232:235], v[100:103], a[92:95], v[232:235]
    s_mul_i32 s43, s49, 262144
    buffer_load_dwordx4 v248, s[24:27], s43 offen  lds
    v_mfma_f32_16x16x32_bf16 v[232:235], v[96:99], a[76:79], v[232:235]
    v_mfma_f32_16x16x32_bf16 v[236:239], v[104:107], a[76:79], v[236:239]
    ds_read_b64_tr_b16 v[76:77], v243 offset:57344
    v_mfma_f32_16x16x32_bf16 v[236:239], v[108:111], a[92:95], v[236:239]
    ds_read_b64_tr_b16 v[78:79], v243 offset:61440
    v_mfma_f32_16x16x32_bf16 v[204:207], v[108:111], a[88:91], v[204:207]
    s_add_u32 s49, s49, 1
    v_mfma_f32_16x16x32_bf16 v[204:207], v[104:107], a[72:75], v[204:207]
    s_and_b32 s49, s49, 15
    buffer_load_dwordx4 v249, s[24:27], s43 offen offset:1024  lds
    v_mfma_f32_16x16x32_bf16 v[172:175], v[104:107], a[68:71], v[172:175]
    v_mfma_f32_16x16x32_bf16 v[172:175], v[108:111], a[84:87], v[172:175]
    v_mfma_f32_16x16x32_bf16 v[140:143], v[108:111], a[80:83], v[140:143]
    v_mfma_f32_16x16x32_bf16 v[140:143], v[104:107], a[64:67], v[140:143]
    s_waitcnt vmcnt(14) lgkmcnt(0)
    v_mfma_f32_16x16x32_bf16 v[112:115], v[48:51], a[96:99], v[112:115]
    ds_read_b64_tr_b16 v[80:81], v244 offset:49152
    v_mfma_f32_16x16x32_bf16 v[112:115], v[52:55], a[112:115], v[112:115]
    ds_read_b64_tr_b16 v[82:83], v244 offset:53248
    v_mfma_f32_16x16x32_bf16 v[144:147], v[52:55], a[116:119], v[144:147]
    s_lshl_b32 s44, s50, 12
    buffer_load_dwordx4 a[160:163], v20, s[28:31], s44 offen offset:0 sc1
    v_mfma_f32_16x16x32_bf16 v[144:147], v[48:51], a[100:103], v[144:147]
    v_mfma_f32_16x16x32_bf16 v[176:179], v[48:51], a[104:107], v[176:179]
    ds_read_b64_tr_b16 v[84:85], v244 offset:57344
    v_mfma_f32_16x16x32_bf16 v[176:179], v[52:55], a[120:123], v[176:179]
    ds_read_b64_tr_b16 v[86:87], v244 offset:61440
    v_mfma_f32_16x16x32_bf16 v[208:211], v[52:55], a[124:127], v[208:211]
    s_add_u32 s50, s50, 1
    ds_read_b64_tr_b16 v[88:89], v245 offset:49152
    v_mfma_f32_16x16x32_bf16 v[208:211], v[48:51], a[108:111], v[208:211]
    s_and_b32 s50, s50, 15
    buffer_load_dwordx4 a[164:167], v20, s[28:31], s44 offen offset:1024 sc1
    v_mfma_f32_16x16x32_bf16 v[212:215], v[56:59], a[108:111], v[212:215]
    v_mfma_f32_16x16x32_bf16 v[212:215], v[60:63], a[124:127], v[212:215]
    ds_read_b64_tr_b16 v[90:91], v245 offset:53248
    v_mfma_f32_16x16x32_bf16 v[180:183], v[60:63], a[120:123], v[180:183]
    ds_read_b64_tr_b16 v[92:93], v245 offset:57344
    v_mfma_f32_16x16x32_bf16 v[180:183], v[56:59], a[104:107], v[180:183]
    ds_read_b64_tr_b16 v[94:95], v245 offset:61440
    v_mfma_f32_16x16x32_bf16 v[148:151], v[56:59], a[100:103], v[148:151]
    buffer_load_dwordx4 a[168:171], v20, s[28:31], s44 offen offset:2048 sc1
    v_mfma_f32_16x16x32_bf16 v[148:151], v[60:63], a[116:119], v[148:151]
    v_mfma_f32_16x16x32_bf16 v[116:119], v[60:63], a[112:115], v[116:119]
    ds_read_b64_tr_b16 v[96:97], v246 offset:49152
    v_mfma_f32_16x16x32_bf16 v[116:119], v[56:59], a[96:99], v[116:119]
    ds_read_b64_tr_b16 v[98:99], v246 offset:53248
    v_mfma_f32_16x16x32_bf16 v[120:123], v[64:67], a[96:99], v[120:123]
    ds_read_b64_tr_b16 v[100:101], v246 offset:57344
    v_mfma_f32_16x16x32_bf16 v[120:123], v[68:71], a[112:115], v[120:123]
    buffer_load_dwordx4 a[172:175], v20, s[28:31], s44 offen offset:3072 sc1
    v_mfma_f32_16x16x32_bf16 v[152:155], v[68:71], a[116:119], v[152:155]
    v_mfma_f32_16x16x32_bf16 v[152:155], v[64:67], a[100:103], v[152:155]
    ds_read_b64_tr_b16 v[102:103], v246 offset:61440
    v_mfma_f32_16x16x32_bf16 v[184:187], v[64:67], a[104:107], v[184:187]
    ds_read_b64_tr_b16 v[104:105], v247 offset:49152
    v_mfma_f32_16x16x32_bf16 v[184:187], v[68:71], a[120:123], v[184:187]
    s_add_u32 m0, s48, 147456
    ds_read_b64_tr_b16 v[106:107], v247 offset:53248
    v_mfma_f32_16x16x32_bf16 v[216:219], v[68:71], a[124:127], v[216:219]
    s_mul_i32 s43, s49, 262144
    buffer_load_dwordx4 v248, s[24:27], s43 offen  lds
    v_mfma_f32_16x16x32_bf16 v[216:219], v[64:67], a[108:111], v[216:219]
    v_mfma_f32_16x16x32_bf16 v[220:223], v[72:75], a[108:111], v[220:223]
    ds_read_b64_tr_b16 v[108:109], v247 offset:57344
    v_mfma_f32_16x16x32_bf16 v[220:223], v[76:79], a[124:127], v[220:223]
    ds_read_b64_tr_b16 v[110:111], v247 offset:61440
    v_mfma_f32_16x16x32_bf16 v[188:191], v[76:79], a[120:123], v[188:191]
    s_add_u32 s49, s49, 1
    v_mfma_f32_16x16x32_bf16 v[188:191], v[72:75], a[104:107], v[188:191]
    s_and_b32 s49, s49, 15
    buffer_load_dwordx4 v249, s[24:27], s43 offen offset:1024  lds
    v_mfma_f32_16x16x32_bf16 v[156:159], v[72:75], a[100:103], v[156:159]
    v_mfma_f32_16x16x32_bf16 v[156:159], v[76:79], a[116:119], v[156:159]
    v_mfma_f32_16x16x32_bf16 v[124:127], v[76:79], a[112:115], v[124:127]
    v_mfma_f32_16x16x32_bf16 v[124:127], v[72:75], a[96:99], v[124:127]
    s_waitcnt vmcnt(20) lgkmcnt(0)
    s_barrier
    v_add_u32 v240, 65536, v240
    v_add_u32 v241, 65536, v241
    v_add_u32 v242, 65536, v242
    v_add_u32 v243, 65536, v243
    v_add_u32 v244, 65536, v244
    v_add_u32 v245, 65536, v245
    v_add_u32 v246, 65536, v246
    v_add_u32 v247, 65536, v247
    v_mfma_f32_16x16x32_bf16 v[128:131], v[80:83], a[96:99], v[128:131]
    ds_read_b64_tr_b16 v[48:49], v240 offset:0
    v_mfma_f32_16x16x32_bf16 v[128:131], v[84:87], a[112:115], v[128:131]
    ds_read_b64_tr_b16 v[50:51], v240 offset:4096
    v_mfma_f32_16x16x32_bf16 v[160:163], v[84:87], a[116:119], v[160:163]
    s_lshl_b32 s44, s50, 12
    buffer_load_dwordx4 a[176:179], v20, s[28:31], s44 offen offset:0 sc1
    v_mfma_f32_16x16x32_bf16 v[160:163], v[80:83], a[100:103], v[160:163]
    v_mfma_f32_16x16x32_bf16 v[192:195], v[80:83], a[104:107], v[192:195]
    ds_read_b64_tr_b16 v[52:53], v240 offset:8192
    v_mfma_f32_16x16x32_bf16 v[192:195], v[84:87], a[120:123], v[192:195]
    ds_read_b64_tr_b16 v[54:55], v240 offset:12288
    v_mfma_f32_16x16x32_bf16 v[224:227], v[84:87], a[124:127], v[224:227]
    s_add_u32 s50, s50, 1
    ds_read_b64_tr_b16 v[56:57], v241 offset:0
    v_mfma_f32_16x16x32_bf16 v[224:227], v[80:83], a[108:111], v[224:227]
    s_and_b32 s50, s50, 15
    buffer_load_dwordx4 a[180:183], v20, s[28:31], s44 offen offset:1024 sc1
    v_mfma_f32_16x16x32_bf16 v[228:231], v[88:91], a[108:111], v[228:231]
    v_mfma_f32_16x16x32_bf16 v[228:231], v[92:95], a[124:127], v[228:231]
    ds_read_b64_tr_b16 v[58:59], v241 offset:4096
    v_mfma_f32_16x16x32_bf16 v[196:199], v[92:95], a[120:123], v[196:199]
    ds_read_b64_tr_b16 v[60:61], v241 offset:8192
    v_mfma_f32_16x16x32_bf16 v[196:199], v[88:91], a[104:107], v[196:199]
    ds_read_b64_tr_b16 v[62:63], v241 offset:12288
    v_mfma_f32_16x16x32_bf16 v[164:167], v[88:91], a[100:103], v[164:167]
    buffer_load_dwordx4 a[184:187], v20, s[28:31], s44 offen offset:2048 sc1
    v_mfma_f32_16x16x32_bf16 v[164:167], v[92:95], a[116:119], v[164:167]
    v_mfma_f32_16x16x32_bf16 v[132:135], v[92:95], a[112:115], v[132:135]
    ds_read_b64_tr_b16 v[64:65], v242 offset:0
    v_mfma_f32_16x16x32_bf16 v[132:135], v[88:91], a[96:99], v[132:135]
    ds_read_b64_tr_b16 v[66:67], v242 offset:4096
    v_mfma_f32_16x16x32_bf16 v[136:139], v[96:99], a[96:99], v[136:139]
    ds_read_b64_tr_b16 v[68:69], v242 offset:8192
    v_mfma_f32_16x16x32_bf16 v[136:139], v[100:103], a[112:115], v[136:139]
    buffer_load_dwordx4 a[188:191], v20, s[28:31], s44 offen offset:3072 sc1
    v_mfma_f32_16x16x32_bf16 v[168:171], v[100:103], a[116:119], v[168:171]
    s_branch L_over1
.p2align 12
L_stub1:
    s_setpc_b64 s[46:47]
L_over1:
    v_mfma_f32_16x16x32_bf16 v[168:171], v[96:99], a[100:103], v[168:171]
    ds_read_b64_tr_b16 v[70:71], v242 offset:12288
    v_mfma_f32_16x16x32_bf16 v[200:203], v[96:99], a[104:107], v[200:203]
    ds_read_b64_tr_b16 v[72:73], v243 offset:0
    v_mfma_f32_16x16x32_bf16 v[200:203], v[100:103], a[120:123], v[200:203]
    s_add_u32 m0, s48, 155648
    ds_read_b64_tr_b16 v[74:75], v243 offset:4096
    v_mfma_f32_16x16x32_bf16 v[232:235], v[100:103], a[124:127], v[232:235]
    s_mul_i32 s43, s49, 262144
    buffer_load_dwordx4 v248, s[24:27], s43 offen  lds
    v_mfma_f32_16x16x32_bf16 v[232:235], v[96:99], a[108:111], v[232:235]
    v_mfma_f32_16x16x32_bf16 v[236:239], v[104:107], a[108:111], v[236:239]
    ds_read_b64_tr_b16 v[76:77], v243 offset:8192
    v_mfma_f32_16x16x32_bf16 v[236:239], v[108:111], a[124:127], v[236:239]
    ds_read_b64_tr_b16 v[78:79], v243 offset:12288
    v_mfma_f32_16x16x32_bf16 v[204:207], v[108:111], a[120:123], v[204:207]
    s_add_u32 s49, s49, 1
    v_mfma_f32_16x16x32_bf16 v[204:207], v[104:107], a[104:107], v[204:207]
    s_and_b32 s49, s49, 15
    buffer_load_dwordx4 v249, s[24:27], s43 offen offset:1024  lds
    v_mfma_f32_16x16x32_bf16 v[172:175], v[104:107], a[100:103], v[172:175]
    v_mfma_f32_16x16x32_bf16 v[172:175], v[108:111], a[116:119], v[172:175]
    v_mfma_f32_16x16x32_bf16 v[140:143], v[108:111], a[112:115], v[140:143]
    v_mfma_f32_16x16x32_bf16 v[140:143], v[104:107], a[96:99], v[140:143]
    s_waitcnt vmcnt(14) lgkmcnt(0)
    v_mfma_f32_16x16x32_bf16 v[112:115], v[48:51], a[128:131], v[112:115]
    ds_read_b64_tr_b16 v[80:81], v244 offset:0
    v_mfma_f32_16x16x32_bf16 v[112:115], v[52:55], a[144:147], v[112:115]
    ds_read_b64_tr_b16 v[82:83], v244 offset:4096
    v_mfma_f32_16x16x32_bf16 v[144:147], v[52:55], a[148:151], v[144:147]
    s_lshl_b32 s44, s50, 12
    buffer_load_dwordx4 a[192:195], v20, s[28:31], s44 offen offset:0 sc1
    v_mfma_f32_16x16x32_bf16 v[144:147], v[48:51], a[132:135], v[144:147]
    v_mfma_f32_16x16x32_bf16 v[176:179], v[48:51], a[136:139], v[176:179]
    ds_read_b64_tr_b16 v[84:85], v244 offset:8192
    v_mfma_f32_16x16x32_bf16 v[176:179], v[52:55], a[152:155], v[176:179]
    ds_read_b64_tr_b16 v[86:87], v244 offset:12288
    v_mfma_f32_16x16x32_bf16 v[208:211], v[52:55], a[156:159], v[208:211]
    ds_read_b64_tr_b16 v[88:89], v245 offset:0
    v_mfma_f32_16x16x32_bf16 v[208:211], v[48:51], a[140:143], v[208:211]
    ds_read_b64_tr_b16 v[90:91], v245 offset:4096
    v_mfma_f32_16x16x32_bf16 v[212:215], v[56:59], a[140:143], v[212:215]
    s_add_u32 s50, s50, 1
    ds_read_b64_tr_b16 v[92:93], v245 offset:8192
    v_mfma_f32_16x16x32_bf16 v[212:215], v[60:63], a[156:159], v[212:215]
    s_and_b32 s50, s50, 15
    buffer_load_dwordx4 a[196:199], v20, s[28:31], s44 offen offset:1024 sc1
    v_mfma_f32_16x16x32_bf16 v[180:183], v[60:63], a[152:155], v[180:183]
    v_mfma_f32_16x16x32_bf16 v[180:183], v[56:59], a[136:139], v[180:183]
    ds_read_b64_tr_b16 v[94:95], v245 offset:12288
    v_mfma_f32_16x16x32_bf16 v[148:151], v[56:59], a[132:135], v[148:151]
    ds_read_b64_tr_b16 v[96:97], v246 offset:0
    v_mfma_f32_16x16x32_bf16 v[148:151], v[60:63], a[148:151], v[148:151]
    ds_read_b64_tr_b16 v[98:99], v246 offset:4096
    v_mfma_f32_16x16x32_bf16 v[116:119], v[60:63], a[144:147], v[116:119]
    ds_read_b64_tr_b16 v[100:101], v246 offset:8192
    v_mfma_f32_16x16x32_bf16 v[116:119], v[56:59], a[128:131], v[116:119]
    ds_read_b64_tr_b16 v[102:103], v246 offset:12288
    v_mfma_f32_16x16x32_bf16 v[120:123], v[64:67], a[128:131], v[120:123]
    ds_read_b64_tr_b16 v[104:105], v247 offset:0
    v_mfma_f32_16x16x32_bf16 v[120:123], v[68:71], a[144:147], v[120:123]
    buffer_load_dwordx4 a[200:203], v20, s[28:31], s44 offen offset:2048 sc1
    v_mfma_f32_16x16x32_bf16 v[152:155], v[68:71], a[148:151], v[152:155]
    v_mfma_f32_16x16x32_bf16 v[152:155], v[64:67], a[132:135], v[152:155]
    ds_read_b64_tr_b16 v[106:107], v247 offset:4096
    v_mfma_f32_16x16x32_bf16 v[184:187], v[64:67], a[136:139], v[184:187]
    ds_read_b64_tr_b16 v[108:109], v247 offset:8192
    v_mfma_f32_16x16x32_bf16 v[184:187], v[68:71], a[152:155], v[184:187]
    ds_read_b64_tr_b16 v[110:111], v247 offset:12288
    v_mfma_f32_16x16x32_bf16 v[216:219], v[68:71], a[156:159], v[216:219]
    v_mfma_f32_16x16x32_bf16 v[216:219], v[64:67], a[140:143], v[216:219]
    v_mfma_f32_16x16x32_bf16 v[220:223], v[72:75], a[140:143], v[220:223]
    buffer_load_dwordx4 a[204:207], v20, s[28:31], s44 offen offset:3072 sc1
    v_mfma_f32_16x16x32_bf16 v[220:223], v[76:79], a[156:159], v[220:223]
    v_mfma_f32_16x16x32_bf16 v[188:191], v[76:79], a[152:155], v[188:191]
    v_mfma_f32_16x16x32_bf16 v[188:191], v[72:75], a[136:139], v[188:191]
    v_mfma_f32_16x16x32_bf16 v[156:159], v[72:75], a[132:135], v[156:159]
    v_mfma_f32_16x16x32_bf16 v[156:159], v[76:79], a[148:151], v[156:159]
    v_mfma_f32_16x16x32_bf16 v[124:127], v[76:79], a[144:147], v[124:127]
    v_mfma_f32_16x16x32_bf16 v[124:127], v[72:75], a[128:131], v[124:127]
    s_waitcnt vmcnt(18) lgkmcnt(0)
    s_barrier
    v_mfma_f32_16x16x32_bf16 v[128:131], v[80:83], a[128:131], v[128:131]
    ds_read_b64_tr_b16 v[48:49], v240 offset:16384
    ds_read_b64_tr_b16 v[50:51], v240 offset:20480
    v_mfma_f32_16x16x32_bf16 v[128:131], v[84:87], a[144:147], v[128:131]
    ds_read_b64_tr_b16 v[52:53], v240 offset:24576
    ds_read_b64_tr_b16 v[54:55], v240 offset:28672
    v_mfma_f32_16x16x32_bf16 v[160:163], v[84:87], a[148:151], v[160:163]
    s_lshl_b32 s44, s50, 12
    buffer_load_dwordx4 a[208:211], v20, s[28:31], s44 offen offset:0 sc1
    v_mfma_f32_16x16x32_bf16 v[160:163], v[80:83], a[132:135], v[160:163]
    v_mfma_f32_16x16x32_bf16 v[192:195], v[80:83], a[136:139], v[192:195]
    s_add_u32 s50, s50, 1
    ds_read_b64_tr_b16 v[56:57], v241 offset:16384
    ds_read_b64_tr_b16 v[58:59], v241 offset:20480
    v_mfma_f32_16x16x32_bf16 v[192:195], v[84:87], a[152:155], v[192:195]
    s_and_b32 s50, s50, 15
    buffer_load_dwordx4 a[212:215], v20, s[28:31], s44 offen offset:1024 sc1
    v_mfma_f32_16x16x32_bf16 v[224:227], v[84:87], a[156:159], v[224:227]
    v_mfma_f32_16x16x32_bf16 v[224:227], v[80:83], a[140:143], v[224:227]
    ds_read_b64_tr_b16 v[60:61], v241 offset:24576
    ds_read_b64_tr_b16 v[62:63], v241 offset:28672
    v_mfma_f32_16x16x32_bf16 v[228:231], v[88:91], a[140:143], v[228:231]
    ds_read_b64_tr_b16 v[64:65], v242 offset:16384
    ds_read_b64_tr_b16 v[66:67], v242 offset:20480
    v_mfma_f32_16x16x32_bf16 v[228:231], v[92:95], a[156:159], v[228:231]
    buffer_load_dwordx4 a[216:219], v20, s[28:31], s44 offen offset:2048 sc1
    v_mfma_f32_16x16x32_bf16 v[196:199], v[92:95], a[152:155], v[196:199]
    v_mfma_f32_16x16x32_bf16 v[196:199], v[88:91], a[136:139], v[196:199]
    ds_read_b64_tr_b16 v[68:69], v242 offset:24576
    ds_read_b64_tr_b16 v[70:71], v242 offset:28672
    v_mfma_f32_16x16x32_bf16 v[164:167], v[88:91], a[132:135], v[164:167]
    ds_read_b64_tr_b16 v[72:73], v243 offset:16384
    ds_read_b64_tr_b16 v[74:75], v243 offset:20480
    v_mfma_f32_16x16x32_bf16 v[164:167], v[92:95], a[148:151], v[164:167]
    buffer_load_dwordx4 a[220:223], v20, s[28:31], s44 offen offset:3072 sc1
    v_mfma_f32_16x16x32_bf16 v[132:135], v[92:95], a[144:147], v[132:135]
    v_mfma_f32_16x16x32_bf16 v[132:135], v[88:91], a[128:131], v[132:135]
    ds_read_b64_tr_b16 v[76:77], v243 offset:24576
    ds_read_b64_tr_b16 v[78:79], v243 offset:28672
    v_mfma_f32_16x16x32_bf16 v[136:139], v[96:99], a[128:131], v[136:139]
    v_mfma_f32_16x16x32_bf16 v[136:139], v[100:103], a[144:147], v[136:139]
    s_lshl_b32 s44, s50, 12
    buffer_load_dwordx4 a[224:227], v20, s[28:31], s44 offen offset:0 sc1
    v_mfma_f32_16x16x32_bf16 v[168:171], v[100:103], a[148:151], v[168:171]
    v_mfma_f32_16x16x32_bf16 v[168:171], v[96:99], a[132:135], v[168:171]
    s_add_u32 s50, s50, 1
    v_mfma_f32_16x16x32_bf16 v[200:203], v[96:99], a[136:139], v[200:203]
    s_and_b32 s50, s50, 15
    buffer_load_dwordx4 a[228:231], v20, s[28:31], s44 offen offset:1024 sc1
    v_mfma_f32_16x16x32_bf16 v[200:203], v[100:103], a[152:155], v[200:203]
    v_mfma_f32_16x16x32_bf16 v[232:235], v[100:103], a[156:159], v[232:235]
    v_mfma_f32_16x16x32_bf16 v[232:235], v[96:99], a[140:143], v[232:235]
    v_mfma_f32_16x16x32_bf16 v[236:239], v[104:107], a[140:143], v[236:239]
    buffer_load_dwordx4 a[232:235], v20, s[28:31], s44 offen offset:2048 sc1
    v_mfma_f32_16x16x32_bf16 v[236:239], v[108:111], a[156:159], v[236:239]
    v_mfma_f32_16x16x32_bf16 v[204:207], v[108:111], a[152:155], v[204:207]
    v_mfma_f32_16x16x32_bf16 v[204:207], v[104:107], a[136:139], v[204:207]
    v_mfma_f32_16x16x32_bf16 v[172:175], v[104:107], a[132:135], v[172:175]
    buffer_load_dwordx4 a[236:239], v20, s[28:31], s44 offen offset:3072 sc1
    v_mfma_f32_16x16x32_bf16 v[172:175], v[108:111], a[148:151], v[172:175]
    v_mfma_f32_16x16x32_bf16 v[140:143], v[108:111], a[144:147], v[140:143]
    v_mfma_f32_16x16x32_bf16 v[140:143], v[104:107], a[128:131], v[140:143]
    s_waitcnt vmcnt(14) lgkmcnt(0)
    v_mfma_f32_16x16x32_bf16 v[112:115], v[48:51], a[160:163], v[112:115]
    ds_read_b64_tr_b16 v[80:81], v244 offset:16384
    v_mfma_f32_16x16x32_bf16 v[112:115], v[52:55], a[176:179], v[112:115]
    ds_read_b64_tr_b16 v[82:83], v244 offset:20480
    v_mfma_f32_16x16x32_bf16 v[144:147], v[52:55], a[180:183], v[144:147]
    s_lshl_b32 s44, s50, 12
    buffer_load_dwordx4 a[240:243], v20, s[28:31], s44 offen offset:0 sc1
    v_mfma_f32_16x16x32_bf16 v[144:147], v[48:51], a[164:167], v[144:147]
    v_mfma_f32_16x16x32_bf16 v[176:179], v[48:51], a[168:171], v[176:179]
    ds_read_b64_tr_b16 v[84:85], v244 offset:24576
    v_mfma_f32_16x16x32_bf16 v[176:179], v[52:55], a[184:187], v[176:179]
    ds_read_b64_tr_b16 v[86:87], v244 offset:28672
    v_mfma_f32_16x16x32_bf16 v[208:211], v[52:55], a[188:191], v[208:211]
    ds_read_b64_tr_b16 v[88:89], v245 offset:16384
    v_mfma_f32_16x16x32_bf16 v[208:211], v[48:51], a[172:175], v[208:211]
    s_add_u32 s50, s50, 1
    ds_read_b64_tr_b16 v[90:91], v245 offset:20480
    v_mfma_f32_16x16x32_bf16 v[212:215], v[56:59], a[172:175], v[212:215]
    s_and_b32 s50, s50, 15
    buffer_load_dwordx4 a[244:247], v20, s[28:31], s44 offen offset:1024 sc1
    v_mfma_f32_16x16x32_bf16 v[212:215], v[60:63], a[188:191], v[212:215]
    v_mfma_f32_16x16x32_bf16 v[180:183], v[60:63], a[184:187], v[180:183]
    ds_read_b64_tr_b16 v[92:93], v245 offset:24576
    v_mfma_f32_16x16x32_bf16 v[180:183], v[56:59], a[168:171], v[180:183]
    ds_read_b64_tr_b16 v[94:95], v245 offset:28672
    v_mfma_f32_16x16x32_bf16 v[148:151], v[56:59], a[164:167], v[148:151]
    ds_read_b64_tr_b16 v[96:97], v246 offset:16384
    v_mfma_f32_16x16x32_bf16 v[148:151], v[60:63], a[180:183], v[148:151]
    ds_read_b64_tr_b16 v[98:99], v246 offset:20480
    v_mfma_f32_16x16x32_bf16 v[116:119], v[60:63], a[176:179], v[116:119]
    buffer_load_dwordx4 a[248:251], v20, s[28:31], s44 offen offset:2048 sc1
    v_mfma_f32_16x16x32_bf16 v[116:119], v[56:59], a[160:163], v[116:119]
    v_mfma_f32_16x16x32_bf16 v[120:123], v[64:67], a[160:163], v[120:123]
    ds_read_b64_tr_b16 v[100:101], v246 offset:24576
    v_mfma_f32_16x16x32_bf16 v[120:123], v[68:71], a[176:179], v[120:123]
    ds_read_b64_tr_b16 v[102:103], v246 offset:28672
    v_mfma_f32_16x16x32_bf16 v[152:155], v[68:71], a[180:183], v[152:155]
    ds_read_b64_tr_b16 v[104:105], v247 offset:16384
    v_mfma_f32_16x16x32_bf16 v[152:155], v[64:67], a[164:167], v[152:155]
    ds_read_b64_tr_b16 v[106:107], v247 offset:20480
    v_mfma_f32_16x16x32_bf16 v[184:187], v[64:67], a[168:171], v[184:187]
    buffer_load_dwordx4 a[252:255], v20, s[28:31], s44 offen offset:3072 sc1
    v_mfma_f32_16x16x32_bf16 v[184:187], v[68:71], a[184:187], v[184:187]
    v_mfma_f32_16x16x32_bf16 v[216:219], v[68:71], a[188:191], v[216:219]
    ds_read_b64_tr_b16 v[108:109], v247 offset:24576
    v_mfma_f32_16x16x32_bf16 v[216:219], v[64:67], a[172:175], v[216:219]
    ds_read_b64_tr_b16 v[110:111], v247 offset:28672
    v_mfma_f32_16x16x32_bf16 v[220:223], v[72:75], a[172:175], v[220:223]
    v_mfma_f32_16x16x32_bf16 v[220:223], v[76:79], a[188:191], v[220:223]
    v_mfma_f32_16x16x32_bf16 v[188:191], v[76:79], a[184:187], v[188:191]
    buffer_load_dword v47, off, s[52:55], s91 sc1
    v_mfma_f32_16x16x32_bf16 v[188:191], v[72:75], a[168:171], v[188:191]
    v_mfma_f32_16x16x32_bf16 v[156:159], v[72:75], a[164:167], v[156:159]
    v_mfma_f32_16x16x32_bf16 v[156:159], v[76:79], a[180:183], v[156:159]
    v_mfma_f32_16x16x32_bf16 v[124:127], v[76:79], a[176:179], v[124:127]
    v_mfma_f32_16x16x32_bf16 v[124:127], v[72:75], a[160:163], v[124:127]
    s_waitcnt vmcnt(17) lgkmcnt(0)
    s_barrier
    v_mfma_f32_16x16x32_bf16 v[128:131], v[80:83], a[160:163], v[128:131]
    ds_read_b64_tr_b16 a[0:1], v240 offset:32768
    v_mfma_f32_16x16x32_bf16 v[128:131], v[84:87], a[176:179], v[128:131]
    s_add_u32 m0, s37, 0
    ds_read_b64_tr_b16 a[2:3], v240 offset:36864
    v_mfma_f32_16x16x32_bf16 v[160:163], v[84:87], a[180:183], v[160:163]
    s_mov_b32 s36, 0
    buffer_load_dwordx4 v16, s[16:19], s36 offen offset:0 nt lds
    v_mfma_f32_16x16x32_bf16 v[160:163], v[80:83], a[164:167], v[160:163]
    v_mfma_f32_16x16x32_bf16 v[192:195], v[80:83], a[168:171], v[192:195]
    ds_read_b64_tr_b16 a[4:5], v240 offset:40960
    v_mfma_f32_16x16x32_bf16 v[192:195], v[84:87], a[184:187], v[192:195]
    ds_read_b64_tr_b16 a[6:7], v240 offset:45056
    v_mfma_f32_16x16x32_bf16 v[224:227], v[84:87], a[188:191], v[224:227]
    ds_read_b64_tr_b16 a[8:9], v240 offset:49152
    v_mfma_f32_16x16x32_bf16 v[224:227], v[80:83], a[172:175], v[224:227]
    ds_read_b64_tr_b16 a[10:11], v240 offset:53248
    v_mfma_f32_16x16x32_bf16 v[228:231], v[88:91], a[172:175], v[228:231]
    ds_read_b64_tr_b16 a[12:13], v240 offset:57344
    v_mfma_f32_16x16x32_bf16 v[228:231], v[92:95], a[188:191], v[228:231]
    buffer_load_dwordx4 v17, s[16:19], s36 offen offset:1024 nt lds
    v_mfma_f32_16x16x32_bf16 v[196:199], v[92:95], a[184:187], v[196:199]
    v_mfma_f32_16x16x32_bf16 v[196:199], v[88:91], a[168:171], v[196:199]
    ds_read_b64_tr_b16 a[14:15], v240 offset:61440
    v_mfma_f32_16x16x32_bf16 v[164:167], v[88:91], a[164:167], v[164:167]
    ds_read_b64_tr_b16 a[16:17], v241 offset:32768
    v_mfma_f32_16x16x32_bf16 v[164:167], v[92:95], a[180:183], v[164:167]
    ds_read_b64_tr_b16 a[18:19], v241 offset:36864
    v_mfma_f32_16x16x32_bf16 v[132:135], v[92:95], a[176:179], v[132:135]
    ds_read_b64_tr_b16 a[20:21], v241 offset:40960
    v_mfma_f32_16x16x32_bf16 v[132:135], v[88:91], a[160:163], v[132:135]
    ds_read_b64_tr_b16 a[22:23], v241 offset:45056
    v_mfma_f32_16x16x32_bf16 v[136:139], v[96:99], a[160:163], v[136:139]
    ds_read_b64_tr_b16 a[24:25], v241 offset:49152
    v_mfma_f32_16x16x32_bf16 v[136:139], v[100:103], a[176:179], v[136:139]
    buffer_load_dwordx4 v41, s[16:19], s36 offen offset:2048 nt lds
    v_mfma_f32_16x16x32_bf16 v[168:171], v[100:103], a[180:183], v[168:171]
    v_mfma_f32_16x16x32_bf16 v[168:171], v[96:99], a[164:167], v[168:171]
    ds_read_b64_tr_b16 a[26:27], v241 offset:53248
    v_mfma_f32_16x16x32_bf16 v[200:203], v[96:99], a[168:171], v[200:203]
    ds_read_b64_tr_b16 a[28:29], v241 offset:57344
    v_mfma_f32_16x16x32_bf16 v[200:203], v[100:103], a[184:187], v[200:203]
    ds_read_b64_tr_b16 a[30:31], v241 offset:61440
    v_mfma_f32_16x16x32_bf16 v[232:235], v[100:103], a[188:191], v[232:235]
    v_mfma_f32_16x16x32_bf16 v[232:235], v[96:99], a[172:175], v[232:235]
    v_mfma_f32_16x16x32_bf16 v[236:239], v[104:107], a[172:175], v[236:239]
    buffer_load_dwordx4 v42, s[16:19], s36 offen offset:3072 nt lds
    v_mfma_f32_16x16x32_bf16 v[236:239], v[108:111], a[188:191], v[236:239]
    v_mfma_f32_16x16x32_bf16 v[204:207], v[108:111], a[184:187], v[204:207]
    v_mfma_f32_16x16x32_bf16 v[204:207], v[104:107], a[168:171], v[204:207]
    v_mfma_f32_16x16x32_bf16 v[172:175], v[104:107], a[164:167], v[172:175]
    v_mfma_f32_16x16x32_bf16 v[172:175], v[108:111], a[180:183], v[172:175]
    v_mfma_f32_16x16x32_bf16 v[140:143], v[108:111], a[176:179], v[140:143]
    v_mfma_f32_16x16x32_bf16 v[140:143], v[104:107], a[160:163], v[140:143]
    s_waitcnt vmcnt(5) lgkmcnt(0)
    v_mfma_f32_16x16x32_bf16 v[112:115], a[0:3], a[192:195], v[112:115]
    ds_read_b64_tr_b16 a[32:33], v242 offset:32768
    v_mfma_f32_16x16x32_bf16 v[112:115], a[4:7], a[208:211], v[112:115]
    s_add_u32 m0, s37, 32768
    ds_read_b64_tr_b16 a[34:35], v242 offset:36864
    v_mfma_f32_16x16x32_bf16 v[112:115], a[8:11], a[224:227], v[112:115]
    s_mov_b32 s36, 16384
    buffer_load_dwordx4 v16, s[16:19], s36 offen offset:0 nt lds
    v_mfma_f32_16x16x32_bf16 v[112:115], a[12:15], a[240:243], v[112:115]
    v_mfma_f32_16x16x32_bf16 v[144:147], a[12:15], a[244:247], v[144:147]
    ds_read_b64_tr_b16 a[36:37], v242 offset:40960
    v_mfma_f32_16x16x32_bf16 v[144:147], a[8:11], a[228:231], v[144:147]
    ds_read_b64_tr_b16 a[38:39], v242 offset:45056
    v_mfma_f32_16x16x32_bf16 v[144:147], a[4:7], a[212:215], v[144:147]
    ds_read_b64_tr_b16 a[40:41], v242 offset:49152
    v_mfma_f32_16x16x32_bf16 v[144:147], a[0:3], a[196:199], v[144:147]
    ds_read_b64_tr_b16 a[42:43], v242 offset:53248
    v_mfma_f32_16x16x32_bf16 v[176:179], a[0:3], a[200:203], v[176:179]
    ds_read_b64_tr_b16 a[44:45], v242 offset:57344
    v_mfma_f32_16x16x32_bf16 v[176:179], a[4:7], a[216:219], v[176:179]
    buffer_load_dwordx4 v17, s[16:19], s36 offen offset:1024 nt lds
    v_mfma_f32_16x16x32_bf16 v[176:179], a[8:11], a[232:235], v[176:179]
    v_mfma_f32_16x16x32_bf16 v[176:179], a[12:15], a[248:251], v[176:179]
    ds_read_b64_tr_b16 a[46:47], v242 offset:61440
    v_mfma_f32_16x16x32_bf16 v[208:211], a[12:15], a[252:255], v[208:211]
    ds_read_b64_tr_b16 a[48:49], v243 offset:32768
    v_mfma_f32_16x16x32_bf16 v[208:211], a[8:11], a[236:239], v[208:211]
    ds_read_b64_tr_b16 a[50:51], v243 offset:36864
    v_mfma_f32_16x16x32_bf16 v[208:211], a[4:7], a[220:223], v[208:211]
    ds_read_b64_tr_b16 a[52:53], v243 offset:40960
    v_mfma_f32_16x16x32_bf16 v[208:211], a[0:3], a[204:207], v[208:211]
    ds_read_b64_tr_b16 a[54:55], v243 offset:45056
    v_mfma_f32_16x16x32_bf16 v[212:215], a[16:19], a[204:207], v[212:215]
    ds_read_b64_tr_b16 a[56:57], v243 offset:49152
    v_mfma_f32_16x16x32_bf16 v[212:215], a[20:23], a[220:223], v[212:215]
    buffer_load_dwordx4 v41, s[16:19], s36 offen offset:2048 nt lds
    v_mfma_f32_16x16x32_bf16 v[212:215], a[24:27], a[236:239], v[212:215]
    v_mfma_f32_16x16x32_bf16 v[212:215], a[28:31], a[252:255], v[212:215]
    ds_read_b64_tr_b16 a[58:59], v243 offset:53248
    v_mfma_f32_16x16x32_bf16 v[180:183], a[28:31], a[248:251], v[180:183]
    ds_read_b64_tr_b16 a[60:61], v243 offset:57344
    v_mfma_f32_16x16x32_bf16 v[180:183], a[24:27], a[232:235], v[180:183]
    ds_read_b64_tr_b16 a[62:63], v243 offset:61440
    v_mfma_f32_16x16x32_bf16 v[180:183], a[20:23], a[216:219], v[180:183]
    v_mfma_f32_16x16x32_bf16 v[180:183], a[16:19], a[200:203], v[180:183]
    v_mfma_f32_16x16x32_bf16 v[148:151], a[16:19], a[196:199], v[148:151]
    buffer_load_dwordx4 v42, s[16:19], s36 offen offset:3072 nt lds
    v_mfma_f32_16x16x32_bf16 v[148:151], a[20:23], a[212:215], v[148:151]
    v_mfma_f32_16x16x32_bf16 v[148:151], a[24:27], a[228:231], v[148:151]
    v_mfma_f32_16x16x32_bf16 v[148:151], a[28:31], a[244:247], v[148:151]
    v_mfma_f32_16x16x32_bf16 v[116:119], a[28:31], a[240:243], v[116:119]
    v_mfma_f32_16x16x32_bf16 v[116:119], a[24:27], a[224:227], v[116:119]
    v_mfma_f32_16x16x32_bf16 v[116:119], a[20:23], a[208:211], v[116:119]
    v_mfma_f32_16x16x32_bf16 v[116:119], a[16:19], a[192:195], v[116:119]
    s_waitcnt vmcnt(9) lgkmcnt(0)
    v_mfma_f32_16x16x32_bf16 v[120:123], a[32:35], a[192:195], v[120:123]
    ds_read_b64_tr_b16 a[0:1], v244 offset:32768
    ds_read_b64_tr_b16 a[2:3], v244 offset:36864
    v_mfma_f32_16x16x32_bf16 v[120:123], a[36:39], a[208:211], v[120:123]
    s_add_u32 m0, s37, 49152
    ds_read_b64_tr_b16 a[4:5], v244 offset:40960
    ds_read_b64_tr_b16 a[6:7], v244 offset:45056
    v_mfma_f32_16x16x32_bf16 v[120:123], a[40:43], a[224:227], v[120:123]
    s_mov_b32 s44, 0
    buffer_load_dwordx4 v18, s[20:23], s44 offen offset:0 nt lds
    v_mfma_f32_16x16x32_bf16 v[120:123], a[44:47], a[240:243], v[120:123]
    v_mfma_f32_16x16x32_bf16 v[152:155], a[44:47], a[244:247], v[152:155]
    ds_read_b64_tr_b16 a[8:9], v244 offset:49152
    ds_read_b64_tr_b16 a[10:11], v244 offset:53248
    v_mfma_f32_16x16x32_bf16 v[152:155], a[40:43], a[228:231], v[152:155]
    ds_read_b64_tr_b16 a[12:13], v244 offset:57344
    ds_read_b64_tr_b16 a[14:15], v244 offset:61440
    v_mfma_f32_16x16x32_bf16 v[152:155], a[36:39], a[212:215], v[152:155]
    ds_read_b64_tr_b16 a[16:17], v245 offset:32768
    ds_read_b64_tr_b16 a[18:19], v245 offset:36864
    v_mfma_f32_16x16x32_bf16 v[152:155], a[32:35], a[196:199], v[152:155]
    ds_read_b64_tr_b16 a[20:21], v245 offset:40960
    ds_read_b64_tr_b16 a[22:23], v245 offset:45056
    v_mfma_f32_16x16x32_bf16 v[184:187], a[32:35], a[200:203], v[184:187]
    ds_read_b64_tr_b16 a[24:25], v245 offset:49152
    ds_read_b64_tr_b16 a[26:27], v245 offset:53248
    v_mfma_f32_16x16x32_bf16 v[184:187], a[36:39], a[216:219], v[184:187]
    buffer_load_dwordx4 v19, s[20:23], s44 offen offset:1024 nt lds
    v_mfma_f32_16x16x32_bf16 v[184:187], a[40:43], a[232:235], v[184:187]
    v_mfma_f32_16x16x32_bf16 v[184:187], a[44:47], a[248:251], v[184:187]
    ds_read_b64_tr_b16 a[28:29], v245 offset:57344
    ds_read_b64_tr_b16 a[30:31], v245 offset:61440
    v_mfma_f32_16x16x32_bf16 v[216:219], a[44:47], a[252:255], v[216:219]
    v_cvt_pk_bf16_f32 v48, v112, v113
    v_cvt_pk_bf16_f32 v49, v114, v115
    v_mfma_f32_16x16x32_bf16 v[216:219], a[40:43], a[236:239], v[216:219]
    v_cvt_pk_bf16_f32 v50, v116, v117
    v_cvt_pk_bf16_f32 v51, v118, v119
    v_mfma_f32_16x16x32_bf16 v[216:219], a[36:39], a[220:223], v[216:219]
    v_cvt_pk_bf16_f32 v64, v144, v145
    v_cvt_pk_bf16_f32 v65, v146, v147
    v_mfma_f32_16x16x32_bf16 v[216:219], a[32:35], a[204:207], v[216:219]
    v_cvt_pk_bf16_f32 v66, v148, v149
    v_cvt_pk_bf16_f32 v67, v150, v151
    v_mfma_f32_16x16x32_bf16 v[220:223], a[48:51], a[204:207], v[220:223]
    v_cvt_pk_bf16_f32 v80, v176, v177
    v_cvt_pk_bf16_f32 v81, v178, v179
    v_mfma_f32_16x16x32_bf16 v[220:223], a[52:55], a[220:223], v[220:223]
    buffer_load_dwordx4 v18, s[20:23], s44 offen offset:2048 nt lds
    v_mfma_f32_16x16x32_bf16 v[220:223], a[56:59], a[236:239], v[220:223]
    v_cvt_pk_bf16_f32 v82, v180, v181
    v_cvt_pk_bf16_f32 v83, v182, v183
    v_mfma_f32_16x16x32_bf16 v[220:223], a[60:63], a[252:255], v[220:223]
    v_cvt_pk_bf16_f32 v96, v208, v209
    v_cvt_pk_bf16_f32 v97, v210, v211
    v_mfma_f32_16x16x32_bf16 v[188:191], a[60:63], a[248:251], v[188:191]
    v_cvt_pk_bf16_f32 v98, v212, v213
    v_cvt_pk_bf16_f32 v99, v214, v215
    v_mfma_f32_16x16x32_bf16 v[188:191], a[56:59], a[232:235], v[188:191]
    v_permlane32_swap_b32 v48, v50
    v_permlane32_swap_b32 v49, v51
    v_mfma_f32_16x16x32_bf16 v[188:191], a[52:55], a[216:219], v[188:191]
    v_permlane32_swap_b32 v64, v66
    v_permlane32_swap_b32 v65, v67
    v_mfma_f32_16x16x32_bf16 v[188:191], a[48:51], a[200:203], v[188:191]
    v_permlane32_swap_b32 v80, v82
    v_permlane32_swap_b32 v81, v83
    v_mfma_f32_16x16x32_bf16 v[156:159], a[48:51], a[196:199], v[156:159]
    buffer_load_dwordx4 v19, s[20:23], s44 offen offset:3072 nt lds
    v_mfma_f32_16x16x32_bf16 v[156:159], a[52:55], a[212:215], v[156:159]
    v_permlane32_swap_b32 v96, v98
    v_permlane32_swap_b32 v97, v99
    v_mfma_f32_16x16x32_bf16 v[156:159], a[56:59], a[228:231], v[156:159]
    v_permlane16_swap_b32 v48, v50
    v_permlane16_swap_b32 v49, v51
    v_mfma_f32_16x16x32_bf16 v[156:159], a[60:63], a[244:247], v[156:159]
    v_permlane16_swap_b32 v64, v66
    v_permlane16_swap_b32 v65, v67
    v_mfma_f32_16x16x32_bf16 v[124:127], a[60:63], a[240:243], v[124:127]
    v_permlane16_swap_b32 v80, v82
    v_permlane16_swap_b32 v81, v83
    v_mfma_f32_16x16x32_bf16 v[124:127], a[56:59], a[224:227], v[124:127]
    v_permlane16_swap_b32 v96, v98
    v_permlane16_swap_b32 v97, v99
    v_mfma_f32_16x16x32_bf16 v[124:127], a[52:55], a[208:211], v[124:127]
    v_mfma_f32_16x16x32_bf16 v[124:127], a[48:51], a[192:195], v[124:127]
    s_waitcnt vmcnt(13) lgkmcnt(0)
    v_mfma_f32_16x16x32_bf16 v[128:131], a[0:3], a[192:195], v[128:131]
    ds_read_b64_tr_b16 a[32:33], v246 offset:32768
    ds_read_b64_tr_b16 a[34:35], v246 offset:36864
    v_mfma_f32_16x16x32_bf16 v[128:131], a[4:7], a[208:211], v[128:131]
    ds_read_b64_tr_b16 a[36:37], v246 offset:40960
    ds_read_b64_tr_b16 a[38:39], v246 offset:45056
    v_mfma_f32_16x16x32_bf16 v[128:131], a[8:11], a[224:227], v[128:131]
    ds_read_b64_tr_b16 a[40:41], v246 offset:49152
    ds_read_b64_tr_b16 a[42:43], v246 offset:53248
    v_mfma_f32_16x16x32_bf16 v[128:131], a[12:15], a[240:243], v[128:131]
    ds_read_b64_tr_b16 a[44:45], v246 offset:57344
    ds_read_b64_tr_b16 a[46:47], v246 offset:61440
    v_mfma_f32_16x16x32_bf16 v[160:163], a[12:15], a[244:247], v[160:163]
    ds_read_b64_tr_b16 a[48:49], v247 offset:32768
    ds_read_b64_tr_b16 a[50:51], v247 offset:36864
    v_mfma_f32_16x16x32_bf16 v[160:163], a[8:11], a[228:231], v[160:163]
    ds_read_b64_tr_b16 a[52:53], v247 offset:40960
    ds_read_b64_tr_b16 a[54:55], v247 offset:45056
    v_mfma_f32_16x16x32_bf16 v[160:163], a[4:7], a[212:215], v[160:163]
    ds_read_b64_tr_b16 a[56:57], v247 offset:49152
    ds_read_b64_tr_b16 a[58:59], v247 offset:53248
    v_mfma_f32_16x16x32_bf16 v[160:163], a[0:3], a[196:199], v[160:163]
    ds_read_b64_tr_b16 a[60:61], v247 offset:57344
    ds_read_b64_tr_b16 a[62:63], v247 offset:61440
    v_mfma_f32_16x16x32_bf16 v[192:195], a[0:3], a[200:203], v[192:195]
    v_cvt_pk_bf16_f32 v52, v120, v121
    v_cvt_pk_bf16_f32 v53, v122, v123
    v_mfma_f32_16x16x32_bf16 v[192:195], a[4:7], a[216:219], v[192:195]
    v_cvt_pk_bf16_f32 v54, v124, v125
    v_cvt_pk_bf16_f32 v55, v126, v127
    v_mfma_f32_16x16x32_bf16 v[192:195], a[8:11], a[232:235], v[192:195]
    v_cvt_pk_bf16_f32 v68, v152, v153
    v_cvt_pk_bf16_f32 v69, v154, v155
    v_mfma_f32_16x16x32_bf16 v[192:195], a[12:15], a[248:251], v[192:195]
    v_cvt_pk_bf16_f32 v70, v156, v157
    v_cvt_pk_bf16_f32 v71, v158, v159
    v_mfma_f32_16x16x32_bf16 v[224:227], a[12:15], a[252:255], v[224:227]
    v_cvt_pk_bf16_f32 v84, v184, v185
    v_cvt_pk_bf16_f32 v85, v186, v187
    v_mfma_f32_16x16x32_bf16 v[224:227], a[8:11], a[236:239], v[224:227]
    v_cvt_pk_bf16_f32 v86, v188, v189
    v_cvt_pk_bf16_f32 v87, v190, v191
    v_mfma_f32_16x16x32_bf16 v[224:227], a[4:7], a[220:223], v[224:227]
    v_cvt_pk_bf16_f32 v100, v216, v217
    v_cvt_pk_bf16_f32 v101, v218, v219
    v_mfma_f32_16x16x32_bf16 v[224:227], a[0:3], a[204:207], v[224:227]
    v_cvt_pk_bf16_f32 v102, v220, v221
    v_cvt_pk_bf16_f32 v103, v222, v223
    v_mfma_f32_16x16x32_bf16 v[228:231], a[16:19], a[204:207], v[228:231]
    v_permlane32_swap_b32 v52, v54
    v_permlane32_swap_b32 v53, v55
    v_mfma_f32_16x16x32_bf16 v[228:231], a[20:23], a[220:223], v[228:231]
    v_permlane32_swap_b32 v68, v70
    v_permlane32_swap_b32 v69, v71
    v_mfma_f32_16x16x32_bf16 v[228:231], a[24:27], a[236:239], v[228:231]
    v_permlane32_swap_b32 v84, v86
    v_permlane32_swap_b32 v85, v87
    v_mfma_f32_16x16x32_bf16 v[228:231], a[28:31], a[252:255], v[228:231]
    v_permlane32_swap_b32 v100, v102
    v_permlane32_swap_b32 v101, v103
    v_mfma_f32_16x16x32_bf16 v[196:199], a[28:31], a[248:251], v[196:199]
    v_permlane16_swap_b32 v52, v54
    v_permlane16_swap_b32 v53, v55
    v_mfma_f32_16x16x32_bf16 v[196:199], a[24:27], a[232:235], v[196:199]
    v_permlane16_swap_b32 v68, v70
    v_permlane16_swap_b32 v69, v71
    v_mfma_f32_16x16x32_bf16 v[196:199], a[20:23], a[216:219], v[196:199]
    v_permlane16_swap_b32 v84, v86
    v_permlane16_swap_b32 v85, v87
    v_mfma_f32_16x16x32_bf16 v[196:199], a[16:19], a[200:203], v[196:199]
    v_permlane16_swap_b32 v100, v102
    v_permlane16_swap_b32 v101, v103
    v_mfma_f32_16x16x32_bf16 v[164:167], a[16:19], a[196:199], v[164:167]
    v_mfma_f32_16x16x32_bf16 v[164:167], a[20:23], a[212:215], v[164:167]
    v_mfma_f32_16x16x32_bf16 v[164:167], a[24:27], a[228:231], v[164:167]
    v_mfma_f32_16x16x32_bf16 v[164:167], a[28:31], a[244:247], v[164:167]
    v_mfma_f32_16x16x32_bf16 v[132:135], a[28:31], a[240:243], v[132:135]
    v_mfma_f32_16x16x32_bf16 v[132:135], a[24:27], a[224:227], v[132:135]
    v_mfma_f32_16x16x32_bf16 v[132:135], a[20:23], a[208:211], v[132:135]
    v_mfma_f32_16x16x32_bf16 v[132:135], a[16:19], a[192:195], v[132:135]
    s_waitcnt vmcnt(8) lgkmcnt(0)
    s_barrier
    v_mfma_f32_16x16x32_bf16 v[136:139], a[32:35], a[192:195], v[136:139]
    ds_read_b128 a[160:163], v4 offset:0
    ds_read_b128 a[164:167], v5 offset:0
    v_mfma_f32_16x16x32_bf16 v[136:139], a[36:39], a[208:211], v[136:139]
    ds_read_b128 a[168:171], v6 offset:0
    ds_read_b128 a[172:175], v7 offset:0
    v_mfma_f32_16x16x32_bf16 v[136:139], a[40:43], a[224:227], v[136:139]
    ds_read_b128 a[176:179], v4 offset:4096
    ds_read_b128 a[180:183], v5 offset:4096
    v_mfma_f32_16x16x32_bf16 v[136:139], a[44:47], a[240:243], v[136:139]
    ds_read_b128 a[184:187], v6 offset:4096
    ds_read_b128 a[188:191], v7 offset:4096
    v_mfma_f32_16x16x32_bf16 v[168:171], a[32:35], a[196:199], v[168:171]
    ds_read_b128 a[128:131], v4 offset:8192
    ds_read_b128 a[132:135], v5 offset:8192
    v_mfma_f32_16x16x32_bf16 v[168:171], a[36:39], a[212:215], v[168:171]
    ds_read_b128 a[136:139], v6 offset:8192
    ds_read_b128 a[140:143], v7 offset:8192
    v_mfma_f32_16x16x32_bf16 v[168:171], a[40:43], a[228:231], v[168:171]
    ds_read_b128 a[144:147], v4 offset:12288
    ds_read_b128 a[148:151], v5 offset:12288
    v_mfma_f32_16x16x32_bf16 v[168:171], a[44:47], a[244:247], v[168:171]
    ds_read_b128 a[152:155], v6 offset:12288
    ds_read_b128 a[156:159], v7 offset:12288
    v_mfma_f32_16x16x32_bf16 v[200:203], a[32:35], a[200:203], v[200:203]
    v_cvt_pk_bf16_f32 v56, v128, v129
    v_cvt_pk_bf16_f32 v57, v130, v131
    v_mfma_f32_16x16x32_bf16 v[200:203], a[36:39], a[216:219], v[200:203]
    v_cvt_pk_bf16_f32 v58, v132, v133
    v_cvt_pk_bf16_f32 v59, v134, v135
    v_mfma_f32_16x16x32_bf16 v[200:203], a[40:43], a[232:235], v[200:203]
    v_cvt_pk_bf16_f32 v72, v160, v161
    v_cvt_pk_bf16_f32 v73, v162, v163
    v_mfma_f32_16x16x32_bf16 v[200:203], a[44:47], a[248:251], v[200:203]
    v_cvt_pk_bf16_f32 v74, v164, v165
    v_cvt_pk_bf16_f32 v75, v166, v167
    v_mfma_f32_16x16x32_bf16 v[232:235], a[32:35], a[204:207], v[232:235]
    v_cvt_pk_bf16_f32 v88, v192, v193
    v_cvt_pk_bf16_f32 v89, v194, v195
    v_mfma_f32_16x16x32_bf16 v[232:235], a[36:39], a[220:223], v[232:235]
    v_cvt_pk_bf16_f32 v90, v196, v197
    v_cvt_pk_bf16_f32 v91, v198, v199
    v_mfma_f32_16x16x32_bf16 v[232:235], a[40:43], a[236:239], v[232:235]
    v_cvt_pk_bf16_f32 v104, v224, v225
    v_cvt_pk_bf16_f32 v105, v226, v227
    v_mfma_f32_16x16x32_bf16 v[232:235], a[44:47], a[252:255], v[232:235]
    v_cvt_pk_bf16_f32 v106, v228, v229
    v_cvt_pk_bf16_f32 v107, v230, v231
    v_mfma_f32_16x16x32_bf16 v[140:143], a[48:51], a[192:195], v[140:143]
    v_permlane32_swap_b32 v56, v58
    v_permlane32_swap_b32 v57, v59
    v_mfma_f32_16x16x32_bf16 v[140:143], a[52:55], a[208:211], v[140:143]
    v_permlane32_swap_b32 v72, v74
    v_permlane32_swap_b32 v73, v75
    v_mfma_f32_16x16x32_bf16 v[140:143], a[56:59], a[224:227], v[140:143]
    v_permlane32_swap_b32 v88, v90
    v_permlane32_swap_b32 v89, v91
    v_mfma_f32_16x16x32_bf16 v[140:143], a[60:63], a[240:243], v[140:143]
    v_permlane32_swap_b32 v104, v106
    v_permlane32_swap_b32 v105, v107
    v_mfma_f32_16x16x32_bf16 v[172:175], a[48:51], a[196:199], v[172:175]
    v_permlane16_swap_b32 v56, v58
    v_permlane16_swap_b32 v57, v59
    v_mfma_f32_16x16x32_bf16 v[172:175], a[52:55], a[212:215], v[172:175]
    s_branch L_over2
.p2align 12
L_stub2:
    s_setpc_b64 s[46:47]
L_over2:
    v_permlane16_swap_b32 v72, v74
    v_permlane16_swap_b32 v73, v75
    v_mfma_f32_16x16x32_bf16 v[172:175], a[56:59], a[228:231], v[172:175]
    v_permlane16_swap_b32 v88, v90
    v_permlane16_swap_b32 v89, v91
    v_mfma_f32_16x16x32_bf16 v[172:175], a[60:63], a[244:247], v[172:175]
    v_permlane16_swap_b32 v104, v106
    v_permlane16_swap_b32 v105, v107
    v_mfma_f32_16x16x32_bf16 v[204:207], a[48:51], a[200:203], v[204:207]
    v_mfma_f32_16x16x32_bf16 v[204:207], a[52:55], a[216:219], v[204:207]
    v_mfma_f32_16x16x32_bf16 v[204:207], a[56:59], a[232:235], v[204:207]
    v_mfma_f32_16x16x32_bf16 v[204:207], a[60:63], a[248:251], v[204:207]
    v_mfma_f32_16x16x32_bf16 v[236:239], a[48:51], a[204:207], v[236:239]
    v_mfma_f32_16x16x32_bf16 v[236:239], a[52:55], a[220:223], v[236:239]
    v_mfma_f32_16x16x32_bf16 v[236:239], a[56:59], a[236:239], v[236:239]
    v_mfma_f32_16x16x32_bf16 v[236:239], a[60:63], a[252:255], v[236:239]
    v_cmp_ne_u32 vcc, s90, v47
    s_lshl_b32 s49, s14, 2
    s_lshl_b32 s40, s59, 19
    s_lshl_b32 s41, s58, 16
    s_add_u32 s41, s40, s41
    s_add_u32 s28, s41, 4194304
    s_add_u32 s28, s72, s28
    s_addc_u32 s29, s73, 0
    s_and_b32 s29, s29, 0xffff
    s_mov_b32 s30, 65536
    s_mov_b32 s31, 0x20000
    s_cmp_eq_u64 vcc, 0
    s_cselect_b32 s91, 1, 0
    v_cvt_pk_bf16_f32 v60, v136, v137
    v_cvt_pk_bf16_f32 v61, v138, v139
    v_cvt_pk_bf16_f32 v62, v140, v141
    v_cvt_pk_bf16_f32 v63, v142, v143
    s_waitcnt lgkmcnt(0)
    s_barrier
    v_mfma_f32_16x16x32_bf16 v[112:115], a[160:163], v[48:51], 0
    s_add_u32 m0, s37, 0
    s_mov_b32 s36, 32768
    v_cvt_pk_bf16_f32 v76, v168, v169
    v_cvt_pk_bf16_f32 v77, v170, v171
    v_mfma_f32_16x16x32_bf16 v[112:115], a[164:167], v[52:55], v[112:115]
    v_cvt_pk_bf16_f32 v78, v172, v173
    v_cvt_pk_bf16_f32 v79, v174, v175
    v_mfma_f32_16x16x32_bf16 v[112:115], a[168:171], v[56:59], v[112:115]
    v_cvt_pk_bf16_f32 v92, v200, v201
    v_cvt_pk_bf16_f32 v93, v202, v203
    v_mfma_f32_16x16x32_bf16 v[120:123], a[160:163], v[64:67], 0
    v_cvt_pk_bf16_f32 v94, v204, v205
    v_cvt_pk_bf16_f32 v95, v206, v207
    v_mfma_f32_16x16x32_bf16 v[120:123], a[164:167], v[68:71], v[120:123]
    v_cvt_pk_bf16_f32 v108, v232, v233
    v_cvt_pk_bf16_f32 v109, v234, v235
    v_mfma_f32_16x16x32_bf16 v[120:123], a[168:171], v[72:75], v[120:123]
    v_cvt_pk_bf16_f32 v110, v236, v237
    v_cvt_pk_bf16_f32 v111, v238, v239
    v_mfma_f32_16x16x32_bf16 v[128:131], a[160:163], v[80:83], 0
    v_permlane32_swap_b32 v60, v62
    v_permlane32_swap_b32 v61, v63
    v_mfma_f32_16x16x32_bf16 v[128:131], a[164:167], v[84:87], v[128:131]
    v_permlane32_swap_b32 v76, v78
    v_permlane32_swap_b32 v77, v79
    v_mfma_f32_16x16x32_bf16 v[128:131], a[168:171], v[88:91], v[128:131]
    v_permlane32_swap_b32 v92, v94
    v_permlane32_swap_b32 v93, v95
    v_mfma_f32_16x16x32_bf16 v[136:139], a[160:163], v[96:99], 0
    v_permlane32_swap_b32 v108, v110
    v_permlane32_swap_b32 v109, v111
    v_mfma_f32_16x16x32_bf16 v[136:139], a[164:167], v[100:103], v[136:139]
    v_permlane16_swap_b32 v60, v62
    v_permlane16_swap_b32 v61, v63
    v_mfma_f32_16x16x32_bf16 v[136:139], a[168:171], v[104:107], v[136:139]
    v_permlane16_swap_b32 v76, v78
    v_permlane16_swap_b32 v77, v79
    v_mfma_f32_16x16x32_bf16 v[116:119], a[176:179], v[48:51], 0
    v_permlane16_swap_b32 v92, v94
    v_permlane16_swap_b32 v93, v95
    v_mfma_f32_16x16x32_bf16 v[116:119], a[180:183], v[52:55], v[116:119]
    v_permlane16_swap_b32 v108, v110
    v_permlane16_swap_b32 v109, v111
    v_mfma_f32_16x16x32_bf16 v[116:119], a[184:187], v[56:59], v[116:119]
    v_mfma_f32_16x16x32_bf16 v[124:127], a[176:179], v[64:67], 0
    v_mov_b32 v224, 0
    v_mov_b32 v225, 0
    v_mfma_f32_16x16x32_bf16 v[124:127], a[180:183], v[68:71], v[124:127]
    buffer_load_dwordx4 v16, s[16:19], s36 offen offset:0 nt lds
    v_mfma_f32_16x16x32_bf16 v[124:127], a[184:187], v[72:75], v[124:127]
    v_mov_b32 v226, 0
    v_mov_b32 v227, 0
    v_mfma_f32_16x16x32_bf16 v[132:135], a[176:179], v[80:83], 0
    buffer_load_dwordx4 v17, s[16:19], s36 offen offset:1024 nt lds
    v_mfma_f32_16x16x32_bf16 v[132:135], a[180:183], v[84:87], v[132:135]
    v_mov_b32 v228, 0
    v_mov_b32 v229, 0
    v_mfma_f32_16x16x32_bf16 v[132:135], a[184:187], v[88:91], v[132:135]
    buffer_load_dwordx4 v41, s[16:19], s36 offen offset:2048 nt lds
    v_mfma_f32_16x16x32_bf16 v[140:143], a[176:179], v[96:99], 0
    v_mov_b32 v230, 0
    v_mov_b32 v231, 0
    v_mfma_f32_16x16x32_bf16 v[140:143], a[180:183], v[100:103], v[140:143]
    buffer_load_dwordx4 v42, s[16:19], s36 offen offset:3072 nt lds
    v_mfma_f32_16x16x32_bf16 v[140:143], a[184:187], v[104:107], v[140:143]
    s_mov_b32 s3, 0x07060302
    s_mov_b32 s38, 15
    v_lshlrev_b32 v47, 5, v0
    v_mfma_f32_16x16x32_bf16 v[112:115], a[172:175], v[60:63], v[112:115]
    v_mfma_f32_16x16x32_bf16 v[116:119], a[188:191], v[60:63], v[116:119]
    v_mfma_f32_16x16x32_bf16 v[120:123], a[172:175], v[76:79], v[120:123]
    v_mfma_f32_16x16x32_bf16 v[124:127], a[188:191], v[76:79], v[124:127]
    s_mov_b32 s41, 0
    v_mfma_f32_16x16x32_bf16 v[128:131], a[172:175], v[92:95], v[128:131]
    v_mfma_f32_16x16x32_bf16 v[132:135], a[188:191], v[92:95], v[132:135]
    v_mfma_f32_16x16x32_bf16 v[136:139], a[172:175], v[108:111], v[136:139]
    v_mfma_f32_16x16x32_bf16 v[140:143], a[188:191], v[108:111], v[140:143]
    s_mov_b32 s36, 49152
    s_mov_b32 s44, 16384
    s_nop 0
    v_max3_f32 v28, v112, v113, v114
    v_max3_f32 v32, v115, v116, v117
    v_max3_f32 v28, v28, v118, v119
    v_max_f32 v28, v28, v32
    v_max3_f32 v29, v120, v121, v122
    v_max3_f32 v33, v123, v124, v125
    v_max3_f32 v29, v29, v126, v127
    v_max_f32 v29, v29, v33
    v_max3_f32 v30, v128, v129, v130
    v_max3_f32 v34, v131, v132, v133
    v_max3_f32 v30, v30, v134, v135
    v_max_f32 v30, v30, v34
    v_max3_f32 v31, v136, v137, v138
    v_max3_f32 v35, v139, v140, v141
    v_max3_f32 v31, v31, v142, v143
    v_max_f32 v31, v31, v35
    v_mov_b32 v32, v28
    v_mov_b32 v33, v29
    v_mov_b32 v34, v30
    v_mov_b32 v35, v31
    v_permlane16_swap_b32 v28, v32
    v_permlane16_swap_b32 v29, v33
    v_permlane16_swap_b32 v30, v34
    v_permlane16_swap_b32 v31, v35
    v_max_f32 v28, v28, v32
    v_max_f32 v29, v29, v33
    v_max_f32 v30, v30, v34
    v_max_f32 v31, v31, v35
    v_mov_b32 v32, v28
    v_mov_b32 v33, v29
    v_mov_b32 v34, v30
    v_mov_b32 v35, v31
    v_permlane32_swap_b32 v28, v32
    v_permlane32_swap_b32 v29, v33
    v_permlane32_swap_b32 v30, v34
    v_permlane32_swap_b32 v31, v35
    v_max_f32 v28, v28, v32
    v_max_f32 v29, v29, v33
    v_max_f32 v30, v30, v34
    v_max_f32 v31, v31, v35
    v_ceil_f32 v28, v28
    v_ceil_f32 v29, v29
    v_ceil_f32 v30, v30
    v_ceil_f32 v31, v31
    v_sub_f32 v208, 0xc2200000, v28
    v_sub_f32 v209, 0xc2200000, v28
    v_sub_f32 v210, 0xc2200000, v28
    v_sub_f32 v211, 0xc2200000, v28
    v_sub_f32 v212, 0xc2200000, v29
    v_sub_f32 v213, 0xc2200000, v29
    v_sub_f32 v214, 0xc2200000, v29
    v_sub_f32 v215, 0xc2200000, v29
    v_sub_f32 v216, 0xc2200000, v30
    v_sub_f32 v217, 0xc2200000, v30
    v_sub_f32 v218, 0xc2200000, v30
    v_sub_f32 v219, 0xc2200000, v30
    v_sub_f32 v220, 0xc2200000, v31
    v_sub_f32 v221, 0xc2200000, v31
    v_sub_f32 v222, 0xc2200000, v31
    v_sub_f32 v223, 0xc2200000, v31
    v_add_f32 v112, v112, v208
    v_add_f32 v113, v113, v208
    v_add_f32 v114, v114, v208
    v_add_f32 v115, v115, v208
    v_add_f32 v116, v116, v208
    v_add_f32 v117, v117, v208
    v_add_f32 v118, v118, v208
    v_add_f32 v119, v119, v208
    v_add_f32 v120, v120, v212
    v_add_f32 v121, v121, v212
    v_add_f32 v122, v122, v212
    v_add_f32 v123, v123, v212
    v_add_f32 v124, v124, v212
    v_add_f32 v125, v125, v212
    v_add_f32 v126, v126, v212
    v_add_f32 v127, v127, v212
    v_add_f32 v128, v128, v216
    v_add_f32 v129, v129, v216
    v_add_f32 v130, v130, v216
    v_add_f32 v131, v131, v216
    v_add_f32 v132, v132, v216
    v_add_f32 v133, v133, v216
    v_add_f32 v134, v134, v216
    v_add_f32 v135, v135, v216
    v_add_f32 v136, v136, v220
    v_add_f32 v137, v137, v220
    v_add_f32 v138, v138, v220
    v_add_f32 v139, v139, v220
    v_add_f32 v140, v140, v220
    v_add_f32 v141, v141, v220
    v_add_f32 v142, v142, v220
    v_add_f32 v143, v143, v220
    s_waitcnt lgkmcnt(0)
    v_exp_f32 v28, v112 clamp
    v_mfma_f32_16x16x32_bf16 v[144:147], a[128:131], v[48:51], v[208:211]
    v_exp_f32 v29, v113 clamp
    v_mfma_f32_16x16x32_bf16 v[144:147], a[132:135], v[52:55], v[144:147]
    v_exp_f32 v30, v114 clamp
    v_mfma_f32_16x16x32_bf16 v[144:147], a[136:139], v[56:59], v[144:147]
    v_perm_b32 v176, v29, v28, s3
    v_exp_f32 v31, v115 clamp
    v_mfma_f32_16x16x32_bf16 v[144:147], a[140:143], v[60:63], v[144:147]
    v_exp_f32 v32, v116 clamp
    v_mfma_f32_16x16x32_bf16 v[148:151], a[156:159], v[60:63], v[208:211]
    v_perm_b32 v177, v31, v30, s3
    v_exp_f32 v33, v117 clamp
    v_mfma_f32_16x16x32_bf16 v[148:151], a[152:155], v[56:59], v[148:151]
    v_exp_f32 v34, v118 clamp
    v_mfma_f32_16x16x32_bf16 v[148:151], a[148:151], v[52:55], v[148:151]
    v_perm_b32 v178, v33, v32, s3
    v_exp_f32 v35, v119 clamp
    v_mfma_f32_16x16x32_bf16 v[148:151], a[144:147], v[48:51], v[148:151]
    v_exp_f32 v28, v120 clamp
    v_mfma_f32_16x16x32_bf16 v[156:159], a[144:147], v[64:67], v[212:215]
    v_perm_b32 v179, v35, v34, s3
    v_exp_f32 v29, v121 clamp
    v_mfma_f32_16x16x32_bf16 v[156:159], a[148:151], v[68:71], v[156:159]
    v_mfma_f32_16x16x32_bf16 v[156:159], a[152:155], v[72:75], v[156:159]
    v_exp_f32 v30, v122 clamp
    v_exp_f32 v31, v123 clamp
    v_mfma_f32_16x16x32_bf16 v[156:159], a[156:159], v[76:79], v[156:159]
    v_perm_b32 v180, v29, v28, s3
    v_exp_f32 v32, v124 clamp
    v_mfma_f32_16x16x32_bf16 v[152:155], a[140:143], v[76:79], v[212:215]
    v_exp_f32 v33, v125 clamp
    v_perm_b32 v181, v31, v30, s3
    v_mfma_f32_16x16x32_bf16 v[152:155], a[136:139], v[72:75], v[152:155]
    v_exp_f32 v34, v126 clamp
    v_exp_f32 v35, v127 clamp
    v_mfma_f32_16x16x32_bf16 v[152:155], a[132:135], v[68:71], v[152:155]
    v_perm_b32 v182, v33, v32, s3
    v_perm_b32 v183, v35, v34, s3
    v_exp_f32 v28, v128 clamp
    v_mfma_f32_16x16x32_bf16 v[152:155], a[128:131], v[64:67], v[152:155]
    v_exp_f32 v29, v129 clamp
    s_waitcnt vmcnt(8) lgkmcnt(0)
    v_exp_f32 v30, v130 clamp
    v_smfmac_f32_16x16x64_bf16 v[224:227], v[24:27], v[176:183], v250
    s_barrier
    v_mfma_f32_16x16x32_bf16 v[160:163], a[128:131], v[80:83], v[216:219]
    ds_read_b128 a[224:227], v4 offset:32768
    v_perm_b32 v184, v29, v28, s3
    s_add_u32 m0, s37, 16384
    v_exp_f32 v31, v131 clamp
    v_mfma_f32_16x16x32_bf16 v[160:163], a[132:135], v[84:87], v[160:163]
    ds_read_b128 a[228:231], v5 offset:32768
    v_perm_b32 v185, v31, v30, s3
    v_exp_f32 v32, v132 clamp
    v_exp_f32 v33, v133 clamp
    v_mfma_f32_16x16x32_bf16 v[160:163], a[136:139], v[88:91], v[160:163]
    ds_read_b128 a[232:235], v6 offset:32768
    v_perm_b32 v186, v33, v32, s3
    v_mfma_f32_16x16x32_bf16 v[160:163], a[140:143], v[92:95], v[160:163]
    v_exp_f32 v34, v134 clamp
    v_exp_f32 v35, v135 clamp
    v_mfma_f32_16x16x32_bf16 v[164:167], a[156:159], v[92:95], v[216:219]
    ds_read_b128 a[236:239], v7 offset:32768
    v_perm_b32 v187, v35, v34, s3
    v_exp_f32 v28, v136 clamp
    v_exp_f32 v29, v137 clamp
    v_mfma_f32_16x16x32_bf16 v[164:167], a[152:155], v[88:91], v[164:167]
    ds_read_b128 a[240:243], v4 offset:36864
    v_perm_b32 v188, v29, v28, s3
    v_mfma_f32_16x16x32_bf16 v[164:167], a[148:151], v[84:87], v[164:167]
    v_exp_f32 v30, v138 clamp
    v_exp_f32 v31, v139 clamp
    v_mfma_f32_16x16x32_bf16 v[164:167], a[144:147], v[80:83], v[164:167]
    ds_read_b128 a[244:247], v5 offset:36864
    v_perm_b32 v189, v31, v30, s3
    v_exp_f32 v32, v140 clamp
    v_exp_f32 v33, v141 clamp
    v_mfma_f32_16x16x32_bf16 v[172:175], a[144:147], v[96:99], v[220:223]
    ds_read_b128 a[248:251], v6 offset:36864
    v_perm_b32 v190, v33, v32, s3
    v_mfma_f32_16x16x32_bf16 v[172:175], a[148:151], v[100:103], v[172:175]
    v_exp_f32 v34, v142 clamp
    v_exp_f32 v35, v143 clamp
    v_mfma_f32_16x16x32_bf16 v[172:175], a[152:155], v[104:107], v[172:175]
    ds_read_b128 a[252:255], v7 offset:36864
    v_perm_b32 v191, v35, v34, s3
    s_nop 1
    v_smfmac_f32_16x16x64_bf16 v[228:231], v[24:27], v[184:191], v250
    buffer_load_dwordx4 v18, s[20:23], s44 offen offset:0 nt lds
    v_mfma_f32_16x16x32_bf16 v[172:175], a[156:159], v[108:111], v[172:175]
    buffer_load_dwordx4 v19, s[20:23], s44 offen offset:1024 nt lds
    v_mfma_f32_16x16x32_bf16 v[168:171], a[140:143], v[108:111], v[220:223]
    buffer_load_dwordx4 v18, s[20:23], s44 offen offset:2048 nt lds
    v_mfma_f32_16x16x32_bf16 v[168:171], a[136:139], v[104:107], v[168:171]
    v_mfma_f32_16x16x32_bf16 v[168:171], a[132:135], v[100:103], v[168:171]
    buffer_load_dwordx4 v19, s[20:23], s44 offen offset:3072 nt lds
    v_mfma_f32_16x16x32_bf16 v[168:171], a[128:131], v[96:99], v[168:171]
    s_add_u32 s44, s44, 16384
    s_waitcnt lgkmcnt(0)
    v_exp_f32 v28, v144 clamp
    v_mfma_f32_16x16x32_bf16 v[112:115], a[224:227], v[48:51], v[208:211]
    ds_read_b128 a[128:131], v4 offset:40960
    ds_read_b128 a[132:135], v5 offset:40960
    v_exp_f32 v29, v145 clamp
    v_mfma_f32_16x16x32_bf16 v[112:115], a[228:231], v[52:55], v[112:115]
    ds_read_b128 a[136:139], v6 offset:40960
    v_perm_b32 v192, v29, v28, s3
    v_exp_f32 v30, v146 clamp
    v_mfma_f32_16x16x32_bf16 v[112:115], a[232:235], v[56:59], v[112:115]
    ds_read_b128 a[140:143], v7 offset:40960
    ds_read_b128 a[144:147], v4 offset:45056
    v_exp_f32 v31, v147 clamp
    v_mfma_f32_16x16x32_bf16 v[112:115], a[236:239], v[60:63], v[112:115]
    ds_read_b128 a[148:151], v5 offset:45056
    v_perm_b32 v193, v31, v30, s3
    v_exp_f32 v32, v148 clamp
    v_mfma_f32_16x16x32_bf16 v[116:119], a[252:255], v[60:63], v[208:211]
    ds_read_b128 a[152:155], v6 offset:45056
    ds_read_b128 a[156:159], v7 offset:45056
    v_mfma_f32_16x16x32_bf16 v[116:119], a[248:251], v[56:59], v[116:119]
    v_exp_f32 v33, v149 clamp
    s_nop 0
    v_perm_b32 v194, v33, v32, s3
    v_mfma_f32_16x16x32_bf16 v[116:119], a[244:247], v[52:55], v[116:119]
    v_exp_f32 v34, v150 clamp
    v_exp_f32 v35, v151 clamp
    v_mfma_f32_16x16x32_bf16 v[116:119], a[240:243], v[48:51], v[116:119]
    v_perm_b32 v195, v35, v34, s3
    v_exp_f32 v28, v152 clamp
    v_mfma_f32_16x16x32_bf16 v[124:127], a[240:243], v[64:67], v[212:215]
    s_waitcnt vmcnt(8) lgkmcnt(0)
    v_exp_f32 v29, v153 clamp
    s_barrier
    v_mfma_f32_16x16x32_bf16 v[124:127], a[244:247], v[68:71], v[124:127]
    ds_read_b64_tr_b16 a[160:161], v8 offset:49152
    v_perm_b32 v196, v29, v28, s3
    s_add_u32 m0, s37, 32768
    v_exp_f32 v30, v154 clamp
    v_exp_f32 v31, v155 clamp
    v_mfma_f32_16x16x32_bf16 v[124:127], a[248:251], v[72:75], v[124:127]
    buffer_load_dwordx4 v16, s[16:19], s36 offen offset:0 nt lds
    v_mfma_f32_16x16x32_bf16 v[124:127], a[252:255], v[76:79], v[124:127]
    ds_read_b64_tr_b16 a[162:163], v8 offset:53248
    v_perm_b32 v197, v31, v30, s3
    v_exp_f32 v32, v156 clamp
    v_exp_f32 v33, v157 clamp
    v_mfma_f32_16x16x32_bf16 v[120:123], a[236:239], v[76:79], v[212:215]
    ds_read_b64_tr_b16 a[192:193], v8 offset:57344
    v_perm_b32 v198, v33, v32, s3
    v_mfma_f32_16x16x32_bf16 v[120:123], a[232:235], v[72:75], v[120:123]
    v_exp_f32 v34, v158 clamp
    v_exp_f32 v35, v159 clamp
    v_mfma_f32_16x16x32_bf16 v[120:123], a[228:231], v[68:71], v[120:123]
    ds_read_b64_tr_b16 a[194:195], v8 offset:61440
    v_perm_b32 v199, v35, v34, s3
    v_exp_f32 v28, v160 clamp
    v_mfma_f32_16x16x32_bf16 v[120:123], a[224:227], v[64:67], v[120:123]
    v_exp_f32 v29, v161 clamp
    v_exp_f32 v30, v162 clamp
    v_smfmac_f32_16x16x64_bf16 v[224:227], v[24:27], v[192:199], v250
    ds_read_b64_tr_b16 a[164:165], v9 offset:49152
    v_perm_b32 v200, v29, v28, s3
    v_exp_f32 v31, v163 clamp
    v_mfma_f32_16x16x32_bf16 v[128:131], a[224:227], v[80:83], v[216:219]
    buffer_load_dwordx4 v17, s[16:19], s36 offen offset:1024 nt lds
    v_mfma_f32_16x16x32_bf16 v[128:131], a[228:231], v[84:87], v[128:131]
    ds_read_b64_tr_b16 a[166:167], v9 offset:53248
    v_perm_b32 v201, v31, v30, s3
    v_exp_f32 v32, v164 clamp
    v_exp_f32 v33, v165 clamp
    v_mfma_f32_16x16x32_bf16 v[128:131], a[232:235], v[88:91], v[128:131]
    ds_read_b64_tr_b16 a[196:197], v9 offset:57344
    v_perm_b32 v202, v33, v32, s3
    v_mfma_f32_16x16x32_bf16 v[128:131], a[236:239], v[92:95], v[128:131]
    v_exp_f32 v34, v166 clamp
    v_exp_f32 v35, v167 clamp
    v_mfma_f32_16x16x32_bf16 v[132:135], a[252:255], v[92:95], v[216:219]
    ds_read_b64_tr_b16 a[198:199], v9 offset:61440
    v_perm_b32 v203, v35, v34, s3
    v_exp_f32 v28, v168 clamp
    v_exp_f32 v29, v169 clamp
    v_mfma_f32_16x16x32_bf16 v[132:135], a[248:251], v[88:91], v[132:135]
    ds_read_b64_tr_b16 a[168:169], v10 offset:49152
    v_perm_b32 v204, v29, v28, s3
    v_exp_f32 v30, v170 clamp
    v_mfma_f32_16x16x32_bf16 v[132:135], a[244:247], v[84:87], v[132:135]
    buffer_load_dwordx4 v41, s[16:19], s36 offen offset:2048 nt lds
    v_exp_f32 v31, v171 clamp
    v_mfma_f32_16x16x32_bf16 v[132:135], a[240:243], v[80:83], v[132:135]
    ds_read_b64_tr_b16 a[170:171], v10 offset:53248
    v_perm_b32 v205, v31, v30, s3
    v_mfma_f32_16x16x32_bf16 v[140:143], a[240:243], v[96:99], v[220:223]
    v_exp_f32 v32, v172 clamp
    v_exp_f32 v33, v173 clamp
    v_mfma_f32_16x16x32_bf16 v[140:143], a[244:247], v[100:103], v[140:143]
    ds_read_b64_tr_b16 a[200:201], v10 offset:57344
    v_perm_b32 v206, v33, v32, s3
    v_exp_f32 v34, v174 clamp
    v_mfma_f32_16x16x32_bf16 v[140:143], a[248:251], v[104:107], v[140:143]
    ds_read_b64_tr_b16 a[202:203], v10 offset:61440
    ds_read_b64_tr_b16 a[172:173], v11 offset:49152
    v_exp_f32 v35, v175 clamp
    v_mfma_f32_16x16x32_bf16 v[140:143], a[252:255], v[108:111], v[140:143]
    ds_read_b64_tr_b16 a[174:175], v11 offset:53248
    v_perm_b32 v207, v35, v34, s3
    buffer_load_dwordx4 v42, s[16:19], s36 offen offset:3072 nt lds
    s_nop 0
    v_smfmac_f32_16x16x64_bf16 v[228:231], v[24:27], v[200:207], v250
    v_max3_f32 v36, v224, v225, v226
    v_max_f32 v36, v36, v227
    v_mfma_f32_16x16x32_bf16 v[136:139], a[236:239], v[108:111], v[220:223]
    ds_read_b64_tr_b16 a[204:205], v11 offset:57344
    ds_read_b64_tr_b16 a[206:207], v11 offset:61440
    s_add_u32 s36, s36, 16384
    v_mfma_f32_16x16x32_bf16 v[136:139], a[232:235], v[104:107], v[136:139]
    s_nop 0
    v_max3_f32 v36, v36, v228, v229
    v_max3_f32 v36, v36, v230, v231
    v_mfma_f32_16x16x32_bf16 v[136:139], a[228:231], v[100:103], v[136:139]
    v_cmp_lt_f32 vcc, s39, v36
    v_mfma_f32_16x16x32_bf16 v[136:139], a[224:227], v[96:99], v[136:139]
    s_cbranch_vccnz L_rare_p1
L_back_p1:
    v_mfma_f32_16x16x32_bf16 v[144:147], a[128:131], v[48:51], v[208:211]
    v_exp_f32 v28, v112 clamp
    v_mfma_f32_16x16x32_bf16 v[144:147], a[132:135], v[52:55], v[144:147]
    ds_read_b64_tr_b16 a[176:177], v12 offset:49152
    ds_read_b64_tr_b16 a[178:179], v12 offset:53248
    v_mfma_f32_16x16x32_bf16 v[144:147], a[136:139], v[56:59], v[144:147]
    v_exp_f32 v29, v113 clamp
    v_mfma_f32_16x16x32_bf16 v[144:147], a[140:143], v[60:63], v[144:147]
    ds_read_b64_tr_b16 a[208:209], v12 offset:57344
    ds_read_b64_tr_b16 a[210:211], v12 offset:61440
    v_mfma_f32_16x16x32_bf16 v[148:151], a[156:159], v[60:63], v[208:211]
    v_exp_f32 v30, v114 clamp
    v_mfma_f32_16x16x32_bf16 v[148:151], a[152:155], v[56:59], v[148:151]
    ds_read_b64_tr_b16 a[180:181], v13 offset:49152
    v_perm_b32 v232, v29, v28, s3
    v_mfma_f32_16x16x32_bf16 v[148:151], a[148:151], v[52:55], v[148:151]
    v_exp_f32 v31, v115 clamp
    v_mfma_f32_16x16x32_bf16 v[148:151], a[144:147], v[48:51], v[148:151]
    ds_read_b64_tr_b16 a[182:183], v13 offset:53248
    ds_read_b64_tr_b16 a[212:213], v13 offset:57344
    v_mfma_f32_16x16x32_bf16 v[156:159], a[144:147], v[64:67], v[212:215]
    v_exp_f32 v32, v116 clamp
    v_mfma_f32_16x16x32_bf16 v[156:159], a[148:151], v[68:71], v[156:159]
    ds_read_b64_tr_b16 a[214:215], v13 offset:61440
    v_perm_b32 v233, v31, v30, s3
    v_mfma_f32_16x16x32_bf16 v[156:159], a[152:155], v[72:75], v[156:159]
    v_exp_f32 v33, v117 clamp
    v_mfma_f32_16x16x32_bf16 v[156:159], a[156:159], v[76:79], v[156:159]
    ds_read_b64_tr_b16 a[184:185], v14 offset:49152
    ds_read_b64_tr_b16 a[186:187], v14 offset:53248
    v_mfma_f32_16x16x32_bf16 v[152:155], a[140:143], v[76:79], v[212:215]
    v_exp_f32 v34, v118 clamp
    v_mfma_f32_16x16x32_bf16 v[152:155], a[136:139], v[72:75], v[152:155]
    ds_read_b64_tr_b16 a[216:217], v14 offset:57344
    v_perm_b32 v234, v33, v32, s3
    v_mfma_f32_16x16x32_bf16 v[152:155], a[132:135], v[68:71], v[152:155]
    s_cmp_gt_u32 s38, 4
    v_exp_f32 v35, v119 clamp
    v_mfma_f32_16x16x32_bf16 v[152:155], a[128:131], v[64:67], v[152:155]
    ds_read_b64_tr_b16 a[218:219], v14 offset:61440
    ds_read_b64_tr_b16 a[188:189], v15 offset:49152
    v_mfma_f32_16x16x32_bf16 v[160:163], a[128:131], v[80:83], v[216:219]
    s_cselect_b32 s42, 1, 0
    v_exp_f32 v28, v120 clamp
    v_mfma_f32_16x16x32_bf16 v[160:163], a[132:135], v[84:87], v[160:163]
    ds_read_b64_tr_b16 a[190:191], v15 offset:53248
    v_perm_b32 v235, v35, v34, s3
    v_mfma_f32_16x16x32_bf16 v[160:163], a[136:139], v[88:91], v[160:163]
    s_mov_b32 m0, s51
    v_exp_f32 v29, v121 clamp
    v_mfma_f32_16x16x32_bf16 v[160:163], a[140:143], v[92:95], v[160:163]
    ds_read_b64_tr_b16 a[220:221], v15 offset:57344
    ds_read_b64_tr_b16 a[222:223], v15 offset:61440
    v_mfma_f32_16x16x32_bf16 v[164:167], a[156:159], v[92:95], v[216:219]
    s_lshl_b32 s43, s49, 15
    v_exp_f32 v30, v122 clamp
    v_mfma_f32_16x16x32_bf16 v[164:167], a[152:155], v[88:91], v[164:167]
    s_add_u32 s49, s49, s42
    v_exp_f32 v31, v123 clamp
    v_mfma_f32_16x16x32_bf16 v[164:167], a[148:151], v[84:87], v[164:167]
    buffer_load_dwordx4 v44, s[96:99], s43 offen offset:0  lds
    v_perm_b32 v236, v29, v28, s3
    v_mfma_f32_16x16x32_bf16 v[164:167], a[144:147], v[80:83], v[164:167]
    s_lshl_b32 s42, s42, 13
    v_exp_f32 v32, v124 clamp
    v_mfma_f32_16x16x32_bf16 v[172:175], a[144:147], v[96:99], v[220:223]
    s_and_b32 s49, s49, 15
    v_exp_f32 v33, v125 clamp
    v_mfma_f32_16x16x32_bf16 v[172:175], a[148:151], v[100:103], v[172:175]
    buffer_load_dwordx4 v45, s[96:99], s43 offen offset:1024  lds
    v_perm_b32 v237, v31, v30, s3
    v_mfma_f32_16x16x32_bf16 v[172:175], a[152:155], v[104:107], v[172:175]
    s_add_u32 s51, s51, s42
    v_exp_f32 v34, v126 clamp
    v_mfma_f32_16x16x32_bf16 v[172:175], a[156:159], v[108:111], v[172:175]
    v_exp_f32 v35, v127 clamp
    v_mfma_f32_16x16x32_bf16 v[168:171], a[140:143], v[108:111], v[220:223]
    v_perm_b32 v238, v33, v32, s3
    v_perm_b32 v239, v35, v34, s3
    v_mfma_f32_16x16x32_bf16 v[168:171], a[136:139], v[104:107], v[168:171]
    v_exp_f32 v28, v128 clamp
    v_mfma_f32_16x16x32_bf16 v[168:171], a[132:135], v[100:103], v[168:171]
    v_exp_f32 v29, v129 clamp
    v_mfma_f32_16x16x32_bf16 v[168:171], a[128:131], v[96:99], v[168:171]
    s_waitcnt vmcnt(10) lgkmcnt(0)
    v_exp_f32 v30, v130 clamp
    v_smfmac_f32_16x16x64_bf16 v[224:227], v[24:27], v[232:239], v250
    s_barrier
    v_mfma_f32_16x16x32_bf16 a[0:3], a[160:163], v[176:179], 0
    ds_read_b128 a[224:227], v4 offset:0
    v_perm_b32 v240, v29, v28, s3
    v_mfma_f32_16x16x32_bf16 a[0:3], a[192:195], v[192:195], a[0:3]
    s_add_u32 m0, s37, 49152
    v_exp_f32 v31, v131 clamp
    v_mfma_f32_16x16x32_bf16 a[4:7], a[196:199], v[192:195], 0
    ds_read_b128 a[228:231], v5 offset:0
    v_perm_b32 v241, v31, v30, s3
    v_mfma_f32_16x16x32_bf16 a[4:7], a[164:167], v[176:179], a[4:7]
    v_exp_f32 v32, v132 clamp
    v_mfma_f32_16x16x32_bf16 a[8:11], a[168:171], v[176:179], 0
    v_exp_f32 v33, v133 clamp
    v_mfma_f32_16x16x32_bf16 a[8:11], a[200:203], v[192:195], a[8:11]
    ds_read_b128 a[232:235], v6 offset:0
    v_perm_b32 v242, v33, v32, s3
    v_mfma_f32_16x16x32_bf16 a[12:15], a[204:207], v[192:195], 0
    v_exp_f32 v34, v134 clamp
    v_mfma_f32_16x16x32_bf16 a[12:15], a[172:175], v[176:179], a[12:15]
    v_exp_f32 v35, v135 clamp
    v_mfma_f32_16x16x32_bf16 a[16:19], a[176:179], v[176:179], 0
    ds_read_b128 a[236:239], v7 offset:0
    v_perm_b32 v243, v35, v34, s3
    v_mfma_f32_16x16x32_bf16 a[16:19], a[208:211], v[192:195], a[16:19]
    v_exp_f32 v28, v136 clamp
    v_mfma_f32_16x16x32_bf16 a[20:23], a[212:215], v[192:195], 0
    v_exp_f32 v29, v137 clamp
    v_mfma_f32_16x16x32_bf16 a[20:23], a[180:183], v[176:179], a[20:23]
    ds_read_b128 a[240:243], v4 offset:4096
    v_perm_b32 v244, v29, v28, s3
    v_mfma_f32_16x16x32_bf16 a[24:27], a[184:187], v[176:179], 0
    v_exp_f32 v30, v138 clamp
    v_mfma_f32_16x16x32_bf16 a[24:27], a[216:219], v[192:195], a[24:27]
    v_exp_f32 v31, v139 clamp
    v_mfma_f32_16x16x32_bf16 a[28:31], a[220:223], v[192:195], 0
    ds_read_b128 a[244:247], v5 offset:4096
    v_perm_b32 v245, v31, v30, s3
    v_mfma_f32_16x16x32_bf16 a[28:31], a[188:191], v[176:179], a[28:31]
    v_exp_f32 v32, v140 clamp
    v_mfma_f32_16x16x32_bf16 a[32:35], a[160:163], v[180:183], 0
    v_exp_f32 v33, v141 clamp
    v_mfma_f32_16x16x32_bf16 a[32:35], a[192:195], v[196:199], a[32:35]
    ds_read_b128 a[248:251], v6 offset:4096
    v_perm_b32 v246, v33, v32, s3
    v_mfma_f32_16x16x32_bf16 a[36:39], a[196:199], v[196:199], 0
    v_exp_f32 v34, v142 clamp
    v_mfma_f32_16x16x32_bf16 a[36:39], a[164:167], v[180:183], a[36:39]
    v_exp_f32 v35, v143 clamp
    v_mfma_f32_16x16x32_bf16 a[40:43], a[168:171], v[180:183], 0
    ds_read_b128 a[252:255], v7 offset:4096
    v_perm_b32 v247, v35, v34, s3
    v_mfma_f32_16x16x32_bf16 a[40:43], a[200:203], v[196:199], a[40:43]
    v_max3_f32 v36, v224, v225, v226
    v_max_f32 v36, v36, v227
    v_smfmac_f32_16x16x64_bf16 v[228:231], v[24:27], v[240:247], v250
    buffer_load_dwordx4 v18, s[20:23], s44 offen offset:0 nt lds
    v_mfma_f32_16x16x32_bf16 a[44:47], a[204:207], v[196:199], 0
    v_mfma_f32_16x16x32_bf16 a[44:47], a[172:175], v[180:183], a[44:47]
    s_branch L_over3
.p2align 12
L_stub3:
    s_setpc_b64 s[46:47]
L_over3:
    buffer_load_dwordx4 v19, s[20:23], s44 offen offset:1024 nt lds
    v_mfma_f32_16x16x32_bf16 a[48:51], a[176:179], v[180:183], 0
    v_mfma_f32_16x16x32_bf16 a[48:51], a[208:211], v[196:199], a[48:51]
    buffer_load_dwordx4 v18, s[20:23], s44 offen offset:2048 nt lds
    v_mfma_f32_16x16x32_bf16 a[52:55], a[212:215], v[196:199], 0
    v_mfma_f32_16x16x32_bf16 a[52:55], a[180:183], v[180:183], a[52:55]
    v_max3_f32 v36, v36, v228, v229
    v_max3_f32 v36, v36, v230, v231
    v_mfma_f32_16x16x32_bf16 a[56:59], a[184:187], v[180:183], 0
    v_cmp_lt_f32 vcc, s39, v36
    v_mfma_f32_16x16x32_bf16 a[56:59], a[216:219], v[196:199], a[56:59]
    buffer_load_dwordx4 v19, s[20:23], s44 offen offset:3072 nt lds
    v_mfma_f32_16x16x32_bf16 a[60:63], a[220:223], v[196:199], 0
    s_add_u32 s44, s44, 16384
    v_mfma_f32_16x16x32_bf16 a[60:63], a[188:191], v[180:183], a[60:63]
    s_cbranch_vccnz L_rare_p2
L_back_p2:
    v_mfma_f32_16x16x32_bf16 a[64:67], a[160:163], v[184:187], 0
    v_exp_f32 v28, v144 clamp
    v_mfma_f32_16x16x32_bf16 a[64:67], a[192:195], v[200:203], a[64:67]
    ds_read_b128 a[128:131], v4 offset:8192
    ds_read_b128 a[132:135], v5 offset:8192
    v_mfma_f32_16x16x32_bf16 a[68:71], a[196:199], v[200:203], 0
    v_exp_f32 v29, v145 clamp
    v_mfma_f32_16x16x32_bf16 a[68:71], a[164:167], v[184:187], a[68:71]
    ds_read_b128 a[136:139], v6 offset:8192
    v_perm_b32 v192, v29, v28, s3
    v_mfma_f32_16x16x32_bf16 a[72:75], a[168:171], v[184:187], 0
    v_exp_f32 v30, v146 clamp
    v_mfma_f32_16x16x32_bf16 a[72:75], a[200:203], v[200:203], a[72:75]
    ds_read_b128 a[140:143], v7 offset:8192
    ds_read_b128 a[144:147], v4 offset:12288
    v_mfma_f32_16x16x32_bf16 a[76:79], a[204:207], v[200:203], 0
    v_exp_f32 v31, v147 clamp
    v_mfma_f32_16x16x32_bf16 a[76:79], a[172:175], v[184:187], a[76:79]
    ds_read_b128 a[148:151], v5 offset:12288
    v_perm_b32 v193, v31, v30, s3
    v_mfma_f32_16x16x32_bf16 a[80:83], a[176:179], v[184:187], 0
    s_cmp_le_u32 s38, 7
    v_exp_f32 v32, v148 clamp
    v_mfma_f32_16x16x32_bf16 a[80:83], a[208:211], v[200:203], a[80:83]
    ds_read_b128 a[152:155], v6 offset:12288
    ds_read_b128 a[156:159], v7 offset:12288
    v_mfma_f32_16x16x32_bf16 a[84:87], a[212:215], v[200:203], 0
    s_cselect_b32 s34, 16384, 0
    v_exp_f32 v33, v149 clamp
    v_mfma_f32_16x16x32_bf16 a[84:87], a[180:183], v[184:187], a[84:87]
    buffer_load_dword v2, v47, s[32:35], s41 offen
    v_perm_b32 v194, v33, v32, s3
    v_mfma_f32_16x16x32_bf16 a[88:91], a[184:187], v[184:187], 0
    s_lshr_b32 s42, s34, 3
    v_exp_f32 v34, v150 clamp
    v_mfma_f32_16x16x32_bf16 a[88:91], a[216:219], v[200:203], a[88:91]
    s_add_u32 s41, s41, s42
    v_exp_f32 v35, v151 clamp
    v_mfma_f32_16x16x32_bf16 a[92:95], a[220:223], v[200:203], 0
    v_perm_b32 v195, v35, v34, s3
    v_mfma_f32_16x16x32_bf16 a[92:95], a[188:191], v[184:187], a[92:95]
    v_exp_f32 v28, v152 clamp
    v_mfma_f32_16x16x32_bf16 a[96:99], a[160:163], v[188:191], 0
    s_waitcnt vmcnt(11) lgkmcnt(0)
    v_exp_f32 v29, v153 clamp
    v_mfma_f32_16x16x32_bf16 a[96:99], a[192:195], v[204:207], a[96:99]
    s_barrier
    v_mfma_f32_16x16x32_bf16 a[100:103], a[196:199], v[204:207], 0
    ds_read_b64_tr_b16 a[160:161], v8 offset:16384
    v_perm_b32 v196, v29, v28, s3
    v_mfma_f32_16x16x32_bf16 a[100:103], a[164:167], v[188:191], a[100:103]
    s_add_u32 m0, s37, 0
    v_exp_f32 v30, v154 clamp
    v_mfma_f32_16x16x32_bf16 a[104:107], a[168:171], v[188:191], 0
    v_exp_f32 v31, v155 clamp
    v_mfma_f32_16x16x32_bf16 a[104:107], a[200:203], v[204:207], a[104:107]
    buffer_load_dwordx4 v16, s[16:19], s36 offen offset:0 nt lds
    v_mfma_f32_16x16x32_bf16 a[108:111], a[204:207], v[204:207], 0
    ds_read_b64_tr_b16 a[162:163], v8 offset:20480
    v_perm_b32 v197, v31, v30, s3
    v_mfma_f32_16x16x32_bf16 a[108:111], a[172:175], v[188:191], a[108:111]
    v_exp_f32 v32, v156 clamp
    v_mfma_f32_16x16x32_bf16 a[112:115], a[176:179], v[188:191], 0
    v_exp_f32 v33, v157 clamp
    v_mfma_f32_16x16x32_bf16 a[112:115], a[208:211], v[204:207], a[112:115]
    ds_read_b64_tr_b16 a[192:193], v8 offset:24576
    v_perm_b32 v198, v33, v32, s3
    v_mfma_f32_16x16x32_bf16 a[116:119], a[212:215], v[204:207], 0
    v_exp_f32 v34, v158 clamp
    v_mfma_f32_16x16x32_bf16 a[116:119], a[180:183], v[188:191], a[116:119]
    v_exp_f32 v35, v159 clamp
    v_mfma_f32_16x16x32_bf16 a[120:123], a[184:187], v[188:191], 0
    ds_read_b64_tr_b16 a[194:195], v8 offset:28672
    v_perm_b32 v199, v35, v34, s3
    v_mfma_f32_16x16x32_bf16 a[120:123], a[216:219], v[204:207], a[120:123]
    v_exp_f32 v28, v160 clamp
    v_mfma_f32_16x16x32_bf16 a[124:127], a[220:223], v[204:207], 0
    v_exp_f32 v29, v161 clamp
    v_mfma_f32_16x16x32_bf16 a[124:127], a[188:191], v[188:191], a[124:127]
    v_exp_f32 v30, v162 clamp
    v_smfmac_f32_16x16x64_bf16 v[224:227], v[24:27], v[192:199], v250
    ds_read_b64_tr_b16 a[164:165], v9 offset:16384
    v_perm_b32 v200, v29, v28, s3
    v_mfma_f32_16x16x32_bf16 v[112:115], a[224:227], v[48:51], v[208:211]
    v_exp_f32 v31, v163 clamp
    v_mfma_f32_16x16x32_bf16 v[112:115], a[228:231], v[52:55], v[112:115]
    buffer_load_dwordx4 v17, s[16:19], s36 offen offset:1024 nt lds
    v_mfma_f32_16x16x32_bf16 v[112:115], a[232:235], v[56:59], v[112:115]
    ds_read_b64_tr_b16 a[166:167], v9 offset:20480
    v_perm_b32 v201, v31, v30, s3
    v_mfma_f32_16x16x32_bf16 v[112:115], a[236:239], v[60:63], v[112:115]
    v_exp_f32 v32, v164 clamp
    v_mfma_f32_16x16x32_bf16 v[116:119], a[252:255], v[60:63], v[208:211]
    v_exp_f32 v33, v165 clamp
    v_mfma_f32_16x16x32_bf16 v[116:119], a[248:251], v[56:59], v[116:119]
    ds_read_b64_tr_b16 a[196:197], v9 offset:24576
    v_perm_b32 v202, v33, v32, s3
    v_mfma_f32_16x16x32_bf16 v[116:119], a[244:247], v[52:55], v[116:119]
    v_exp_f32 v34, v166 clamp
    v_mfma_f32_16x16x32_bf16 v[116:119], a[240:243], v[48:51], v[116:119]
    v_exp_f32 v35, v167 clamp
    v_mfma_f32_16x16x32_bf16 v[124:127], a[240:243], v[64:67], v[212:215]
    ds_read_b64_tr_b16 a[198:199], v9 offset:28672
    v_perm_b32 v203, v35, v34, s3
    v_mfma_f32_16x16x32_bf16 v[124:127], a[244:247], v[68:71], v[124:127]
    v_exp_f32 v28, v168 clamp
    v_mfma_f32_16x16x32_bf16 v[124:127], a[248:251], v[72:75], v[124:127]
    v_exp_f32 v29, v169 clamp
    v_mfma_f32_16x16x32_bf16 v[124:127], a[252:255], v[76:79], v[124:127]
    ds_read_b64_tr_b16 a[168:169], v10 offset:16384
    v_perm_b32 v204, v29, v28, s3
    v_mfma_f32_16x16x32_bf16 v[120:123], a[236:239], v[76:79], v[212:215]
    v_exp_f32 v30, v170 clamp
    v_mfma_f32_16x16x32_bf16 v[120:123], a[232:235], v[72:75], v[120:123]
    buffer_load_dwordx4 v41, s[16:19], s36 offen offset:2048 nt lds
    v_mfma_f32_16x16x32_bf16 v[120:123], a[228:231], v[68:71], v[120:123]
    v_exp_f32 v31, v171 clamp
    v_mfma_f32_16x16x32_bf16 v[120:123], a[224:227], v[64:67], v[120:123]
    ds_read_b64_tr_b16 a[170:171], v10 offset:20480
    v_perm_b32 v205, v31, v30, s3
    v_mfma_f32_16x16x32_bf16 v[128:131], a[224:227], v[80:83], v[216:219]
    v_exp_f32 v32, v172 clamp
    v_mfma_f32_16x16x32_bf16 v[128:131], a[228:231], v[84:87], v[128:131]
    v_exp_f32 v33, v173 clamp
    v_mfma_f32_16x16x32_bf16 v[128:131], a[232:235], v[88:91], v[128:131]
    ds_read_b64_tr_b16 a[200:201], v10 offset:24576
    v_perm_b32 v206, v33, v32, s3
    v_mfma_f32_16x16x32_bf16 v[128:131], a[236:239], v[92:95], v[128:131]
    v_exp_f32 v34, v174 clamp
    v_mfma_f32_16x16x32_bf16 v[132:135], a[252:255], v[92:95], v[216:219]
    ds_read_b64_tr_b16 a[202:203], v10 offset:28672
    ds_read_b64_tr_b16 a[172:173], v11 offset:16384
    v_mfma_f32_16x16x32_bf16 v[132:135], a[248:251], v[88:91], v[132:135]
    v_exp_f32 v35, v175 clamp
    v_mfma_f32_16x16x32_bf16 v[132:135], a[244:247], v[84:87], v[132:135]
    ds_read_b64_tr_b16 a[174:175], v11 offset:20480
    v_perm_b32 v207, v35, v34, s3
    v_mfma_f32_16x16x32_bf16 v[132:135], a[240:243], v[80:83], v[132:135]
    buffer_load_dwordx4 v42, s[16:19], s36 offen offset:3072 nt lds
    v_smfmac_f32_16x16x64_bf16 v[228:231], v[24:27], v[200:207], v250
    v_max3_f32 v36, v224, v225, v226
    v_max_f32 v36, v36, v227
    v_mfma_f32_16x16x32_bf16 v[140:143], a[240:243], v[96:99], v[220:223]
    ds_read_b64_tr_b16 a[204:205], v11 offset:24576
    ds_read_b64_tr_b16 a[206:207], v11 offset:28672
    v_mfma_f32_16x16x32_bf16 v[140:143], a[244:247], v[100:103], v[140:143]
    s_add_u32 s36, s36, 16384
    v_mfma_f32_16x16x32_bf16 v[140:143], a[248:251], v[104:107], v[140:143]
    s_sub_u32 s38, s38, 1
    v_mfma_f32_16x16x32_bf16 v[140:143], a[252:255], v[108:111], v[140:143]
    v_max3_f32 v36, v36, v228, v229
    v_max3_f32 v36, v36, v230, v231
    v_mfma_f32_16x16x32_bf16 v[136:139], a[236:239], v[108:111], v[220:223]
    v_cmp_lt_f32 vcc, s39, v36
    v_mfma_f32_16x16x32_bf16 v[136:139], a[232:235], v[104:107], v[136:139]
    v_mfma_f32_16x16x32_bf16 v[136:139], a[228:231], v[100:103], v[136:139]
    v_mfma_f32_16x16x32_bf16 v[136:139], a[224:227], v[96:99], v[136:139]
    s_cbranch_vccnz L_rare_p3
L_back_p3:
    s_lshl_b32 s40, s15, 8
    s_add_u32 s40, s40, s2
    s_sub_u32 s40, s40, 64
    s_cmp_ge_u32 s40, 128
    s_cbranch_scc1 L_n2_main_kernel
    s_mov_b64 exec, 1
    v_mov_b32 v1, 1
    v_mov_b32 v3, 0
    global_atomic_add v3, v1, s[100:101] offset:4 sc1
    s_mov_b64 exec, -1
L_n2_main_kernel:
    s_branch L_loop_main_kernel
.p2align 6
L_loop_main_kernel:
    v_mfma_f32_16x16x32_bf16 v[144:147], a[128:131], v[48:51], v[208:211]
    v_exp_f32 v28, v112 clamp
    v_mfma_f32_16x16x32_bf16 v[144:147], a[132:135], v[52:55], v[144:147]
    ds_read_b64_tr_b16 a[176:177], v12 offset:16384
    ds_read_b64_tr_b16 a[178:179], v12 offset:20480
    v_mfma_f32_16x16x32_bf16 v[144:147], a[136:139], v[56:59], v[144:147]
    v_exp_f32 v29, v113 clamp
    v_mfma_f32_16x16x32_bf16 v[144:147], a[140:143], v[60:63], v[144:147]
    ds_read_b64_tr_b16 a[208:209], v12 offset:24576
    ds_read_b64_tr_b16 a[210:211], v12 offset:28672
    v_mfma_f32_16x16x32_bf16 v[148:151], a[156:159], v[60:63], v[208:211]
    v_exp_f32 v30, v114 clamp
    v_mfma_f32_16x16x32_bf16 v[148:151], a[152:155], v[56:59], v[148:151]
    ds_read_b64_tr_b16 a[180:181], v13 offset:16384
    v_perm_b32 v176, v29, v28, s3
    v_mfma_f32_16x16x32_bf16 v[148:151], a[148:151], v[52:55], v[148:151]
    v_exp_f32 v31, v115 clamp
    v_mfma_f32_16x16x32_bf16 v[148:151], a[144:147], v[48:51], v[148:151]
    ds_read_b64_tr_b16 a[182:183], v13 offset:20480
    ds_read_b64_tr_b16 a[212:213], v13 offset:24576
    v_mfma_f32_16x16x32_bf16 v[156:159], a[144:147], v[64:67], v[212:215]
    v_exp_f32 v32, v116 clamp
    v_mfma_f32_16x16x32_bf16 v[156:159], a[148:151], v[68:71], v[156:159]
    ds_read_b64_tr_b16 a[214:215], v13 offset:28672
    v_perm_b32 v177, v31, v30, s3
    v_mfma_f32_16x16x32_bf16 v[156:159], a[152:155], v[72:75], v[156:159]
    v_exp_f32 v33, v117 clamp
    v_mfma_f32_16x16x32_bf16 v[156:159], a[156:159], v[76:79], v[156:159]
    ds_read_b64_tr_b16 a[184:185], v14 offset:16384
    ds_read_b64_tr_b16 a[186:187], v14 offset:20480
    v_mfma_f32_16x16x32_bf16 v[152:155], a[140:143], v[76:79], v[212:215]
    v_exp_f32 v34, v118 clamp
    v_mfma_f32_16x16x32_bf16 v[152:155], a[136:139], v[72:75], v[152:155]
    ds_read_b64_tr_b16 a[216:217], v14 offset:24576
    v_perm_b32 v178, v33, v32, s3
    v_mfma_f32_16x16x32_bf16 v[152:155], a[132:135], v[68:71], v[152:155]
    s_cmp_le_u32 s38, s81
    v_exp_f32 v35, v119 clamp
    v_mfma_f32_16x16x32_bf16 v[152:155], a[128:131], v[64:67], v[152:155]
    ds_read_b64_tr_b16 a[218:219], v14 offset:28672
    ds_read_b64_tr_b16 a[188:189], v15 offset:16384
    v_mfma_f32_16x16x32_bf16 v[160:163], a[128:131], v[80:83], v[216:219]
    s_cselect_b32 s62, s87, 0
    v_exp_f32 v28, v120 clamp
    v_mfma_f32_16x16x32_bf16 v[160:163], a[132:135], v[84:87], v[160:163]
    ds_read_b64_tr_b16 a[190:191], v15 offset:20480
    v_perm_b32 v179, v35, v34, s3
    v_mfma_f32_16x16x32_bf16 v[160:163], a[136:139], v[88:91], v[160:163]
    s_cmp_gt_u32 s38, s86
    v_exp_f32 v29, v121 clamp
    v_mfma_f32_16x16x32_bf16 v[160:163], a[140:143], v[92:95], v[160:163]
    ds_read_b64_tr_b16 a[220:221], v15 offset:24576
    ds_read_b64_tr_b16 a[222:223], v15 offset:28672
    v_mfma_f32_16x16x32_bf16 v[164:167], a[156:159], v[92:95], v[216:219]
    s_cselect_b32 s62, s62, 0
    v_exp_f32 v30, v122 clamp
    v_mfma_f32_16x16x32_bf16 v[164:167], a[152:155], v[88:91], v[164:167]
    v_exp_f32 v31, v123 clamp
    v_mfma_f32_16x16x32_bf16 v[164:167], a[148:151], v[84:87], v[164:167]
    buffer_load_dword v46, v43, s[60:63], s80 offen
    v_perm_b32 v180, v29, v28, s3
    v_mfma_f32_16x16x32_bf16 v[164:167], a[144:147], v[80:83], v[164:167]
    s_min_u32 s42, s62, s88
    v_exp_f32 v32, v124 clamp
    v_mfma_f32_16x16x32_bf16 v[172:175], a[144:147], v[96:99], v[220:223]
    s_add_u32 s80, s80, s42
    v_exp_f32 v33, v125 clamp
    v_mfma_f32_16x16x32_bf16 v[172:175], a[148:151], v[100:103], v[172:175]
    v_perm_b32 v181, v31, v30, s3
    v_mfma_f32_16x16x32_bf16 v[172:175], a[152:155], v[104:107], v[172:175]
    v_exp_f32 v34, v126 clamp
    v_mfma_f32_16x16x32_bf16 v[172:175], a[156:159], v[108:111], v[172:175]
    v_exp_f32 v35, v127 clamp
    v_mfma_f32_16x16x32_bf16 v[168:171], a[140:143], v[108:111], v[220:223]
    v_perm_b32 v182, v33, v32, s3
    v_perm_b32 v183, v35, v34, s3
    v_mfma_f32_16x16x32_bf16 v[168:171], a[136:139], v[104:107], v[168:171]
    v_exp_f32 v28, v128 clamp
    v_mfma_f32_16x16x32_bf16 v[168:171], a[132:135], v[100:103], v[168:171]
    v_exp_f32 v29, v129 clamp
    v_mfma_f32_16x16x32_bf16 v[168:171], a[128:131], v[96:99], v[168:171]
    s_waitcnt vmcnt(12) lgkmcnt(0)
    v_exp_f32 v30, v130 clamp
    v_smfmac_f32_16x16x64_bf16 v[224:227], v[24:27], v[176:183], v250
    s_barrier
    v_mfma_f32_16x16x32_bf16 a[0:3], a[160:163], v[232:235], a[0:3]
    ds_read_b128 a[224:227], v4 offset:32768
    v_perm_b32 v184, v29, v28, s3
    v_mfma_f32_16x16x32_bf16 a[0:3], a[192:195], v[192:195], a[0:3]
    s_add_u32 m0, s37, 16384
    v_exp_f32 v31, v131 clamp
    v_mfma_f32_16x16x32_bf16 a[4:7], a[196:199], v[192:195], a[4:7]
    ds_read_b128 a[228:231], v5 offset:32768
    v_perm_b32 v185, v31, v30, s3
    v_mfma_f32_16x16x32_bf16 a[4:7], a[164:167], v[232:235], a[4:7]
    v_exp_f32 v32, v132 clamp
    v_mfma_f32_16x16x32_bf16 a[8:11], a[168:171], v[232:235], a[8:11]
    v_exp_f32 v33, v133 clamp
    v_mfma_f32_16x16x32_bf16 a[8:11], a[200:203], v[192:195], a[8:11]
    ds_read_b128 a[232:235], v6 offset:32768
    v_perm_b32 v186, v33, v32, s3
    v_mfma_f32_16x16x32_bf16 a[12:15], a[204:207], v[192:195], a[12:15]
    v_exp_f32 v34, v134 clamp
    v_mfma_f32_16x16x32_bf16 a[12:15], a[172:175], v[232:235], a[12:15]
    v_exp_f32 v35, v135 clamp
    v_mfma_f32_16x16x32_bf16 a[16:19], a[176:179], v[232:235], a[16:19]
    ds_read_b128 a[236:239], v7 offset:32768
    v_perm_b32 v187, v35, v34, s3
    v_mfma_f32_16x16x32_bf16 a[16:19], a[208:211], v[192:195], a[16:19]
    v_exp_f32 v28, v136 clamp
    v_mfma_f32_16x16x32_bf16 a[20:23], a[212:215], v[192:195], a[20:23]
    v_exp_f32 v29, v137 clamp
    v_mfma_f32_16x16x32_bf16 a[20:23], a[180:183], v[232:235], a[20:23]
    ds_read_b128 a[240:243], v4 offset:36864
    v_perm_b32 v188, v29, v28, s3
    v_mfma_f32_16x16x32_bf16 a[24:27], a[184:187], v[232:235], a[24:27]
    v_exp_f32 v30, v138 clamp
    v_mfma_f32_16x16x32_bf16 a[24:27], a[216:219], v[192:195], a[24:27]
    v_exp_f32 v31, v139 clamp
    v_mfma_f32_16x16x32_bf16 a[28:31], a[220:223], v[192:195], a[28:31]
    ds_read_b128 a[244:247], v5 offset:36864
    v_perm_b32 v189, v31, v30, s3
    v_mfma_f32_16x16x32_bf16 a[28:31], a[188:191], v[232:235], a[28:31]
    v_exp_f32 v32, v140 clamp
    v_mfma_f32_16x16x32_bf16 a[32:35], a[160:163], v[236:239], a[32:35]
    v_exp_f32 v33, v141 clamp
    v_mfma_f32_16x16x32_bf16 a[32:35], a[192:195], v[196:199], a[32:35]
    ds_read_b128 a[248:251], v6 offset:36864
    v_perm_b32 v190, v33, v32, s3
    v_mfma_f32_16x16x32_bf16 a[36:39], a[196:199], v[196:199], a[36:39]
    v_exp_f32 v34, v142 clamp
    v_mfma_f32_16x16x32_bf16 a[36:39], a[164:167], v[236:239], a[36:39]
    v_exp_f32 v35, v143 clamp
    v_mfma_f32_16x16x32_bf16 a[40:43], a[168:171], v[236:239], a[40:43]
    ds_read_b128 a[252:255], v7 offset:36864
    v_perm_b32 v191, v35, v34, s3
    v_mfma_f32_16x16x32_bf16 a[40:43], a[200:203], v[196:199], a[40:43]
    v_max3_f32 v36, v224, v225, v226
    v_max_f32 v36, v36, v227
    v_smfmac_f32_16x16x64_bf16 v[228:231], v[24:27], v[184:191], v250
    buffer_load_dwordx4 v18, s[20:23], s44 offen offset:0 nt lds
    v_mfma_f32_16x16x32_bf16 a[44:47], a[204:207], v[196:199], a[44:47]
    v_mfma_f32_16x16x32_bf16 a[44:47], a[172:175], v[236:239], a[44:47]
    buffer_load_dwordx4 v19, s[20:23], s44 offen offset:1024 nt lds
    v_mfma_f32_16x16x32_bf16 a[48:51], a[176:179], v[236:239], a[48:51]
    v_mfma_f32_16x16x32_bf16 a[48:51], a[208:211], v[196:199], a[48:51]
    buffer_load_dwordx4 v18, s[20:23], s44 offen offset:2048 nt lds
    v_mfma_f32_16x16x32_bf16 a[52:55], a[212:215], v[196:199], a[52:55]
    v_mfma_f32_16x16x32_bf16 a[52:55], a[180:183], v[236:239], a[52:55]
    v_max3_f32 v36, v36, v228, v229
    v_max3_f32 v36, v36, v230, v231
    v_mfma_f32_16x16x32_bf16 a[56:59], a[184:187], v[236:239], a[56:59]
    v_cmp_lt_f32 vcc, s39, v36
    v_mfma_f32_16x16x32_bf16 a[56:59], a[216:219], v[196:199], a[56:59]
    buffer_load_dwordx4 v19, s[20:23], s44 offen offset:3072 nt lds
    v_mfma_f32_16x16x32_bf16 a[60:63], a[220:223], v[196:199], a[60:63]
    s_add_u32 s44, s44, 16384
    v_mfma_f32_16x16x32_bf16 a[60:63], a[188:191], v[236:239], a[60:63]
    s_cbranch_vccnz L_rare_l0
L_back_l0:
    v_mfma_f32_16x16x32_bf16 a[64:67], a[160:163], v[240:243], a[64:67]
    v_exp_f32 v28, v144 clamp
    v_mfma_f32_16x16x32_bf16 a[64:67], a[192:195], v[200:203], a[64:67]
    ds_read_b128 a[128:131], v4 offset:40960
    ds_read_b128 a[132:135], v5 offset:40960
    v_mfma_f32_16x16x32_bf16 a[68:71], a[196:199], v[200:203], a[68:71]
    v_exp_f32 v29, v145 clamp
    v_mfma_f32_16x16x32_bf16 a[68:71], a[164:167], v[240:243], a[68:71]
    ds_read_b128 a[136:139], v6 offset:40960
    v_perm_b32 v192, v29, v28, s3
    v_mfma_f32_16x16x32_bf16 a[72:75], a[168:171], v[240:243], a[72:75]
    v_exp_f32 v30, v146 clamp
    v_mfma_f32_16x16x32_bf16 a[72:75], a[200:203], v[200:203], a[72:75]
    ds_read_b128 a[140:143], v7 offset:40960
    ds_read_b128 a[144:147], v4 offset:45056
    v_mfma_f32_16x16x32_bf16 a[76:79], a[204:207], v[200:203], a[76:79]
    v_exp_f32 v31, v147 clamp
    v_mfma_f32_16x16x32_bf16 a[76:79], a[172:175], v[240:243], a[76:79]
    ds_read_b128 a[148:151], v5 offset:45056
    v_perm_b32 v193, v31, v30, s3
    v_mfma_f32_16x16x32_bf16 a[80:83], a[176:179], v[240:243], a[80:83]
    s_cmp_le_u32 s38, 7
    v_exp_f32 v32, v148 clamp
    v_mfma_f32_16x16x32_bf16 a[80:83], a[208:211], v[200:203], a[80:83]
    ds_read_b128 a[152:155], v6 offset:45056
    ds_read_b128 a[156:159], v7 offset:45056
    v_mfma_f32_16x16x32_bf16 a[84:87], a[212:215], v[200:203], a[84:87]
    s_cselect_b32 s34, 16384, 0
    v_exp_f32 v33, v149 clamp
    v_mfma_f32_16x16x32_bf16 a[84:87], a[180:183], v[240:243], a[84:87]
    buffer_load_dword v2, v47, s[32:35], s41 offen
    v_perm_b32 v194, v33, v32, s3
    v_mfma_f32_16x16x32_bf16 a[88:91], a[184:187], v[240:243], a[88:91]
    s_lshr_b32 s42, s34, 3
    v_exp_f32 v34, v150 clamp
    v_mfma_f32_16x16x32_bf16 a[88:91], a[216:219], v[200:203], a[88:91]
    s_add_u32 s41, s41, s42
    v_exp_f32 v35, v151 clamp
    v_mfma_f32_16x16x32_bf16 a[92:95], a[220:223], v[200:203], a[92:95]
    v_perm_b32 v195, v35, v34, s3
    v_mfma_f32_16x16x32_bf16 a[92:95], a[188:191], v[240:243], a[92:95]
    v_exp_f32 v28, v152 clamp
    v_mfma_f32_16x16x32_bf16 a[96:99], a[160:163], v[244:247], a[96:99]
    s_waitcnt vmcnt(11) lgkmcnt(0)
    v_exp_f32 v29, v153 clamp
    v_mfma_f32_16x16x32_bf16 a[96:99], a[192:195], v[204:207], a[96:99]
    s_barrier
    v_mfma_f32_16x16x32_bf16 a[100:103], a[196:199], v[204:207], a[100:103]
    ds_read_b64_tr_b16 a[160:161], v8 offset:49152
    v_perm_b32 v196, v29, v28, s3
    v_mfma_f32_16x16x32_bf16 a[100:103], a[164:167], v[244:247], a[100:103]
    s_add_u32 m0, s37, 32768
    v_exp_f32 v30, v154 clamp
    v_mfma_f32_16x16x32_bf16 a[104:107], a[168:171], v[244:247], a[104:107]
    v_exp_f32 v31, v155 clamp
    v_mfma_f32_16x16x32_bf16 a[104:107], a[200:203], v[204:207], a[104:107]
    buffer_load_dwordx4 v16, s[16:19], s36 offen offset:0 nt lds
    v_mfma_f32_16x16x32_bf16 a[108:111], a[204:207], v[204:207], a[108:111]
    ds_read_b64_tr_b16 a[162:163], v8 offset:53248
    v_perm_b32 v197, v31, v30, s3
    v_mfma_f32_16x16x32_bf16 a[108:111], a[172:175], v[244:247], a[108:111]
    v_exp_f32 v32, v156 clamp
    v_mfma_f32_16x16x32_bf16 a[112:115], a[176:179], v[244:247], a[112:115]
    v_exp_f32 v33, v157 clamp
    v_mfma_f32_16x16x32_bf16 a[112:115], a[208:211], v[204:207], a[112:115]
    ds_read_b64_tr_b16 a[192:193], v8 offset:57344
    v_perm_b32 v198, v33, v32, s3
    v_mfma_f32_16x16x32_bf16 a[116:119], a[212:215], v[204:207], a[116:119]
    v_exp_f32 v34, v158 clamp
    v_mfma_f32_16x16x32_bf16 a[116:119], a[180:183], v[244:247], a[116:119]
    v_exp_f32 v35, v159 clamp
    v_mfma_f32_16x16x32_bf16 a[120:123], a[184:187], v[244:247], a[120:123]
    ds_read_b64_tr_b16 a[194:195], v8 offset:61440
    v_perm_b32 v199, v35, v34, s3
    v_mfma_f32_16x16x32_bf16 a[120:123], a[216:219], v[204:207], a[120:123]
    v_exp_f32 v28, v160 clamp
    v_mfma_f32_16x16x32_bf16 a[124:127], a[220:223], v[204:207], a[124:127]
    v_exp_f32 v29, v161 clamp
    v_mfma_f32_16x16x32_bf16 a[124:127], a[188:191], v[244:247], a[124:127]
    v_exp_f32 v30, v162 clamp
    v_smfmac_f32_16x16x64_bf16 v[224:227], v[24:27], v[192:199], v250
    ds_read_b64_tr_b16 a[164:165], v9 offset:49152
    v_perm_b32 v200, v29, v28, s3
    v_mfma_f32_16x16x32_bf16 v[112:115], a[224:227], v[48:51], v[208:211]
    v_exp_f32 v31, v163 clamp
    v_mfma_f32_16x16x32_bf16 v[112:115], a[228:231], v[52:55], v[112:115]
    buffer_load_dwordx4 v17, s[16:19], s36 offen offset:1024 nt lds
    v_mfma_f32_16x16x32_bf16 v[112:115], a[232:235], v[56:59], v[112:115]
    ds_read_b64_tr_b16 a[166:167], v9 offset:53248
    v_perm_b32 v201, v31, v30, s3
    v_mfma_f32_16x16x32_bf16 v[112:115], a[236:239], v[60:63], v[112:115]
    v_exp_f32 v32, v164 clamp
    v_mfma_f32_16x16x32_bf16 v[116:119], a[252:255], v[60:63], v[208:211]
    v_exp_f32 v33, v165 clamp
    v_mfma_f32_16x16x32_bf16 v[116:119], a[248:251], v[56:59], v[116:119]
    ds_read_b64_tr_b16 a[196:197], v9 offset:57344
    v_perm_b32 v202, v33, v32, s3
    v_mfma_f32_16x16x32_bf16 v[116:119], a[244:247], v[52:55], v[116:119]
    v_exp_f32 v34, v166 clamp
    v_mfma_f32_16x16x32_bf16 v[116:119], a[240:243], v[48:51], v[116:119]
    v_exp_f32 v35, v167 clamp
    v_mfma_f32_16x16x32_bf16 v[124:127], a[240:243], v[64:67], v[212:215]
    ds_read_b64_tr_b16 a[198:199], v9 offset:61440
    v_perm_b32 v203, v35, v34, s3
    v_mfma_f32_16x16x32_bf16 v[124:127], a[244:247], v[68:71], v[124:127]
    v_exp_f32 v28, v168 clamp
    v_mfma_f32_16x16x32_bf16 v[124:127], a[248:251], v[72:75], v[124:127]
    v_exp_f32 v29, v169 clamp
    v_mfma_f32_16x16x32_bf16 v[124:127], a[252:255], v[76:79], v[124:127]
    ds_read_b64_tr_b16 a[168:169], v10 offset:49152
    v_perm_b32 v204, v29, v28, s3
    v_mfma_f32_16x16x32_bf16 v[120:123], a[236:239], v[76:79], v[212:215]
    v_exp_f32 v30, v170 clamp
    v_mfma_f32_16x16x32_bf16 v[120:123], a[232:235], v[72:75], v[120:123]
    buffer_load_dwordx4 v41, s[16:19], s36 offen offset:2048 nt lds
    v_mfma_f32_16x16x32_bf16 v[120:123], a[228:231], v[68:71], v[120:123]
    v_exp_f32 v31, v171 clamp
    v_mfma_f32_16x16x32_bf16 v[120:123], a[224:227], v[64:67], v[120:123]
    ds_read_b64_tr_b16 a[170:171], v10 offset:53248
    v_perm_b32 v205, v31, v30, s3
    v_mfma_f32_16x16x32_bf16 v[128:131], a[224:227], v[80:83], v[216:219]
    v_exp_f32 v32, v172 clamp
    v_mfma_f32_16x16x32_bf16 v[128:131], a[228:231], v[84:87], v[128:131]
    v_exp_f32 v33, v173 clamp
    v_mfma_f32_16x16x32_bf16 v[128:131], a[232:235], v[88:91], v[128:131]
    ds_read_b64_tr_b16 a[200:201], v10 offset:57344
    v_perm_b32 v206, v33, v32, s3
    v_mfma_f32_16x16x32_bf16 v[128:131], a[236:239], v[92:95], v[128:131]
    v_exp_f32 v34, v174 clamp
    v_mfma_f32_16x16x32_bf16 v[132:135], a[252:255], v[92:95], v[216:219]
    ds_read_b64_tr_b16 a[202:203], v10 offset:61440
    ds_read_b64_tr_b16 a[172:173], v11 offset:49152
    v_mfma_f32_16x16x32_bf16 v[132:135], a[248:251], v[88:91], v[132:135]
    v_exp_f32 v35, v175 clamp
    v_mfma_f32_16x16x32_bf16 v[132:135], a[244:247], v[84:87], v[132:135]
    ds_read_b64_tr_b16 a[174:175], v11 offset:53248
    v_perm_b32 v207, v35, v34, s3
    v_mfma_f32_16x16x32_bf16 v[132:135], a[240:243], v[80:83], v[132:135]
    buffer_load_dwordx4 v42, s[16:19], s36 offen offset:3072 nt lds
    v_smfmac_f32_16x16x64_bf16 v[228:231], v[24:27], v[200:207], v250
    v_max3_f32 v36, v224, v225, v226
    v_max_f32 v36, v36, v227
    v_mfma_f32_16x16x32_bf16 v[140:143], a[240:243], v[96:99], v[220:223]
    ds_read_b64_tr_b16 a[204:205], v11 offset:57344
    ds_read_b64_tr_b16 a[206:207], v11 offset:61440
    v_mfma_f32_16x16x32_bf16 v[140:143], a[244:247], v[100:103], v[140:143]
    s_add_u32 s36, s36, 16384
    v_mfma_f32_16x16x32_bf16 v[140:143], a[248:251], v[104:107], v[140:143]
    v_mfma_f32_16x16x32_bf16 v[140:143], a[252:255], v[108:111], v[140:143]
    v_max3_f32 v36, v36, v228, v229
    v_max3_f32 v36, v36, v230, v231
    v_mfma_f32_16x16x32_bf16 v[136:139], a[236:239], v[108:111], v[220:223]
    v_cmp_lt_f32 vcc, s39, v36
    v_mfma_f32_16x16x32_bf16 v[136:139], a[232:235], v[104:107], v[136:139]
    v_mfma_f32_16x16x32_bf16 v[136:139], a[228:231], v[100:103], v[136:139]
    v_mfma_f32_16x16x32_bf16 v[136:139], a[224:227], v[96:99], v[136:139]
    s_cbranch_vccnz L_rare_l1
L_back_l1:
L_mid_main_kernel:
    v_mfma_f32_16x16x32_bf16 v[144:147], a[128:131], v[48:51], v[208:211]
    v_exp_f32 v28, v112 clamp
    v_mfma_f32_16x16x32_bf16 v[144:147], a[132:135], v[52:55], v[144:147]
    ds_read_b64_tr_b16 a[176:177], v12 offset:49152
    ds_read_b64_tr_b16 a[178:179], v12 offset:53248
    v_mfma_f32_16x16x32_bf16 v[144:147], a[136:139], v[56:59], v[144:147]
    v_exp_f32 v29, v113 clamp
    v_mfma_f32_16x16x32_bf16 v[144:147], a[140:143], v[60:63], v[144:147]
    ds_read_b64_tr_b16 a[208:209], v12 offset:57344
    ds_read_b64_tr_b16 a[210:211], v12 offset:61440
    v_mfma_f32_16x16x32_bf16 v[148:151], a[156:159], v[60:63], v[208:211]
    v_exp_f32 v30, v114 clamp
    v_mfma_f32_16x16x32_bf16 v[148:151], a[152:155], v[56:59], v[148:151]
    ds_read_b64_tr_b16 a[180:181], v13 offset:49152
    v_perm_b32 v232, v29, v28, s3
    v_mfma_f32_16x16x32_bf16 v[148:151], a[148:151], v[52:55], v[148:151]
    v_exp_f32 v31, v115 clamp
    v_mfma_f32_16x16x32_bf16 v[148:151], a[144:147], v[48:51], v[148:151]
    ds_read_b64_tr_b16 a[182:183], v13 offset:53248
    ds_read_b64_tr_b16 a[212:213], v13 offset:57344
    v_mfma_f32_16x16x32_bf16 v[156:159], a[144:147], v[64:67], v[212:215]
    v_exp_f32 v32, v116 clamp
    v_mfma_f32_16x16x32_bf16 v[156:159], a[148:151], v[68:71], v[156:159]
    ds_read_b64_tr_b16 a[214:215], v13 offset:61440
    v_perm_b32 v233, v31, v30, s3
    v_mfma_f32_16x16x32_bf16 v[156:159], a[152:155], v[72:75], v[156:159]
    v_exp_f32 v33, v117 clamp
    v_mfma_f32_16x16x32_bf16 v[156:159], a[156:159], v[76:79], v[156:159]
    ds_read_b64_tr_b16 a[184:185], v14 offset:49152
    ds_read_b64_tr_b16 a[186:187], v14 offset:53248
    v_mfma_f32_16x16x32_bf16 v[152:155], a[140:143], v[76:79], v[212:215]
    v_exp_f32 v34, v118 clamp
    v_mfma_f32_16x16x32_bf16 v[152:155], a[136:139], v[72:75], v[152:155]
    ds_read_b64_tr_b16 a[216:217], v14 offset:57344
    v_perm_b32 v234, v33, v32, s3
    v_mfma_f32_16x16x32_bf16 v[152:155], a[132:135], v[68:71], v[152:155]
    s_cmp_gt_u32 s38, 4
    v_exp_f32 v35, v119 clamp
    v_mfma_f32_16x16x32_bf16 v[152:155], a[128:131], v[64:67], v[152:155]
    ds_read_b64_tr_b16 a[218:219], v14 offset:61440
    ds_read_b64_tr_b16 a[188:189], v15 offset:49152
    v_mfma_f32_16x16x32_bf16 v[160:163], a[128:131], v[80:83], v[216:219]
    s_cselect_b32 s42, 1, 0
    v_exp_f32 v28, v120 clamp
    v_mfma_f32_16x16x32_bf16 v[160:163], a[132:135], v[84:87], v[160:163]
    ds_read_b64_tr_b16 a[190:191], v15 offset:53248
    v_perm_b32 v235, v35, v34, s3
    v_mfma_f32_16x16x32_bf16 v[160:163], a[136:139], v[88:91], v[160:163]
    s_mov_b32 m0, s51
    v_exp_f32 v29, v121 clamp
    v_mfma_f32_16x16x32_bf16 v[160:163], a[140:143], v[92:95], v[160:163]
    ds_read_b64_tr_b16 a[220:221], v15 offset:57344
    ds_read_b64_tr_b16 a[222:223], v15 offset:61440
    v_mfma_f32_16x16x32_bf16 v[164:167], a[156:159], v[92:95], v[216:219]
    s_lshl_b32 s43, s49, 15
    v_exp_f32 v30, v122 clamp
    v_mfma_f32_16x16x32_bf16 v[164:167], a[152:155], v[88:91], v[164:167]
    s_add_u32 s49, s49, s42
    v_exp_f32 v31, v123 clamp
    v_mfma_f32_16x16x32_bf16 v[164:167], a[148:151], v[84:87], v[164:167]
    buffer_load_dwordx4 v44, s[96:99], s43 offen offset:0  lds
    v_perm_b32 v236, v29, v28, s3
    v_mfma_f32_16x16x32_bf16 v[164:167], a[144:147], v[80:83], v[164:167]
    s_lshl_b32 s42, s42, 13
    v_exp_f32 v32, v124 clamp
    v_mfma_f32_16x16x32_bf16 v[172:175], a[144:147], v[96:99], v[220:223]
    s_and_b32 s49, s49, 15
    v_exp_f32 v33, v125 clamp
    v_mfma_f32_16x16x32_bf16 v[172:175], a[148:151], v[100:103], v[172:175]
    buffer_load_dwordx4 v45, s[96:99], s43 offen offset:1024  lds
    v_perm_b32 v237, v31, v30, s3
    v_mfma_f32_16x16x32_bf16 v[172:175], a[152:155], v[104:107], v[172:175]
    s_add_u32 s51, s51, s42
    v_exp_f32 v34, v126 clamp
    v_mfma_f32_16x16x32_bf16 v[172:175], a[156:159], v[108:111], v[172:175]
    v_exp_f32 v35, v127 clamp
    v_mfma_f32_16x16x32_bf16 v[168:171], a[140:143], v[108:111], v[220:223]
    v_perm_b32 v238, v33, v32, s3
    v_perm_b32 v239, v35, v34, s3
    v_mfma_f32_16x16x32_bf16 v[168:171], a[136:139], v[104:107], v[168:171]
    v_exp_f32 v28, v128 clamp
    v_mfma_f32_16x16x32_bf16 v[168:171], a[132:135], v[100:103], v[168:171]
    v_exp_f32 v29, v129 clamp
    v_mfma_f32_16x16x32_bf16 v[168:171], a[128:131], v[96:99], v[168:171]
    s_waitcnt vmcnt(12) lgkmcnt(0)
    v_exp_f32 v30, v130 clamp
    v_smfmac_f32_16x16x64_bf16 v[224:227], v[24:27], v[232:239], v250
    s_barrier
    v_mfma_f32_16x16x32_bf16 a[0:3], a[160:163], v[176:179], a[0:3]
    ds_read_b128 a[224:227], v4 offset:0
    v_perm_b32 v240, v29, v28, s3
    v_mfma_f32_16x16x32_bf16 a[0:3], a[192:195], v[192:195], a[0:3]
    s_add_u32 m0, s37, 49152
    v_exp_f32 v31, v131 clamp
    v_mfma_f32_16x16x32_bf16 a[4:7], a[196:199], v[192:195], a[4:7]
    ds_read_b128 a[228:231], v5 offset:0
    v_perm_b32 v241, v31, v30, s3
    v_mfma_f32_16x16x32_bf16 a[4:7], a[164:167], v[176:179], a[4:7]
    v_exp_f32 v32, v132 clamp
    v_mfma_f32_16x16x32_bf16 a[8:11], a[168:171], v[176:179], a[8:11]
    v_exp_f32 v33, v133 clamp
    v_mfma_f32_16x16x32_bf16 a[8:11], a[200:203], v[192:195], a[8:11]
    ds_read_b128 a[232:235], v6 offset:0
    v_perm_b32 v242, v33, v32, s3
    v_mfma_f32_16x16x32_bf16 a[12:15], a[204:207], v[192:195], a[12:15]
    v_exp_f32 v34, v134 clamp
    v_mfma_f32_16x16x32_bf16 a[12:15], a[172:175], v[176:179], a[12:15]
    v_exp_f32 v35, v135 clamp
    v_mfma_f32_16x16x32_bf16 a[16:19], a[176:179], v[176:179], a[16:19]
    ds_read_b128 a[236:239], v7 offset:0
    v_perm_b32 v243, v35, v34, s3
    v_mfma_f32_16x16x32_bf16 a[16:19], a[208:211], v[192:195], a[16:19]
    v_exp_f32 v28, v136 clamp
    v_mfma_f32_16x16x32_bf16 a[20:23], a[212:215], v[192:195], a[20:23]
    v_exp_f32 v29, v137 clamp
    v_mfma_f32_16x16x32_bf16 a[20:23], a[180:183], v[176:179], a[20:23]
    ds_read_b128 a[240:243], v4 offset:4096
    v_perm_b32 v244, v29, v28, s3
    v_mfma_f32_16x16x32_bf16 a[24:27], a[184:187], v[176:179], a[24:27]
    v_exp_f32 v30, v138 clamp
    v_mfma_f32_16x16x32_bf16 a[24:27], a[216:219], v[192:195], a[24:27]
    v_exp_f32 v31, v139 clamp
    v_mfma_f32_16x16x32_bf16 a[28:31], a[220:223], v[192:195], a[28:31]
    ds_read_b128 a[244:247], v5 offset:4096
    v_perm_b32 v245, v31, v30, s3
    v_mfma_f32_16x16x32_bf16 a[28:31], a[188:191], v[176:179], a[28:31]
    v_exp_f32 v32, v140 clamp
    v_mfma_f32_16x16x32_bf16 a[32:35], a[160:163], v[180:183], a[32:35]
    v_exp_f32 v33, v141 clamp
    v_mfma_f32_16x16x32_bf16 a[32:35], a[192:195], v[196:199], a[32:35]
    ds_read_b128 a[248:251], v6 offset:4096
    v_perm_b32 v246, v33, v32, s3
    v_mfma_f32_16x16x32_bf16 a[36:39], a[196:199], v[196:199], a[36:39]
    v_exp_f32 v34, v142 clamp
    v_mfma_f32_16x16x32_bf16 a[36:39], a[164:167], v[180:183], a[36:39]
    v_exp_f32 v35, v143 clamp
    v_mfma_f32_16x16x32_bf16 a[40:43], a[168:171], v[180:183], a[40:43]
    ds_read_b128 a[252:255], v7 offset:4096
    v_perm_b32 v247, v35, v34, s3
    v_mfma_f32_16x16x32_bf16 a[40:43], a[200:203], v[196:199], a[40:43]
    v_max3_f32 v36, v224, v225, v226
    v_max_f32 v36, v36, v227
    v_smfmac_f32_16x16x64_bf16 v[228:231], v[24:27], v[240:247], v250
    buffer_load_dwordx4 v18, s[20:23], s44 offen offset:0 nt lds
    v_mfma_f32_16x16x32_bf16 a[44:47], a[204:207], v[196:199], a[44:47]
    v_mfma_f32_16x16x32_bf16 a[44:47], a[172:175], v[180:183], a[44:47]
    buffer_load_dwordx4 v19, s[20:23], s44 offen offset:1024 nt lds
    v_mfma_f32_16x16x32_bf16 a[48:51], a[176:179], v[180:183], a[48:51]
    v_mfma_f32_16x16x32_bf16 a[48:51], a[208:211], v[196:199], a[48:51]
    buffer_load_dwordx4 v18, s[20:23], s44 offen offset:2048 nt lds
    v_mfma_f32_16x16x32_bf16 a[52:55], a[212:215], v[196:199], a[52:55]
    v_mfma_f32_16x16x32_bf16 a[52:55], a[180:183], v[180:183], a[52:55]
    v_max3_f32 v36, v36, v228, v229
    v_max3_f32 v36, v36, v230, v231
    v_mfma_f32_16x16x32_bf16 a[56:59], a[184:187], v[180:183], a[56:59]
    v_cmp_lt_f32 vcc, s39, v36
    v_mfma_f32_16x16x32_bf16 a[56:59], a[216:219], v[196:199], a[56:59]
    buffer_load_dwordx4 v19, s[20:23], s44 offen offset:3072 nt lds
    v_mfma_f32_16x16x32_bf16 a[60:63], a[220:223], v[196:199], a[60:63]
    s_add_u32 s44, s44, 16384
    v_mfma_f32_16x16x32_bf16 a[60:63], a[188:191], v[180:183], a[60:63]
    s_cbranch_vccnz L_rare_l2
L_back_l2:
    v_mfma_f32_16x16x32_bf16 a[64:67], a[160:163], v[184:187], a[64:67]
    v_exp_f32 v28, v144 clamp
    v_mfma_f32_16x16x32_bf16 a[64:67], a[192:195], v[200:203], a[64:67]
    ds_read_b128 a[128:131], v4 offset:8192
    ds_read_b128 a[132:135], v5 offset:8192
    v_mfma_f32_16x16x32_bf16 a[68:71], a[196:199], v[200:203], a[68:71]
    v_exp_f32 v29, v145 clamp
    v_mfma_f32_16x16x32_bf16 a[68:71], a[164:167], v[184:187], a[68:71]
    ds_read_b128 a[136:139], v6 offset:8192
    v_perm_b32 v192, v29, v28, s3
    v_mfma_f32_16x16x32_bf16 a[72:75], a[168:171], v[184:187], a[72:75]
    v_exp_f32 v30, v146 clamp
    v_mfma_f32_16x16x32_bf16 a[72:75], a[200:203], v[200:203], a[72:75]
    ds_read_b128 a[140:143], v7 offset:8192
    ds_read_b128 a[144:147], v4 offset:12288
    v_mfma_f32_16x16x32_bf16 a[76:79], a[204:207], v[200:203], a[76:79]
    v_exp_f32 v31, v147 clamp
    v_mfma_f32_16x16x32_bf16 a[76:79], a[172:175], v[184:187], a[76:79]
    ds_read_b128 a[148:151], v5 offset:12288
    v_perm_b32 v193, v31, v30, s3
    v_mfma_f32_16x16x32_bf16 a[80:83], a[176:179], v[184:187], a[80:83]
    s_cmp_le_u32 s38, 7
    v_exp_f32 v32, v148 clamp
    v_mfma_f32_16x16x32_bf16 a[80:83], a[208:211], v[200:203], a[80:83]
    ds_read_b128 a[152:155], v6 offset:12288
    ds_read_b128 a[156:159], v7 offset:12288
    v_mfma_f32_16x16x32_bf16 a[84:87], a[212:215], v[200:203], a[84:87]
    s_cselect_b32 s34, 16384, 0
    v_exp_f32 v33, v149 clamp
    v_mfma_f32_16x16x32_bf16 a[84:87], a[180:183], v[184:187], a[84:87]
    buffer_load_dword v2, v47, s[32:35], s41 offen
    v_perm_b32 v194, v33, v32, s3
    v_mfma_f32_16x16x32_bf16 a[88:91], a[184:187], v[184:187], a[88:91]
    s_lshr_b32 s42, s34, 3
    v_exp_f32 v34, v150 clamp
    v_mfma_f32_16x16x32_bf16 a[88:91], a[216:219], v[200:203], a[88:91]
    s_add_u32 s41, s41, s42
    v_exp_f32 v35, v151 clamp
    v_mfma_f32_16x16x32_bf16 a[92:95], a[220:223], v[200:203], a[92:95]
    v_perm_b32 v195, v35, v34, s3
    v_mfma_f32_16x16x32_bf16 a[92:95], a[188:191], v[184:187], a[92:95]
    v_exp_f32 v28, v152 clamp
    v_mfma_f32_16x16x32_bf16 a[96:99], a[160:163], v[188:191], a[96:99]
    s_waitcnt vmcnt(12) lgkmcnt(0)
    v_exp_f32 v29, v153 clamp
    v_mfma_f32_16x16x32_bf16 a[96:99], a[192:195], v[204:207], a[96:99]
    s_barrier
    v_mfma_f32_16x16x32_bf16 a[100:103], a[196:199], v[204:207], a[100:103]
    ds_read_b64_tr_b16 a[160:161], v8 offset:16384
    v_perm_b32 v196, v29, v28, s3
    v_mfma_f32_16x16x32_bf16 a[100:103], a[164:167], v[188:191], a[100:103]
    s_add_u32 m0, s37, 0
    v_exp_f32 v30, v154 clamp
    v_mfma_f32_16x16x32_bf16 a[104:107], a[168:171], v[188:191], a[104:107]
    v_exp_f32 v31, v155 clamp
    v_mfma_f32_16x16x32_bf16 a[104:107], a[200:203], v[204:207], a[104:107]
    buffer_load_dwordx4 v16, s[16:19], s36 offen offset:0 nt lds
    v_mfma_f32_16x16x32_bf16 a[108:111], a[204:207], v[204:207], a[108:111]
    ds_read_b64_tr_b16 a[162:163], v8 offset:20480
    v_perm_b32 v197, v31, v30, s3
    v_mfma_f32_16x16x32_bf16 a[108:111], a[172:175], v[188:191], a[108:111]
    v_exp_f32 v32, v156 clamp
    v_mfma_f32_16x16x32_bf16 a[112:115], a[176:179], v[188:191], a[112:115]
    v_exp_f32 v33, v157 clamp
    v_mfma_f32_16x16x32_bf16 a[112:115], a[208:211], v[204:207], a[112:115]
    ds_read_b64_tr_b16 a[192:193], v8 offset:24576
    v_perm_b32 v198, v33, v32, s3
    v_mfma_f32_16x16x32_bf16 a[116:119], a[212:215], v[204:207], a[116:119]
    v_exp_f32 v34, v158 clamp
    v_mfma_f32_16x16x32_bf16 a[116:119], a[180:183], v[188:191], a[116:119]
    v_exp_f32 v35, v159 clamp
    v_mfma_f32_16x16x32_bf16 a[120:123], a[184:187], v[188:191], a[120:123]
    ds_read_b64_tr_b16 a[194:195], v8 offset:28672
    v_perm_b32 v199, v35, v34, s3
    v_mfma_f32_16x16x32_bf16 a[120:123], a[216:219], v[204:207], a[120:123]
    v_exp_f32 v28, v160 clamp
    v_mfma_f32_16x16x32_bf16 a[124:127], a[220:223], v[204:207], a[124:127]
    v_exp_f32 v29, v161 clamp
    v_mfma_f32_16x16x32_bf16 a[124:127], a[188:191], v[188:191], a[124:127]
    v_exp_f32 v30, v162 clamp
    v_smfmac_f32_16x16x64_bf16 v[224:227], v[24:27], v[192:199], v250
    ds_read_b64_tr_b16 a[164:165], v9 offset:16384
    v_perm_b32 v200, v29, v28, s3
    v_mfma_f32_16x16x32_bf16 v[112:115], a[224:227], v[48:51], v[208:211]
    v_exp_f32 v31, v163 clamp
    v_mfma_f32_16x16x32_bf16 v[112:115], a[228:231], v[52:55], v[112:115]
    buffer_load_dwordx4 v17, s[16:19], s36 offen offset:1024 nt lds
    v_mfma_f32_16x16x32_bf16 v[112:115], a[232:235], v[56:59], v[112:115]
    ds_read_b64_tr_b16 a[166:167], v9 offset:20480
    v_perm_b32 v201, v31, v30, s3
    v_mfma_f32_16x16x32_bf16 v[112:115], a[236:239], v[60:63], v[112:115]
    v_exp_f32 v32, v164 clamp
    v_mfma_f32_16x16x32_bf16 v[116:119], a[252:255], v[60:63], v[208:211]
    v_exp_f32 v33, v165 clamp
    v_mfma_f32_16x16x32_bf16 v[116:119], a[248:251], v[56:59], v[116:119]
    ds_read_b64_tr_b16 a[196:197], v9 offset:24576
    v_perm_b32 v202, v33, v32, s3
    v_mfma_f32_16x16x32_bf16 v[116:119], a[244:247], v[52:55], v[116:119]
    v_exp_f32 v34, v166 clamp
    v_mfma_f32_16x16x32_bf16 v[116:119], a[240:243], v[48:51], v[116:119]
    v_exp_f32 v35, v167 clamp
    v_mfma_f32_16x16x32_bf16 v[124:127], a[240:243], v[64:67], v[212:215]
    ds_read_b64_tr_b16 a[198:199], v9 offset:28672
    v_perm_b32 v203, v35, v34, s3
    v_mfma_f32_16x16x32_bf16 v[124:127], a[244:247], v[68:71], v[124:127]
    v_exp_f32 v28, v168 clamp
    v_mfma_f32_16x16x32_bf16 v[124:127], a[248:251], v[72:75], v[124:127]
    v_exp_f32 v29, v169 clamp
    v_mfma_f32_16x16x32_bf16 v[124:127], a[252:255], v[76:79], v[124:127]
    ds_read_b64_tr_b16 a[168:169], v10 offset:16384
    v_perm_b32 v204, v29, v28, s3
    v_mfma_f32_16x16x32_bf16 v[120:123], a[236:239], v[76:79], v[212:215]
    v_exp_f32 v30, v170 clamp
    v_mfma_f32_16x16x32_bf16 v[120:123], a[232:235], v[72:75], v[120:123]
    buffer_load_dwordx4 v41, s[16:19], s36 offen offset:2048 nt lds
    v_mfma_f32_16x16x32_bf16 v[120:123], a[228:231], v[68:71], v[120:123]
    v_exp_f32 v31, v171 clamp
    v_mfma_f32_16x16x32_bf16 v[120:123], a[224:227], v[64:67], v[120:123]
    ds_read_b64_tr_b16 a[170:171], v10 offset:20480
    v_perm_b32 v205, v31, v30, s3
    v_mfma_f32_16x16x32_bf16 v[128:131], a[224:227], v[80:83], v[216:219]
    v_exp_f32 v32, v172 clamp
    v_mfma_f32_16x16x32_bf16 v[128:131], a[228:231], v[84:87], v[128:131]
    v_exp_f32 v33, v173 clamp
    v_mfma_f32_16x16x32_bf16 v[128:131], a[232:235], v[88:91], v[128:131]
    ds_read_b64_tr_b16 a[200:201], v10 offset:24576
    v_perm_b32 v206, v33, v32, s3
    v_mfma_f32_16x16x32_bf16 v[128:131], a[236:239], v[92:95], v[128:131]
    v_exp_f32 v34, v174 clamp
    v_mfma_f32_16x16x32_bf16 v[132:135], a[252:255], v[92:95], v[216:219]
    ds_read_b64_tr_b16 a[202:203], v10 offset:28672
    ds_read_b64_tr_b16 a[172:173], v11 offset:16384
    v_mfma_f32_16x16x32_bf16 v[132:135], a[248:251], v[88:91], v[132:135]
    v_exp_f32 v35, v175 clamp
    v_mfma_f32_16x16x32_bf16 v[132:135], a[244:247], v[84:87], v[132:135]
    ds_read_b64_tr_b16 a[174:175], v11 offset:20480
    v_perm_b32 v207, v35, v34, s3
    v_mfma_f32_16x16x32_bf16 v[132:135], a[240:243], v[80:83], v[132:135]
    buffer_load_dwordx4 v42, s[16:19], s36 offen offset:3072 nt lds
    v_smfmac_f32_16x16x64_bf16 v[228:231], v[24:27], v[200:207], v250
    v_max3_f32 v36, v224, v225, v226
    v_max_f32 v36, v36, v227
    v_mfma_f32_16x16x32_bf16 v[140:143], a[240:243], v[96:99], v[220:223]
    ds_read_b64_tr_b16 a[204:205], v11 offset:24576
    ds_read_b64_tr_b16 a[206:207], v11 offset:28672
    v_mfma_f32_16x16x32_bf16 v[140:143], a[244:247], v[100:103], v[140:143]
    s_add_u32 s36, s36, 16384
    v_mfma_f32_16x16x32_bf16 v[140:143], a[248:251], v[104:107], v[140:143]
    s_sub_u32 s38, s38, 1
    v_mfma_f32_16x16x32_bf16 v[140:143], a[252:255], v[108:111], v[140:143]
    v_max3_f32 v36, v36, v228, v229
    v_max3_f32 v36, v36, v230, v231
    v_mfma_f32_16x16x32_bf16 v[136:139], a[236:239], v[108:111], v[220:223]
    v_cmp_lt_f32 vcc, s39, v36
    v_mfma_f32_16x16x32_bf16 v[136:139], a[232:235], v[104:107], v[136:139]
    v_mfma_f32_16x16x32_bf16 v[136:139], a[228:231], v[100:103], v[136:139]
    v_mfma_f32_16x16x32_bf16 v[136:139], a[224:227], v[96:99], v[136:139]
    s_cbranch_vccnz L_rare_l3
L_back_l3:
    s_cmp_lg_u32 s38, 0
    s_cbranch_scc1 L_loop_main_kernel
L_exit_main_kernel:
    v_mfma_f32_16x16x32_bf16 v[144:147], a[128:131], v[48:51], v[208:211]
    s_mov_b32 s34, 16384
    v_exp_f32 v28, v112 clamp
    v_mfma_f32_16x16x32_bf16 v[144:147], a[132:135], v[52:55], v[144:147]
    ds_read_b64_tr_b16 a[176:177], v12 offset:16384
    ds_read_b64_tr_b16 a[178:179], v12 offset:20480
    v_mfma_f32_16x16x32_bf16 v[144:147], a[136:139], v[56:59], v[144:147]
    s_getpc_b64 s[60:61]
L_pc_tail:
    v_exp_f32 v29, v113 clamp
    v_mfma_f32_16x16x32_bf16 v[144:147], a[140:143], v[60:63], v[144:147]
    ds_read_b64_tr_b16 a[208:209], v12 offset:24576
    ds_read_b64_tr_b16 a[210:211], v12 offset:28672
    v_mfma_f32_16x16x32_bf16 v[148:151], a[156:159], v[60:63], v[208:211]
    s_add_u32 s60, s60, L_tail_main_kernel-L_pc_tail
    v_exp_f32 v30, v114 clamp
    v_mfma_f32_16x16x32_bf16 v[148:151], a[152:155], v[56:59], v[148:151]
    ds_read_b64_tr_b16 a[180:181], v13 offset:16384
    v_perm_b32 v176, v29, v28, s3
    v_mfma_f32_16x16x32_bf16 v[148:151], a[148:151], v[52:55], v[148:151]
    s_addc_u32 s61, s61, 0
    v_exp_f32 v31, v115 clamp
    v_mfma_f32_16x16x32_bf16 v[148:151], a[144:147], v[48:51], v[148:151]
    ds_read_b64_tr_b16 a[182:183], v13 offset:20480
    ds_read_b64_tr_b16 a[212:213], v13 offset:24576
    v_mfma_f32_16x16x32_bf16 v[156:159], a[144:147], v[64:67], v[212:215]
    s_and_b32 s61, s61, 0xffff
    v_exp_f32 v32, v116 clamp
    v_mfma_f32_16x16x32_bf16 v[156:159], a[148:151], v[68:71], v[156:159]
    ds_read_b64_tr_b16 a[214:215], v13 offset:28672
    v_perm_b32 v177, v31, v30, s3
    v_mfma_f32_16x16x32_bf16 v[156:159], a[152:155], v[72:75], v[156:159]
    s_mov_b32 s62, L_hot_end-L_tail_main_kernel
    v_exp_f32 v33, v117 clamp
    v_mfma_f32_16x16x32_bf16 v[156:159], a[156:159], v[76:79], v[156:159]
    ds_read_b64_tr_b16 a[184:185], v14 offset:16384
    ds_read_b64_tr_b16 a[186:187], v14 offset:20480
    v_mfma_f32_16x16x32_bf16 v[152:155], a[140:143], v[76:79], v[212:215]
    s_mov_b32 s63, 0x20000
    v_exp_f32 v34, v118 clamp
    v_mfma_f32_16x16x32_bf16 v[152:155], a[136:139], v[72:75], v[152:155]
    ds_read_b64_tr_b16 a[216:217], v14 offset:24576
    v_perm_b32 v178, v33, v32, s3
    v_mfma_f32_16x16x32_bf16 v[152:155], a[132:135], v[68:71], v[152:155]
    s_cmp_lt_u32 s2, 16
    v_exp_f32 v35, v119 clamp
    v_mfma_f32_16x16x32_bf16 v[152:155], a[128:131], v[64:67], v[152:155]
    ds_read_b64_tr_b16 a[218:219], v14 offset:28672
    ds_read_b64_tr_b16 a[188:189], v15 offset:16384
    v_mfma_f32_16x16x32_bf16 v[160:163], a[128:131], v[80:83], v[216:219]
    s_cselect_b32 s62, s62, 0
    v_exp_f32 v28, v120 clamp
    v_mfma_f32_16x16x32_bf16 v[160:163], a[132:135], v[84:87], v[160:163]
    ds_read_b64_tr_b16 a[190:191], v15 offset:20480
    v_perm_b32 v179, v35, v34, s3
    v_mfma_f32_16x16x32_bf16 v[160:163], a[136:139], v[88:91], v[160:163]
    s_lshl_b32 s42, s15, 13
    v_exp_f32 v29, v121 clamp
    v_mfma_f32_16x16x32_bf16 v[160:163], a[140:143], v[92:95], v[160:163]
    ds_read_b64_tr_b16 a[220:221], v15 offset:24576
    ds_read_b64_tr_b16 a[222:223], v15 offset:28672
    v_mfma_f32_16x16x32_bf16 v[164:167], a[156:159], v[92:95], v[216:219]
    v_exp_f32 v30, v122 clamp
    v_mfma_f32_16x16x32_bf16 v[164:167], a[152:155], v[88:91], v[164:167]
    v_exp_f32 v31, v123 clamp
    v_mfma_f32_16x16x32_bf16 v[164:167], a[148:151], v[84:87], v[164:167]
    v_lshlrev_b32 v47, 7, v0
    v_perm_b32 v180, v29, v28, s3
    v_mfma_f32_16x16x32_bf16 v[164:167], a[144:147], v[80:83], v[164:167]
    v_exp_f32 v32, v124 clamp
    v_mfma_f32_16x16x32_bf16 v[172:175], a[144:147], v[96:99], v[220:223]
    v_exp_f32 v33, v125 clamp
    v_mfma_f32_16x16x32_bf16 v[172:175], a[148:151], v[100:103], v[172:175]
    buffer_load_dword v46, v47, s[60:63], s42 offen
    v_perm_b32 v181, v31, v30, s3
    v_mfma_f32_16x16x32_bf16 v[172:175], a[152:155], v[104:107], v[172:175]
    v_exp_f32 v34, v126 clamp
    v_mfma_f32_16x16x32_bf16 v[172:175], a[156:159], v[108:111], v[172:175]
    v_exp_f32 v35, v127 clamp
    v_mfma_f32_16x16x32_bf16 v[168:171], a[140:143], v[108:111], v[220:223]
    v_perm_b32 v182, v33, v32, s3
    v_perm_b32 v183, v35, v34, s3
    v_mfma_f32_16x16x32_bf16 v[168:171], a[136:139], v[104:107], v[168:171]
    v_exp_f32 v28, v128 clamp
    v_mfma_f32_16x16x32_bf16 v[168:171], a[132:135], v[100:103], v[168:171]
    v_exp_f32 v29, v129 clamp
    v_mfma_f32_16x16x32_bf16 v[168:171], a[128:131], v[96:99], v[168:171]
    s_waitcnt vmcnt(12) lgkmcnt(0)
    v_exp_f32 v30, v130 clamp
    v_smfmac_f32_16x16x64_bf16 v[224:227], v[24:27], v[176:183], v250
    s_barrier
    v_mfma_f32_16x16x32_bf16 a[0:3], a[160:163], v[232:235], a[0:3]
    ds_read_b128 a[224:227], v4 offset:32768
    v_perm_b32 v184, v29, v28, s3
    v_mfma_f32_16x16x32_bf16 a[0:3], a[192:195], v[192:195], a[0:3]
    s_add_u32 m0, s37, 16384
    v_exp_f32 v31, v131 clamp
    v_mfma_f32_16x16x32_bf16 a[4:7], a[196:199], v[192:195], a[4:7]
    ds_read_b128 a[228:231], v5 offset:32768
    v_perm_b32 v185, v31, v30, s3
    v_mfma_f32_16x16x32_bf16 a[4:7], a[164:167], v[232:235], a[4:7]
    v_exp_f32 v32, v132 clamp
    v_mfma_f32_16x16x32_bf16 a[8:11], a[168:171], v[232:235], a[8:11]
    v_exp_f32 v33, v133 clamp
    v_mfma_f32_16x16x32_bf16 a[8:11], a[200:203], v[192:195], a[8:11]
    ds_read_b128 a[232:235], v6 offset:32768
    v_perm_b32 v186, v33, v32, s3
    v_mfma_f32_16x16x32_bf16 a[12:15], a[204:207], v[192:195], a[12:15]
    v_exp_f32 v34, v134 clamp
    v_mfma_f32_16x16x32_bf16 a[12:15], a[172:175], v[232:235], a[12:15]
    v_exp_f32 v35, v135 clamp
    v_mfma_f32_16x16x32_bf16 a[16:19], a[176:179], v[232:235], a[16:19]
    ds_read_b128 a[236:239], v7 offset:32768
    v_perm_b32 v187, v35, v34, s3
    v_mfma_f32_16x16x32_bf16 a[16:19], a[208:211], v[192:195], a[16:19]
    v_exp_f32 v28, v136 clamp
    v_mfma_f32_16x16x32_bf16 a[20:23], a[212:215], v[192:195], a[20:23]
    v_exp_f32 v29, v137 clamp
    v_mfma_f32_16x16x32_bf16 a[20:23], a[180:183], v[232:235], a[20:23]
    ds_read_b128 a[240:243], v4 offset:36864
    v_perm_b32 v188, v29, v28, s3
    v_mfma_f32_16x16x32_bf16 a[24:27], a[184:187], v[232:235], a[24:27]
    v_exp_f32 v30, v138 clamp
    v_mfma_f32_16x16x32_bf16 a[24:27], a[216:219], v[192:195], a[24:27]
    v_exp_f32 v31, v139 clamp
    v_mfma_f32_16x16x32_bf16 a[28:31], a[220:223], v[192:195], a[28:31]
    ds_read_b128 a[244:247], v5 offset:36864
    v_perm_b32 v189, v31, v30, s3
    v_mfma_f32_16x16x32_bf16 a[28:31], a[188:191], v[232:235], a[28:31]
    v_exp_f32 v32, v140 clamp
    v_mfma_f32_16x16x32_bf16 a[32:35], a[160:163], v[236:239], a[32:35]
    v_exp_f32 v33, v141 clamp
    v_mfma_f32_16x16x32_bf16 a[32:35], a[192:195], v[196:199], a[32:35]
    ds_read_b128 a[248:251], v6 offset:36864
    v_perm_b32 v190, v33, v32, s3
    v_mfma_f32_16x16x32_bf16 a[36:39], a[196:199], v[196:199], a[36:39]
    v_exp_f32 v34, v142 clamp
    v_mfma_f32_16x16x32_bf16 a[36:39], a[164:167], v[236:239], a[36:39]
    v_exp_f32 v35, v143 clamp
    v_mfma_f32_16x16x32_bf16 a[40:43], a[168:171], v[236:239], a[40:43]
    ds_read_b128 a[252:255], v7 offset:36864
    v_perm_b32 v191, v35, v34, s3
    v_mfma_f32_16x16x32_bf16 a[40:43], a[200:203], v[196:199], a[40:43]
    v_max3_f32 v36, v224, v225, v226
    v_max_f32 v36, v36, v227
    v_smfmac_f32_16x16x64_bf16 v[228:231], v[24:27], v[184:191], v250
    buffer_load_dwordx4 v18, s[20:23], s44 offen offset:0 nt lds
    v_mfma_f32_16x16x32_bf16 a[44:47], a[204:207], v[196:199], a[44:47]
    v_mfma_f32_16x16x32_bf16 a[44:47], a[172:175], v[236:239], a[44:47]
    buffer_load_dwordx4 v19, s[20:23], s44 offen offset:1024 nt lds
    v_mfma_f32_16x16x32_bf16 a[48:51], a[176:179], v[236:239], a[48:51]
    v_mfma_f32_16x16x32_bf16 a[48:51], a[208:211], v[196:199], a[48:51]
    buffer_load_dwordx4 v18, s[20:23], s44 offen offset:2048 nt lds
    v_mfma_f32_16x16x32_bf16 a[52:55], a[212:215], v[196:199], a[52:55]
    v_mfma_f32_16x16x32_bf16 a[52:55], a[180:183], v[236:239], a[52:55]
    v_max3_f32 v36, v36, v228, v229
    v_max3_f32 v36, v36, v230, v231
    v_mfma_f32_16x16x32_bf16 a[56:59], a[184:187], v[236:239], a[56:59]
    v_cmp_lt_f32 vcc, s39, v36
    v_mfma_f32_16x16x32_bf16 a[56:59], a[216:219], v[196:199], a[56:59]
    buffer_load_dwordx4 v19, s[20:23], s44 offen offset:3072 nt lds
    v_mfma_f32_16x16x32_bf16 a[60:63], a[220:223], v[196:199], a[60:63]
    s_add_u32 s44, s44, 16384
    v_mfma_f32_16x16x32_bf16 a[60:63], a[188:191], v[236:239], a[60:63]
    s_cbranch_vccnz L_rare_e0
L_back_e0:
    v_mfma_f32_16x16x32_bf16 a[64:67], a[160:163], v[240:243], a[64:67]
    s_add_u32 s49, s49, 1
    v_exp_f32 v28, v144 clamp
    v_mfma_f32_16x16x32_bf16 a[64:67], a[192:195], v[200:203], a[64:67]
    ds_read_b128 a[128:131], v4 offset:40960
    ds_read_b128 a[132:135], v5 offset:40960
    v_mfma_f32_16x16x32_bf16 a[68:71], a[196:199], v[200:203], a[68:71]
    s_and_b32 s49, s49, 15
    v_exp_f32 v29, v145 clamp
    v_mfma_f32_16x16x32_bf16 a[68:71], a[164:167], v[240:243], a[68:71]
    ds_read_b128 a[136:139], v6 offset:40960
    v_perm_b32 v192, v29, v28, s3
    v_mfma_f32_16x16x32_bf16 a[72:75], a[168:171], v[240:243], a[72:75]
    s_lshl_b32 s43, s49, 15
    v_exp_f32 v30, v146 clamp
    v_mfma_f32_16x16x32_bf16 a[72:75], a[200:203], v[200:203], a[72:75]
    ds_read_b128 a[140:143], v7 offset:40960
    ds_read_b128 a[144:147], v4 offset:45056
    v_mfma_f32_16x16x32_bf16 a[76:79], a[204:207], v[200:203], a[76:79]
    s_add_u32 s49, s49, 1
    v_exp_f32 v31, v147 clamp
    v_mfma_f32_16x16x32_bf16 a[76:79], a[172:175], v[240:243], a[76:79]
    ds_read_b128 a[148:151], v5 offset:45056
    v_perm_b32 v193, v31, v30, s3
    v_mfma_f32_16x16x32_bf16 a[80:83], a[176:179], v[240:243], a[80:83]
    s_and_b32 s49, s49, 15
    v_exp_f32 v32, v148 clamp
    v_mfma_f32_16x16x32_bf16 a[80:83], a[208:211], v[200:203], a[80:83]
    ds_read_b128 a[152:155], v6 offset:45056
    ds_read_b128 a[156:159], v7 offset:45056
    v_mfma_f32_16x16x32_bf16 a[84:87], a[212:215], v[200:203], a[84:87]
    s_lshl_b32 s42, s49, 15
    v_exp_f32 v33, v149 clamp
    v_mfma_f32_16x16x32_bf16 a[84:87], a[180:183], v[240:243], a[84:87]
    v_perm_b32 v194, v33, v32, s3
    v_mfma_f32_16x16x32_bf16 a[88:91], a[184:187], v[240:243], a[88:91]
    s_add_u32 m0, s48, 32768
    v_exp_f32 v34, v150 clamp
    v_mfma_f32_16x16x32_bf16 a[88:91], a[216:219], v[200:203], a[88:91]
    v_exp_f32 v35, v151 clamp
    v_mfma_f32_16x16x32_bf16 a[92:95], a[220:223], v[200:203], a[92:95]
    v_perm_b32 v195, v35, v34, s3
    v_mfma_f32_16x16x32_bf16 a[92:95], a[188:191], v[240:243], a[92:95]
    v_exp_f32 v28, v152 clamp
    v_mfma_f32_16x16x32_bf16 a[96:99], a[160:163], v[244:247], a[96:99]
    s_waitcnt vmcnt(10) lgkmcnt(0)
    v_exp_f32 v29, v153 clamp
    v_mfma_f32_16x16x32_bf16 a[96:99], a[192:195], v[204:207], a[96:99]
    s_barrier
    v_mfma_f32_16x16x32_bf16 a[100:103], a[196:199], v[204:207], a[100:103]
    ds_read_b64_tr_b16 a[160:161], v8 offset:49152
    v_perm_b32 v196, v29, v28, s3
    v_mfma_f32_16x16x32_bf16 a[100:103], a[164:167], v[244:247], a[100:103]
    v_exp_f32 v30, v154 clamp
    v_mfma_f32_16x16x32_bf16 a[104:107], a[168:171], v[244:247], a[104:107]
    v_exp_f32 v31, v155 clamp
    v_mfma_f32_16x16x32_bf16 a[104:107], a[200:203], v[204:207], a[104:107]
    buffer_load_dwordx4 v44, s[96:99], s43 offen offset:0  lds
    v_mfma_f32_16x16x32_bf16 a[108:111], a[204:207], v[204:207], a[108:111]
    ds_read_b64_tr_b16 a[162:163], v8 offset:53248
    v_perm_b32 v197, v31, v30, s3
    v_mfma_f32_16x16x32_bf16 a[108:111], a[172:175], v[244:247], a[108:111]
    v_exp_f32 v32, v156 clamp
    v_mfma_f32_16x16x32_bf16 a[112:115], a[176:179], v[244:247], a[112:115]
    v_exp_f32 v33, v157 clamp
    v_mfma_f32_16x16x32_bf16 a[112:115], a[208:211], v[204:207], a[112:115]
    ds_read_b64_tr_b16 a[192:193], v8 offset:57344
    v_perm_b32 v198, v33, v32, s3
    v_mfma_f32_16x16x32_bf16 a[116:119], a[212:215], v[204:207], a[116:119]
    v_exp_f32 v34, v158 clamp
    v_mfma_f32_16x16x32_bf16 a[116:119], a[180:183], v[244:247], a[116:119]
    v_exp_f32 v35, v159 clamp
    v_mfma_f32_16x16x32_bf16 a[120:123], a[184:187], v[244:247], a[120:123]
    ds_read_b64_tr_b16 a[194:195], v8 offset:61440
    v_perm_b32 v199, v35, v34, s3
    v_mfma_f32_16x16x32_bf16 a[120:123], a[216:219], v[204:207], a[120:123]
    s_branch L_over4
.p2align 12
L_stub4:
    s_setpc_b64 s[46:47]
L_over4:
    v_exp_f32 v28, v160 clamp
    v_mfma_f32_16x16x32_bf16 a[124:127], a[220:223], v[204:207], a[124:127]
    v_exp_f32 v29, v161 clamp
    v_mfma_f32_16x16x32_bf16 a[124:127], a[188:191], v[244:247], a[124:127]
    v_exp_f32 v30, v162 clamp
    v_smfmac_f32_16x16x64_bf16 v[224:227], v[24:27], v[192:199], v250
    ds_read_b64_tr_b16 a[164:165], v9 offset:49152
    v_perm_b32 v200, v29, v28, s3
    v_mfma_f32_16x16x32_bf16 v[112:115], a[224:227], v[48:51], v[208:211]
    v_exp_f32 v31, v163 clamp
    v_mfma_f32_16x16x32_bf16 v[112:115], a[228:231], v[52:55], v[112:115]
    buffer_load_dwordx4 v45, s[96:99], s43 offen offset:1024  lds
    v_mfma_f32_16x16x32_bf16 v[112:115], a[232:235], v[56:59], v[112:115]
    ds_read_b64_tr_b16 a[166:167], v9 offset:53248
    v_perm_b32 v201, v31, v30, s3
    v_mfma_f32_16x16x32_bf16 v[112:115], a[236:239], v[60:63], v[112:115]
    v_exp_f32 v32, v164 clamp
    v_mfma_f32_16x16x32_bf16 v[116:119], a[252:255], v[60:63], v[208:211]
    v_exp_f32 v33, v165 clamp
    v_mfma_f32_16x16x32_bf16 v[116:119], a[248:251], v[56:59], v[116:119]
    ds_read_b64_tr_b16 a[196:197], v9 offset:57344
    v_perm_b32 v202, v33, v32, s3
    v_mfma_f32_16x16x32_bf16 v[116:119], a[244:247], v[52:55], v[116:119]
    v_exp_f32 v34, v166 clamp
    v_mfma_f32_16x16x32_bf16 v[116:119], a[240:243], v[48:51], v[116:119]
    v_exp_f32 v35, v167 clamp
    v_mfma_f32_16x16x32_bf16 v[124:127], a[240:243], v[64:67], v[212:215]
    ds_read_b64_tr_b16 a[198:199], v9 offset:61440
    v_perm_b32 v203, v35, v34, s3
    v_mfma_f32_16x16x32_bf16 v[124:127], a[244:247], v[68:71], v[124:127]
    v_exp_f32 v28, v168 clamp
    v_mfma_f32_16x16x32_bf16 v[124:127], a[248:251], v[72:75], v[124:127]
    v_exp_f32 v29, v169 clamp
    v_mfma_f32_16x16x32_bf16 v[124:127], a[252:255], v[76:79], v[124:127]
    ds_read_b64_tr_b16 a[168:169], v10 offset:49152
    v_perm_b32 v204, v29, v28, s3
    v_mfma_f32_16x16x32_bf16 v[120:123], a[236:239], v[76:79], v[212:215]
    s_add_u32 m0, s48, 40960
    v_exp_f32 v30, v170 clamp
    v_mfma_f32_16x16x32_bf16 v[120:123], a[232:235], v[72:75], v[120:123]
    buffer_load_dwordx4 v44, s[96:99], s42 offen offset:0  lds
    v_mfma_f32_16x16x32_bf16 v[120:123], a[228:231], v[68:71], v[120:123]
    v_exp_f32 v31, v171 clamp
    v_mfma_f32_16x16x32_bf16 v[120:123], a[224:227], v[64:67], v[120:123]
    ds_read_b64_tr_b16 a[170:171], v10 offset:53248
    v_perm_b32 v205, v31, v30, s3
    v_mfma_f32_16x16x32_bf16 v[128:131], a[224:227], v[80:83], v[216:219]
    v_exp_f32 v32, v172 clamp
    v_mfma_f32_16x16x32_bf16 v[128:131], a[228:231], v[84:87], v[128:131]
    v_exp_f32 v33, v173 clamp
    v_mfma_f32_16x16x32_bf16 v[128:131], a[232:235], v[88:91], v[128:131]
    ds_read_b64_tr_b16 a[200:201], v10 offset:57344
    v_perm_b32 v206, v33, v32, s3
    v_mfma_f32_16x16x32_bf16 v[128:131], a[236:239], v[92:95], v[128:131]
    v_exp_f32 v34, v174 clamp
    v_mfma_f32_16x16x32_bf16 v[132:135], a[252:255], v[92:95], v[216:219]
    ds_read_b64_tr_b16 a[202:203], v10 offset:61440
    ds_read_b64_tr_b16 a[172:173], v11 offset:49152
    v_mfma_f32_16x16x32_bf16 v[132:135], a[248:251], v[88:91], v[132:135]
    v_exp_f32 v35, v175 clamp
    v_mfma_f32_16x16x32_bf16 v[132:135], a[244:247], v[84:87], v[132:135]
    ds_read_b64_tr_b16 a[174:175], v11 offset:53248
    v_perm_b32 v207, v35, v34, s3
    v_mfma_f32_16x16x32_bf16 v[132:135], a[240:243], v[80:83], v[132:135]
    buffer_load_dwordx4 v45, s[96:99], s42 offen offset:1024  lds
    v_smfmac_f32_16x16x64_bf16 v[228:231], v[24:27], v[200:207], v250
    v_max3_f32 v36, v224, v225, v226
    v_max_f32 v36, v36, v227
    v_mfma_f32_16x16x32_bf16 v[140:143], a[240:243], v[96:99], v[220:223]
    ds_read_b64_tr_b16 a[204:205], v11 offset:57344
    ds_read_b64_tr_b16 a[206:207], v11 offset:61440
    v_mfma_f32_16x16x32_bf16 v[140:143], a[244:247], v[100:103], v[140:143]
    v_mfma_f32_16x16x32_bf16 v[140:143], a[248:251], v[104:107], v[140:143]
    v_mfma_f32_16x16x32_bf16 v[140:143], a[252:255], v[108:111], v[140:143]
    v_max3_f32 v36, v36, v228, v229
    v_max3_f32 v36, v36, v230, v231
    v_mfma_f32_16x16x32_bf16 v[136:139], a[236:239], v[108:111], v[220:223]
    v_cmp_lt_f32 vcc, s39, v36
    v_mfma_f32_16x16x32_bf16 v[136:139], a[232:235], v[104:107], v[136:139]
    v_mfma_f32_16x16x32_bf16 v[136:139], a[228:231], v[100:103], v[136:139]
    v_mfma_f32_16x16x32_bf16 v[136:139], a[224:227], v[96:99], v[136:139]
    s_cbranch_vccnz L_rare_e1
L_back_e1:
    v_mfma_f32_16x16x32_bf16 v[144:147], a[128:131], v[48:51], v[208:211]
    s_add_u32 s49, s49, 1
    v_exp_f32 v28, v112 clamp
    v_mfma_f32_16x16x32_bf16 v[144:147], a[132:135], v[52:55], v[144:147]
    ds_read_b64_tr_b16 a[176:177], v12 offset:49152
    ds_read_b64_tr_b16 a[178:179], v12 offset:53248
    v_mfma_f32_16x16x32_bf16 v[144:147], a[136:139], v[56:59], v[144:147]
    s_and_b32 s49, s49, 15
    v_exp_f32 v29, v113 clamp
    v_mfma_f32_16x16x32_bf16 v[144:147], a[140:143], v[60:63], v[144:147]
    ds_read_b64_tr_b16 a[208:209], v12 offset:57344
    ds_read_b64_tr_b16 a[210:211], v12 offset:61440
    v_mfma_f32_16x16x32_bf16 v[148:151], a[156:159], v[60:63], v[208:211]
    s_lshl_b32 s43, s49, 15
    v_exp_f32 v30, v114 clamp
    v_mfma_f32_16x16x32_bf16 v[148:151], a[152:155], v[56:59], v[148:151]
    ds_read_b64_tr_b16 a[180:181], v13 offset:49152
    v_perm_b32 v232, v29, v28, s3
    v_mfma_f32_16x16x32_bf16 v[148:151], a[148:151], v[52:55], v[148:151]
    s_add_u32 s49, s49, 1
    v_exp_f32 v31, v115 clamp
    v_mfma_f32_16x16x32_bf16 v[148:151], a[144:147], v[48:51], v[148:151]
    ds_read_b64_tr_b16 a[182:183], v13 offset:53248
    ds_read_b64_tr_b16 a[212:213], v13 offset:57344
    v_mfma_f32_16x16x32_bf16 v[156:159], a[144:147], v[64:67], v[212:215]
    s_and_b32 s49, s49, 15
    v_exp_f32 v32, v116 clamp
    v_mfma_f32_16x16x32_bf16 v[156:159], a[148:151], v[68:71], v[156:159]
    ds_read_b64_tr_b16 a[214:215], v13 offset:61440
    v_perm_b32 v233, v31, v30, s3
    v_mfma_f32_16x16x32_bf16 v[156:159], a[152:155], v[72:75], v[156:159]
    s_lshl_b32 s42, s49, 15
    v_exp_f32 v33, v117 clamp
    v_mfma_f32_16x16x32_bf16 v[156:159], a[156:159], v[76:79], v[156:159]
    ds_read_b64_tr_b16 a[184:185], v14 offset:49152
    ds_read_b64_tr_b16 a[186:187], v14 offset:53248
    v_mfma_f32_16x16x32_bf16 v[152:155], a[140:143], v[76:79], v[212:215]
    s_add_u32 m0, s48, 49152
    v_exp_f32 v34, v118 clamp
    v_mfma_f32_16x16x32_bf16 v[152:155], a[136:139], v[72:75], v[152:155]
    ds_read_b64_tr_b16 a[216:217], v14 offset:57344
    v_perm_b32 v234, v33, v32, s3
    v_mfma_f32_16x16x32_bf16 v[152:155], a[132:135], v[68:71], v[152:155]
    v_exp_f32 v35, v119 clamp
    v_mfma_f32_16x16x32_bf16 v[152:155], a[128:131], v[64:67], v[152:155]
    ds_read_b64_tr_b16 a[218:219], v14 offset:61440
    ds_read_b64_tr_b16 a[188:189], v15 offset:49152
    v_mfma_f32_16x16x32_bf16 v[160:163], a[128:131], v[80:83], v[216:219]
    v_exp_f32 v28, v120 clamp
    v_mfma_f32_16x16x32_bf16 v[160:163], a[132:135], v[84:87], v[160:163]
    ds_read_b64_tr_b16 a[190:191], v15 offset:53248
    v_perm_b32 v235, v35, v34, s3
    v_mfma_f32_16x16x32_bf16 v[160:163], a[136:139], v[88:91], v[160:163]
    v_exp_f32 v29, v121 clamp
    v_mfma_f32_16x16x32_bf16 v[160:163], a[140:143], v[92:95], v[160:163]
    ds_read_b64_tr_b16 a[220:221], v15 offset:57344
    ds_read_b64_tr_b16 a[222:223], v15 offset:61440
    v_mfma_f32_16x16x32_bf16 v[164:167], a[156:159], v[92:95], v[216:219]
    v_exp_f32 v30, v122 clamp
    v_mfma_f32_16x16x32_bf16 v[164:167], a[152:155], v[88:91], v[164:167]
    v_exp_f32 v31, v123 clamp
    v_mfma_f32_16x16x32_bf16 v[164:167], a[148:151], v[84:87], v[164:167]
    v_perm_b32 v236, v29, v28, s3
    v_mfma_f32_16x16x32_bf16 v[164:167], a[144:147], v[80:83], v[164:167]
    v_exp_f32 v32, v124 clamp
    v_mfma_f32_16x16x32_bf16 v[172:175], a[144:147], v[96:99], v[220:223]
    v_exp_f32 v33, v125 clamp
    v_mfma_f32_16x16x32_bf16 v[172:175], a[148:151], v[100:103], v[172:175]
    v_perm_b32 v237, v31, v30, s3
    v_mfma_f32_16x16x32_bf16 v[172:175], a[152:155], v[104:107], v[172:175]
    v_exp_f32 v34, v126 clamp
    v_mfma_f32_16x16x32_bf16 v[172:175], a[156:159], v[108:111], v[172:175]
    v_exp_f32 v35, v127 clamp
    v_mfma_f32_16x16x32_bf16 v[168:171], a[140:143], v[108:111], v[220:223]
    v_perm_b32 v238, v33, v32, s3
    v_perm_b32 v239, v35, v34, s3
    v_mfma_f32_16x16x32_bf16 v[168:171], a[136:139], v[104:107], v[168:171]
    v_exp_f32 v28, v128 clamp
    v_mfma_f32_16x16x32_bf16 v[168:171], a[132:135], v[100:103], v[168:171]
    v_exp_f32 v29, v129 clamp
    v_mfma_f32_16x16x32_bf16 v[168:171], a[128:131], v[96:99], v[168:171]
    s_waitcnt vmcnt(9) lgkmcnt(0)
    v_exp_f32 v30, v130 clamp
    v_smfmac_f32_16x16x64_bf16 v[224:227], v[24:27], v[232:239], v250
    s_barrier
    v_mfma_f32_16x16x32_bf16 a[0:3], a[160:163], v[176:179], a[0:3]
    v_perm_b32 v240, v29, v28, s3
    v_mfma_f32_16x16x32_bf16 a[0:3], a[192:195], v[192:195], a[0:3]
    v_exp_f32 v31, v131 clamp
    v_mfma_f32_16x16x32_bf16 a[4:7], a[196:199], v[192:195], a[4:7]
    v_perm_b32 v241, v31, v30, s3
    v_mfma_f32_16x16x32_bf16 a[4:7], a[164:167], v[176:179], a[4:7]
    v_exp_f32 v32, v132 clamp
    v_mfma_f32_16x16x32_bf16 a[8:11], a[168:171], v[176:179], a[8:11]
    v_exp_f32 v33, v133 clamp
    v_mfma_f32_16x16x32_bf16 a[8:11], a[200:203], v[192:195], a[8:11]
    v_perm_b32 v242, v33, v32, s3
    v_mfma_f32_16x16x32_bf16 a[12:15], a[204:207], v[192:195], a[12:15]
    v_exp_f32 v34, v134 clamp
    v_mfma_f32_16x16x32_bf16 a[12:15], a[172:175], v[176:179], a[12:15]
    v_exp_f32 v35, v135 clamp
    v_mfma_f32_16x16x32_bf16 a[16:19], a[176:179], v[176:179], a[16:19]
    v_perm_b32 v243, v35, v34, s3
    v_mfma_f32_16x16x32_bf16 a[16:19], a[208:211], v[192:195], a[16:19]
    v_exp_f32 v28, v136 clamp
    v_mfma_f32_16x16x32_bf16 a[20:23], a[212:215], v[192:195], a[20:23]
    v_exp_f32 v29, v137 clamp
    v_mfma_f32_16x16x32_bf16 a[20:23], a[180:183], v[176:179], a[20:23]
    v_perm_b32 v244, v29, v28, s3
    v_mfma_f32_16x16x32_bf16 a[24:27], a[184:187], v[176:179], a[24:27]
    v_exp_f32 v30, v138 clamp
    v_mfma_f32_16x16x32_bf16 a[24:27], a[216:219], v[192:195], a[24:27]
    v_exp_f32 v31, v139 clamp
    v_mfma_f32_16x16x32_bf16 a[28:31], a[220:223], v[192:195], a[28:31]
    v_perm_b32 v245, v31, v30, s3
    v_mfma_f32_16x16x32_bf16 a[28:31], a[188:191], v[176:179], a[28:31]
    v_exp_f32 v32, v140 clamp
    v_mfma_f32_16x16x32_bf16 a[32:35], a[160:163], v[180:183], a[32:35]
    v_exp_f32 v33, v141 clamp
    v_mfma_f32_16x16x32_bf16 a[32:35], a[192:195], v[196:199], a[32:35]
    v_perm_b32 v246, v33, v32, s3
    v_mfma_f32_16x16x32_bf16 a[36:39], a[196:199], v[196:199], a[36:39]
    v_exp_f32 v34, v142 clamp
    v_mfma_f32_16x16x32_bf16 a[36:39], a[164:167], v[180:183], a[36:39]
    v_exp_f32 v35, v143 clamp
    v_mfma_f32_16x16x32_bf16 a[40:43], a[168:171], v[180:183], a[40:43]
    v_perm_b32 v247, v35, v34, s3
    v_mfma_f32_16x16x32_bf16 a[40:43], a[200:203], v[196:199], a[40:43]
    v_max3_f32 v36, v224, v225, v226
    v_max_f32 v36, v36, v227
    v_smfmac_f32_16x16x64_bf16 v[228:231], v[24:27], v[240:247], v250
    buffer_load_dwordx4 v44, s[96:99], s43 offen offset:0  lds
    v_mfma_f32_16x16x32_bf16 a[44:47], a[204:207], v[196:199], a[44:47]
    v_mfma_f32_16x16x32_bf16 a[44:47], a[172:175], v[180:183], a[44:47]
    buffer_load_dwordx4 v45, s[96:99], s43 offen offset:1024  lds
    v_mfma_f32_16x16x32_bf16 a[48:51], a[176:179], v[180:183], a[48:51]
    s_add_u32 m0, s48, 57344
    v_mfma_f32_16x16x32_bf16 a[48:51], a[208:211], v[196:199], a[48:51]
    buffer_load_dwordx4 v44, s[96:99], s42 offen offset:0  lds
    v_mfma_f32_16x16x32_bf16 a[52:55], a[212:215], v[196:199], a[52:55]
    v_mfma_f32_16x16x32_bf16 a[52:55], a[180:183], v[180:183], a[52:55]
    v_max3_f32 v36, v36, v228, v229
    v_max3_f32 v36, v36, v230, v231
    v_mfma_f32_16x16x32_bf16 a[56:59], a[184:187], v[180:183], a[56:59]
    v_cmp_lt_f32 vcc, s39, v36
    v_mfma_f32_16x16x32_bf16 a[56:59], a[216:219], v[196:199], a[56:59]
    buffer_load_dwordx4 v45, s[96:99], s42 offen offset:1024  lds
    v_mfma_f32_16x16x32_bf16 a[60:63], a[220:223], v[196:199], a[60:63]
    v_mfma_f32_16x16x32_bf16 a[60:63], a[188:191], v[180:183], a[60:63]
    s_cbranch_vccnz L_rare_e2
L_back_e2:
    v_mfma_f32_16x16x32_bf16 a[64:67], a[160:163], v[184:187], a[64:67]
    v_exp_f32 v28, v144 clamp
    v_mfma_f32_16x16x32_bf16 a[64:67], a[192:195], v[200:203], a[64:67]
    v_bfe_u32 v41, v0, 2, 3
    v_and_b32 v42, 3, v0
    v_mfma_f32_16x16x32_bf16 a[68:71], a[196:199], v[200:203], a[68:71]
    v_exp_f32 v29, v145 clamp
    v_mfma_f32_16x16x32_bf16 a[68:71], a[164:167], v[184:187], a[68:71]
    v_lshlrev_b32 v42, 3, v42
    v_perm_b32 v192, v29, v28, s3
    v_mfma_f32_16x16x32_bf16 a[72:75], a[168:171], v[184:187], a[72:75]
    v_exp_f32 v30, v146 clamp
    v_mfma_f32_16x16x32_bf16 a[72:75], a[200:203], v[200:203], a[72:75]
    v_lshl_add_u32 v42, v41, 8, v42
    v_lshrrev_b32 v43, 5, v0
    v_mfma_f32_16x16x32_bf16 a[76:79], a[204:207], v[200:203], a[76:79]
    v_exp_f32 v31, v147 clamp
    v_mfma_f32_16x16x32_bf16 a[76:79], a[172:175], v[184:187], a[76:79]
    v_lshl_add_u32 v42, v43, 11, v42
    v_perm_b32 v193, v31, v30, s3
    v_mfma_f32_16x16x32_bf16 a[80:83], a[176:179], v[184:187], a[80:83]
    v_exp_f32 v32, v148 clamp
    v_mfma_f32_16x16x32_bf16 a[80:83], a[208:211], v[200:203], a[80:83]
    v_add_u32 v42, 32768, v42
    v_xor_b32 v43, 0, v41
    v_mfma_f32_16x16x32_bf16 a[84:87], a[212:215], v[200:203], a[84:87]
    v_exp_f32 v33, v149 clamp
    v_mfma_f32_16x16x32_bf16 a[84:87], a[180:183], v[184:187], a[84:87]
    v_lshl_add_u32 v4, v43, 5, v42
    v_perm_b32 v194, v33, v32, s3
    v_mfma_f32_16x16x32_bf16 a[88:91], a[184:187], v[184:187], a[88:91]
    v_exp_f32 v34, v150 clamp
    v_mfma_f32_16x16x32_bf16 a[88:91], a[216:219], v[200:203], a[88:91]
    v_exp_f32 v35, v151 clamp
    v_mfma_f32_16x16x32_bf16 a[92:95], a[220:223], v[200:203], a[92:95]
    v_xor_b32 v43, 1, v41
    v_perm_b32 v195, v35, v34, s3
    v_mfma_f32_16x16x32_bf16 a[92:95], a[188:191], v[184:187], a[92:95]
    v_exp_f32 v28, v152 clamp
    v_mfma_f32_16x16x32_bf16 a[96:99], a[160:163], v[188:191], a[96:99]
    s_waitcnt vmcnt(8) lgkmcnt(0)
    v_exp_f32 v29, v153 clamp
    v_mfma_f32_16x16x32_bf16 a[96:99], a[192:195], v[204:207], a[96:99]
    s_barrier
    v_mfma_f32_16x16x32_bf16 a[100:103], a[196:199], v[204:207], a[100:103]
    ds_read_b64_tr_b16 a[160:161], v8 offset:16384
    v_perm_b32 v196, v29, v28, s3
    v_mfma_f32_16x16x32_bf16 a[100:103], a[164:167], v[188:191], a[100:103]
    v_exp_f32 v30, v154 clamp
    v_mfma_f32_16x16x32_bf16 a[104:107], a[168:171], v[188:191], a[104:107]
    v_exp_f32 v31, v155 clamp
    v_mfma_f32_16x16x32_bf16 a[104:107], a[200:203], v[204:207], a[104:107]
    v_lshl_add_u32 v5, v43, 5, v42
    v_xor_b32 v43, 2, v41
    v_mfma_f32_16x16x32_bf16 a[108:111], a[204:207], v[204:207], a[108:111]
    ds_read_b64_tr_b16 a[162:163], v8 offset:20480
    v_perm_b32 v197, v31, v30, s3
    v_mfma_f32_16x16x32_bf16 a[108:111], a[172:175], v[188:191], a[108:111]
    v_exp_f32 v32, v156 clamp
    v_mfma_f32_16x16x32_bf16 a[112:115], a[176:179], v[188:191], a[112:115]
    v_exp_f32 v33, v157 clamp
    v_mfma_f32_16x16x32_bf16 a[112:115], a[208:211], v[204:207], a[112:115]
    ds_read_b64_tr_b16 a[192:193], v8 offset:24576
    v_perm_b32 v198, v33, v32, s3
    v_mfma_f32_16x16x32_bf16 a[116:119], a[212:215], v[204:207], a[116:119]
    v_exp_f32 v34, v158 clamp
    v_mfma_f32_16x16x32_bf16 a[116:119], a[180:183], v[188:191], a[116:119]
    v_exp_f32 v35, v159 clamp
    v_mfma_f32_16x16x32_bf16 a[120:123], a[184:187], v[188:191], a[120:123]
    ds_read_b64_tr_b16 a[194:195], v8 offset:28672
    v_perm_b32 v199, v35, v34, s3
    v_mfma_f32_16x16x32_bf16 a[120:123], a[216:219], v[204:207], a[120:123]
    v_exp_f32 v28, v160 clamp
    v_mfma_f32_16x16x32_bf16 a[124:127], a[220:223], v[204:207], a[124:127]
    v_exp_f32 v29, v161 clamp
    v_mfma_f32_16x16x32_bf16 a[124:127], a[188:191], v[188:191], a[124:127]
    ds_read_b64_tr_b16 a[164:165], v9 offset:16384
    ds_read_b64_tr_b16 a[166:167], v9 offset:20480
    ds_read_b64_tr_b16 a[196:197], v9 offset:24576
    ds_read_b64_tr_b16 a[198:199], v9 offset:28672
    ds_read_b64_tr_b16 a[168:169], v10 offset:16384
    ds_read_b64_tr_b16 a[170:171], v10 offset:20480
    ds_read_b64_tr_b16 a[200:201], v10 offset:24576
    ds_read_b64_tr_b16 a[202:203], v10 offset:28672
    ds_read_b64_tr_b16 a[172:173], v11 offset:16384
    ds_read_b64_tr_b16 a[174:175], v11 offset:20480
    ds_read_b64_tr_b16 a[204:205], v11 offset:24576
    ds_read_b64_tr_b16 a[206:207], v11 offset:28672
    ds_read_b64_tr_b16 a[176:177], v12 offset:16384
    ds_read_b64_tr_b16 a[178:179], v12 offset:20480
    ds_read_b64_tr_b16 a[208:209], v12 offset:24576
    ds_read_b64_tr_b16 a[210:211], v12 offset:28672
    ds_read_b64_tr_b16 a[180:181], v13 offset:16384
    ds_read_b64_tr_b16 a[182:183], v13 offset:20480
    ds_read_b64_tr_b16 a[212:213], v13 offset:24576
    ds_read_b64_tr_b16 a[214:215], v13 offset:28672
    ds_read_b64_tr_b16 a[184:185], v14 offset:16384
    ds_read_b64_tr_b16 a[186:187], v14 offset:20480
    ds_read_b64_tr_b16 a[216:217], v14 offset:24576
    ds_read_b64_tr_b16 a[218:219], v14 offset:28672
    ds_read_b64_tr_b16 a[188:189], v15 offset:16384
    ds_read_b64_tr_b16 a[190:191], v15 offset:20480
    ds_read_b64_tr_b16 a[220:221], v15 offset:24576
    ds_read_b64_tr_b16 a[222:223], v15 offset:28672
    v_exp_f32 v30, v162 clamp
    v_smfmac_f32_16x16x64_bf16 v[224:227], v[24:27], v[192:199], v250
    v_perm_b32 v200, v29, v28, s3
    v_exp_f32 v31, v163 clamp
    s_nop 0
    v_perm_b32 v201, v31, v30, s3
    v_exp_f32 v32, v164 clamp
    v_exp_f32 v33, v165 clamp
    s_nop 0
    v_perm_b32 v202, v33, v32, s3
    v_exp_f32 v34, v166 clamp
    v_exp_f32 v35, v167 clamp
    v_lshl_add_u32 v6, v43, 5, v42
    v_xor_b32 v43, 3, v41
    v_lshl_add_u32 v7, v43, 5, v42
    v_xor_b32 v43, 4, v41
    v_lshl_add_u32 v16, v43, 5, v42
    v_xor_b32 v43, 5, v41
    v_lshl_add_u32 v17, v43, 5, v42
    v_xor_b32 v43, 6, v41
    v_lshl_add_u32 v18, v43, 5, v42
    v_xor_b32 v43, 7, v41
    v_lshl_add_u32 v19, v43, 5, v42
    v_perm_b32 v203, v35, v34, s3
    v_exp_f32 v28, v168 clamp
    v_exp_f32 v29, v169 clamp
    s_nop 0
    v_perm_b32 v204, v29, v28, s3
    v_exp_f32 v30, v170 clamp
    v_exp_f32 v31, v171 clamp
    s_nop 0
    v_perm_b32 v205, v31, v30, s3
    v_exp_f32 v32, v172 clamp
    v_exp_f32 v33, v173 clamp
    s_nop 0
    v_perm_b32 v206, v33, v32, s3
    v_exp_f32 v34, v174 clamp
    v_exp_f32 v35, v175 clamp
    s_nop 0
    v_perm_b32 v207, v35, v34, s3
    s_nop 1
    v_smfmac_f32_16x16x64_bf16 v[228:231], v[24:27], v[200:207], v250
    v_max3_f32 v36, v224, v225, v226
    v_max_f32 v36, v36, v227
    s_nop 5
    v_max3_f32 v36, v36, v228, v229
    s_nop 3
    v_max3_f32 v36, v36, v230, v231
    v_cmp_lt_f32 vcc, s39, v36
    s_cbranch_vccnz L_rare_e3
L_back_e3:
L_tail_main_kernel:
    s_lshl_b32 s40, s57, 3
    s_add_u32 s40, s40, s58
    s_lshl_b32 s40, s40, 7
    s_add_u32 s77, s40, 180224
    buffer_load_dword v3, off, s[52:55], s77 sc1
    s_cmp_eq_u32 s91, 0
    s_cbranch_scc1 L_ofar_main_kernel
    s_movk_i32 s42, 4096
    s_movk_i32 s43, 8192
    s_movk_i32 s44, 12288
    v_add_f32 v28, v224, v225
    v_add_f32 v30, v226, v227
    v_add_f32 v32, v228, v229
    v_add_f32 v34, v230, v231
    s_waitcnt lgkmcnt(0)
    v_mfma_f32_16x16x32_bf16 a[0:3], a[160:163], v[232:235], a[0:3]
    v_rcp_f32 v28, v28
    v_mfma_f32_16x16x32_bf16 a[0:3], a[192:195], v[192:195], a[0:3]
    v_rcp_f32 v30, v30
    v_mfma_f32_16x16x32_bf16 a[4:7], a[196:199], v[192:195], a[4:7]
    v_rcp_f32 v32, v32
    v_mfma_f32_16x16x32_bf16 a[4:7], a[164:167], v[232:235], a[4:7]
    v_rcp_f32 v34, v34
    v_mfma_f32_16x16x32_bf16 a[8:11], a[168:171], v[232:235], a[8:11]
    ds_read_b64_tr_b16 a[224:225], v4 offset:32768
    v_mfma_f32_16x16x32_bf16 a[8:11], a[200:203], v[192:195], a[8:11]
    ds_read_b64_tr_b16 a[226:227], v4 offset:36864
    v_mfma_f32_16x16x32_bf16 a[12:15], a[204:207], v[192:195], a[12:15]
    ds_read_b64_tr_b16 a[228:229], v4 offset:40960
    v_accvgpr_read_b32 v112, a0
    v_accvgpr_read_b32 v113, a1
    v_accvgpr_read_b32 v114, a2
    v_accvgpr_read_b32 v115, a3
    v_accvgpr_read_b32 v116, a4
    v_mfma_f32_16x16x32_bf16 a[12:15], a[172:175], v[232:235], a[12:15]
    ds_read_b64_tr_b16 a[230:231], v4 offset:45056
    v_accvgpr_read_b32 v117, a5
    v_accvgpr_read_b32 v118, a6
    v_accvgpr_read_b32 v119, a7
    v_mul_f32 v112, v112, v28
    v_mul_f32 v113, v113, v28
    v_mfma_f32_16x16x32_bf16 a[16:19], a[176:179], v[232:235], a[16:19]
    ds_read_b64_tr_b16 a[232:233], v4 offset:49152
    v_mul_f32 v114, v114, v28
    v_mul_f32 v115, v115, v28
    v_mul_f32 v116, v116, v28
    v_mul_f32 v117, v117, v28
    v_mul_f32 v118, v118, v28
    v_mfma_f32_16x16x32_bf16 a[16:19], a[208:211], v[192:195], a[16:19]
    ds_read_b64_tr_b16 a[234:235], v4 offset:53248
    v_mul_f32 v119, v119, v28
    v_cvt_pk_bf16_f32 v48, v112, v113
    v_cvt_pk_bf16_f32 v49, v114, v115
    v_cvt_pk_bf16_f32 v50, v116, v117
    v_cvt_pk_bf16_f32 v51, v118, v119
    v_mfma_f32_16x16x32_bf16 a[20:23], a[212:215], v[192:195], a[20:23]
    buffer_store_dwordx4 v[48:51], v20, s[32:35], 0 offen offset:0
    v_accvgpr_read_b32 v120, a8
    v_accvgpr_read_b32 v121, a9
    v_accvgpr_read_b32 v122, a10
    v_accvgpr_read_b32 v123, a11
    v_accvgpr_read_b32 v124, a12
    v_mfma_f32_16x16x32_bf16 a[20:23], a[180:183], v[232:235], a[20:23]
    ds_read_b64_tr_b16 a[236:237], v4 offset:57344
    v_accvgpr_read_b32 v125, a13
    v_accvgpr_read_b32 v126, a14
    v_accvgpr_read_b32 v127, a15
    v_mul_f32 v120, v120, v28
    v_mul_f32 v121, v121, v28
    v_mfma_f32_16x16x32_bf16 a[24:27], a[184:187], v[232:235], a[24:27]
    ds_read_b64_tr_b16 a[238:239], v4 offset:61440
    v_mul_f32 v122, v122, v28
    v_mul_f32 v123, v123, v28
    v_mul_f32 v124, v124, v28
    v_mul_f32 v125, v125, v28
    v_mul_f32 v126, v126, v28
    v_mfma_f32_16x16x32_bf16 a[24:27], a[216:219], v[192:195], a[24:27]
    ds_read_b64_tr_b16 a[240:241], v5 offset:32768
    v_mul_f32 v127, v127, v28
    v_cvt_pk_bf16_f32 v64, v120, v121
    v_cvt_pk_bf16_f32 v65, v122, v123
    v_cvt_pk_bf16_f32 v66, v124, v125
    v_cvt_pk_bf16_f32 v67, v126, v127
    v_mfma_f32_16x16x32_bf16 a[28:31], a[220:223], v[192:195], a[28:31]
    buffer_store_dwordx4 v[64:67], v20, s[32:35], s42 offen offset:0
    v_accvgpr_read_b32 v128, a16
    v_accvgpr_read_b32 v129, a17
    v_accvgpr_read_b32 v130, a18
    v_accvgpr_read_b32 v131, a19
    v_accvgpr_read_b32 v132, a20
    v_mfma_f32_16x16x32_bf16 a[28:31], a[188:191], v[232:235], a[28:31]
    ds_read_b64_tr_b16 a[242:243], v5 offset:36864
    v_accvgpr_read_b32 v133, a21
    v_accvgpr_read_b32 v134, a22
    v_accvgpr_read_b32 v135, a23
    v_mul_f32 v128, v128, v28
    v_mul_f32 v129, v129, v28
    v_mfma_f32_16x16x32_bf16 a[32:35], a[160:163], v[236:239], a[32:35]
    ds_read_b64_tr_b16 a[244:245], v5 offset:40960
    v_mul_f32 v130, v130, v28
    v_mul_f32 v131, v131, v28
    v_mul_f32 v132, v132, v28
    v_mul_f32 v133, v133, v28
    v_mul_f32 v134, v134, v28
    v_mfma_f32_16x16x32_bf16 a[32:35], a[192:195], v[196:199], a[32:35]
    ds_read_b64_tr_b16 a[246:247], v5 offset:45056
    v_mul_f32 v135, v135, v28
    v_cvt_pk_bf16_f32 v80, v128, v129
    v_cvt_pk_bf16_f32 v81, v130, v131
    v_cvt_pk_bf16_f32 v82, v132, v133
    v_cvt_pk_bf16_f32 v83, v134, v135
    v_mfma_f32_16x16x32_bf16 a[36:39], a[196:199], v[196:199], a[36:39]
    buffer_store_dwordx4 v[80:83], v20, s[32:35], s43 offen offset:0
    v_accvgpr_read_b32 v136, a24
    v_accvgpr_read_b32 v137, a25
    v_accvgpr_read_b32 v138, a26
    v_accvgpr_read_b32 v139, a27
    v_accvgpr_read_b32 v140, a28
    v_mfma_f32_16x16x32_bf16 a[36:39], a[164:167], v[236:239], a[36:39]
    ds_read_b64_tr_b16 a[248:249], v5 offset:49152
    v_accvgpr_read_b32 v141, a29
    v_accvgpr_read_b32 v142, a30
    v_accvgpr_read_b32 v143, a31
    v_mul_f32 v136, v136, v28
    v_mul_f32 v137, v137, v28
    v_mfma_f32_16x16x32_bf16 a[40:43], a[168:171], v[236:239], a[40:43]
    ds_read_b64_tr_b16 a[250:251], v5 offset:53248
    v_mul_f32 v138, v138, v28
    v_mul_f32 v139, v139, v28
    v_mul_f32 v140, v140, v28
    v_mul_f32 v141, v141, v28
    v_mul_f32 v142, v142, v28
    v_mfma_f32_16x16x32_bf16 a[40:43], a[200:203], v[196:199], a[40:43]
    ds_read_b64_tr_b16 a[252:253], v5 offset:57344
    v_mul_f32 v143, v143, v28
    v_cvt_pk_bf16_f32 v96, v136, v137
    v_cvt_pk_bf16_f32 v97, v138, v139
    v_cvt_pk_bf16_f32 v98, v140, v141
    v_cvt_pk_bf16_f32 v99, v142, v143
    v_mfma_f32_16x16x32_bf16 a[44:47], a[204:207], v[196:199], a[44:47]
    buffer_store_dwordx4 v[96:99], v20, s[32:35], s44 offen offset:0
    v_accvgpr_read_b32 v144, a32
    v_accvgpr_read_b32 v145, a33
    v_accvgpr_read_b32 v146, a34
    v_accvgpr_read_b32 v147, a35
    v_accvgpr_read_b32 v148, a36
    v_mfma_f32_16x16x32_bf16 a[44:47], a[172:175], v[236:239], a[44:47]
    ds_read_b64_tr_b16 a[254:255], v5 offset:61440
    v_accvgpr_read_b32 v149, a37
    v_accvgpr_read_b32 v150, a38
    v_accvgpr_read_b32 v151, a39
    v_mul_f32 v144, v144, v30
    v_mul_f32 v145, v145, v30
    v_mfma_f32_16x16x32_bf16 a[48:51], a[176:179], v[236:239], a[48:51]
    v_mul_f32 v146, v146, v30
    v_mul_f32 v147, v147, v30
    v_mul_f32 v148, v148, v30
    v_mul_f32 v149, v149, v30
    v_mul_f32 v150, v150, v30
    v_mfma_f32_16x16x32_bf16 a[48:51], a[208:211], v[196:199], a[48:51]
    v_mul_f32 v151, v151, v30
    v_cvt_pk_bf16_f32 v52, v144, v145
    v_cvt_pk_bf16_f32 v53, v146, v147
    v_cvt_pk_bf16_f32 v54, v148, v149
    v_cvt_pk_bf16_f32 v55, v150, v151
    v_mfma_f32_16x16x32_bf16 a[52:55], a[212:215], v[196:199], a[52:55]
    buffer_store_dwordx4 v[52:55], v20, s[32:35], 0 offen offset:1024
    v_accvgpr_read_b32 v152, a40
    v_accvgpr_read_b32 v153, a41
    v_accvgpr_read_b32 v154, a42
    v_accvgpr_read_b32 v155, a43
    v_accvgpr_read_b32 v156, a44
    v_mfma_f32_16x16x32_bf16 a[52:55], a[180:183], v[236:239], a[52:55]
    s_branch L_over5
.p2align 12
L_stub5:
    s_setpc_b64 s[46:47]
L_over5:
    v_accvgpr_read_b32 v157, a45
    v_accvgpr_read_b32 v158, a46
    v_accvgpr_read_b32 v159, a47
    v_mul_f32 v152, v152, v30
    v_mul_f32 v153, v153, v30
    v_mfma_f32_16x16x32_bf16 a[56:59], a[184:187], v[236:239], a[56:59]
    v_mul_f32 v154, v154, v30
    v_mul_f32 v155, v155, v30
    v_mul_f32 v156, v156, v30
    v_mul_f32 v157, v157, v30
    v_mul_f32 v158, v158, v30
    v_mfma_f32_16x16x32_bf16 a[56:59], a[216:219], v[196:199], a[56:59]
    v_mul_f32 v159, v159, v30
    v_cvt_pk_bf16_f32 v68, v152, v153
    v_cvt_pk_bf16_f32 v69, v154, v155
    v_cvt_pk_bf16_f32 v70, v156, v157
    v_cvt_pk_bf16_f32 v71, v158, v159
    v_mfma_f32_16x16x32_bf16 a[60:63], a[220:223], v[196:199], a[60:63]
    buffer_store_dwordx4 v[68:71], v20, s[32:35], s42 offen offset:1024
    v_accvgpr_read_b32 v160, a48
    v_accvgpr_read_b32 v161, a49
    v_accvgpr_read_b32 v162, a50
    v_accvgpr_read_b32 v163, a51
    v_accvgpr_read_b32 v164, a52
    v_mfma_f32_16x16x32_bf16 a[60:63], a[188:191], v[236:239], a[60:63]
    v_accvgpr_read_b32 v165, a53
    v_accvgpr_read_b32 v166, a54
    v_accvgpr_read_b32 v167, a55
    v_mul_f32 v160, v160, v30
    v_mul_f32 v161, v161, v30
    v_mfma_f32_16x16x32_bf16 a[64:67], a[160:163], v[240:243], a[64:67]
    v_mul_f32 v162, v162, v30
    v_mul_f32 v163, v163, v30
    v_mul_f32 v164, v164, v30
    v_mul_f32 v165, v165, v30
    v_mul_f32 v166, v166, v30
    v_mfma_f32_16x16x32_bf16 a[64:67], a[192:195], v[200:203], a[64:67]
    v_mul_f32 v167, v167, v30
    v_cvt_pk_bf16_f32 v84, v160, v161
    v_cvt_pk_bf16_f32 v85, v162, v163
    v_cvt_pk_bf16_f32 v86, v164, v165
    v_cvt_pk_bf16_f32 v87, v166, v167
    v_mfma_f32_16x16x32_bf16 a[68:71], a[196:199], v[200:203], a[68:71]
    buffer_store_dwordx4 v[84:87], v20, s[32:35], s43 offen offset:1024
    v_accvgpr_read_b32 v168, a56
    v_accvgpr_read_b32 v169, a57
    v_accvgpr_read_b32 v170, a58
    v_accvgpr_read_b32 v171, a59
    v_accvgpr_read_b32 v172, a60
    v_mfma_f32_16x16x32_bf16 a[68:71], a[164:167], v[240:243], a[68:71]
    v_accvgpr_read_b32 v173, a61
    v_accvgpr_read_b32 v174, a62
    v_accvgpr_read_b32 v175, a63
    v_mul_f32 v168, v168, v30
    v_mul_f32 v169, v169, v30
    v_mfma_f32_16x16x32_bf16 a[72:75], a[168:171], v[240:243], a[72:75]
    v_mul_f32 v170, v170, v30
    v_mul_f32 v171, v171, v30
    v_mul_f32 v172, v172, v30
    v_mul_f32 v173, v173, v30
    v_mul_f32 v174, v174, v30
    v_mfma_f32_16x16x32_bf16 a[72:75], a[200:203], v[200:203], a[72:75]
    v_mul_f32 v175, v175, v30
    v_cvt_pk_bf16_f32 v100, v168, v169
    v_cvt_pk_bf16_f32 v101, v170, v171
    v_cvt_pk_bf16_f32 v102, v172, v173
    v_cvt_pk_bf16_f32 v103, v174, v175
    v_mfma_f32_16x16x32_bf16 a[76:79], a[204:207], v[200:203], a[76:79]
    buffer_store_dwordx4 v[100:103], v20, s[32:35], s44 offen offset:1024
    v_accvgpr_read_b32 v112, a64
    v_accvgpr_read_b32 v113, a65
    v_accvgpr_read_b32 v114, a66
    v_accvgpr_read_b32 v115, a67
    v_accvgpr_read_b32 v116, a68
    v_mfma_f32_16x16x32_bf16 a[76:79], a[172:175], v[240:243], a[76:79]
    v_accvgpr_read_b32 v117, a69
    v_accvgpr_read_b32 v118, a70
    v_accvgpr_read_b32 v119, a71
    v_mul_f32 v112, v112, v32
    v_mul_f32 v113, v113, v32
    v_mfma_f32_16x16x32_bf16 a[80:83], a[176:179], v[240:243], a[80:83]
    v_mul_f32 v114, v114, v32
    v_mul_f32 v115, v115, v32
    v_mul_f32 v116, v116, v32
    v_mul_f32 v117, v117, v32
    v_mul_f32 v118, v118, v32
    v_mfma_f32_16x16x32_bf16 a[80:83], a[208:211], v[200:203], a[80:83]
    v_mul_f32 v119, v119, v32
    v_cvt_pk_bf16_f32 v56, v112, v113
    v_cvt_pk_bf16_f32 v57, v114, v115
    v_cvt_pk_bf16_f32 v58, v116, v117
    v_cvt_pk_bf16_f32 v59, v118, v119
    v_mfma_f32_16x16x32_bf16 a[84:87], a[212:215], v[200:203], a[84:87]
    buffer_store_dwordx4 v[56:59], v20, s[32:35], 0 offen offset:2048
    v_accvgpr_read_b32 v120, a72
    v_accvgpr_read_b32 v121, a73
    v_accvgpr_read_b32 v122, a74
    v_accvgpr_read_b32 v123, a75
    v_accvgpr_read_b32 v124, a76
    v_mfma_f32_16x16x32_bf16 a[84:87], a[180:183], v[240:243], a[84:87]
    v_accvgpr_read_b32 v125, a77
    v_accvgpr_read_b32 v126, a78
    v_accvgpr_read_b32 v127, a79
    v_mul_f32 v120, v120, v32
    v_mul_f32 v121, v121, v32
    v_mfma_f32_16x16x32_bf16 a[88:91], a[184:187], v[240:243], a[88:91]
    v_mul_f32 v122, v122, v32
    v_mul_f32 v123, v123, v32
    v_mul_f32 v124, v124, v32
    v_mul_f32 v125, v125, v32
    v_mul_f32 v126, v126, v32
    v_mfma_f32_16x16x32_bf16 a[88:91], a[216:219], v[200:203], a[88:91]
    v_mul_f32 v127, v127, v32
    v_cvt_pk_bf16_f32 v72, v120, v121
    v_cvt_pk_bf16_f32 v73, v122, v123
    v_cvt_pk_bf16_f32 v74, v124, v125
    v_cvt_pk_bf16_f32 v75, v126, v127
    v_mfma_f32_16x16x32_bf16 a[92:95], a[220:223], v[200:203], a[92:95]
    buffer_store_dwordx4 v[72:75], v20, s[32:35], s42 offen offset:2048
    v_accvgpr_read_b32 v128, a80
    v_accvgpr_read_b32 v129, a81
    v_accvgpr_read_b32 v130, a82
    v_accvgpr_read_b32 v131, a83
    v_accvgpr_read_b32 v132, a84
    v_mfma_f32_16x16x32_bf16 a[92:95], a[188:191], v[240:243], a[92:95]
    v_accvgpr_read_b32 v133, a85
    v_accvgpr_read_b32 v134, a86
    v_accvgpr_read_b32 v135, a87
    v_mul_f32 v128, v128, v32
    v_mul_f32 v129, v129, v32
    v_mfma_f32_16x16x32_bf16 a[96:99], a[160:163], v[244:247], a[96:99]
    v_mul_f32 v130, v130, v32
    v_mul_f32 v131, v131, v32
    v_mul_f32 v132, v132, v32
    v_mul_f32 v133, v133, v32
    v_mul_f32 v134, v134, v32
    v_mfma_f32_16x16x32_bf16 a[96:99], a[192:195], v[204:207], a[96:99]
    v_mul_f32 v135, v135, v32
    v_cvt_pk_bf16_f32 v88, v128, v129
    v_cvt_pk_bf16_f32 v89, v130, v131
    v_cvt_pk_bf16_f32 v90, v132, v133
    v_cvt_pk_bf16_f32 v91, v134, v135
    v_mfma_f32_16x16x32_bf16 a[100:103], a[196:199], v[204:207], a[100:103]
    buffer_store_dwordx4 v[88:91], v20, s[32:35], s43 offen offset:2048
    v_accvgpr_read_b32 v136, a88
    v_accvgpr_read_b32 v137, a89
    v_accvgpr_read_b32 v138, a90
    v_accvgpr_read_b32 v139, a91
    v_accvgpr_read_b32 v140, a92
    v_mfma_f32_16x16x32_bf16 a[100:103], a[164:167], v[244:247], a[100:103]
    v_accvgpr_read_b32 v141, a93
    v_accvgpr_read_b32 v142, a94
    v_accvgpr_read_b32 v143, a95
    v_mul_f32 v136, v136, v32
    v_mul_f32 v137, v137, v32
    v_mfma_f32_16x16x32_bf16 a[104:107], a[168:171], v[244:247], a[104:107]
    v_mul_f32 v138, v138, v32
    v_mul_f32 v139, v139, v32
    v_mul_f32 v140, v140, v32
    v_mul_f32 v141, v141, v32
    v_mul_f32 v142, v142, v32
    v_mfma_f32_16x16x32_bf16 a[104:107], a[200:203], v[204:207], a[104:107]
    v_mul_f32 v143, v143, v32
    v_cvt_pk_bf16_f32 v104, v136, v137
    v_cvt_pk_bf16_f32 v105, v138, v139
    v_cvt_pk_bf16_f32 v106, v140, v141
    v_cvt_pk_bf16_f32 v107, v142, v143
    v_mfma_f32_16x16x32_bf16 a[108:111], a[204:207], v[204:207], a[108:111]
    buffer_store_dwordx4 v[104:107], v20, s[32:35], s44 offen offset:2048
    v_accvgpr_read_b32 v144, a96
    v_accvgpr_read_b32 v145, a97
    v_accvgpr_read_b32 v146, a98
    v_accvgpr_read_b32 v147, a99
    v_accvgpr_read_b32 v148, a100
    v_mfma_f32_16x16x32_bf16 a[108:111], a[172:175], v[244:247], a[108:111]
    v_accvgpr_read_b32 v149, a101
    v_accvgpr_read_b32 v150, a102
    v_accvgpr_read_b32 v151, a103
    v_mul_f32 v144, v144, v34
    v_mul_f32 v145, v145, v34
    v_mfma_f32_16x16x32_bf16 a[112:115], a[176:179], v[244:247], a[112:115]
    v_mul_f32 v146, v146, v34
    v_mul_f32 v147, v147, v34
    v_mul_f32 v148, v148, v34
    v_mul_f32 v149, v149, v34
    v_mul_f32 v150, v150, v34
    v_mfma_f32_16x16x32_bf16 a[112:115], a[208:211], v[204:207], a[112:115]
    v_mul_f32 v151, v151, v34
    v_cvt_pk_bf16_f32 v60, v144, v145
    v_cvt_pk_bf16_f32 v61, v146, v147
    v_cvt_pk_bf16_f32 v62, v148, v149
    v_cvt_pk_bf16_f32 v63, v150, v151
    v_mfma_f32_16x16x32_bf16 a[116:119], a[212:215], v[204:207], a[116:119]
    buffer_store_dwordx4 v[60:63], v20, s[32:35], 0 offen offset:3072
    v_accvgpr_read_b32 v152, a104
    v_accvgpr_read_b32 v153, a105
    v_accvgpr_read_b32 v154, a106
    v_accvgpr_read_b32 v155, a107
    v_accvgpr_read_b32 v156, a108
    v_mfma_f32_16x16x32_bf16 a[116:119], a[180:183], v[244:247], a[116:119]
    v_accvgpr_read_b32 v157, a109
    v_accvgpr_read_b32 v158, a110
    v_accvgpr_read_b32 v159, a111
    v_mul_f32 v152, v152, v34
    v_mul_f32 v153, v153, v34
    v_mfma_f32_16x16x32_bf16 a[120:123], a[184:187], v[244:247], a[120:123]
    v_mul_f32 v154, v154, v34
    v_mul_f32 v155, v155, v34
    v_mul_f32 v156, v156, v34
    v_mul_f32 v157, v157, v34
    v_mul_f32 v158, v158, v34
    v_mfma_f32_16x16x32_bf16 a[120:123], a[216:219], v[204:207], a[120:123]
    v_mul_f32 v159, v159, v34
    v_cvt_pk_bf16_f32 v76, v152, v153
    v_cvt_pk_bf16_f32 v77, v154, v155
    v_cvt_pk_bf16_f32 v78, v156, v157
    v_cvt_pk_bf16_f32 v79, v158, v159
    v_mfma_f32_16x16x32_bf16 a[124:127], a[220:223], v[204:207], a[124:127]
    buffer_store_dwordx4 v[76:79], v20, s[32:35], s42 offen offset:3072
    v_accvgpr_read_b32 v160, a112
    v_accvgpr_read_b32 v161, a113
    v_accvgpr_read_b32 v162, a114
    v_accvgpr_read_b32 v163, a115
    v_accvgpr_read_b32 v164, a116
    v_mfma_f32_16x16x32_bf16 a[124:127], a[188:191], v[244:247], a[124:127]
    v_accvgpr_read_b32 v165, a117
    v_accvgpr_read_b32 v166, a118
    v_accvgpr_read_b32 v167, a119
    v_mul_f32 v160, v160, v34
    v_mul_f32 v161, v161, v34
    v_mul_f32 v162, v162, v34
    v_mul_f32 v163, v163, v34
    v_mul_f32 v164, v164, v34
    v_mul_f32 v165, v165, v34
    v_mul_f32 v166, v166, v34
    v_mul_f32 v167, v167, v34
    v_cvt_pk_bf16_f32 v92, v160, v161
    v_cvt_pk_bf16_f32 v93, v162, v163
    v_cvt_pk_bf16_f32 v94, v164, v165
    v_cvt_pk_bf16_f32 v95, v166, v167
    v_accvgpr_read_b32 v168, a120
    v_accvgpr_read_b32 v169, a121
    v_accvgpr_read_b32 v170, a122
    v_accvgpr_read_b32 v171, a123
    buffer_store_dwordx4 v[92:95], v20, s[32:35], s43 offen offset:3072
    v_accvgpr_read_b32 v172, a124
    v_accvgpr_read_b32 v173, a125
    v_accvgpr_read_b32 v174, a126
    v_accvgpr_read_b32 v175, a127
    v_mul_f32 v168, v168, v34
    v_mul_f32 v169, v169, v34
    v_mul_f32 v170, v170, v34
    v_mul_f32 v171, v171, v34
    v_mul_f32 v172, v172, v34
    v_mul_f32 v173, v173, v34
    v_mul_f32 v174, v174, v34
    v_mul_f32 v175, v175, v34
    v_cvt_pk_bf16_f32 v108, v168, v169
    v_cvt_pk_bf16_f32 v109, v170, v171
    v_cvt_pk_bf16_f32 v110, v172, v173
    v_cvt_pk_bf16_f32 v111, v174, v175
    buffer_store_dwordx4 v[108:111], v20, s[32:35], s44 offen offset:3072
L_oback_main_kernel:
    s_lshl_b32 s40, s57, 3
    s_add_u32 s40, s40, s58
    s_lshl_b32 s40, s40, 7
    s_add_u32 s77, s40, 180224
    s_waitcnt lgkmcnt(0)
    v_mfma_f32_16x16x32_bf16 v[112:115], a[224:227], v[48:51], 0
    s_cmp_lt_u32 s78, 31
    ds_read_b64_tr_b16 a[192:193], v6 offset:32768
    ds_read_b64_tr_b16 a[194:195], v6 offset:36864
    s_cselect_b32 s82, 0, 5
    s_cmp_lt_u32 s79, 242
    v_mfma_f32_16x16x32_bf16 v[112:115], a[228:231], v[64:67], v[112:115]
    s_cselect_b32 s82, s82, 5
    ds_read_b64_tr_b16 a[196:197], v6 offset:40960
    ds_read_b64_tr_b16 a[198:199], v6 offset:45056
    s_min_u32 s79, s79, 241
    s_cmp_ge_u32 s79, 121
    v_mfma_f32_16x16x32_bf16 v[112:115], a[232:235], v[80:83], v[112:115]
    s_cselect_b32 s40, 121, 0
    ds_read_b64_tr_b16 a[200:201], v6 offset:49152
    ds_read_b64_tr_b16 a[202:203], v6 offset:53248
    s_cselect_b32 s41, 11, 0
    s_sub_u32 s40, s79, s40
    v_mfma_f32_16x16x32_bf16 v[112:115], a[236:239], v[96:99], v[112:115]
    s_cmp_ge_u32 s40, 66
    ds_read_b64_tr_b16 a[204:205], v6 offset:57344
    ds_read_b64_tr_b16 a[206:207], v6 offset:61440
    s_cselect_b32 s42, 66, 0
    s_cselect_b32 s43, 6, 0
    v_mfma_f32_16x16x32_bf16 v[144:147], a[236:239], v[100:103], 0
    s_cselect_b32 s83, 5, 6
    ds_read_b64_tr_b16 a[208:209], v7 offset:32768
    ds_read_b64_tr_b16 a[210:211], v7 offset:36864
    s_cselect_b32 s84, 52, 43
    s_sub_u32 s40, s40, s42
    v_mfma_f32_16x16x32_bf16 v[144:147], a[232:235], v[84:87], v[144:147]
    s_add_u32 s41, s41, s43
    ds_read_b64_tr_b16 a[212:213], v7 offset:40960
    ds_read_b64_tr_b16 a[214:215], v7 offset:45056
    s_mul_i32 s84, s84, s40
    s_lshr_b32 s84, s84, 8
    v_mfma_f32_16x16x32_bf16 v[144:147], a[228:231], v[68:71], v[144:147]
    s_mul_i32 s83, s83, s84
    ds_read_b64_tr_b16 a[216:217], v7 offset:49152
    ds_read_b64_tr_b16 a[218:219], v7 offset:53248
    s_sub_u32 s83, s40, s83
    s_add_u32 s83, s83, s41
    v_mfma_f32_16x16x32_bf16 v[144:147], a[224:227], v[52:55], v[144:147]
    s_cmp_ge_u32 s15, 2
    ds_read_b64_tr_b16 a[220:221], v7 offset:57344
    ds_read_b64_tr_b16 a[222:223], v7 offset:61440
    s_cselect_b32 s40, s66, s64
    s_cselect_b32 s41, s67, s65
    v_mfma_f32_16x16x32_bf16 v[176:179], a[224:227], v[56:59], 0
    s_lshl_b32 s42, s83, 7
    s_add_u32 s24, s40, s42
    s_addc_u32 s25, s41, 0
    s_sub_u32 s26, 1409024, s42
    s_cmp_eq_u32 s82, 0
    v_mfma_f32_16x16x32_bf16 v[176:179], a[228:231], v[72:75], v[176:179]
    s_cselect_b32 s26, s26, 0
    s_and_b32 s25, s25, 0xffff
    s_mov_b32 s27, 0x20000
    s_mul_i32 s85, s79, 0
    s_mul_i32 s40, s84, 1
    v_mfma_f32_16x16x32_bf16 v[176:179], a[232:235], v[88:91], v[176:179]
    s_add_u32 s85, s85, s40
    s_mul_i32 s40, s58, 2
    s_add_u32 s85, s85, s40
    s_and_b32 s85, s85, 15
    s_mov_b32 s49, s85
    v_mfma_f32_16x16x32_bf16 v[176:179], a[236:239], v[104:107], v[176:179]
    s_lshl_b32 s50, s14, 2
    s_add_u32 s50, s50, 4
    s_and_b32 s50, s50, 15
    s_lshl_b32 s40, s58, 21
    s_lshl_b32 s41, s59, 16
    v_mfma_f32_16x16x32_bf16 v[208:211], a[236:239], v[108:111], 0
    s_add_u32 s40, s40, s41
    s_lshl_b32 s41, s14, 14
    s_add_u32 s40, s40, s41
    s_add_u32 s32, s40, 20971520
    s_add_u32 s32, s72, s32
    v_mfma_f32_16x16x32_bf16 v[208:211], a[232:235], v[92:95], v[208:211]
    s_addc_u32 s33, s73, 0
    s_and_b32 s33, s33, 0xffff
    s_mov_b32 s34, 16384
    s_mov_b32 s35, 0x20000
    v_lshrrev_b32 v38, 3, v0
    v_mfma_f32_16x16x32_bf16 v[208:211], a[228:231], v[76:79], v[208:211]
    v_and_b32 v39, 7, v0
    v_bfe_u32 v40, v0, 4, 2
    v_lshlrev_b32 v40, 1, v40
    v_xor_b32 v39, v39, v40
    v_mfma_f32_16x16x32_bf16 v[208:211], a[224:227], v[60:63], v[208:211]
    v_mul_u32_u24 v38, 2752, v38
    v_lshl_add_u32 v44, v39, 4, v38
    s_and_b32 s40, s15, 1
    s_mul_i32 s40, s40, 44032
    v_mfma_f32_16x16x32_bf16 v[212:215], a[240:243], v[60:63], 0
    v_add_u32 v44, s40, v44
    v_add_u32 v45, 20992, v44
    v_add_u32 v8, 0x10000, v4
    v_add_u32 v9, 0x10000, v5
    v_mfma_f32_16x16x32_bf16 v[212:215], a[244:247], v[76:79], v[212:215]
    v_add_u32 v10, 0x10000, v6
    v_add_u32 v11, 0x10000, v7
    v_add_u32 v12, 0x10000, v16
    v_add_u32 v13, 0x10000, v17
    v_mfma_f32_16x16x32_bf16 v[212:215], a[248:251], v[92:95], v[212:215]
    v_add_u32 v14, 0x10000, v18
    v_add_u32 v15, 0x10000, v19
    v_and_b32 v2, 3, v0
    v_lshlrev_b32 v2, 2, v2
    v_mfma_f32_16x16x32_bf16 v[212:215], a[252:255], v[108:111], v[212:215]
    s_mul_i32 s40, s58, 1
    s_mul_i32 s41, s57, 1
    s_add_u32 s40, s40, s41
    s_and_b32 s40, s40, 3
    s_lshl_b32 s36, s40, 12
    v_mfma_f32_16x16x32_bf16 v[180:183], a[252:255], v[104:107], 0
    s_mov_b32 s51, s74
    s_add_u32 s60, s51, 20971520
    s_add_u32 s60, s72, s60
    s_addc_u32 s61, s73, 0
    s_and_b32 s61, s61, 0xffff
    v_mfma_f32_16x16x32_bf16 v[180:183], a[248:251], v[88:91], v[180:183]
    s_mov_b32 s62, 14745600
    s_mov_b32 s63, 0x20000
    s_lshl_b32 s80, s57, 10
    s_add_u32 s80, s80, 131080
    s_and_b32 s40, s2, 7
    v_mfma_f32_16x16x32_bf16 v[180:183], a[244:247], v[72:75], v[180:183]
    s_lshl_b32 s40, s40, 7
    s_add_u32 s40, s40, s80
    s_add_u32 s96, s72, s40
    s_addc_u32 s97, s73, 0
    s_mov_b32 s99, 0
    v_mfma_f32_16x16x32_bf16 v[180:183], a[240:243], v[56:59], v[180:183]
    s_lshl_b32 s81, s15, 3
    s_lshl_b32 s86, s15, 22
    s_add_u32 s87, s86, 2097152
    s_lshl_b32 s88, s58, 2
    s_lshl_b32 s88, 1, s88
    v_mfma_f32_16x16x32_bf16 v[148:151], a[240:243], v[52:55], 0
    v_lshrrev_b32 v46, 2, v0
    v_and_b32 v47, 3, v0
    v_lshlrev_b32 v46, 12, v46
    v_lshl_add_u32 v46, v47, 8, v46
    v_mfma_f32_16x16x32_bf16 v[148:151], a[244:247], v[68:71], v[148:151]
    v_mfma_f32_16x16x32_bf16 v[148:151], a[248:251], v[84:87], v[148:151]
    v_mfma_f32_16x16x32_bf16 v[148:151], a[252:255], v[100:103], v[148:151]
    v_mfma_f32_16x16x32_bf16 v[116:119], a[252:255], v[96:99], 0
    v_mfma_f32_16x16x32_bf16 v[116:119], a[248:251], v[80:83], v[116:119]
    v_mfma_f32_16x16x32_bf16 v[116:119], a[244:247], v[64:67], v[116:119]
    v_mfma_f32_16x16x32_bf16 v[116:119], a[240:243], v[48:51], v[116:119]
    v_mov_b32 v1, 1
    s_lshl_b32 s40, s14, 2
    s_add_u32 s40, s40, s77
    s_waitcnt vmcnt(0)
    s_barrier
    s_cmp_lg_u32 s15, 0
    s_cbranch_scc1 L_of1_main_kernel
    s_mov_b64 exec, 1
    s_cmp_eq_u32 s91, 0
    s_cbranch_scc1 L_of2_main_kernel
    buffer_store_dword v1, off, s[52:55], s40 offset:32
L_of3_main_kernel:
    s_mov_b64 exec, -1
L_of1_main_kernel:
    s_waitcnt lgkmcnt(0)
    v_mfma_f32_16x16x32_bf16 v[120:123], a[192:195], v[48:51], 0
    ds_read_b64_tr_b16 a[224:225], v16 offset:32768
    ds_read_b64_tr_b16 a[226:227], v16 offset:36864
    v_mfma_f32_16x16x32_bf16 v[120:123], a[196:199], v[64:67], v[120:123]
    ds_read_b64_tr_b16 a[228:229], v16 offset:40960
    ds_read_b64_tr_b16 a[230:231], v16 offset:45056
    v_mfma_f32_16x16x32_bf16 v[120:123], a[200:203], v[80:83], v[120:123]
    ds_read_b64_tr_b16 a[232:233], v16 offset:49152
    ds_read_b64_tr_b16 a[234:235], v16 offset:53248
    v_mfma_f32_16x16x32_bf16 v[120:123], a[204:207], v[96:99], v[120:123]
    ds_read_b64_tr_b16 a[236:237], v16 offset:57344
    ds_read_b64_tr_b16 a[238:239], v16 offset:61440
    v_mfma_f32_16x16x32_bf16 v[152:155], a[204:207], v[100:103], 0
    ds_read_b64_tr_b16 a[240:241], v17 offset:32768
    ds_read_b64_tr_b16 a[242:243], v17 offset:36864
    v_mfma_f32_16x16x32_bf16 v[152:155], a[200:203], v[84:87], v[152:155]
    ds_read_b64_tr_b16 a[244:245], v17 offset:40960
    ds_read_b64_tr_b16 a[246:247], v17 offset:45056
    v_mfma_f32_16x16x32_bf16 v[152:155], a[196:199], v[68:71], v[152:155]
    ds_read_b64_tr_b16 a[248:249], v17 offset:49152
    ds_read_b64_tr_b16 a[250:251], v17 offset:53248
    v_mfma_f32_16x16x32_bf16 v[152:155], a[192:195], v[52:55], v[152:155]
    ds_read_b64_tr_b16 a[252:253], v17 offset:57344
    ds_read_b64_tr_b16 a[254:255], v17 offset:61440
    v_mfma_f32_16x16x32_bf16 v[184:187], a[192:195], v[56:59], 0
    v_mfma_f32_16x16x32_bf16 v[184:187], a[196:199], v[72:75], v[184:187]
    v_mfma_f32_16x16x32_bf16 v[184:187], a[200:203], v[88:91], v[184:187]
    v_mfma_f32_16x16x32_bf16 v[184:187], a[204:207], v[104:107], v[184:187]
    v_mfma_f32_16x16x32_bf16 v[216:219], a[204:207], v[108:111], 0
    v_mfma_f32_16x16x32_bf16 v[216:219], a[200:203], v[92:95], v[216:219]
    v_mfma_f32_16x16x32_bf16 v[216:219], a[196:199], v[76:79], v[216:219]
    buffer_load_dword v3, v2, s[52:55], s77 offen offset:32 sc1
    v_mfma_f32_16x16x32_bf16 v[216:219], a[192:195], v[60:63], v[216:219]
    v_mfma_f32_16x16x32_bf16 v[220:223], a[208:211], v[60:63], 0
    v_mfma_f32_16x16x32_bf16 v[220:223], a[212:215], v[76:79], v[220:223]
    v_mfma_f32_16x16x32_bf16 v[220:223], a[216:219], v[92:95], v[220:223]
    v_mfma_f32_16x16x32_bf16 v[220:223], a[220:223], v[108:111], v[220:223]
    v_mfma_f32_16x16x32_bf16 v[188:191], a[220:223], v[104:107], 0
    v_mfma_f32_16x16x32_bf16 v[188:191], a[216:219], v[88:91], v[188:191]
    v_mfma_f32_16x16x32_bf16 v[188:191], a[212:215], v[72:75], v[188:191]
    v_mfma_f32_16x16x32_bf16 v[188:191], a[208:211], v[56:59], v[188:191]
    v_mfma_f32_16x16x32_bf16 v[156:159], a[208:211], v[52:55], 0
    v_mfma_f32_16x16x32_bf16 v[156:159], a[212:215], v[68:71], v[156:159]
    v_mfma_f32_16x16x32_bf16 v[156:159], a[216:219], v[84:87], v[156:159]
    v_mfma_f32_16x16x32_bf16 v[156:159], a[220:223], v[100:103], v[156:159]
    v_mfma_f32_16x16x32_bf16 v[124:127], a[220:223], v[96:99], 0
    v_mfma_f32_16x16x32_bf16 v[124:127], a[216:219], v[80:83], v[124:127]
    v_mfma_f32_16x16x32_bf16 v[124:127], a[212:215], v[64:67], v[124:127]
    v_mfma_f32_16x16x32_bf16 v[124:127], a[208:211], v[48:51], v[124:127]
    s_mov_b32 s40, 0
L_opoll_main_kernel:
    s_waitcnt vmcnt(0)
    v_cmp_eq_u32 vcc, 0, v3
    s_add_u32 s40, s40, 1
    s_cbranch_vccnz L_oslow_main_kernel
L_oready_main_kernel:
    s_waitcnt lgkmcnt(0)
    v_mfma_f32_16x16x32_bf16 v[128:131], a[224:227], v[48:51], 0
    ds_read_b64_tr_b16 a[192:193], v18 offset:32768
    ds_read_b64_tr_b16 a[194:195], v18 offset:36864
    v_mfma_f32_16x16x32_bf16 v[128:131], a[228:231], v[64:67], v[128:131]
    ds_read_b64_tr_b16 a[196:197], v18 offset:40960
    ds_read_b64_tr_b16 a[198:199], v18 offset:45056
    v_mfma_f32_16x16x32_bf16 v[128:131], a[232:235], v[80:83], v[128:131]
    s_lshl_b32 s44, s50, 12
    buffer_load_dwordx4 a[0:3], v20, s[28:31], s44 offen offset:0 sc1
    v_mfma_f32_16x16x32_bf16 v[128:131], a[236:239], v[96:99], v[128:131]
    v_mfma_f32_16x16x32_bf16 v[160:163], a[236:239], v[100:103], 0
    s_add_u32 s50, s50, 1
    ds_read_b64_tr_b16 a[200:201], v18 offset:49152
    ds_read_b64_tr_b16 a[202:203], v18 offset:53248
    v_mfma_f32_16x16x32_bf16 v[160:163], a[232:235], v[84:87], v[160:163]
    s_and_b32 s50, s50, 15
    buffer_load_dwordx4 a[4:7], v20, s[28:31], s44 offen offset:1024 sc1
    v_mfma_f32_16x16x32_bf16 v[160:163], a[228:231], v[68:71], v[160:163]
    v_mfma_f32_16x16x32_bf16 v[160:163], a[224:227], v[52:55], v[160:163]
    ds_read_b64_tr_b16 a[204:205], v18 offset:57344
    ds_read_b64_tr_b16 a[206:207], v18 offset:61440
    v_mfma_f32_16x16x32_bf16 v[192:195], a[224:227], v[56:59], 0
    ds_read_b64_tr_b16 a[208:209], v19 offset:32768
    ds_read_b64_tr_b16 a[210:211], v19 offset:36864
    v_mfma_f32_16x16x32_bf16 v[192:195], a[228:231], v[72:75], v[192:195]
    buffer_load_dwordx4 a[8:11], v20, s[28:31], s44 offen offset:2048 sc1
    v_mfma_f32_16x16x32_bf16 v[192:195], a[232:235], v[88:91], v[192:195]
    v_mfma_f32_16x16x32_bf16 v[192:195], a[236:239], v[104:107], v[192:195]
    ds_read_b64_tr_b16 a[212:213], v19 offset:40960
    ds_read_b64_tr_b16 a[214:215], v19 offset:45056
    v_mfma_f32_16x16x32_bf16 v[224:227], a[236:239], v[108:111], 0
    ds_read_b64_tr_b16 a[216:217], v19 offset:49152
    ds_read_b64_tr_b16 a[218:219], v19 offset:53248
    v_mfma_f32_16x16x32_bf16 v[224:227], a[232:235], v[92:95], v[224:227]
    buffer_load_dwordx4 a[12:15], v20, s[28:31], s44 offen offset:3072 sc1
    v_mfma_f32_16x16x32_bf16 v[224:227], a[228:231], v[76:79], v[224:227]
    v_mfma_f32_16x16x32_bf16 v[224:227], a[224:227], v[60:63], v[224:227]
    ds_read_b64_tr_b16 a[220:221], v19 offset:57344
    ds_read_b64_tr_b16 a[222:223], v19 offset:61440
    v_mfma_f32_16x16x32_bf16 v[228:231], a[240:243], v[60:63], 0
    v_mfma_f32_16x16x32_bf16 v[228:231], a[244:247], v[76:79], v[228:231]
    s_lshl_b32 s44, s50, 12
    buffer_load_dwordx4 a[16:19], v20, s[28:31], s44 offen offset:0 sc1
    v_mfma_f32_16x16x32_bf16 v[228:231], a[248:251], v[92:95], v[228:231]
    v_mfma_f32_16x16x32_bf16 v[228:231], a[252:255], v[108:111], v[228:231]
    s_add_u32 s50, s50, 1
    v_mfma_f32_16x16x32_bf16 v[196:199], a[252:255], v[104:107], 0
    s_and_b32 s50, s50, 15
    buffer_load_dwordx4 a[20:23], v20, s[28:31], s44 offen offset:1024 sc1
    v_mfma_f32_16x16x32_bf16 v[196:199], a[248:251], v[88:91], v[196:199]
    v_mfma_f32_16x16x32_bf16 v[196:199], a[244:247], v[72:75], v[196:199]
    v_mfma_f32_16x16x32_bf16 v[196:199], a[240:243], v[56:59], v[196:199]
    v_mfma_f32_16x16x32_bf16 v[164:167], a[240:243], v[52:55], 0
    buffer_load_dwordx4 a[24:27], v20, s[28:31], s44 offen offset:2048 sc1
    v_mfma_f32_16x16x32_bf16 v[164:167], a[244:247], v[68:71], v[164:167]
    v_mfma_f32_16x16x32_bf16 v[164:167], a[248:251], v[84:87], v[164:167]
    v_mfma_f32_16x16x32_bf16 v[164:167], a[252:255], v[100:103], v[164:167]
    v_mfma_f32_16x16x32_bf16 v[132:135], a[252:255], v[96:99], 0
    buffer_load_dwordx4 a[28:31], v20, s[28:31], s44 offen offset:3072 sc1
    v_mfma_f32_16x16x32_bf16 v[132:135], a[248:251], v[80:83], v[132:135]
    v_mfma_f32_16x16x32_bf16 v[132:135], a[244:247], v[64:67], v[132:135]
    v_mfma_f32_16x16x32_bf16 v[132:135], a[240:243], v[48:51], v[132:135]
    s_waitcnt lgkmcnt(0)
    v_mfma_f32_16x16x32_bf16 v[136:139], a[192:195], v[48:51], 0
    ds_read_b64_tr_b16 a[224:225], v8 offset:0
    ds_read_b64_tr_b16 a[226:227], v8 offset:4096
    v_mfma_f32_16x16x32_bf16 v[136:139], a[196:199], v[64:67], v[136:139]
    ds_read_b64_tr_b16 a[228:229], v8 offset:8192
    ds_read_b64_tr_b16 a[230:231], v8 offset:12288
    v_mfma_f32_16x16x32_bf16 v[136:139], a[200:203], v[80:83], v[136:139]
    v_mov_b32 v36, 0
    global_load_dword v36, v36, s[100:101] offset:4 sc1
    v_mfma_f32_16x16x32_bf16 v[136:139], a[204:207], v[96:99], v[136:139]
    v_mfma_f32_16x16x32_bf16 v[168:171], a[204:207], v[100:103], 0
    ds_read_b64_tr_b16 a[232:233], v9 offset:0
    ds_read_b64_tr_b16 a[234:235], v9 offset:4096
    v_mfma_f32_16x16x32_bf16 v[168:171], a[200:203], v[84:87], v[168:171]
    s_lshl_b32 s44, s50, 12
    buffer_load_dwordx4 a[32:35], v20, s[28:31], s44 offen offset:0 sc1
    v_mfma_f32_16x16x32_bf16 v[168:171], a[196:199], v[68:71], v[168:171]
    v_mfma_f32_16x16x32_bf16 v[168:171], a[192:195], v[52:55], v[168:171]
    s_add_u32 s50, s50, 1
    ds_read_b64_tr_b16 a[236:237], v9 offset:8192
    ds_read_b64_tr_b16 a[238:239], v9 offset:12288
    v_mfma_f32_16x16x32_bf16 v[200:203], a[192:195], v[56:59], 0
    s_and_b32 s50, s50, 15
    buffer_load_dwordx4 a[36:39], v20, s[28:31], s44 offen offset:1024 sc1
    v_mfma_f32_16x16x32_bf16 v[200:203], a[196:199], v[72:75], v[200:203]
    v_mfma_f32_16x16x32_bf16 v[200:203], a[200:203], v[88:91], v[200:203]
    ds_read_b64_tr_b16 a[240:241], v10 offset:0
    ds_read_b64_tr_b16 a[242:243], v10 offset:4096
    v_mfma_f32_16x16x32_bf16 v[200:203], a[204:207], v[104:107], v[200:203]
    ds_read_b64_tr_b16 a[244:245], v10 offset:8192
    ds_read_b64_tr_b16 a[246:247], v10 offset:12288
    v_mfma_f32_16x16x32_bf16 v[232:235], a[204:207], v[108:111], 0
    buffer_load_dwordx4 a[40:43], v20, s[28:31], s44 offen offset:2048 sc1
    v_mfma_f32_16x16x32_bf16 v[232:235], a[200:203], v[92:95], v[232:235]
    v_mfma_f32_16x16x32_bf16 v[232:235], a[196:199], v[76:79], v[232:235]
    ds_read_b64_tr_b16 a[248:249], v11 offset:0
    ds_read_b64_tr_b16 a[250:251], v11 offset:4096
    v_mfma_f32_16x16x32_bf16 v[232:235], a[192:195], v[60:63], v[232:235]
    buffer_load_dwordx4 a[44:47], v20, s[28:31], s44 offen offset:3072 sc1
    v_mfma_f32_16x16x32_bf16 v[236:239], a[208:211], v[60:63], 0
    v_mfma_f32_16x16x32_bf16 v[236:239], a[212:215], v[76:79], v[236:239]
    ds_read_b64_tr_b16 a[252:253], v11 offset:8192
    ds_read_b64_tr_b16 a[254:255], v11 offset:12288
    v_mfma_f32_16x16x32_bf16 v[236:239], a[216:219], v[92:95], v[236:239]
    s_lshl_b32 s44, s50, 12
    buffer_load_dwordx4 a[48:51], v20, s[28:31], s44 offen offset:0 sc1
    v_mfma_f32_16x16x32_bf16 v[236:239], a[220:223], v[108:111], v[236:239]
    v_mfma_f32_16x16x32_bf16 v[204:207], a[220:223], v[104:107], 0
    v_mfma_f32_16x16x32_bf16 v[204:207], a[216:219], v[88:91], v[204:207]
    s_add_u32 s50, s50, 1
    v_mfma_f32_16x16x32_bf16 v[204:207], a[212:215], v[72:75], v[204:207]
    s_and_b32 s50, s50, 15
    buffer_load_dwordx4 a[52:55], v20, s[28:31], s44 offen offset:1024 sc1
    v_mfma_f32_16x16x32_bf16 v[204:207], a[208:211], v[56:59], v[204:207]
    v_mfma_f32_16x16x32_bf16 v[172:175], a[208:211], v[52:55], 0
    v_mfma_f32_16x16x32_bf16 v[172:175], a[212:215], v[68:71], v[172:175]
    buffer_load_dwordx4 a[56:59], v20, s[28:31], s44 offen offset:2048 sc1
    v_mfma_f32_16x16x32_bf16 v[172:175], a[216:219], v[84:87], v[172:175]
    v_mfma_f32_16x16x32_bf16 v[172:175], a[220:223], v[100:103], v[172:175]
    s_branch L_over6
.p2align 12
L_stub6:
    s_setpc_b64 s[46:47]
L_over6:
    v_mfma_f32_16x16x32_bf16 v[140:143], a[220:223], v[96:99], 0
    buffer_load_dwordx4 a[60:63], v20, s[28:31], s44 offen offset:3072 sc1
    v_mfma_f32_16x16x32_bf16 v[140:143], a[216:219], v[80:83], v[140:143]
    v_mfma_f32_16x16x32_bf16 v[140:143], a[212:215], v[64:67], v[140:143]
    v_mfma_f32_16x16x32_bf16 v[140:143], a[208:211], v[48:51], v[140:143]
    s_waitcnt vmcnt(9) lgkmcnt(0)
    v_mfma_f32_16x16x32_bf16 v[112:115], a[224:227], a[0:3], v[112:115]
    ds_read_b64_tr_b16 a[192:193], v12 offset:0
    ds_read_b64_tr_b16 a[194:195], v12 offset:4096
    v_mfma_f32_16x16x32_bf16 v[112:115], a[228:231], a[16:19], v[112:115]
    ds_read_b64_tr_b16 a[196:197], v12 offset:8192
    ds_read_b64_tr_b16 a[198:199], v12 offset:12288
    v_mfma_f32_16x16x32_bf16 v[144:147], a[228:231], a[20:23], v[144:147]
    s_lshl_b32 s44, s50, 12
    buffer_load_dwordx4 a[64:67], v20, s[28:31], s44 offen offset:0 sc1
    v_mfma_f32_16x16x32_bf16 v[144:147], a[224:227], a[4:7], v[144:147]
    v_mfma_f32_16x16x32_bf16 v[176:179], a[224:227], a[8:11], v[176:179]
    s_add_u32 s50, s50, 1
    ds_read_b64_tr_b16 a[200:201], v13 offset:0
    ds_read_b64_tr_b16 a[202:203], v13 offset:4096
    v_mfma_f32_16x16x32_bf16 v[176:179], a[228:231], a[24:27], v[176:179]
    s_and_b32 s50, s50, 15
    buffer_load_dwordx4 a[68:71], v20, s[28:31], s44 offen offset:1024 sc1
    v_mfma_f32_16x16x32_bf16 v[208:211], a[228:231], a[28:31], v[208:211]
    v_mfma_f32_16x16x32_bf16 v[208:211], a[224:227], a[12:15], v[208:211]
    ds_read_b64_tr_b16 a[204:205], v13 offset:8192
    ds_read_b64_tr_b16 a[206:207], v13 offset:12288
    v_mfma_f32_16x16x32_bf16 v[212:215], a[232:235], a[12:15], v[212:215]
    ds_read_b64_tr_b16 a[208:209], v14 offset:0
    ds_read_b64_tr_b16 a[210:211], v14 offset:4096
    v_mfma_f32_16x16x32_bf16 v[212:215], a[236:239], a[28:31], v[212:215]
    buffer_load_dwordx4 a[72:75], v20, s[28:31], s44 offen offset:2048 sc1
    v_mfma_f32_16x16x32_bf16 v[180:183], a[236:239], a[24:27], v[180:183]
    v_mfma_f32_16x16x32_bf16 v[180:183], a[232:235], a[8:11], v[180:183]
    ds_read_b64_tr_b16 a[212:213], v14 offset:8192
    ds_read_b64_tr_b16 a[214:215], v14 offset:12288
    v_mfma_f32_16x16x32_bf16 v[148:151], a[232:235], a[4:7], v[148:151]
    ds_read_b64_tr_b16 a[216:217], v15 offset:0
    ds_read_b64_tr_b16 a[218:219], v15 offset:4096
    v_mfma_f32_16x16x32_bf16 v[148:151], a[236:239], a[20:23], v[148:151]
    buffer_load_dwordx4 a[76:79], v20, s[28:31], s44 offen offset:3072 sc1
    v_mfma_f32_16x16x32_bf16 v[116:119], a[236:239], a[16:19], v[116:119]
    v_mfma_f32_16x16x32_bf16 v[116:119], a[232:235], a[0:3], v[116:119]
    ds_read_b64_tr_b16 a[220:221], v15 offset:8192
    ds_read_b64_tr_b16 a[222:223], v15 offset:12288
    v_mfma_f32_16x16x32_bf16 v[120:123], a[240:243], a[0:3], v[120:123]
    v_mfma_f32_16x16x32_bf16 v[120:123], a[244:247], a[16:19], v[120:123]
    s_lshl_b32 s44, s50, 12
    buffer_load_dwordx4 a[80:83], v20, s[28:31], s44 offen offset:0 sc1
    v_mfma_f32_16x16x32_bf16 v[152:155], a[244:247], a[20:23], v[152:155]
    v_mfma_f32_16x16x32_bf16 v[152:155], a[240:243], a[4:7], v[152:155]
    s_add_u32 s50, s50, 1
    v_mfma_f32_16x16x32_bf16 v[184:187], a[240:243], a[8:11], v[184:187]
    s_and_b32 s50, s50, 15
    buffer_load_dwordx4 a[84:87], v20, s[28:31], s44 offen offset:1024 sc1
    v_mfma_f32_16x16x32_bf16 v[184:187], a[244:247], a[24:27], v[184:187]
    v_mfma_f32_16x16x32_bf16 v[216:219], a[244:247], a[28:31], v[216:219]
    v_mfma_f32_16x16x32_bf16 v[216:219], a[240:243], a[12:15], v[216:219]
    v_mfma_f32_16x16x32_bf16 v[220:223], a[248:251], a[12:15], v[220:223]
    buffer_load_dwordx4 a[88:91], v20, s[28:31], s44 offen offset:2048 sc1
    v_mfma_f32_16x16x32_bf16 v[220:223], a[252:255], a[28:31], v[220:223]
    v_mfma_f32_16x16x32_bf16 v[188:191], a[252:255], a[24:27], v[188:191]
    v_mfma_f32_16x16x32_bf16 v[188:191], a[248:251], a[8:11], v[188:191]
    v_mfma_f32_16x16x32_bf16 v[156:159], a[248:251], a[4:7], v[156:159]
    buffer_load_dwordx4 a[92:95], v20, s[28:31], s44 offen offset:3072 sc1
    v_mfma_f32_16x16x32_bf16 v[156:159], a[252:255], a[20:23], v[156:159]
    v_mfma_f32_16x16x32_bf16 v[124:127], a[252:255], a[16:19], v[124:127]
    v_mfma_f32_16x16x32_bf16 v[124:127], a[248:251], a[0:3], v[124:127]
    s_waitcnt vmcnt(17) lgkmcnt(0)
    v_mfma_f32_16x16x32_bf16 v[128:131], a[192:195], a[0:3], v[128:131]
    ds_read_b64_tr_b16 a[224:225], v8 offset:16384
    ds_read_b64_tr_b16 a[226:227], v8 offset:20480
    v_mfma_f32_16x16x32_bf16 v[128:131], a[196:199], a[16:19], v[128:131]
    ds_read_b64_tr_b16 a[228:229], v8 offset:24576
    ds_read_b64_tr_b16 a[230:231], v8 offset:28672
    v_mfma_f32_16x16x32_bf16 v[160:163], a[196:199], a[20:23], v[160:163]
    s_lshl_b32 s44, s50, 12
    buffer_load_dwordx4 a[96:99], v20, s[28:31], s44 offen offset:0 sc1
    v_mfma_f32_16x16x32_bf16 v[160:163], a[192:195], a[4:7], v[160:163]
    v_mfma_f32_16x16x32_bf16 v[192:195], a[192:195], a[8:11], v[192:195]
    s_add_u32 s50, s50, 1
    ds_read_b64_tr_b16 a[232:233], v9 offset:16384
    ds_read_b64_tr_b16 a[234:235], v9 offset:20480
    v_mfma_f32_16x16x32_bf16 v[192:195], a[196:199], a[24:27], v[192:195]
    s_and_b32 s50, s50, 15
    buffer_load_dwordx4 a[100:103], v20, s[28:31], s44 offen offset:1024 sc1
    v_mfma_f32_16x16x32_bf16 v[224:227], a[196:199], a[28:31], v[224:227]
    v_mfma_f32_16x16x32_bf16 v[224:227], a[192:195], a[12:15], v[224:227]
    ds_read_b64_tr_b16 a[236:237], v9 offset:24576
    ds_read_b64_tr_b16 a[238:239], v9 offset:28672
    v_mfma_f32_16x16x32_bf16 v[228:231], a[200:203], a[12:15], v[228:231]
    ds_read_b64_tr_b16 a[240:241], v10 offset:16384
    ds_read_b64_tr_b16 a[242:243], v10 offset:20480
    v_mfma_f32_16x16x32_bf16 v[228:231], a[204:207], a[28:31], v[228:231]
    buffer_load_dwordx4 a[104:107], v20, s[28:31], s44 offen offset:2048 sc1
    v_mfma_f32_16x16x32_bf16 v[196:199], a[204:207], a[24:27], v[196:199]
    v_mfma_f32_16x16x32_bf16 v[196:199], a[200:203], a[8:11], v[196:199]
    ds_read_b64_tr_b16 a[244:245], v10 offset:24576
    ds_read_b64_tr_b16 a[246:247], v10 offset:28672
    v_mfma_f32_16x16x32_bf16 v[164:167], a[200:203], a[4:7], v[164:167]
    ds_read_b64_tr_b16 a[248:249], v11 offset:16384
    ds_read_b64_tr_b16 a[250:251], v11 offset:20480
    v_mfma_f32_16x16x32_bf16 v[164:167], a[204:207], a[20:23], v[164:167]
    buffer_load_dwordx4 a[108:111], v20, s[28:31], s44 offen offset:3072 sc1
    v_mfma_f32_16x16x32_bf16 v[132:135], a[204:207], a[16:19], v[132:135]
    v_mfma_f32_16x16x32_bf16 v[132:135], a[200:203], a[0:3], v[132:135]
    ds_read_b64_tr_b16 a[252:253], v11 offset:24576
    ds_read_b64_tr_b16 a[254:255], v11 offset:28672
    v_mfma_f32_16x16x32_bf16 v[136:139], a[208:211], a[0:3], v[136:139]
    v_mfma_f32_16x16x32_bf16 v[136:139], a[212:215], a[16:19], v[136:139]
    s_lshl_b32 s44, s50, 12
    buffer_load_dwordx4 a[112:115], v20, s[28:31], s44 offen offset:0 sc1
    v_mfma_f32_16x16x32_bf16 v[168:171], a[212:215], a[20:23], v[168:171]
    v_mfma_f32_16x16x32_bf16 v[168:171], a[208:211], a[4:7], v[168:171]
    s_add_u32 s50, s50, 1
    v_mfma_f32_16x16x32_bf16 v[200:203], a[208:211], a[8:11], v[200:203]
    s_and_b32 s50, s50, 15
    buffer_load_dwordx4 a[116:119], v20, s[28:31], s44 offen offset:1024 sc1
    v_mfma_f32_16x16x32_bf16 v[200:203], a[212:215], a[24:27], v[200:203]
    v_mfma_f32_16x16x32_bf16 v[232:235], a[212:215], a[28:31], v[232:235]
    v_mfma_f32_16x16x32_bf16 v[232:235], a[208:211], a[12:15], v[232:235]
    v_mfma_f32_16x16x32_bf16 v[236:239], a[216:219], a[12:15], v[236:239]
    buffer_load_dwordx4 a[120:123], v20, s[28:31], s44 offen offset:2048 sc1
    v_mfma_f32_16x16x32_bf16 v[236:239], a[220:223], a[28:31], v[236:239]
    v_mfma_f32_16x16x32_bf16 v[204:207], a[220:223], a[24:27], v[204:207]
    v_mfma_f32_16x16x32_bf16 v[204:207], a[216:219], a[8:11], v[204:207]
    v_mfma_f32_16x16x32_bf16 v[172:175], a[216:219], a[4:7], v[172:175]
    buffer_load_dwordx4 a[124:127], v20, s[28:31], s44 offen offset:3072 sc1
    v_mfma_f32_16x16x32_bf16 v[172:175], a[220:223], a[20:23], v[172:175]
    v_mfma_f32_16x16x32_bf16 v[140:143], a[220:223], a[16:19], v[140:143]
    v_mfma_f32_16x16x32_bf16 v[140:143], a[216:219], a[0:3], v[140:143]
    s_waitcnt vmcnt(16) lgkmcnt(0)
    v_mfma_f32_16x16x32_bf16 v[112:115], a[224:227], a[32:35], v[112:115]
    ds_read_b64_tr_b16 a[192:193], v12 offset:16384
    ds_read_b64_tr_b16 a[194:195], v12 offset:20480
    v_mfma_f32_16x16x32_bf16 v[112:115], a[228:231], a[48:51], v[112:115]
    ds_read_b64_tr_b16 a[196:197], v12 offset:24576
    ds_read_b64_tr_b16 a[198:199], v12 offset:28672
    v_mfma_f32_16x16x32_bf16 v[144:147], a[228:231], a[52:55], v[144:147]
    s_lshl_b32 s44, s50, 12
    buffer_load_dwordx4 a[128:131], v20, s[28:31], s44 offen offset:0 sc1
    v_mfma_f32_16x16x32_bf16 v[144:147], a[224:227], a[36:39], v[144:147]
    v_mfma_f32_16x16x32_bf16 v[176:179], a[224:227], a[40:43], v[176:179]
    s_add_u32 s50, s50, 1
    ds_read_b64_tr_b16 a[200:201], v13 offset:16384
    ds_read_b64_tr_b16 a[202:203], v13 offset:20480
    v_mfma_f32_16x16x32_bf16 v[176:179], a[228:231], a[56:59], v[176:179]
    s_and_b32 s50, s50, 15
    buffer_load_dwordx4 a[132:135], v20, s[28:31], s44 offen offset:1024 sc1
    v_mfma_f32_16x16x32_bf16 v[208:211], a[228:231], a[60:63], v[208:211]
    v_mfma_f32_16x16x32_bf16 v[208:211], a[224:227], a[44:47], v[208:211]
    ds_read_b64_tr_b16 a[204:205], v13 offset:24576
    ds_read_b64_tr_b16 a[206:207], v13 offset:28672
    v_mfma_f32_16x16x32_bf16 v[212:215], a[232:235], a[44:47], v[212:215]
    ds_read_b64_tr_b16 a[208:209], v14 offset:16384
    ds_read_b64_tr_b16 a[210:211], v14 offset:20480
    v_mfma_f32_16x16x32_bf16 v[212:215], a[236:239], a[60:63], v[212:215]
    buffer_load_dwordx4 a[136:139], v20, s[28:31], s44 offen offset:2048 sc1
    v_mfma_f32_16x16x32_bf16 v[180:183], a[236:239], a[56:59], v[180:183]
    v_mfma_f32_16x16x32_bf16 v[180:183], a[232:235], a[40:43], v[180:183]
    ds_read_b64_tr_b16 a[212:213], v14 offset:24576
    ds_read_b64_tr_b16 a[214:215], v14 offset:28672
    v_mfma_f32_16x16x32_bf16 v[148:151], a[232:235], a[36:39], v[148:151]
    ds_read_b64_tr_b16 a[216:217], v15 offset:16384
    ds_read_b64_tr_b16 a[218:219], v15 offset:20480
    v_mfma_f32_16x16x32_bf16 v[148:151], a[236:239], a[52:55], v[148:151]
    buffer_load_dwordx4 a[140:143], v20, s[28:31], s44 offen offset:3072 sc1
    v_mfma_f32_16x16x32_bf16 v[116:119], a[236:239], a[48:51], v[116:119]
    v_mfma_f32_16x16x32_bf16 v[116:119], a[232:235], a[32:35], v[116:119]
    ds_read_b64_tr_b16 a[220:221], v15 offset:24576
    ds_read_b64_tr_b16 a[222:223], v15 offset:28672
    v_mfma_f32_16x16x32_bf16 v[120:123], a[240:243], a[32:35], v[120:123]
    v_mfma_f32_16x16x32_bf16 v[120:123], a[244:247], a[48:51], v[120:123]
    s_lshl_b32 s44, s50, 12
    buffer_load_dwordx4 a[144:147], v20, s[28:31], s44 offen offset:0 sc1
    v_mfma_f32_16x16x32_bf16 v[152:155], a[244:247], a[52:55], v[152:155]
    v_mfma_f32_16x16x32_bf16 v[152:155], a[240:243], a[36:39], v[152:155]
    s_add_u32 s50, s50, 1
    v_mfma_f32_16x16x32_bf16 v[184:187], a[240:243], a[40:43], v[184:187]
    s_and_b32 s50, s50, 15
    buffer_load_dwordx4 a[148:151], v20, s[28:31], s44 offen offset:1024 sc1
    v_mfma_f32_16x16x32_bf16 v[184:187], a[244:247], a[56:59], v[184:187]
    v_mfma_f32_16x16x32_bf16 v[216:219], a[244:247], a[60:63], v[216:219]
    v_mfma_f32_16x16x32_bf16 v[216:219], a[240:243], a[44:47], v[216:219]
    v_mfma_f32_16x16x32_bf16 v[220:223], a[248:251], a[44:47], v[220:223]
    buffer_load_dwordx4 a[152:155], v20, s[28:31], s44 offen offset:2048 sc1
    v_mfma_f32_16x16x32_bf16 v[220:223], a[252:255], a[60:63], v[220:223]
    v_mfma_f32_16x16x32_bf16 v[188:191], a[252:255], a[56:59], v[188:191]
    v_mfma_f32_16x16x32_bf16 v[188:191], a[248:251], a[40:43], v[188:191]
    v_mfma_f32_16x16x32_bf16 v[156:159], a[248:251], a[36:39], v[156:159]
    buffer_load_dwordx4 a[156:159], v20, s[28:31], s44 offen offset:3072 sc1
    v_mfma_f32_16x16x32_bf16 v[156:159], a[252:255], a[52:55], v[156:159]
    v_mfma_f32_16x16x32_bf16 v[124:127], a[252:255], a[48:51], v[124:127]
    v_mfma_f32_16x16x32_bf16 v[124:127], a[248:251], a[32:35], v[124:127]
    s_waitcnt vmcnt(24) lgkmcnt(0)
    v_mfma_f32_16x16x32_bf16 v[128:131], a[192:195], a[32:35], v[128:131]
    ds_read_b64_tr_b16 a[224:225], v8 offset:32768
    ds_read_b64_tr_b16 a[226:227], v8 offset:36864
    v_mfma_f32_16x16x32_bf16 v[128:131], a[196:199], a[48:51], v[128:131]
    ds_read_b64_tr_b16 a[228:229], v8 offset:40960
    ds_read_b64_tr_b16 a[230:231], v8 offset:45056
    v_mfma_f32_16x16x32_bf16 v[160:163], a[196:199], a[52:55], v[160:163]
    s_lshl_b32 s44, s50, 12
    buffer_load_dwordx4 a[160:163], v20, s[28:31], s44 offen offset:0 sc1
    v_mfma_f32_16x16x32_bf16 v[160:163], a[192:195], a[36:39], v[160:163]
    v_mfma_f32_16x16x32_bf16 v[192:195], a[192:195], a[40:43], v[192:195]
    s_add_u32 s50, s50, 1
    ds_read_b64_tr_b16 a[232:233], v8 offset:49152
    ds_read_b64_tr_b16 a[234:235], v8 offset:53248
    v_mfma_f32_16x16x32_bf16 v[192:195], a[196:199], a[56:59], v[192:195]
    s_and_b32 s50, s50, 15
    buffer_load_dwordx4 a[164:167], v20, s[28:31], s44 offen offset:1024 sc1
    v_mfma_f32_16x16x32_bf16 v[224:227], a[196:199], a[60:63], v[224:227]
    v_mfma_f32_16x16x32_bf16 v[224:227], a[192:195], a[44:47], v[224:227]
    ds_read_b64_tr_b16 a[236:237], v8 offset:57344
    ds_read_b64_tr_b16 a[238:239], v8 offset:61440
    v_mfma_f32_16x16x32_bf16 v[228:231], a[200:203], a[44:47], v[228:231]
    ds_read_b64_tr_b16 a[240:241], v9 offset:32768
    ds_read_b64_tr_b16 a[242:243], v9 offset:36864
    v_mfma_f32_16x16x32_bf16 v[228:231], a[204:207], a[60:63], v[228:231]
    buffer_load_dwordx4 a[168:171], v20, s[28:31], s44 offen offset:2048 sc1
    v_mfma_f32_16x16x32_bf16 v[196:199], a[204:207], a[56:59], v[196:199]
    v_mfma_f32_16x16x32_bf16 v[196:199], a[200:203], a[40:43], v[196:199]
    ds_read_b64_tr_b16 a[244:245], v9 offset:40960
    ds_read_b64_tr_b16 a[246:247], v9 offset:45056
    v_mfma_f32_16x16x32_bf16 v[164:167], a[200:203], a[36:39], v[164:167]
    ds_read_b64_tr_b16 a[248:249], v9 offset:49152
    ds_read_b64_tr_b16 a[250:251], v9 offset:53248
    v_mfma_f32_16x16x32_bf16 v[164:167], a[204:207], a[52:55], v[164:167]
    buffer_load_dwordx4 a[172:175], v20, s[28:31], s44 offen offset:3072 sc1
    v_mfma_f32_16x16x32_bf16 v[132:135], a[204:207], a[48:51], v[132:135]
    v_mfma_f32_16x16x32_bf16 v[132:135], a[200:203], a[32:35], v[132:135]
    ds_read_b64_tr_b16 a[252:253], v9 offset:57344
    ds_read_b64_tr_b16 a[254:255], v9 offset:61440
    v_mfma_f32_16x16x32_bf16 v[136:139], a[208:211], a[32:35], v[136:139]
    v_mfma_f32_16x16x32_bf16 v[136:139], a[212:215], a[48:51], v[136:139]
    s_lshl_b32 s44, s50, 12
    buffer_load_dwordx4 a[176:179], v20, s[28:31], s44 offen offset:0 sc1
    v_mfma_f32_16x16x32_bf16 v[168:171], a[212:215], a[52:55], v[168:171]
    v_mfma_f32_16x16x32_bf16 v[168:171], a[208:211], a[36:39], v[168:171]
    s_add_u32 s50, s50, 1
    v_mfma_f32_16x16x32_bf16 v[200:203], a[208:211], a[40:43], v[200:203]
    s_and_b32 s50, s50, 15
    buffer_load_dwordx4 a[180:183], v20, s[28:31], s44 offen offset:1024 sc1
    v_mfma_f32_16x16x32_bf16 v[200:203], a[212:215], a[56:59], v[200:203]
    v_mfma_f32_16x16x32_bf16 v[232:235], a[212:215], a[60:63], v[232:235]
    v_mfma_f32_16x16x32_bf16 v[232:235], a[208:211], a[44:47], v[232:235]
    v_mfma_f32_16x16x32_bf16 v[236:239], a[216:219], a[44:47], v[236:239]
    buffer_load_dwordx4 a[184:187], v20, s[28:31], s44 offen offset:2048 sc1
    v_mfma_f32_16x16x32_bf16 v[236:239], a[220:223], a[60:63], v[236:239]
    v_mfma_f32_16x16x32_bf16 v[204:207], a[220:223], a[56:59], v[204:207]
    v_mfma_f32_16x16x32_bf16 v[204:207], a[216:219], a[40:43], v[204:207]
    v_mfma_f32_16x16x32_bf16 v[172:175], a[216:219], a[36:39], v[172:175]
    buffer_load_dwordx4 a[188:191], v20, s[28:31], s44 offen offset:3072 sc1
    v_mfma_f32_16x16x32_bf16 v[172:175], a[220:223], a[52:55], v[172:175]
    v_mfma_f32_16x16x32_bf16 v[140:143], a[220:223], a[48:51], v[140:143]
    v_mfma_f32_16x16x32_bf16 v[140:143], a[216:219], a[32:35], v[140:143]
    s_waitcnt vmcnt(16) lgkmcnt(0)
    s_barrier
    v_mfma_f32_16x16x32_bf16 v[112:115], a[224:227], a[64:67], v[112:115]
    ds_read_b64_tr_b16 a[192:193], v4 offset:0
    v_mfma_f32_16x16x32_bf16 v[112:115], a[228:231], a[80:83], v[112:115]
    s_add_u32 m0, s48, 0
    ds_read_b64_tr_b16 a[194:195], v4 offset:4096
    v_mfma_f32_16x16x32_bf16 v[112:115], a[232:235], a[96:99], v[112:115]
    s_mul_i32 s43, s49, 88064
    buffer_load_dwordx4 v44, s[24:27], s43 offen  lds
    v_mfma_f32_16x16x32_bf16 v[112:115], a[236:239], a[112:115], v[112:115]
    v_mfma_f32_16x16x32_bf16 v[144:147], a[236:239], a[116:119], v[144:147]
    ds_read_b64_tr_b16 a[196:197], v4 offset:8192
    v_mfma_f32_16x16x32_bf16 v[144:147], a[232:235], a[100:103], v[144:147]
    ds_read_b64_tr_b16 a[198:199], v4 offset:12288
    v_mfma_f32_16x16x32_bf16 v[144:147], a[228:231], a[84:87], v[144:147]
    ds_read_b64_tr_b16 a[200:201], v4 offset:16384
    v_mfma_f32_16x16x32_bf16 v[144:147], a[224:227], a[68:71], v[144:147]
    ds_read_b64_tr_b16 a[202:203], v4 offset:20480
    v_mfma_f32_16x16x32_bf16 v[176:179], a[224:227], a[72:75], v[176:179]
    ds_read_b64_tr_b16 a[204:205], v4 offset:24576
    v_mfma_f32_16x16x32_bf16 v[176:179], a[228:231], a[88:91], v[176:179]
    ds_read_b64_tr_b16 a[206:207], v4 offset:28672
    v_mfma_f32_16x16x32_bf16 v[176:179], a[232:235], a[104:107], v[176:179]
    ds_read_b64_tr_b16 a[208:209], v5 offset:0
    v_mfma_f32_16x16x32_bf16 v[176:179], a[236:239], a[120:123], v[176:179]
    ds_read_b64_tr_b16 a[210:211], v5 offset:4096
    v_mfma_f32_16x16x32_bf16 v[208:211], a[236:239], a[124:127], v[208:211]
    ds_read_b64_tr_b16 a[212:213], v5 offset:8192
    v_mfma_f32_16x16x32_bf16 v[208:211], a[232:235], a[108:111], v[208:211]
    ds_read_b64_tr_b16 a[214:215], v5 offset:12288
    v_mfma_f32_16x16x32_bf16 v[208:211], a[228:231], a[92:95], v[208:211]
    ds_read_b64_tr_b16 a[216:217], v5 offset:16384
    v_mfma_f32_16x16x32_bf16 v[208:211], a[224:227], a[76:79], v[208:211]
    ds_read_b64_tr_b16 a[218:219], v5 offset:20480
    v_mfma_f32_16x16x32_bf16 v[212:215], a[240:243], a[76:79], v[212:215]
    s_add_u32 s49, s49, 1
    ds_read_b64_tr_b16 a[220:221], v5 offset:24576
    v_mfma_f32_16x16x32_bf16 v[212:215], a[244:247], a[92:95], v[212:215]
    s_and_b32 s49, s49, 15
    buffer_load_dwordx4 v45, s[24:27], s43 offen offset:1024  lds
    v_mfma_f32_16x16x32_bf16 v[212:215], a[248:251], a[108:111], v[212:215]
    v_mfma_f32_16x16x32_bf16 v[212:215], a[252:255], a[124:127], v[212:215]
    ds_read_b64_tr_b16 a[222:223], v5 offset:28672
    v_mfma_f32_16x16x32_bf16 v[180:183], a[252:255], a[120:123], v[180:183]
    v_mfma_f32_16x16x32_bf16 v[180:183], a[248:251], a[104:107], v[180:183]
    v_mfma_f32_16x16x32_bf16 v[180:183], a[244:247], a[88:91], v[180:183]
    v_mfma_f32_16x16x32_bf16 v[180:183], a[240:243], a[72:75], v[180:183]
    v_mfma_f32_16x16x32_bf16 v[148:151], a[240:243], a[68:71], v[148:151]
    v_mfma_f32_16x16x32_bf16 v[148:151], a[244:247], a[84:87], v[148:151]
    v_mfma_f32_16x16x32_bf16 v[148:151], a[248:251], a[100:103], v[148:151]
    v_mfma_f32_16x16x32_bf16 v[148:151], a[252:255], a[116:119], v[148:151]
    v_mfma_f32_16x16x32_bf16 v[116:119], a[252:255], a[112:115], v[116:119]
    v_mfma_f32_16x16x32_bf16 v[116:119], a[248:251], a[96:99], v[116:119]
    v_mfma_f32_16x16x32_bf16 v[116:119], a[244:247], a[80:83], v[116:119]
    v_mfma_f32_16x16x32_bf16 v[116:119], a[240:243], a[64:67], v[116:119]
    s_waitcnt vmcnt(2) lgkmcnt(0)
    v_mfma_f32_16x16x32_bf16 v[112:115], a[192:195], a[128:131], v[112:115]
    ds_read_b64_tr_b16 a[224:225], v10 offset:32768
    v_mfma_f32_16x16x32_bf16 v[112:115], a[196:199], a[144:147], v[112:115]
    s_add_u32 m0, s48, 8192
    ds_read_b64_tr_b16 a[226:227], v10 offset:36864
    v_mfma_f32_16x16x32_bf16 v[112:115], a[200:203], a[160:163], v[112:115]
    s_mul_i32 s43, s49, 88064
    buffer_load_dwordx4 v44, s[24:27], s43 offen  lds
    v_mfma_f32_16x16x32_bf16 v[112:115], a[204:207], a[176:179], v[112:115]
    v_mfma_f32_16x16x32_bf16 v[144:147], a[204:207], a[180:183], v[144:147]
    ds_read_b64_tr_b16 a[228:229], v10 offset:40960
    v_mfma_f32_16x16x32_bf16 v[144:147], a[200:203], a[164:167], v[144:147]
    ds_read_b64_tr_b16 a[230:231], v10 offset:45056
    v_mfma_f32_16x16x32_bf16 v[144:147], a[196:199], a[148:151], v[144:147]
    ds_read_b64_tr_b16 a[232:233], v10 offset:49152
    v_mfma_f32_16x16x32_bf16 v[144:147], a[192:195], a[132:135], v[144:147]
    ds_read_b64_tr_b16 a[234:235], v10 offset:53248
    v_mfma_f32_16x16x32_bf16 v[176:179], a[192:195], a[136:139], v[176:179]
    ds_read_b64_tr_b16 a[236:237], v10 offset:57344
    v_mfma_f32_16x16x32_bf16 v[176:179], a[196:199], a[152:155], v[176:179]
    ds_read_b64_tr_b16 a[238:239], v10 offset:61440
    v_mfma_f32_16x16x32_bf16 v[176:179], a[200:203], a[168:171], v[176:179]
    ds_read_b64_tr_b16 a[240:241], v11 offset:32768
    v_mfma_f32_16x16x32_bf16 v[176:179], a[204:207], a[184:187], v[176:179]
    ds_read_b64_tr_b16 a[242:243], v11 offset:36864
    v_mfma_f32_16x16x32_bf16 v[208:211], a[204:207], a[188:191], v[208:211]
    ds_read_b64_tr_b16 a[244:245], v11 offset:40960
    v_mfma_f32_16x16x32_bf16 v[208:211], a[200:203], a[172:175], v[208:211]
    ds_read_b64_tr_b16 a[246:247], v11 offset:45056
    v_mfma_f32_16x16x32_bf16 v[208:211], a[196:199], a[156:159], v[208:211]
    ds_read_b64_tr_b16 a[248:249], v11 offset:49152
    v_mfma_f32_16x16x32_bf16 v[208:211], a[192:195], a[140:143], v[208:211]
    ds_read_b64_tr_b16 a[250:251], v11 offset:53248
    v_mfma_f32_16x16x32_bf16 v[212:215], a[208:211], a[140:143], v[212:215]
    s_add_u32 s49, s49, 1
    ds_read_b64_tr_b16 a[252:253], v11 offset:57344
    v_mfma_f32_16x16x32_bf16 v[212:215], a[212:215], a[156:159], v[212:215]
    s_and_b32 s49, s49, 15
    buffer_load_dwordx4 v45, s[24:27], s43 offen offset:1024  lds
    v_mfma_f32_16x16x32_bf16 v[212:215], a[216:219], a[172:175], v[212:215]
    v_mfma_f32_16x16x32_bf16 v[212:215], a[220:223], a[188:191], v[212:215]
    ds_read_b64_tr_b16 a[254:255], v11 offset:61440
    v_mfma_f32_16x16x32_bf16 v[180:183], a[220:223], a[184:187], v[180:183]
    v_mfma_f32_16x16x32_bf16 v[180:183], a[216:219], a[168:171], v[180:183]
    v_mfma_f32_16x16x32_bf16 v[180:183], a[212:215], a[152:155], v[180:183]
    v_mfma_f32_16x16x32_bf16 v[180:183], a[208:211], a[136:139], v[180:183]
    v_mfma_f32_16x16x32_bf16 v[148:151], a[208:211], a[132:135], v[148:151]
    v_mfma_f32_16x16x32_bf16 v[148:151], a[212:215], a[148:151], v[148:151]
    v_mfma_f32_16x16x32_bf16 v[148:151], a[216:219], a[164:167], v[148:151]
    v_mfma_f32_16x16x32_bf16 v[148:151], a[220:223], a[180:183], v[148:151]
    v_mfma_f32_16x16x32_bf16 v[116:119], a[220:223], a[176:179], v[116:119]
    v_mfma_f32_16x16x32_bf16 v[116:119], a[216:219], a[160:163], v[116:119]
    v_mfma_f32_16x16x32_bf16 v[116:119], a[212:215], a[144:147], v[116:119]
    v_mfma_f32_16x16x32_bf16 v[116:119], a[208:211], a[128:131], v[116:119]
    s_waitcnt vmcnt(20) lgkmcnt(0)
    v_mfma_f32_16x16x32_bf16 v[120:123], a[224:227], a[64:67], v[120:123]
    ds_read_b64_tr_b16 a[192:193], v6 offset:0
    ds_read_b64_tr_b16 a[194:195], v6 offset:4096
    v_mfma_f32_16x16x32_bf16 v[120:123], a[228:231], a[80:83], v[120:123]
    s_add_u32 m0, s48, 16384
    ds_read_b64_tr_b16 a[196:197], v6 offset:8192
    ds_read_b64_tr_b16 a[198:199], v6 offset:12288
    v_mfma_f32_16x16x32_bf16 v[120:123], a[232:235], a[96:99], v[120:123]
    s_mul_i32 s43, s49, 88064
    buffer_load_dwordx4 v44, s[24:27], s43 offen  lds
    v_mfma_f32_16x16x32_bf16 v[120:123], a[236:239], a[112:115], v[120:123]
    v_mfma_f32_16x16x32_bf16 v[152:155], a[236:239], a[116:119], v[152:155]
    ds_read_b64_tr_b16 a[200:201], v6 offset:16384
    ds_read_b64_tr_b16 a[202:203], v6 offset:20480
    v_mfma_f32_16x16x32_bf16 v[152:155], a[232:235], a[100:103], v[152:155]
    ds_read_b64_tr_b16 a[204:205], v6 offset:24576
    ds_read_b64_tr_b16 a[206:207], v6 offset:28672
    v_mfma_f32_16x16x32_bf16 v[152:155], a[228:231], a[84:87], v[152:155]
    ds_read_b64_tr_b16 a[208:209], v7 offset:0
    ds_read_b64_tr_b16 a[210:211], v7 offset:4096
    v_mfma_f32_16x16x32_bf16 v[152:155], a[224:227], a[68:71], v[152:155]
    ds_read_b64_tr_b16 a[212:213], v7 offset:8192
    ds_read_b64_tr_b16 a[214:215], v7 offset:12288
    v_mfma_f32_16x16x32_bf16 v[184:187], a[224:227], a[72:75], v[184:187]
    ds_read_b64_tr_b16 a[216:217], v7 offset:16384
    ds_read_b64_tr_b16 a[218:219], v7 offset:20480
    v_mfma_f32_16x16x32_bf16 v[184:187], a[228:231], a[88:91], v[184:187]
    ds_read_b64_tr_b16 a[220:221], v7 offset:24576
    ds_read_b64_tr_b16 a[222:223], v7 offset:28672
    v_mfma_f32_16x16x32_bf16 v[184:187], a[232:235], a[104:107], v[184:187]
    s_xor_b32 s42, s36, 0
    v_cvt_pk_bf16_f32 v48, v112, v113
    v_cvt_pk_bf16_f32 v49, v114, v115
    v_mfma_f32_16x16x32_bf16 v[184:187], a[236:239], a[120:123], v[184:187]
    v_cvt_pk_bf16_f32 v50, v116, v117
    v_cvt_pk_bf16_f32 v51, v118, v119
    v_mfma_f32_16x16x32_bf16 v[216:219], a[236:239], a[124:127], v[216:219]
    buffer_store_dwordx4 v[48:51], v20, s[32:35], s42 offen offset:0 sc1
    v_mfma_f32_16x16x32_bf16 v[216:219], a[232:235], a[108:111], v[216:219]
    v_mfma_f32_16x16x32_bf16 v[216:219], a[228:231], a[92:95], v[216:219]
    v_cvt_pk_bf16_f32 v52, v144, v145
    v_cvt_pk_bf16_f32 v53, v146, v147
    v_mfma_f32_16x16x32_bf16 v[216:219], a[224:227], a[76:79], v[216:219]
    v_cvt_pk_bf16_f32 v54, v148, v149
    v_cvt_pk_bf16_f32 v55, v150, v151
    v_mfma_f32_16x16x32_bf16 v[220:223], a[240:243], a[76:79], v[220:223]
    s_add_u32 s49, s49, 1
    buffer_store_dwordx4 v[52:55], v20, s[32:35], s42 offen offset:1024 sc1
    v_mfma_f32_16x16x32_bf16 v[220:223], a[244:247], a[92:95], v[220:223]
    s_and_b32 s49, s49, 15
    buffer_load_dwordx4 v45, s[24:27], s43 offen offset:1024  lds
    v_mfma_f32_16x16x32_bf16 v[220:223], a[248:251], a[108:111], v[220:223]
    v_mfma_f32_16x16x32_bf16 v[220:223], a[252:255], a[124:127], v[220:223]
    v_cvt_pk_bf16_f32 v56, v176, v177
    v_cvt_pk_bf16_f32 v57, v178, v179
    v_mfma_f32_16x16x32_bf16 v[188:191], a[252:255], a[120:123], v[188:191]
    v_cvt_pk_bf16_f32 v58, v180, v181
    v_cvt_pk_bf16_f32 v59, v182, v183
    v_mfma_f32_16x16x32_bf16 v[188:191], a[248:251], a[104:107], v[188:191]
    buffer_store_dwordx4 v[56:59], v20, s[32:35], s42 offen offset:2048 sc1
    v_mfma_f32_16x16x32_bf16 v[188:191], a[244:247], a[88:91], v[188:191]
    v_mfma_f32_16x16x32_bf16 v[188:191], a[240:243], a[72:75], v[188:191]
    v_cvt_pk_bf16_f32 v60, v208, v209
    v_cvt_pk_bf16_f32 v61, v210, v211
    v_mfma_f32_16x16x32_bf16 v[156:159], a[240:243], a[68:71], v[156:159]
    v_cvt_pk_bf16_f32 v62, v212, v213
    v_cvt_pk_bf16_f32 v63, v214, v215
    v_mfma_f32_16x16x32_bf16 v[156:159], a[244:247], a[84:87], v[156:159]
    buffer_store_dwordx4 v[60:63], v20, s[32:35], s42 offen offset:3072 sc1
    v_mfma_f32_16x16x32_bf16 v[156:159], a[248:251], a[100:103], v[156:159]
    v_mfma_f32_16x16x32_bf16 v[156:159], a[252:255], a[116:119], v[156:159]
    v_mfma_f32_16x16x32_bf16 v[124:127], a[252:255], a[112:115], v[124:127]
    v_mfma_f32_16x16x32_bf16 v[124:127], a[248:251], a[96:99], v[124:127]
    v_mfma_f32_16x16x32_bf16 v[124:127], a[244:247], a[80:83], v[124:127]
    v_mfma_f32_16x16x32_bf16 v[124:127], a[240:243], a[64:67], v[124:127]
    s_waitcnt vmcnt(10) lgkmcnt(0)
    v_mfma_f32_16x16x32_bf16 v[120:123], a[192:195], a[128:131], v[120:123]
    ds_read_b64_tr_b16 a[224:225], v12 offset:32768
    v_mfma_f32_16x16x32_bf16 v[120:123], a[196:199], a[144:147], v[120:123]
    s_add_u32 m0, s48, 24576
    ds_read_b64_tr_b16 a[226:227], v12 offset:36864
    v_mfma_f32_16x16x32_bf16 v[120:123], a[200:203], a[160:163], v[120:123]
    s_mul_i32 s43, s49, 88064
    buffer_load_dwordx4 v44, s[24:27], s43 offen  lds
    v_mfma_f32_16x16x32_bf16 v[120:123], a[204:207], a[176:179], v[120:123]
    v_mfma_f32_16x16x32_bf16 v[152:155], a[204:207], a[180:183], v[152:155]
    ds_read_b64_tr_b16 a[228:229], v12 offset:40960
    v_mfma_f32_16x16x32_bf16 v[152:155], a[200:203], a[164:167], v[152:155]
    ds_read_b64_tr_b16 a[230:231], v12 offset:45056
    v_mfma_f32_16x16x32_bf16 v[152:155], a[196:199], a[148:151], v[152:155]
    ds_read_b64_tr_b16 a[232:233], v12 offset:49152
    v_mfma_f32_16x16x32_bf16 v[152:155], a[192:195], a[132:135], v[152:155]
    ds_read_b64_tr_b16 a[234:235], v12 offset:53248
    v_mfma_f32_16x16x32_bf16 v[184:187], a[192:195], a[136:139], v[184:187]
    ds_read_b64_tr_b16 a[236:237], v12 offset:57344
    v_mfma_f32_16x16x32_bf16 v[184:187], a[196:199], a[152:155], v[184:187]
    ds_read_b64_tr_b16 a[238:239], v12 offset:61440
    v_mfma_f32_16x16x32_bf16 v[184:187], a[200:203], a[168:171], v[184:187]
    ds_read_b64_tr_b16 a[240:241], v13 offset:32768
    v_mfma_f32_16x16x32_bf16 v[184:187], a[204:207], a[184:187], v[184:187]
    ds_read_b64_tr_b16 a[242:243], v13 offset:36864
    v_mfma_f32_16x16x32_bf16 v[216:219], a[204:207], a[188:191], v[216:219]
    ds_read_b64_tr_b16 a[244:245], v13 offset:40960
    v_mfma_f32_16x16x32_bf16 v[216:219], a[200:203], a[172:175], v[216:219]
    ds_read_b64_tr_b16 a[246:247], v13 offset:45056
    v_mfma_f32_16x16x32_bf16 v[216:219], a[196:199], a[156:159], v[216:219]
    ds_read_b64_tr_b16 a[248:249], v13 offset:49152
    v_mfma_f32_16x16x32_bf16 v[216:219], a[192:195], a[140:143], v[216:219]
    ds_read_b64_tr_b16 a[250:251], v13 offset:53248
    v_mfma_f32_16x16x32_bf16 v[220:223], a[208:211], a[140:143], v[220:223]
    s_add_u32 s49, s49, 1
    ds_read_b64_tr_b16 a[252:253], v13 offset:57344
    v_mfma_f32_16x16x32_bf16 v[220:223], a[212:215], a[156:159], v[220:223]
    s_and_b32 s49, s49, 15
    buffer_load_dwordx4 v45, s[24:27], s43 offen offset:1024  lds
    v_mfma_f32_16x16x32_bf16 v[220:223], a[216:219], a[172:175], v[220:223]
    v_mfma_f32_16x16x32_bf16 v[220:223], a[220:223], a[188:191], v[220:223]
    ds_read_b64_tr_b16 a[254:255], v13 offset:61440
    v_mfma_f32_16x16x32_bf16 v[188:191], a[220:223], a[184:187], v[188:191]
    v_mfma_f32_16x16x32_bf16 v[188:191], a[216:219], a[168:171], v[188:191]
    v_mfma_f32_16x16x32_bf16 v[188:191], a[212:215], a[152:155], v[188:191]
    v_mfma_f32_16x16x32_bf16 v[188:191], a[208:211], a[136:139], v[188:191]
    v_mfma_f32_16x16x32_bf16 v[156:159], a[208:211], a[132:135], v[156:159]
    v_mfma_f32_16x16x32_bf16 v[156:159], a[212:215], a[148:151], v[156:159]
    v_mfma_f32_16x16x32_bf16 v[156:159], a[216:219], a[164:167], v[156:159]
    v_mfma_f32_16x16x32_bf16 v[156:159], a[220:223], a[180:183], v[156:159]
    v_mfma_f32_16x16x32_bf16 v[124:127], a[220:223], a[176:179], v[124:127]
    v_mfma_f32_16x16x32_bf16 v[124:127], a[216:219], a[160:163], v[124:127]
    v_mfma_f32_16x16x32_bf16 v[124:127], a[212:215], a[144:147], v[124:127]
    v_mfma_f32_16x16x32_bf16 v[124:127], a[208:211], a[128:131], v[124:127]
    s_waitcnt vmcnt(28) lgkmcnt(0)
    v_mfma_f32_16x16x32_bf16 v[128:131], a[224:227], a[64:67], v[128:131]
    ds_read_b64_tr_b16 a[192:193], v16 offset:0
    ds_read_b64_tr_b16 a[194:195], v16 offset:4096
    v_mfma_f32_16x16x32_bf16 v[128:131], a[228:231], a[80:83], v[128:131]
    ds_read_b64_tr_b16 a[196:197], v16 offset:8192
    ds_read_b64_tr_b16 a[198:199], v16 offset:12288
    v_mfma_f32_16x16x32_bf16 v[128:131], a[232:235], a[96:99], v[128:131]
    ds_read_b64_tr_b16 a[200:201], v16 offset:16384
    ds_read_b64_tr_b16 a[202:203], v16 offset:20480
    v_mfma_f32_16x16x32_bf16 v[128:131], a[236:239], a[112:115], v[128:131]
    ds_read_b64_tr_b16 a[204:205], v16 offset:24576
    ds_read_b64_tr_b16 a[206:207], v16 offset:28672
    v_mfma_f32_16x16x32_bf16 v[160:163], a[236:239], a[116:119], v[160:163]
    ds_read_b64_tr_b16 a[208:209], v17 offset:0
    ds_read_b64_tr_b16 a[210:211], v17 offset:4096
    v_mfma_f32_16x16x32_bf16 v[160:163], a[232:235], a[100:103], v[160:163]
    ds_read_b64_tr_b16 a[212:213], v17 offset:8192
    ds_read_b64_tr_b16 a[214:215], v17 offset:12288
    v_mfma_f32_16x16x32_bf16 v[160:163], a[228:231], a[84:87], v[160:163]
    ds_read_b64_tr_b16 a[216:217], v17 offset:16384
    ds_read_b64_tr_b16 a[218:219], v17 offset:20480
    v_mfma_f32_16x16x32_bf16 v[160:163], a[224:227], a[68:71], v[160:163]
    ds_read_b64_tr_b16 a[220:221], v17 offset:24576
    ds_read_b64_tr_b16 a[222:223], v17 offset:28672
    v_mfma_f32_16x16x32_bf16 v[192:195], a[224:227], a[72:75], v[192:195]
    s_xor_b32 s42, s36, 4096
    v_cvt_pk_bf16_f32 v64, v120, v121
    v_cvt_pk_bf16_f32 v65, v122, v123
    v_mfma_f32_16x16x32_bf16 v[192:195], a[228:231], a[88:91], v[192:195]
    v_cvt_pk_bf16_f32 v66, v124, v125
    v_cvt_pk_bf16_f32 v67, v126, v127
    v_mfma_f32_16x16x32_bf16 v[192:195], a[232:235], a[104:107], v[192:195]
    s_branch L_over7
.p2align 12
L_stub7:
    s_setpc_b64 s[46:47]
L_over7:
    buffer_store_dwordx4 v[64:67], v20, s[32:35], s42 offen offset:0 sc1
    v_mfma_f32_16x16x32_bf16 v[192:195], a[236:239], a[120:123], v[192:195]
    v_mfma_f32_16x16x32_bf16 v[224:227], a[236:239], a[124:127], v[224:227]
    v_cvt_pk_bf16_f32 v68, v152, v153
    v_cvt_pk_bf16_f32 v69, v154, v155
    v_mfma_f32_16x16x32_bf16 v[224:227], a[232:235], a[108:111], v[224:227]
    v_cvt_pk_bf16_f32 v70, v156, v157
    v_cvt_pk_bf16_f32 v71, v158, v159
    v_mfma_f32_16x16x32_bf16 v[224:227], a[228:231], a[92:95], v[224:227]
    buffer_store_dwordx4 v[68:71], v20, s[32:35], s42 offen offset:1024 sc1
    v_mfma_f32_16x16x32_bf16 v[224:227], a[224:227], a[76:79], v[224:227]
    v_mfma_f32_16x16x32_bf16 v[228:231], a[240:243], a[76:79], v[228:231]
    v_cvt_pk_bf16_f32 v72, v184, v185
    v_cvt_pk_bf16_f32 v73, v186, v187
    v_mfma_f32_16x16x32_bf16 v[228:231], a[244:247], a[92:95], v[228:231]
    v_cvt_pk_bf16_f32 v74, v188, v189
    v_cvt_pk_bf16_f32 v75, v190, v191
    v_mfma_f32_16x16x32_bf16 v[228:231], a[248:251], a[108:111], v[228:231]
    buffer_store_dwordx4 v[72:75], v20, s[32:35], s42 offen offset:2048 sc1
    v_mfma_f32_16x16x32_bf16 v[228:231], a[252:255], a[124:127], v[228:231]
    v_mfma_f32_16x16x32_bf16 v[196:199], a[252:255], a[120:123], v[196:199]
    v_cvt_pk_bf16_f32 v76, v216, v217
    v_cvt_pk_bf16_f32 v77, v218, v219
    v_mfma_f32_16x16x32_bf16 v[196:199], a[248:251], a[104:107], v[196:199]
    v_cvt_pk_bf16_f32 v78, v220, v221
    v_cvt_pk_bf16_f32 v79, v222, v223
    v_mfma_f32_16x16x32_bf16 v[196:199], a[244:247], a[88:91], v[196:199]
    buffer_store_dwordx4 v[76:79], v20, s[32:35], s42 offen offset:3072 sc1
    v_mfma_f32_16x16x32_bf16 v[196:199], a[240:243], a[72:75], v[196:199]
    v_mfma_f32_16x16x32_bf16 v[164:167], a[240:243], a[68:71], v[164:167]
    v_mfma_f32_16x16x32_bf16 v[164:167], a[244:247], a[84:87], v[164:167]
    v_mfma_f32_16x16x32_bf16 v[164:167], a[248:251], a[100:103], v[164:167]
    v_mfma_f32_16x16x32_bf16 v[164:167], a[252:255], a[116:119], v[164:167]
    v_mfma_f32_16x16x32_bf16 v[132:135], a[252:255], a[112:115], v[132:135]
    v_mfma_f32_16x16x32_bf16 v[132:135], a[248:251], a[96:99], v[132:135]
    v_mfma_f32_16x16x32_bf16 v[132:135], a[244:247], a[80:83], v[132:135]
    v_mfma_f32_16x16x32_bf16 v[132:135], a[240:243], a[64:67], v[132:135]
    s_waitcnt vmcnt(16) lgkmcnt(0)
    v_mfma_f32_16x16x32_bf16 v[128:131], a[192:195], a[128:131], v[128:131]
    ds_read_b64_tr_b16 a[224:225], v14 offset:32768
    v_mfma_f32_16x16x32_bf16 v[128:131], a[196:199], a[144:147], v[128:131]
    ds_read_b64_tr_b16 a[226:227], v14 offset:36864
    v_mfma_f32_16x16x32_bf16 v[128:131], a[200:203], a[160:163], v[128:131]
    ds_read_b64_tr_b16 a[228:229], v14 offset:40960
    v_mfma_f32_16x16x32_bf16 v[128:131], a[204:207], a[176:179], v[128:131]
    ds_read_b64_tr_b16 a[230:231], v14 offset:45056
    v_mfma_f32_16x16x32_bf16 v[160:163], a[204:207], a[180:183], v[160:163]
    ds_read_b64_tr_b16 a[232:233], v14 offset:49152
    v_mfma_f32_16x16x32_bf16 v[160:163], a[200:203], a[164:167], v[160:163]
    ds_read_b64_tr_b16 a[234:235], v14 offset:53248
    v_mfma_f32_16x16x32_bf16 v[160:163], a[196:199], a[148:151], v[160:163]
    ds_read_b64_tr_b16 a[236:237], v14 offset:57344
    v_mfma_f32_16x16x32_bf16 v[160:163], a[192:195], a[132:135], v[160:163]
    ds_read_b64_tr_b16 a[238:239], v14 offset:61440
    v_mfma_f32_16x16x32_bf16 v[192:195], a[192:195], a[136:139], v[192:195]
    ds_read_b64_tr_b16 a[240:241], v15 offset:32768
    v_mfma_f32_16x16x32_bf16 v[192:195], a[196:199], a[152:155], v[192:195]
    ds_read_b64_tr_b16 a[242:243], v15 offset:36864
    v_mfma_f32_16x16x32_bf16 v[192:195], a[200:203], a[168:171], v[192:195]
    ds_read_b64_tr_b16 a[244:245], v15 offset:40960
    v_mfma_f32_16x16x32_bf16 v[192:195], a[204:207], a[184:187], v[192:195]
    ds_read_b64_tr_b16 a[246:247], v15 offset:45056
    v_mfma_f32_16x16x32_bf16 v[224:227], a[204:207], a[188:191], v[224:227]
    ds_read_b64_tr_b16 a[248:249], v15 offset:49152
    v_mfma_f32_16x16x32_bf16 v[224:227], a[200:203], a[172:175], v[224:227]
    ds_read_b64_tr_b16 a[250:251], v15 offset:53248
    v_mfma_f32_16x16x32_bf16 v[224:227], a[196:199], a[156:159], v[224:227]
    ds_read_b64_tr_b16 a[252:253], v15 offset:57344
    v_mfma_f32_16x16x32_bf16 v[224:227], a[192:195], a[140:143], v[224:227]
    ds_read_b64_tr_b16 a[254:255], v15 offset:61440
    v_mfma_f32_16x16x32_bf16 v[228:231], a[208:211], a[140:143], v[228:231]
    v_mfma_f32_16x16x32_bf16 v[228:231], a[212:215], a[156:159], v[228:231]
    v_mfma_f32_16x16x32_bf16 v[228:231], a[216:219], a[172:175], v[228:231]
    v_mfma_f32_16x16x32_bf16 v[228:231], a[220:223], a[188:191], v[228:231]
    v_mfma_f32_16x16x32_bf16 v[196:199], a[220:223], a[184:187], v[196:199]
    v_mfma_f32_16x16x32_bf16 v[196:199], a[216:219], a[168:171], v[196:199]
    v_mfma_f32_16x16x32_bf16 v[196:199], a[212:215], a[152:155], v[196:199]
    v_mfma_f32_16x16x32_bf16 v[196:199], a[208:211], a[136:139], v[196:199]
    v_mfma_f32_16x16x32_bf16 v[164:167], a[208:211], a[132:135], v[164:167]
    v_mfma_f32_16x16x32_bf16 v[164:167], a[212:215], a[148:151], v[164:167]
    v_mfma_f32_16x16x32_bf16 v[164:167], a[216:219], a[164:167], v[164:167]
    v_mfma_f32_16x16x32_bf16 v[164:167], a[220:223], a[180:183], v[164:167]
    v_mfma_f32_16x16x32_bf16 v[132:135], a[220:223], a[176:179], v[132:135]
    v_mfma_f32_16x16x32_bf16 v[132:135], a[216:219], a[160:163], v[132:135]
    v_mfma_f32_16x16x32_bf16 v[132:135], a[212:215], a[144:147], v[132:135]
    v_mfma_f32_16x16x32_bf16 v[132:135], a[208:211], a[128:131], v[132:135]
    s_waitcnt vmcnt(32) lgkmcnt(0)
    v_mfma_f32_16x16x32_bf16 v[136:139], a[224:227], a[64:67], v[136:139]
    ds_read_b64_tr_b16 a[192:193], v18 offset:0
    ds_read_b64_tr_b16 a[194:195], v18 offset:4096
    v_mfma_f32_16x16x32_bf16 v[136:139], a[228:231], a[80:83], v[136:139]
    ds_read_b64_tr_b16 a[196:197], v18 offset:8192
    ds_read_b64_tr_b16 a[198:199], v18 offset:12288
    v_mfma_f32_16x16x32_bf16 v[136:139], a[232:235], a[96:99], v[136:139]
    ds_read_b64_tr_b16 a[200:201], v18 offset:16384
    ds_read_b64_tr_b16 a[202:203], v18 offset:20480
    v_mfma_f32_16x16x32_bf16 v[136:139], a[236:239], a[112:115], v[136:139]
    ds_read_b64_tr_b16 a[204:205], v18 offset:24576
    ds_read_b64_tr_b16 a[206:207], v18 offset:28672
    v_mfma_f32_16x16x32_bf16 v[168:171], a[236:239], a[116:119], v[168:171]
    ds_read_b64_tr_b16 a[208:209], v19 offset:0
    ds_read_b64_tr_b16 a[210:211], v19 offset:4096
    v_mfma_f32_16x16x32_bf16 v[168:171], a[232:235], a[100:103], v[168:171]
    ds_read_b64_tr_b16 a[212:213], v19 offset:8192
    ds_read_b64_tr_b16 a[214:215], v19 offset:12288
    v_mfma_f32_16x16x32_bf16 v[168:171], a[228:231], a[84:87], v[168:171]
    ds_read_b64_tr_b16 a[216:217], v19 offset:16384
    ds_read_b64_tr_b16 a[218:219], v19 offset:20480
    v_mfma_f32_16x16x32_bf16 v[168:171], a[224:227], a[68:71], v[168:171]
    ds_read_b64_tr_b16 a[220:221], v19 offset:24576
    ds_read_b64_tr_b16 a[222:223], v19 offset:28672
    v_mfma_f32_16x16x32_bf16 v[200:203], a[224:227], a[72:75], v[200:203]
    s_xor_b32 s42, s36, 8192
    v_cvt_pk_bf16_f32 v80, v128, v129
    v_cvt_pk_bf16_f32 v81, v130, v131
    v_mfma_f32_16x16x32_bf16 v[200:203], a[228:231], a[88:91], v[200:203]
    v_cvt_pk_bf16_f32 v82, v132, v133
    v_cvt_pk_bf16_f32 v83, v134, v135
    v_mfma_f32_16x16x32_bf16 v[200:203], a[232:235], a[104:107], v[200:203]
    buffer_store_dwordx4 v[80:83], v20, s[32:35], s42 offen offset:0 sc1
    v_mfma_f32_16x16x32_bf16 v[200:203], a[236:239], a[120:123], v[200:203]
    v_mfma_f32_16x16x32_bf16 v[232:235], a[236:239], a[124:127], v[232:235]
    v_cvt_pk_bf16_f32 v84, v160, v161
    v_cvt_pk_bf16_f32 v85, v162, v163
    v_mfma_f32_16x16x32_bf16 v[232:235], a[232:235], a[108:111], v[232:235]
    v_cvt_pk_bf16_f32 v86, v164, v165
    v_cvt_pk_bf16_f32 v87, v166, v167
    v_mfma_f32_16x16x32_bf16 v[232:235], a[228:231], a[92:95], v[232:235]
    buffer_store_dwordx4 v[84:87], v20, s[32:35], s42 offen offset:1024 sc1
    v_mfma_f32_16x16x32_bf16 v[232:235], a[224:227], a[76:79], v[232:235]
    v_mfma_f32_16x16x32_bf16 v[236:239], a[240:243], a[76:79], v[236:239]
    v_cvt_pk_bf16_f32 v88, v192, v193
    v_cvt_pk_bf16_f32 v89, v194, v195
    v_mfma_f32_16x16x32_bf16 v[236:239], a[244:247], a[92:95], v[236:239]
    v_cvt_pk_bf16_f32 v90, v196, v197
    v_cvt_pk_bf16_f32 v91, v198, v199
    v_mfma_f32_16x16x32_bf16 v[236:239], a[248:251], a[108:111], v[236:239]
    buffer_store_dwordx4 v[88:91], v20, s[32:35], s42 offen offset:2048 sc1
    v_mfma_f32_16x16x32_bf16 v[236:239], a[252:255], a[124:127], v[236:239]
    v_mfma_f32_16x16x32_bf16 v[204:207], a[252:255], a[120:123], v[204:207]
    v_cvt_pk_bf16_f32 v92, v224, v225
    v_cvt_pk_bf16_f32 v93, v226, v227
    v_mfma_f32_16x16x32_bf16 v[204:207], a[248:251], a[104:107], v[204:207]
    v_cvt_pk_bf16_f32 v94, v228, v229
    v_cvt_pk_bf16_f32 v95, v230, v231
    v_mfma_f32_16x16x32_bf16 v[204:207], a[244:247], a[88:91], v[204:207]
    buffer_store_dwordx4 v[92:95], v20, s[32:35], s42 offen offset:3072 sc1
    v_mfma_f32_16x16x32_bf16 v[204:207], a[240:243], a[72:75], v[204:207]
    v_mfma_f32_16x16x32_bf16 v[172:175], a[240:243], a[68:71], v[172:175]
    v_mfma_f32_16x16x32_bf16 v[172:175], a[244:247], a[84:87], v[172:175]
    v_mfma_f32_16x16x32_bf16 v[172:175], a[248:251], a[100:103], v[172:175]
    v_mfma_f32_16x16x32_bf16 v[172:175], a[252:255], a[116:119], v[172:175]
    v_mfma_f32_16x16x32_bf16 v[140:143], a[252:255], a[112:115], v[140:143]
    v_mfma_f32_16x16x32_bf16 v[140:143], a[248:251], a[96:99], v[140:143]
    v_mfma_f32_16x16x32_bf16 v[140:143], a[244:247], a[80:83], v[140:143]
    v_mfma_f32_16x16x32_bf16 v[140:143], a[240:243], a[64:67], v[140:143]
    s_waitcnt vmcnt(20) lgkmcnt(0)
    v_mfma_f32_16x16x32_bf16 v[136:139], a[192:195], a[128:131], v[136:139]
    s_xor_b32 s42, s36, 12288
    v_mfma_f32_16x16x32_bf16 v[136:139], a[196:199], a[144:147], v[136:139]
    v_mfma_f32_16x16x32_bf16 v[136:139], a[200:203], a[160:163], v[136:139]
    v_mfma_f32_16x16x32_bf16 v[136:139], a[204:207], a[176:179], v[136:139]
    v_mfma_f32_16x16x32_bf16 v[140:143], a[220:223], a[176:179], v[140:143]
    v_mfma_f32_16x16x32_bf16 v[140:143], a[216:219], a[160:163], v[140:143]
    v_mfma_f32_16x16x32_bf16 v[140:143], a[212:215], a[144:147], v[140:143]
    v_mfma_f32_16x16x32_bf16 v[140:143], a[208:211], a[128:131], v[140:143]
    v_mfma_f32_16x16x32_bf16 v[168:171], a[192:195], a[132:135], v[168:171]
    v_mfma_f32_16x16x32_bf16 v[168:171], a[196:199], a[148:151], v[168:171]
    v_mfma_f32_16x16x32_bf16 v[168:171], a[200:203], a[164:167], v[168:171]
    v_mfma_f32_16x16x32_bf16 v[168:171], a[204:207], a[180:183], v[168:171]
    v_mfma_f32_16x16x32_bf16 v[172:175], a[220:223], a[180:183], v[172:175]
    v_mfma_f32_16x16x32_bf16 v[172:175], a[216:219], a[164:167], v[172:175]
    v_mfma_f32_16x16x32_bf16 v[172:175], a[212:215], a[148:151], v[172:175]
    v_mfma_f32_16x16x32_bf16 v[172:175], a[208:211], a[132:135], v[172:175]
    v_mfma_f32_16x16x32_bf16 v[200:203], a[192:195], a[136:139], v[200:203]
    v_cvt_pk_bf16_f32 v96, v136, v137
    v_cvt_pk_bf16_f32 v97, v138, v139
    v_mfma_f32_16x16x32_bf16 v[200:203], a[196:199], a[152:155], v[200:203]
    v_cvt_pk_bf16_f32 v98, v140, v141
    v_cvt_pk_bf16_f32 v99, v142, v143
    v_mfma_f32_16x16x32_bf16 v[200:203], a[200:203], a[168:171], v[200:203]
    buffer_store_dwordx4 v[96:99], v20, s[32:35], s42 offen offset:0 sc1
    v_mfma_f32_16x16x32_bf16 v[200:203], a[204:207], a[184:187], v[200:203]
    v_mfma_f32_16x16x32_bf16 v[204:207], a[220:223], a[184:187], v[204:207]
    v_mfma_f32_16x16x32_bf16 v[204:207], a[216:219], a[168:171], v[204:207]
    v_mfma_f32_16x16x32_bf16 v[204:207], a[212:215], a[152:155], v[204:207]
    v_mfma_f32_16x16x32_bf16 v[204:207], a[208:211], a[136:139], v[204:207]
    v_mfma_f32_16x16x32_bf16 v[232:235], a[192:195], a[140:143], v[232:235]
    v_cvt_pk_bf16_f32 v100, v168, v169
    v_cvt_pk_bf16_f32 v101, v170, v171
    v_mfma_f32_16x16x32_bf16 v[232:235], a[196:199], a[156:159], v[232:235]
    v_cvt_pk_bf16_f32 v102, v172, v173
    v_cvt_pk_bf16_f32 v103, v174, v175
    v_mfma_f32_16x16x32_bf16 v[232:235], a[200:203], a[172:175], v[232:235]
    buffer_store_dwordx4 v[100:103], v20, s[32:35], s42 offen offset:1024 sc1
    v_mfma_f32_16x16x32_bf16 v[232:235], a[204:207], a[188:191], v[232:235]
    v_mfma_f32_16x16x32_bf16 v[236:239], a[220:223], a[188:191], v[236:239]
    v_mfma_f32_16x16x32_bf16 v[236:239], a[216:219], a[172:175], v[236:239]
    v_mfma_f32_16x16x32_bf16 v[236:239], a[212:215], a[156:159], v[236:239]
    v_mfma_f32_16x16x32_bf16 v[236:239], a[208:211], a[140:143], v[236:239]
    v_cvt_pk_bf16_f32 v104, v200, v201
    v_cvt_pk_bf16_f32 v105, v202, v203
    v_cvt_pk_bf16_f32 v106, v204, v205
    v_cvt_pk_bf16_f32 v107, v206, v207
    buffer_store_dwordx4 v[104:107], v20, s[32:35], s42 offen offset:2048 sc1
    s_nop 3
    v_cvt_pk_bf16_f32 v108, v232, v233
    v_cvt_pk_bf16_f32 v109, v234, v235
    v_cvt_pk_bf16_f32 v110, v236, v237
    v_cvt_pk_bf16_f32 v111, v238, v239
    buffer_store_dwordx4 v[108:111], v20, s[32:35], s42 offen offset:3072 sc1
    v_and_b32 v4, 7, v21
    v_lshrrev_b32 v5, 5, v21
    v_bfe_u32 v6, v21, 3, 2
    v_lshlrev_b32 v8, 12, v5
    v_lshl_add_u32 v8, v6, 8, v8
    v_lshl_add_u32 v8, v4, 4, v8
    v_lshlrev_b32 v9, 7, v5
    v_lshl_add_u32 v9, v6, 4, v9
    v_lshrrev_b32 v7, 1, v9
    v_lshl_add_u32 v7, v4, 10, v7
    v_add_u32 v10, s48, v20
    s_lshl_b32 s41, s57, 5
    s_add_u32 s41, s41, s56
    s_lshl_b32 s40, s41, 13
    s_add_u32 s28, s4, s40
    s_addc_u32 s29, s5, 0
    s_and_b32 s29, s29, 0xffff
    s_mov_b32 s30, 8192
    s_mov_b32 s31, 0x20000
    s_mov_b32 s41, 0
L_c2_main_kernel:
    v_cmp_gt_u32 vcc, 128, v36
    s_cbranch_vccz L_c2d_main_kernel
    v_mov_b32 v36, 0
    global_load_dword v36, v36, s[100:101] offset:4 sc1
    s_add_u32 s41, s41, 1
    s_cmp_lt_u32 s41, 0x80000
    s_waitcnt vmcnt(0)
    s_cbranch_scc1 L_c2_main_kernel
L_c2d_main_kernel:
    s_mov_b32 s42, 20480
    buffer_load_dwordx4 v[112:115], v10, s[52:55], s42 offen sc1
    buffer_load_dwordx4 v[116:119], v10, s[52:55], s42 offen offset:1024 sc1
    s_mov_b32 s42, 32768
    buffer_load_dwordx4 v[120:123], v10, s[52:55], s42 offen sc1
    buffer_load_dwordx4 v[124:127], v10, s[52:55], s42 offen offset:1024 sc1
    s_mov_b32 s42, 45056
    buffer_load_dwordx4 v[128:131], v10, s[52:55], s42 offen sc1
    buffer_load_dwordx4 v[132:135], v10, s[52:55], s42 offen offset:1024 sc1
    s_mov_b32 s42, 57344
    buffer_load_dwordx4 v[136:139], v10, s[52:55], s42 offen sc1
    buffer_load_dwordx4 v[140:143], v10, s[52:55], s42 offen offset:1024 sc1
    buffer_load_dwordx2 v[12:13], v7, s[28:31], 0 offen offset:0
    buffer_load_dwordx2 v[14:15], v7, s[28:31], 0 offen offset:32
    buffer_load_dwordx2 v[16:17], v7, s[28:31], 0 offen offset:512
    buffer_load_dwordx2 v[18:19], v7, s[28:31], 0 offen offset:544
    s_load_dword s98, s[96:97], 0 glc
    v_lshlrev_b32 v3, 7, v0
    v_mov_b32 v1, s88
    s_waitcnt vmcnt(12)
    s_barrier
    s_cmp_lg_u32 s15, 0
    s_cbranch_scc1 L_sig3
    s_mov_b64 exec, 255
    buffer_atomic_add v1, v3, s[52:55], s80 offen sc1
    s_mov_b64 exec, -1
L_sig3:
    s_waitcnt lgkmcnt(0)
    s_and_b32 s99, s98, 0x44444444
    s_bitcmp1_b32 s99, 2
    s_cselect_b32 s62, 14745600, 0
    s_mov_b32 s42, 0
    s_mov_b32 s43, 32768
    buffer_load_dwordx4 v[48:51], v8, s[60:63], s42 offen sc1 nt
    buffer_load_dwordx4 v[52:55], v8, s[60:63], s43 offen sc1 nt
    s_bitcmp1_b32 s99, 6
    s_cselect_b32 s62, 14745600, 0
    s_mov_b32 s42, 2097152
    s_mov_b32 s43, 2129920
    buffer_load_dwordx4 v[56:59], v8, s[60:63], s42 offen sc1 nt
    buffer_load_dwordx4 v[60:63], v8, s[60:63], s43 offen sc1 nt
    s_bitcmp1_b32 s99, 10
    s_cselect_b32 s62, 14745600, 0
    s_mov_b32 s42, 4194304
    s_mov_b32 s43, 4227072
    buffer_load_dwordx4 v[64:67], v8, s[60:63], s42 offen sc1 nt
    buffer_load_dwordx4 v[68:71], v8, s[60:63], s43 offen sc1 nt
    s_bitcmp1_b32 s99, 14
    s_cselect_b32 s62, 14745600, 0
    s_mov_b32 s42, 6291456
    s_mov_b32 s43, 6324224
    buffer_load_dwordx4 v[72:75], v8, s[60:63], s42 offen sc1 nt
    buffer_load_dwordx4 v[76:79], v8, s[60:63], s43 offen sc1 nt
    s_bitcmp1_b32 s99, 18
    s_cselect_b32 s62, 14745600, 0
    s_mov_b32 s42, 8388608
    s_mov_b32 s43, 8421376
    buffer_load_dwordx4 v[80:83], v8, s[60:63], s42 offen sc1 nt
    buffer_load_dwordx4 v[84:87], v8, s[60:63], s43 offen sc1 nt
    s_bitcmp1_b32 s99, 22
    s_cselect_b32 s62, 14745600, 0
    s_mov_b32 s42, 10485760
    s_mov_b32 s43, 10518528
    buffer_load_dwordx4 v[88:91], v8, s[60:63], s42 offen sc1 nt
    buffer_load_dwordx4 v[92:95], v8, s[60:63], s43 offen sc1 nt
    s_bitcmp1_b32 s99, 26
    s_cselect_b32 s62, 14745600, 0
    s_mov_b32 s42, 12582912
    s_mov_b32 s43, 12615680
    buffer_load_dwordx4 v[96:99], v8, s[60:63], s42 offen sc1 nt
    buffer_load_dwordx4 v[100:103], v8, s[60:63], s43 offen sc1 nt
    s_bitcmp1_b32 s99, 30
    s_cselect_b32 s62, 14745600, 0
    s_mov_b32 s42, 14680064
    s_mov_b32 s43, 14712832
    buffer_load_dwordx4 v[104:107], v8, s[60:63], s42 offen sc1 nt
    buffer_load_dwordx4 v[108:111], v8, s[60:63], s43 offen sc1 nt
    s_bcnt1_i32_b32 s89, s99
    s_add_u32 s28, s51, 20971520
    s_add_u32 s28, s72, s28
    s_addc_u32 s29, s73, 0
    s_and_b32 s29, s29, 0xffff
    s_mov_b32 s30, 14745600
    s_mov_b32 s31, 0x20000
    s_add_u32 s32, s74, 39845888
    s_add_u32 s32, s72, s32
    s_addc_u32 s33, s73, 0
    s_and_b32 s33, s33, 0xffff
    s_mov_b32 s34, 65536
    s_mov_b32 s35, 0x20000
    s_waitcnt vmcnt(20)
    v_add_f32 v112, v112, v120
    v_add_f32 v128, v128, v136
    v_add_f32 v113, v113, v121
    v_add_f32 v129, v129, v137
    v_add_f32 v114, v114, v122
    v_add_f32 v130, v130, v138
    v_add_f32 v115, v115, v123
    v_add_f32 v131, v131, v139
    v_add_f32 v116, v116, v124
    v_add_f32 v132, v132, v140
    v_add_f32 v117, v117, v125
    v_add_f32 v133, v133, v141
    v_add_f32 v118, v118, v126
    v_add_f32 v134, v134, v142
    v_add_f32 v119, v119, v127
    v_add_f32 v135, v135, v143
    v_add_f32 v112, v112, v128
    v_add_f32 v113, v113, v129
    v_add_f32 v114, v114, v130
    v_add_f32 v115, v115, v131
    v_add_f32 v116, v116, v132
    v_add_f32 v117, v117, v133
    v_add_f32 v118, v118, v134
    v_add_f32 v119, v119, v135
    v_cvt_pk_bf16_f32 v120, v112, v113
    v_cvt_pk_bf16_f32 v121, v114, v115
    v_cvt_pk_bf16_f32 v122, v116, v117
    v_cvt_pk_bf16_f32 v123, v118, v119
    v_lshlrev_b32 v112, 16, v120
    v_and_b32 v113, 0xffff0000, v120
    v_lshlrev_b32 v114, 16, v121
    v_and_b32 v115, 0xffff0000, v121
    v_lshlrev_b32 v116, 16, v122
    v_and_b32 v117, 0xffff0000, v122
    v_lshlrev_b32 v118, 16, v123
    v_and_b32 v119, 0xffff0000, v123
    s_cmp_eq_u32 s15, 2
    s_cselect_b32 s40, 1.0, 0
    v_add_f32 v112, s40, v112
    v_add_f32 v113, s40, v113
    v_add_f32 v114, s40, v114
    v_add_f32 v115, s40, v115
    v_add_f32 v116, s40, v116
    v_add_f32 v117, s40, v117
    v_add_f32 v118, s40, v118
    v_add_f32 v119, s40, v119
    ds_write_b128 v10, v[112:115] offset:32768
    ds_write_b128 v10, v[116:119] offset:33792
    s_waitcnt vmcnt(16)
    v_lshlrev_b32 v176, 16, v12
    v_and_b32 v177, 0xffff0000, v12
    v_lshlrev_b32 v178, 16, v13
    v_and_b32 v179, 0xffff0000, v13
    v_lshlrev_b32 v180, 16, v14
    v_and_b32 v181, 0xffff0000, v14
    v_lshlrev_b32 v182, 16, v15
    v_and_b32 v183, 0xffff0000, v15
    v_lshlrev_b32 v184, 16, v16
    v_and_b32 v185, 0xffff0000, v16
    v_lshlrev_b32 v186, 16, v17
    v_and_b32 v187, 0xffff0000, v17
    v_lshlrev_b32 v188, 16, v18
    v_and_b32 v189, 0xffff0000, v18
    v_lshlrev_b32 v190, 16, v19
    v_and_b32 v191, 0xffff0000, v19
    s_load_dword s98, s[96:97], 0 glc
    s_add_u32 m0, s48, 65536
    s_mul_i32 s43, s49, 88064
    buffer_load_dwordx4 v44, s[24:27], s43 offen  lds
    s_add_u32 s49, s49, 1
    s_and_b32 s49, s49, 15
    buffer_load_dwordx4 v45, s[24:27], s43 offen offset:1024  lds
    s_add_u32 m0, s48, 73728
    s_mul_i32 s43, s49, 88064
    buffer_load_dwordx4 v44, s[24:27], s43 offen  lds
    s_add_u32 s49, s49, 1
    s_and_b32 s49, s49, 15
    buffer_load_dwordx4 v45, s[24:27], s43 offen offset:1024  lds
    s_add_u32 m0, s48, 81920
    s_mul_i32 s43, s49, 88064
    buffer_load_dwordx4 v44, s[24:27], s43 offen  lds
    s_add_u32 s49, s49, 1
    s_and_b32 s49, s49, 15
    buffer_load_dwordx4 v45, s[24:27], s43 offen offset:1024  lds
    s_add_u32 m0, s48, 90112
    s_mul_i32 s43, s49, 88064
    buffer_load_dwordx4 v44, s[24:27], s43 offen  lds
    s_add_u32 s49, s49, 1
    s_and_b32 s49, s49, 15
    buffer_load_dwordx4 v45, s[24:27], s43 offen offset:1024  lds
    s_mov_b32 s41, 0
    s_waitcnt lgkmcnt(0)
    s_barrier
L_pw_main_kernel:
    s_andn2_b32 s40, s98, s99
    s_and_b32 s40, s40, 0x44444444
    s_cbranch_scc0 L_pn_main_kernel
    s_or_b32 s99, s99, s40
    s_bitcmp1_b32 s40, 2
    s_cbranch_scc0 L_pk0_main_kernel
    s_mov_b32 s42, 0
    s_mov_b32 s43, 32768
    buffer_load_dwordx4 v[48:51], v8, s[28:31], s42 offen sc1 nt
    buffer_load_dwordx4 v[52:55], v8, s[28:31], s43 offen sc1 nt
L_pk0_main_kernel:
    s_bitcmp1_b32 s40, 6
    s_cbranch_scc0 L_pk1_main_kernel
    s_mov_b32 s42, 2097152
    s_mov_b32 s43, 2129920
    buffer_load_dwordx4 v[56:59], v8, s[28:31], s42 offen sc1 nt
    buffer_load_dwordx4 v[60:63], v8, s[28:31], s43 offen sc1 nt
L_pk1_main_kernel:
    s_bitcmp1_b32 s40, 10
    s_cbranch_scc0 L_pk2_main_kernel
    s_mov_b32 s42, 4194304
    s_mov_b32 s43, 4227072
    buffer_load_dwordx4 v[64:67], v8, s[28:31], s42 offen sc1 nt
    buffer_load_dwordx4 v[68:71], v8, s[28:31], s43 offen sc1 nt
L_pk2_main_kernel:
    s_bitcmp1_b32 s40, 14
    s_cbranch_scc0 L_pk3_main_kernel
    s_mov_b32 s42, 6291456
    s_mov_b32 s43, 6324224
    buffer_load_dwordx4 v[72:75], v8, s[28:31], s42 offen sc1 nt
    buffer_load_dwordx4 v[76:79], v8, s[28:31], s43 offen sc1 nt
L_pk3_main_kernel:
    s_bitcmp1_b32 s40, 18
    s_cbranch_scc0 L_pk4_main_kernel
    s_mov_b32 s42, 8388608
    s_mov_b32 s43, 8421376
    buffer_load_dwordx4 v[80:83], v8, s[28:31], s42 offen sc1 nt
    buffer_load_dwordx4 v[84:87], v8, s[28:31], s43 offen sc1 nt
L_pk4_main_kernel:
    s_bitcmp1_b32 s40, 22
    s_cbranch_scc0 L_pk5_main_kernel
    s_mov_b32 s42, 10485760
    s_mov_b32 s43, 10518528
    buffer_load_dwordx4 v[88:91], v8, s[28:31], s42 offen sc1 nt
    buffer_load_dwordx4 v[92:95], v8, s[28:31], s43 offen sc1 nt
L_pk5_main_kernel:
    s_bitcmp1_b32 s40, 26
    s_cbranch_scc0 L_pk6_main_kernel
    s_mov_b32 s42, 12582912
    s_mov_b32 s43, 12615680
    buffer_load_dwordx4 v[96:99], v8, s[28:31], s42 offen sc1 nt
    buffer_load_dwordx4 v[100:103], v8, s[28:31], s43 offen sc1 nt
L_pk6_main_kernel:
    s_bitcmp1_b32 s40, 30
    s_cbranch_scc0 L_pk7_main_kernel
    s_mov_b32 s42, 14680064
    s_mov_b32 s43, 14712832
    buffer_load_dwordx4 v[104:107], v8, s[28:31], s42 offen sc1 nt
    buffer_load_dwordx4 v[108:111], v8, s[28:31], s43 offen sc1 nt
L_pk7_main_kernel:
L_pn_main_kernel:
    s_cmp_eq_u32 s99, 0x44444444
    s_cbranch_scc1 L_pr_main_kernel
    s_sleep 4
    s_load_dword s98, s[96:97], 0 glc
    s_add_u32 s41, s41, 1
    s_cmp_lt_u32 s41, 0x80000
    s_waitcnt lgkmcnt(0)
    s_cbranch_scc1 L_pw_main_kernel
L_pr_main_kernel:
    s_add_u32 s60, s74, 37748736
    s_add_u32 s60, s72, s60
    s_addc_u32 s61, s73, 0
    s_and_b32 s61, s61, 0xffff
    s_mov_b32 s62, 65536
    s_mov_b32 s63, 0x20000
    ds_read_b128 v[192:195], v9 offset:32768
    ds_read_b128 v[196:199], v9 offset:32832
    ds_read_b128 v[200:203], v9 offset:33792
    ds_read_b128 v[204:207], v9 offset:33856
    ds_read_b128 v[208:211], v9 offset:36864
    ds_read_b128 v[212:215], v9 offset:36928
    ds_read_b128 v[216:219], v9 offset:37888
    ds_read_b128 v[220:223], v9 offset:37952
    ds_read_b128 v[224:227], v9 offset:34816
    ds_read_b128 v[228:231], v9 offset:34880
    ds_read_b128 v[232:235], v9 offset:35840
    ds_read_b128 v[236:239], v9 offset:35904
    s_lshl_b32 s86, s58, 2
    s_lshr_b32 s87, s2, 6
    s_add_u32 s86, s86, s87
    s_bfe_u32 s87, s2, 0x30003
    v_mov_b32 v128, 0x3f80
    v_mov_b32 v129, 0x3f800000
    s_waitcnt vmcnt(0)
    v_lshlrev_b32 v112, 16, v48
    v_and_b32 v113, 0xffff0000, v48
    v_lshlrev_b32 v114, 16, v49
    v_and_b32 v115, 0xffff0000, v49
    v_lshlrev_b32 v116, 16, v50
    v_and_b32 v117, 0xffff0000, v50
    v_lshlrev_b32 v118, 16, v51
    v_and_b32 v119, 0xffff0000, v51
    v_lshlrev_b32 v120, 16, v52
    v_and_b32 v121, 0xffff0000, v52
    v_lshlrev_b32 v122, 16, v53
    v_and_b32 v123, 0xffff0000, v53
    v_lshlrev_b32 v124, 16, v54
    v_and_b32 v125, 0xffff0000, v54
    v_lshlrev_b32 v126, 16, v55
    v_and_b32 v127, 0xffff0000, v55
    v_dot2c_f32_bf16 v112, v56, v128
    v_dot2c_f32_bf16 v113, v56, v129
    v_dot2c_f32_bf16 v114, v57, v128
    v_dot2c_f32_bf16 v115, v57, v129
    v_dot2c_f32_bf16 v116, v58, v128
    v_dot2c_f32_bf16 v117, v58, v129
    v_dot2c_f32_bf16 v118, v59, v128
    v_dot2c_f32_bf16 v119, v59, v129
    v_dot2c_f32_bf16 v120, v60, v128
    v_dot2c_f32_bf16 v121, v60, v129
    v_dot2c_f32_bf16 v122, v61, v128
    v_dot2c_f32_bf16 v123, v61, v129
    v_dot2c_f32_bf16 v124, v62, v128
    v_dot2c_f32_bf16 v125, v62, v129
    v_dot2c_f32_bf16 v126, v63, v128
    v_dot2c_f32_bf16 v127, v63, v129
    v_dot2c_f32_bf16 v112, v64, v128
    v_dot2c_f32_bf16 v113, v64, v129
    v_dot2c_f32_bf16 v114, v65, v128
    v_dot2c_f32_bf16 v115, v65, v129
    v_dot2c_f32_bf16 v116, v66, v128
    v_dot2c_f32_bf16 v117, v66, v129
    v_dot2c_f32_bf16 v118, v67, v128
    v_dot2c_f32_bf16 v119, v67, v129
    v_dot2c_f32_bf16 v120, v68, v128
    v_dot2c_f32_bf16 v121, v68, v129
    v_dot2c_f32_bf16 v122, v69, v128
    v_dot2c_f32_bf16 v123, v69, v129
    v_dot2c_f32_bf16 v124, v70, v128
    v_dot2c_f32_bf16 v125, v70, v129
    v_dot2c_f32_bf16 v126, v71, v128
    v_dot2c_f32_bf16 v127, v71, v129
    v_dot2c_f32_bf16 v112, v72, v128
    v_dot2c_f32_bf16 v113, v72, v129
    v_dot2c_f32_bf16 v114, v73, v128
    v_dot2c_f32_bf16 v115, v73, v129
    v_dot2c_f32_bf16 v116, v74, v128
    v_dot2c_f32_bf16 v117, v74, v129
    v_dot2c_f32_bf16 v118, v75, v128
    v_dot2c_f32_bf16 v119, v75, v129
    v_dot2c_f32_bf16 v120, v76, v128
    v_dot2c_f32_bf16 v121, v76, v129
    v_dot2c_f32_bf16 v122, v77, v128
    v_dot2c_f32_bf16 v123, v77, v129
    v_dot2c_f32_bf16 v124, v78, v128
    v_dot2c_f32_bf16 v125, v78, v129
    v_dot2c_f32_bf16 v126, v79, v128
    v_dot2c_f32_bf16 v127, v79, v129
    v_dot2c_f32_bf16 v112, v80, v128
    v_dot2c_f32_bf16 v113, v80, v129
    v_dot2c_f32_bf16 v114, v81, v128
    v_dot2c_f32_bf16 v115, v81, v129
    v_dot2c_f32_bf16 v116, v82, v128
    v_dot2c_f32_bf16 v117, v82, v129
    v_dot2c_f32_bf16 v118, v83, v128
    v_dot2c_f32_bf16 v119, v83, v129
    v_dot2c_f32_bf16 v120, v84, v128
    v_dot2c_f32_bf16 v121, v84, v129
    v_dot2c_f32_bf16 v122, v85, v128
    v_dot2c_f32_bf16 v123, v85, v129
    v_dot2c_f32_bf16 v124, v86, v128
    v_dot2c_f32_bf16 v125, v86, v129
    v_dot2c_f32_bf16 v126, v87, v128
    v_dot2c_f32_bf16 v127, v87, v129
    v_dot2c_f32_bf16 v112, v88, v128
    v_dot2c_f32_bf16 v113, v88, v129
    v_dot2c_f32_bf16 v114, v89, v128
    v_dot2c_f32_bf16 v115, v89, v129
    v_dot2c_f32_bf16 v116, v90, v128
    v_dot2c_f32_bf16 v117, v90, v129
    v_dot2c_f32_bf16 v118, v91, v128
    v_dot2c_f32_bf16 v119, v91, v129
    v_dot2c_f32_bf16 v120, v92, v128
    v_dot2c_f32_bf16 v121, v92, v129
    v_dot2c_f32_bf16 v122, v93, v128
    v_dot2c_f32_bf16 v123, v93, v129
    v_dot2c_f32_bf16 v124, v94, v128
    v_dot2c_f32_bf16 v125, v94, v129
    v_dot2c_f32_bf16 v126, v95, v128
    v_dot2c_f32_bf16 v127, v95, v129
    v_dot2c_f32_bf16 v112, v96, v128
    v_dot2c_f32_bf16 v113, v96, v129
    v_dot2c_f32_bf16 v114, v97, v128
    v_dot2c_f32_bf16 v115, v97, v129
    v_dot2c_f32_bf16 v116, v98, v128
    v_dot2c_f32_bf16 v117, v98, v129
    v_dot2c_f32_bf16 v118, v99, v128
    v_dot2c_f32_bf16 v119, v99, v129
    v_dot2c_f32_bf16 v120, v100, v128
    v_dot2c_f32_bf16 v121, v100, v129
    v_dot2c_f32_bf16 v122, v101, v128
    v_dot2c_f32_bf16 v123, v101, v129
    v_dot2c_f32_bf16 v124, v102, v128
    v_dot2c_f32_bf16 v125, v102, v129
    v_dot2c_f32_bf16 v126, v103, v128
    v_dot2c_f32_bf16 v127, v103, v129
    v_dot2c_f32_bf16 v112, v104, v128
    v_dot2c_f32_bf16 v113, v104, v129
    v_dot2c_f32_bf16 v114, v105, v128
    v_dot2c_f32_bf16 v115, v105, v129
    v_dot2c_f32_bf16 v116, v106, v128
    v_dot2c_f32_bf16 v117, v106, v129
    v_dot2c_f32_bf16 v118, v107, v128
    v_dot2c_f32_bf16 v119, v107, v129
    v_dot2c_f32_bf16 v120, v108, v128
    v_dot2c_f32_bf16 v121, v108, v129
    v_dot2c_f32_bf16 v122, v109, v128
    v_dot2c_f32_bf16 v123, v109, v129
    v_dot2c_f32_bf16 v124, v110, v128
    v_dot2c_f32_bf16 v125, v110, v129
    v_dot2c_f32_bf16 v126, v111, v128
    v_dot2c_f32_bf16 v127, v111, v129
    s_waitcnt lgkmcnt(0)
    v_fmac_f32 v176, v192, v112
    v_fmac_f32 v177, v193, v113
    v_fmac_f32 v178, v194, v114
    v_fmac_f32 v179, v195, v115
    v_fmac_f32 v180, v196, v116
    s_branch L_over8
.p2align 12
L_stub8:
    s_setpc_b64 s[46:47]
L_over8:
    v_fmac_f32 v181, v197, v117
    v_fmac_f32 v182, v198, v118
    v_fmac_f32 v183, v199, v119
    v_fmac_f32 v184, v200, v120
    v_fmac_f32 v185, v201, v121
    v_fmac_f32 v186, v202, v122
    v_fmac_f32 v187, v203, v123
    v_fmac_f32 v188, v204, v124
    v_fmac_f32 v189, v205, v125
    v_fmac_f32 v190, v206, v126
    v_fmac_f32 v191, v207, v127
    v_cvt_pk_bf16_f32 v12, v176, v177
    v_cvt_pk_bf16_f32 v13, v178, v179
    v_cvt_pk_bf16_f32 v14, v180, v181
    v_cvt_pk_bf16_f32 v15, v182, v183
    v_cvt_pk_bf16_f32 v16, v184, v185
    v_cvt_pk_bf16_f32 v17, v186, v187
    v_cvt_pk_bf16_f32 v18, v188, v189
    v_cvt_pk_bf16_f32 v19, v190, v191
    v_mov_b32 v136, 0
    v_mov_b32 v137, 0
    v_mov_b32 v139, 0x3f803f80
    v_dot2c_f32_bf16 v136, v12, v139
    v_dot2c_f32_bf16 v137, v12, v12
    v_dot2c_f32_bf16 v136, v13, v139
    v_dot2c_f32_bf16 v137, v13, v13
    v_dot2c_f32_bf16 v136, v14, v139
    v_dot2c_f32_bf16 v137, v14, v14
    v_dot2c_f32_bf16 v136, v15, v139
    v_dot2c_f32_bf16 v137, v15, v15
    v_dot2c_f32_bf16 v136, v16, v139
    v_dot2c_f32_bf16 v137, v16, v16
    v_dot2c_f32_bf16 v136, v17, v139
    v_dot2c_f32_bf16 v137, v17, v17
    v_dot2c_f32_bf16 v136, v18, v139
    v_dot2c_f32_bf16 v137, v18, v18
    v_dot2c_f32_bf16 v136, v19, v139
    v_dot2c_f32_bf16 v137, v19, v19
    s_lshl_b32 s40, s15, 3
    v_bfe_u32 v138, v0, 4, 1
    v_lshl_add_u32 v138, v138, 2, s40
    v_add_f32_dpp v136, v136, v136 row_ror:8 row_mask:0xf bank_mask:0xf
    v_add_f32_dpp v137, v137, v137 row_ror:8 row_mask:0xf bank_mask:0xf
    v_lshl_add_u32 v138, v4, 5, v138
    s_nop 0
    v_permlane16_swap_b32 v136, v137
    v_add_f32 v136, v136, v137
    v_mov_b32 v137, v136
    s_nop 1
    v_permlane32_swap_b32 v136, v137
    v_add_f32 v136, v136, v137
    ds_write_b32 v138, v136 offset:40960
    buffer_store_dwordx4 v[12:15], v8, s[60:63], 0 offen sc1
    buffer_store_dwordx4 v[16:19], v8, s[60:63], s75 offen sc1
    v_lshlrev_b32 v136, 5, v4
    s_waitcnt lgkmcnt(0)
    s_barrier
    ds_read_b128 v[140:143], v136 offset:40960
    ds_read_b128 v[144:147], v136 offset:40976
    v_lshlrev_b32 v176, 16, v12
    v_and_b32 v177, 0xffff0000, v12
    v_lshlrev_b32 v178, 16, v13
    v_and_b32 v179, 0xffff0000, v13
    v_lshlrev_b32 v180, 16, v14
    v_and_b32 v181, 0xffff0000, v14
    v_lshlrev_b32 v182, 16, v15
    v_and_b32 v183, 0xffff0000, v15
    v_lshlrev_b32 v184, 16, v16
    v_and_b32 v185, 0xffff0000, v16
    v_lshlrev_b32 v186, 16, v17
    v_and_b32 v187, 0xffff0000, v17
    v_lshlrev_b32 v188, 16, v18
    v_and_b32 v189, 0xffff0000, v18
    v_lshlrev_b32 v190, 16, v19
    v_and_b32 v191, 0xffff0000, v19
    s_waitcnt lgkmcnt(0)
    v_add_f32 v140, v140, v142
    v_add_f32 v141, v141, v143
    v_add_f32 v144, v144, v146
    v_add_f32 v145, v145, v147
    s_mov_b32 s40, 0x3b000000
    v_add_f32 v140, v140, v144
    v_add_f32 v141, v141, v145
    v_mul_f32 v148, s40, v140
    v_mul_f32 v140, v148, v148
    v_fma_f32 v140, v141, s40, -v140
    v_max_f32 v140, 0, v140
    v_add_f32 v140, 0x3727c5ac, v140
    v_rsq_f32 v149, v140
    s_nop 0
    v_mul_f32 v148, v148, v149
    v_fma_f32 v176, v176, v149, -v148
    v_fma_f32 v177, v177, v149, -v148
    v_fma_f32 v178, v178, v149, -v148
    v_fma_f32 v179, v179, v149, -v148
    v_fma_f32 v180, v180, v149, -v148
    v_fma_f32 v181, v181, v149, -v148
    v_fma_f32 v182, v182, v149, -v148
    v_fma_f32 v183, v183, v149, -v148
    v_fmac_f32 v224, v176, v208
    v_fmac_f32 v225, v177, v209
    v_fmac_f32 v226, v178, v210
    v_fmac_f32 v227, v179, v211
    v_fmac_f32 v228, v180, v212
    v_fmac_f32 v229, v181, v213
    v_fmac_f32 v230, v182, v214
    v_fmac_f32 v231, v183, v215
    v_cvt_pk_bf16_f32 v112, v224, v225
    v_cvt_pk_bf16_f32 v113, v226, v227
    v_cvt_pk_bf16_f32 v114, v228, v229
    v_cvt_pk_bf16_f32 v115, v230, v231
    buffer_store_dwordx4 v[112:115], v8, s[32:35], 0 offen sc1
    v_fma_f32 v184, v184, v149, -v148
    v_fma_f32 v185, v185, v149, -v148
    v_fma_f32 v186, v186, v149, -v148
    v_fma_f32 v187, v187, v149, -v148
    v_fma_f32 v188, v188, v149, -v148
    v_fma_f32 v189, v189, v149, -v148
    v_fma_f32 v190, v190, v149, -v148
    v_fma_f32 v191, v191, v149, -v148
    v_fmac_f32 v232, v184, v216
    v_fmac_f32 v233, v185, v217
    v_fmac_f32 v234, v186, v218
    v_fmac_f32 v235, v187, v219
    v_fmac_f32 v236, v188, v220
    v_fmac_f32 v237, v189, v221
    v_fmac_f32 v238, v190, v222
    v_fmac_f32 v239, v191, v223
    v_cvt_pk_bf16_f32 v116, v232, v233
    v_cvt_pk_bf16_f32 v117, v234, v235
    v_cvt_pk_bf16_f32 v118, v236, v237
    v_cvt_pk_bf16_f32 v119, v238, v239
    buffer_store_dwordx4 v[116:119], v8, s[32:35], s75 offen sc1
    s_add_u32 s77, s76, 131076
    v_lshrrev_b32 v38, 2, v0
    v_and_b32 v39, 3, v0
    v_lshlrev_b32 v39, 3, v39
    v_lshl_add_u32 v39, v38, 7, v39
    v_bfe_u32 v38, v0, 3, 2
    v_xor_b32 v40, 0, v38
    v_lshl_add_u32 v240, v40, 5, v39
    v_add_u32 v244, 4096, v240
    v_xor_b32 v40, 1, v38
    v_lshl_add_u32 v241, v40, 5, v39
    v_add_u32 v245, 4096, v241
    v_xor_b32 v40, 2, v38
    v_lshl_add_u32 v242, v40, 5, v39
    v_add_u32 v246, 4096, v242
    v_xor_b32 v40, 3, v38
    v_lshl_add_u32 v243, v40, 5, v39
    v_add_u32 v247, 4096, v243
    v_lshlrev_b32 v3, 7, v0
    v_mov_b32 v1, 1
    s_waitcnt vmcnt(0)
    s_barrier
    s_cmp_lg_u32 s15, 0
    s_cbranch_scc1 L_sig4
    s_mov_b64 exec, 255
    buffer_atomic_add v1, v3, s[52:55], s77 offen sc1
    s_mov_b64 exec, -1
L_sig4:
    ds_read_b64_tr_b16 v[48:49], v240 offset:0
    ds_read_b64_tr_b16 v[50:51], v240 offset:2048
    ds_read_b64_tr_b16 v[52:53], v241 offset:0
    ds_read_b64_tr_b16 v[54:55], v241 offset:2048
    ds_read_b64_tr_b16 v[56:57], v242 offset:0
    ds_read_b64_tr_b16 v[58:59], v242 offset:2048
    ds_read_b64_tr_b16 v[60:61], v243 offset:0
    ds_read_b64_tr_b16 v[62:63], v243 offset:2048
    ds_read_b64_tr_b16 v[64:65], v244 offset:0
    ds_read_b64_tr_b16 v[66:67], v244 offset:2048
    ds_read_b64_tr_b16 v[68:69], v245 offset:0
    ds_read_b64_tr_b16 v[70:71], v245 offset:2048
    ds_read_b64_tr_b16 v[72:73], v246 offset:0
    ds_read_b64_tr_b16 v[74:75], v246 offset:2048
    ds_read_b64_tr_b16 v[76:77], v247 offset:0
    ds_read_b64_tr_b16 v[78:79], v247 offset:2048
    s_cmp_eq_u32 s15, 0
    s_cbranch_scc1 L_g2_main_kernel
    s_add_u32 m0, s48, 98304
    s_mul_i32 s43, s49, 88064
    buffer_load_dwordx4 v44, s[24:27], s43 offen  lds
    s_add_u32 s49, s49, 1
    s_and_b32 s49, s49, 15
    buffer_load_dwordx4 v45, s[24:27], s43 offen offset:1024  lds
    s_add_u32 m0, s48, 106496
    s_mul_i32 s43, s49, 88064
    buffer_load_dwordx4 v44, s[24:27], s43 offen  lds
    s_add_u32 s49, s49, 1
    s_and_b32 s49, s49, 15
    buffer_load_dwordx4 v45, s[24:27], s43 offen offset:1024  lds
    s_add_u32 m0, s48, 114688
    s_mul_i32 s43, s49, 88064
    buffer_load_dwordx4 v44, s[24:27], s43 offen  lds
    s_add_u32 s49, s49, 1
    s_and_b32 s49, s49, 15
    buffer_load_dwordx4 v45, s[24:27], s43 offen offset:1024  lds
    s_add_u32 m0, s48, 122880
    s_mul_i32 s43, s49, 88064
    buffer_load_dwordx4 v44, s[24:27], s43 offen  lds
    s_add_u32 s49, s49, 1
    s_and_b32 s49, s49, 15
    buffer_load_dwordx4 v45, s[24:27], s43 offen offset:1024  lds
    s_add_u32 m0, s48, 131072
    s_mul_i32 s43, s49, 88064
    buffer_load_dwordx4 v44, s[24:27], s43 offen  lds
    s_add_u32 s49, s49, 1
    s_and_b32 s49, s49, 15
    buffer_load_dwordx4 v45, s[24:27], s43 offen offset:1024  lds
    s_add_u32 m0, s48, 139264
    s_mul_i32 s43, s49, 88064
    buffer_load_dwordx4 v44, s[24:27], s43 offen  lds
    s_add_u32 s49, s49, 1
    s_and_b32 s49, s49, 15
    buffer_load_dwordx4 v45, s[24:27], s43 offen offset:1024  lds
    s_add_u32 m0, s48, 147456
    s_mul_i32 s43, s49, 88064
    buffer_load_dwordx4 v44, s[24:27], s43 offen  lds
    s_add_u32 s49, s49, 1
    s_and_b32 s49, s49, 15
    buffer_load_dwordx4 v45, s[24:27], s43 offen offset:1024  lds
    s_add_u32 m0, s48, 155648
    s_mul_i32 s43, s49, 88064
    buffer_load_dwordx4 v44, s[24:27], s43 offen  lds
    s_add_u32 s49, s49, 1
    s_and_b32 s49, s49, 15
    buffer_load_dwordx4 v45, s[24:27], s43 offen offset:1024  lds
L_g2_main_kernel:
    s_lshl_b32 s89, s84, 2
    s_add_u32 s89, s89, s15
    s_mul_i32 s89, s89, 3
    s_mul_i32 s77, s84, 3072
    s_add_u32 s77, s77, s45
    s_add_u32 s77, s77, 131076
    s_cmp_eq_u32 s84, 10
    s_cselect_b32 s41, 1, 2
    s_mov_b32 s50, s85
    s_add_u32 s42, s89, 0
    s_lshr_b32 s40, s42, 2
    s_lshl_b32 s40, s40, 16
    s_and_b32 s43, s42, 3
    s_lshl_b32 s43, s43, 10
    s_add_u32 s40, s40, s43
    v_add_u32 v4, s40, v20
    s_add_u32 s42, s89, 1
    s_lshr_b32 s40, s42, 2
    s_lshl_b32 s40, s40, 16
    s_and_b32 s43, s42, 3
    s_lshl_b32 s43, s43, 10
    s_add_u32 s40, s40, s43
    v_add_u32 v5, s40, v20
    s_add_u32 s42, s89, 2
    s_lshr_b32 s40, s42, 2
    s_lshl_b32 s40, s40, 16
    s_and_b32 s43, s42, 3
    s_lshl_b32 s43, s43, 10
    s_add_u32 s40, s40, s43
    v_add_u32 v6, s40, v20
    s_add_u32 s28, s72, 39845888
    s_addc_u32 s29, s73, 0
    s_and_b32 s29, s29, 0xffff
    s_mov_b32 s30, 2097152
    s_mov_b32 s31, 0x20000
    s_cmp_eq_u32 s82, 0
    s_cselect_b32 s30, s30, 0
    v_min_u32 v2, s41, v0
    v_lshlrev_b32 v2, 10, v2
    s_cmp_lg_u32 s15, 0
    s_cbranch_scc1 L_wt5
    s_mov_b32 s40, 0
    s_mov_b64 exec, 7
L_poll5:
    v_mov_b32 v1, 0
    buffer_atomic_add v1, v2, s[52:55], s77 offen sc0 sc1
    s_add_u32 s40, s40, 1
    s_waitcnt vmcnt(0)
    v_cmp_gt_u32 vcc, 8, v1
    s_cbranch_vccz L_wt5
    s_cmp_lt_u32 s40, 0x40000
    s_cbranch_scc1 L_poll5
L_wt5:
    s_mov_b64 exec, -1
    s_barrier
    s_lshl_b32 s44, s50, 12
    buffer_load_dwordx4 a[0:3], v4, s[28:31], s44 offen offset:0 sc1
    s_add_u32 s50, s50, 1
    s_and_b32 s50, s50, 15
    buffer_load_dwordx4 a[4:7], v5, s[28:31], s44 offen offset:0 sc1
    buffer_load_dwordx4 a[8:11], v6, s[28:31], s44 offen offset:0 sc1
    s_lshl_b32 s44, s50, 12
    buffer_load_dwordx4 a[12:15], v4, s[28:31], s44 offen offset:0 sc1
    s_add_u32 s50, s50, 1
    s_and_b32 s50, s50, 15
    buffer_load_dwordx4 a[16:19], v5, s[28:31], s44 offen offset:0 sc1
    buffer_load_dwordx4 a[20:23], v6, s[28:31], s44 offen offset:0 sc1
    s_cmp_lg_u32 s15, 0
    s_cbranch_scc1 L_g3_main_kernel
    s_add_u32 m0, s48, 98304
    s_mul_i32 s43, s49, 88064
    buffer_load_dwordx4 v44, s[24:27], s43 offen  lds
    s_add_u32 s49, s49, 1
    s_and_b32 s49, s49, 15
    buffer_load_dwordx4 v45, s[24:27], s43 offen offset:1024  lds
    s_add_u32 m0, s48, 106496
    s_mul_i32 s43, s49, 88064
    buffer_load_dwordx4 v44, s[24:27], s43 offen  lds
    s_add_u32 s49, s49, 1
    s_and_b32 s49, s49, 15
    buffer_load_dwordx4 v45, s[24:27], s43 offen offset:1024  lds
    s_add_u32 m0, s48, 114688
    s_mul_i32 s43, s49, 88064
    buffer_load_dwordx4 v44, s[24:27], s43 offen  lds
    s_add_u32 s49, s49, 1
    s_and_b32 s49, s49, 15
    buffer_load_dwordx4 v45, s[24:27], s43 offen offset:1024  lds
    s_add_u32 m0, s48, 122880
    s_mul_i32 s43, s49, 88064
    buffer_load_dwordx4 v44, s[24:27], s43 offen  lds
    s_add_u32 s49, s49, 1
    s_and_b32 s49, s49, 15
    buffer_load_dwordx4 v45, s[24:27], s43 offen offset:1024  lds
    s_add_u32 m0, s48, 131072
    s_mul_i32 s43, s49, 88064
    buffer_load_dwordx4 v44, s[24:27], s43 offen  lds
    s_add_u32 s49, s49, 1
    s_and_b32 s49, s49, 15
    buffer_load_dwordx4 v45, s[24:27], s43 offen offset:1024  lds
    s_add_u32 m0, s48, 139264
    s_mul_i32 s43, s49, 88064
    buffer_load_dwordx4 v44, s[24:27], s43 offen  lds
    s_add_u32 s49, s49, 1
    s_and_b32 s49, s49, 15
    buffer_load_dwordx4 v45, s[24:27], s43 offen offset:1024  lds
    s_add_u32 m0, s48, 147456
    s_mul_i32 s43, s49, 88064
    buffer_load_dwordx4 v44, s[24:27], s43 offen  lds
    s_add_u32 s49, s49, 1
    s_and_b32 s49, s49, 15
    buffer_load_dwordx4 v45, s[24:27], s43 offen offset:1024  lds
    s_add_u32 m0, s48, 155648
    s_mul_i32 s43, s49, 88064
    buffer_load_dwordx4 v44, s[24:27], s43 offen  lds
    s_add_u32 s49, s49, 1
    s_and_b32 s49, s49, 15
    buffer_load_dwordx4 v45, s[24:27], s43 offen offset:1024  lds
L_g3_main_kernel:
    v_add_u32 v248, 0x10000, v240
    v_add_u32 v249, 0x10000, v241
    v_add_u32 v250, 0x10000, v242
    v_add_u32 v251, 0x10000, v243
    v_add_u32 v252, 0x10000, v244
    v_add_u32 v253, 0x10000, v245
    v_add_u32 v254, 0x10000, v246
    v_add_u32 v255, 0x10000, v247
    s_add_u32 s42, s89, 0
    s_lshr_b32 s40, s42, 2
    s_mul_i32 s40, s40, 176128
    s_and_b32 s42, s42, 3
    s_lshl_b32 s42, s42, 10
    s_add_u32 s40, s40, s42
    s_lshl_b32 s42, s83, 13
    s_add_u32 s40, s40, s42
    v_add_u32 v8, s40, v20
    s_add_u32 s42, s89, 1
    s_lshr_b32 s40, s42, 2
    s_mul_i32 s40, s40, 176128
    s_and_b32 s42, s42, 3
    s_lshl_b32 s42, s42, 10
    s_add_u32 s40, s40, s42
    s_lshl_b32 s42, s83, 13
    s_add_u32 s40, s40, s42
    v_add_u32 v9, s40, v20
    s_add_u32 s42, s89, 2
    s_lshr_b32 s40, s42, 2
    s_mul_i32 s40, s40, 176128
    s_and_b32 s42, s42, 3
    s_lshl_b32 s42, s42, 10
    s_add_u32 s40, s40, s42
    s_lshl_b32 s42, s83, 13
    s_add_u32 s40, s40, s42
    v_add_u32 v10, s40, v20
    s_add_u32 s32, s72, 41943040
    s_addc_u32 s33, s73, 0
    s_and_b32 s33, s33, 0xffff
    s_mov_b32 s34, 5636096
    s_mov_b32 s35, 0x20000
    s_cmp_eq_u32 s82, 0
    s_cselect_b32 s34, s34, 0
    v_lshrrev_b32 v38, 3, v0
    v_and_b32 v39, 7, v0
    v_bfe_u32 v40, v0, 4, 2
    v_lshlrev_b32 v40, 1, v40
    v_xor_b32 v39, v39, v40
    v_mul_u32_u24 v38, 1024, v38
    v_lshl_add_u32 v44, v39, 4, v38
    v_add_u32 v45, 7168, v44
    v_add_u32 v46, 14336, v44
    v_add_u32 v47, 21504, v44
    s_lshl_b32 s42, s87, 7
    s_add_u32 s24, s68, s42
    s_addc_u32 s25, s69, 0
    s_sub_u32 s26, 1409024, s42
    s_and_b32 s25, s25, 0xffff
    s_mov_b32 s27, 0x20000
    s_mul_i32 s88, s15, 360448
    s_mul_i32 s80, s87, 0
    s_lshr_b32 s80, s80, 2
    s_lshl_b32 s81, s80, 12
    v_lshrrev_b32 v12, 4, v0
    s_lshl_b32 s40, s87, 8
    v_lshl_add_u32 v13, v12, 4, s40
    ds_read_b128 v[208:211], v13 offset:38912
    ds_read_b128 v[212:215], v13 offset:38976
    ds_read_b128 v[216:219], v13 offset:39040
    ds_read_b128 v[220:223], v13 offset:39104
    s_lshl_b32 s88, s15, 16
    s_lshl_b32 s80, s15, 15
    s_mul_i32 s40, s86, 176128
    s_lshl_b32 s41, s15, 10
    s_add_u32 s40, s40, s41
    s_add_u32 s16, s40, 41943040
    s_add_u32 s16, s72, s16
    s_addc_u32 s17, s73, 0
    s_and_b32 s17, s17, 0xffff
    s_mov_b32 s18, 176128
    s_mov_b32 s19, 0x20000
    s_lshl_b32 s40, s86, 16
    s_lshl_b32 s42, s87, 13
    s_add_u32 s42, s42, s40
    s_add_u32 s42, s42, s41
    s_lshl_b32 s41, s87, 7
    s_add_u32 s40, s40, s41
    s_lshl_b32 s41, s15, 14
    s_add_u32 s40, s40, s41
    s_add_u32 s20, s70, s40
    s_addc_u32 s21, s71, 0
    s_and_b32 s21, s21, 0xffff
    s_mov_b32 s22, 15488
    s_mov_b32 s23, 0x20000
    s_add_u32 s60, s42, 37748736
    s_add_u32 s60, s72, s60
    s_addc_u32 s61, s73, 0
    s_and_b32 s61, s61, 0xffff
    s_mov_b32 s62, 8192
    s_mov_b32 s63, 0x20000
    s_waitcnt vmcnt(3) lgkmcnt(0)
    v_mfma_f32_16x16x32_bf16 v[112:115], v[48:51], a[0:3], 0
    ds_read_b64_tr_b16 v[80:81], v240 offset:8192
    ds_read_b64_tr_b16 v[82:83], v240 offset:10240
    v_mfma_f32_16x16x32_bf16 v[144:147], v[48:51], a[4:7], 0
    ds_read_b64_tr_b16 v[84:85], v241 offset:8192
    ds_read_b64_tr_b16 v[86:87], v241 offset:10240
    v_mfma_f32_16x16x32_bf16 v[176:179], v[48:51], a[8:11], 0
    s_lshl_b32 s44, s50, 12
    buffer_load_dwordx4 a[24:27], v4, s[28:31], s44 offen offset:0 sc1
    v_mfma_f32_16x16x32_bf16 v[180:183], v[52:55], a[8:11], 0
    v_mfma_f32_16x16x32_bf16 v[148:151], v[52:55], a[4:7], 0
    s_add_u32 s50, s50, 1
    ds_read_b64_tr_b16 v[88:89], v242 offset:8192
    ds_read_b64_tr_b16 v[90:91], v242 offset:10240
    v_mfma_f32_16x16x32_bf16 v[116:119], v[52:55], a[0:3], 0
    s_and_b32 s50, s50, 15
    buffer_load_dwordx4 a[28:31], v5, s[28:31], s44 offen offset:0 sc1
    v_mfma_f32_16x16x32_bf16 v[120:123], v[56:59], a[0:3], 0
    v_mfma_f32_16x16x32_bf16 v[152:155], v[56:59], a[4:7], 0
    ds_read_b64_tr_b16 v[92:93], v243 offset:8192
    ds_read_b64_tr_b16 v[94:95], v243 offset:10240
    v_mfma_f32_16x16x32_bf16 v[184:187], v[56:59], a[8:11], 0
    ds_read_b64_tr_b16 v[96:97], v244 offset:8192
    ds_read_b64_tr_b16 v[98:99], v244 offset:10240
    v_mfma_f32_16x16x32_bf16 v[188:191], v[60:63], a[8:11], 0
    buffer_load_dwordx4 a[32:35], v6, s[28:31], s44 offen offset:0 sc1
    v_mfma_f32_16x16x32_bf16 v[156:159], v[60:63], a[4:7], 0
    v_mfma_f32_16x16x32_bf16 v[124:127], v[60:63], a[0:3], 0
    ds_read_b64_tr_b16 v[100:101], v245 offset:8192
    ds_read_b64_tr_b16 v[102:103], v245 offset:10240
    v_mfma_f32_16x16x32_bf16 v[128:131], v[64:67], a[0:3], 0
    ds_read_b64_tr_b16 v[104:105], v246 offset:8192
    ds_read_b64_tr_b16 v[106:107], v246 offset:10240
    v_mfma_f32_16x16x32_bf16 v[160:163], v[64:67], a[4:7], 0
    s_lshl_b32 s44, s50, 12
    buffer_load_dwordx4 a[36:39], v4, s[28:31], s44 offen offset:0 sc1
    v_mfma_f32_16x16x32_bf16 v[192:195], v[64:67], a[8:11], 0
    v_mfma_f32_16x16x32_bf16 v[196:199], v[68:71], a[8:11], 0
    s_add_u32 s50, s50, 1
    ds_read_b64_tr_b16 v[108:109], v247 offset:8192
    ds_read_b64_tr_b16 v[110:111], v247 offset:10240
    v_mfma_f32_16x16x32_bf16 v[164:167], v[68:71], a[4:7], 0
    s_and_b32 s50, s50, 15
    buffer_load_dwordx4 a[40:43], v5, s[28:31], s44 offen offset:0 sc1
    v_mfma_f32_16x16x32_bf16 v[132:135], v[68:71], a[0:3], 0
    v_mfma_f32_16x16x32_bf16 v[136:139], v[72:75], a[0:3], 0
    v_mfma_f32_16x16x32_bf16 v[168:171], v[72:75], a[4:7], 0
    v_mfma_f32_16x16x32_bf16 v[200:203], v[72:75], a[8:11], 0
    buffer_load_dwordx4 a[44:47], v6, s[28:31], s44 offen offset:0 sc1
    v_mfma_f32_16x16x32_bf16 v[204:207], v[76:79], a[8:11], 0
    v_mfma_f32_16x16x32_bf16 v[172:175], v[76:79], a[4:7], 0
    v_mfma_f32_16x16x32_bf16 v[140:143], v[76:79], a[0:3], 0
    s_waitcnt vmcnt(6) lgkmcnt(0)
    v_mfma_f32_16x16x32_bf16 v[112:115], v[80:83], a[12:15], v[112:115]
    ds_read_b64_tr_b16 v[48:49], v240 offset:16384
    ds_read_b64_tr_b16 v[50:51], v240 offset:18432
    v_mfma_f32_16x16x32_bf16 v[144:147], v[80:83], a[16:19], v[144:147]
    ds_read_b64_tr_b16 v[52:53], v240 offset:24576
    ds_read_b64_tr_b16 v[54:55], v240 offset:26624
    v_mfma_f32_16x16x32_bf16 v[176:179], v[80:83], a[20:23], v[176:179]
    s_lshl_b32 s44, s50, 12
    buffer_load_dwordx4 a[48:51], v4, s[28:31], s44 offen offset:0 sc1
    v_mfma_f32_16x16x32_bf16 v[180:183], v[84:87], a[20:23], v[180:183]
    v_mfma_f32_16x16x32_bf16 v[148:151], v[84:87], a[16:19], v[148:151]
    s_add_u32 s50, s50, 1
    ds_read_b64_tr_b16 v[56:57], v241 offset:16384
    ds_read_b64_tr_b16 v[58:59], v241 offset:18432
    v_mfma_f32_16x16x32_bf16 v[116:119], v[84:87], a[12:15], v[116:119]
    s_and_b32 s50, s50, 15
    buffer_load_dwordx4 a[52:55], v5, s[28:31], s44 offen offset:0 sc1
    v_mfma_f32_16x16x32_bf16 v[120:123], v[88:91], a[12:15], v[120:123]
    v_mfma_f32_16x16x32_bf16 v[152:155], v[88:91], a[16:19], v[152:155]
    ds_read_b64_tr_b16 v[60:61], v241 offset:24576
    ds_read_b64_tr_b16 v[62:63], v241 offset:26624
    v_mfma_f32_16x16x32_bf16 v[184:187], v[88:91], a[20:23], v[184:187]
    ds_read_b64_tr_b16 v[64:65], v242 offset:16384
    ds_read_b64_tr_b16 v[66:67], v242 offset:18432
    v_mfma_f32_16x16x32_bf16 v[188:191], v[92:95], a[20:23], v[188:191]
    buffer_load_dwordx4 a[56:59], v6, s[28:31], s44 offen offset:0 sc1
    v_mfma_f32_16x16x32_bf16 v[156:159], v[92:95], a[16:19], v[156:159]
    v_mfma_f32_16x16x32_bf16 v[124:127], v[92:95], a[12:15], v[124:127]
    ds_read_b64_tr_b16 v[68:69], v242 offset:24576
    ds_read_b64_tr_b16 v[70:71], v242 offset:26624
    v_mfma_f32_16x16x32_bf16 v[128:131], v[96:99], a[12:15], v[128:131]
    ds_read_b64_tr_b16 v[72:73], v243 offset:16384
    ds_read_b64_tr_b16 v[74:75], v243 offset:18432
    v_mfma_f32_16x16x32_bf16 v[160:163], v[96:99], a[16:19], v[160:163]
    s_lshl_b32 s44, s50, 12
    buffer_load_dwordx4 a[60:63], v4, s[28:31], s44 offen offset:0 sc1
    v_mfma_f32_16x16x32_bf16 v[192:195], v[96:99], a[20:23], v[192:195]
    v_mfma_f32_16x16x32_bf16 v[196:199], v[100:103], a[20:23], v[196:199]
    s_add_u32 s50, s50, 1
    ds_read_b64_tr_b16 v[76:77], v243 offset:24576
    ds_read_b64_tr_b16 v[78:79], v243 offset:26624
    v_mfma_f32_16x16x32_bf16 v[164:167], v[100:103], a[16:19], v[164:167]
    s_and_b32 s50, s50, 15
    buffer_load_dwordx4 a[64:67], v5, s[28:31], s44 offen offset:0 sc1
    v_mfma_f32_16x16x32_bf16 v[132:135], v[100:103], a[12:15], v[132:135]
    v_mfma_f32_16x16x32_bf16 v[136:139], v[104:107], a[12:15], v[136:139]
    v_mfma_f32_16x16x32_bf16 v[168:171], v[104:107], a[16:19], v[168:171]
    v_mfma_f32_16x16x32_bf16 v[200:203], v[104:107], a[20:23], v[200:203]
    buffer_load_dwordx4 a[68:71], v6, s[28:31], s44 offen offset:0 sc1
    v_mfma_f32_16x16x32_bf16 v[204:207], v[108:111], a[20:23], v[204:207]
    v_mfma_f32_16x16x32_bf16 v[172:175], v[108:111], a[16:19], v[172:175]
    v_mfma_f32_16x16x32_bf16 v[140:143], v[108:111], a[12:15], v[140:143]
    s_waitcnt vmcnt(6) lgkmcnt(0)
    v_mfma_f32_16x16x32_bf16 v[112:115], v[48:51], a[24:27], v[112:115]
    ds_read_b64_tr_b16 v[80:81], v244 offset:16384
    ds_read_b64_tr_b16 v[82:83], v244 offset:18432
    v_mfma_f32_16x16x32_bf16 v[112:115], v[52:55], a[36:39], v[112:115]
    ds_read_b64_tr_b16 v[84:85], v244 offset:24576
    ds_read_b64_tr_b16 v[86:87], v244 offset:26624
    v_mfma_f32_16x16x32_bf16 v[144:147], v[52:55], a[40:43], v[144:147]
    s_lshl_b32 s44, s50, 12
    buffer_load_dwordx4 a[72:75], v4, s[28:31], s44 offen offset:0 sc1
    v_mfma_f32_16x16x32_bf16 v[144:147], v[48:51], a[28:31], v[144:147]
    v_mfma_f32_16x16x32_bf16 v[176:179], v[48:51], a[32:35], v[176:179]
    s_add_u32 s50, s50, 1
    ds_read_b64_tr_b16 v[88:89], v245 offset:16384
    ds_read_b64_tr_b16 v[90:91], v245 offset:18432
    v_mfma_f32_16x16x32_bf16 v[176:179], v[52:55], a[44:47], v[176:179]
    s_and_b32 s50, s50, 15
    buffer_load_dwordx4 a[76:79], v5, s[28:31], s44 offen offset:0 sc1
    v_mfma_f32_16x16x32_bf16 v[180:183], v[60:63], a[44:47], v[180:183]
    ds_read_b64_tr_b16 v[92:93], v245 offset:24576
    ds_read_b64_tr_b16 v[94:95], v245 offset:26624
    v_mfma_f32_16x16x32_bf16 v[180:183], v[56:59], a[32:35], v[180:183]
    ds_read_b64_tr_b16 v[96:97], v246 offset:16384
    ds_read_b64_tr_b16 v[98:99], v246 offset:18432
    v_mfma_f32_16x16x32_bf16 v[148:151], v[56:59], a[28:31], v[148:151]
    ds_read_b64_tr_b16 v[100:101], v246 offset:24576
    ds_read_b64_tr_b16 v[102:103], v246 offset:26624
    v_mfma_f32_16x16x32_bf16 v[148:151], v[60:63], a[40:43], v[148:151]
    buffer_load_dwordx4 a[80:83], v6, s[28:31], s44 offen offset:0 sc1
    v_mfma_f32_16x16x32_bf16 v[116:119], v[60:63], a[36:39], v[116:119]
    ds_read_b64_tr_b16 v[104:105], v247 offset:16384
    ds_read_b64_tr_b16 v[106:107], v247 offset:18432
    v_mfma_f32_16x16x32_bf16 v[116:119], v[56:59], a[24:27], v[116:119]
    ds_read_b64_tr_b16 v[108:109], v247 offset:24576
    ds_read_b64_tr_b16 v[110:111], v247 offset:26624
    v_mfma_f32_16x16x32_bf16 v[120:123], v[64:67], a[24:27], v[120:123]
    v_mov_b32 v224, v240
    v_mov_b32 v228, v248
    v_mfma_f32_16x16x32_bf16 v[120:123], v[68:71], a[36:39], v[120:123]
    s_lshl_b32 s44, s50, 12
    buffer_load_dwordx4 a[84:87], v4, s[28:31], s44 offen offset:0 sc1
    v_mfma_f32_16x16x32_bf16 v[152:155], v[68:71], a[40:43], v[152:155]
    v_add_u32 v232, 0x20000, v240
    v_mov_b32 v225, v241
    v_mfma_f32_16x16x32_bf16 v[152:155], v[64:67], a[28:31], v[152:155]
    s_add_u32 s50, s50, 1
    v_mov_b32 v229, v249
    v_add_u32 v233, 0x20000, v241
    v_mfma_f32_16x16x32_bf16 v[184:187], v[64:67], a[32:35], v[184:187]
    s_and_b32 s50, s50, 15
    buffer_load_dwordx4 a[88:91], v5, s[28:31], s44 offen offset:0 sc1
    v_mfma_f32_16x16x32_bf16 v[184:187], v[68:71], a[44:47], v[184:187]
    v_mov_b32 v226, v242
    v_mov_b32 v230, v250
    v_mfma_f32_16x16x32_bf16 v[188:191], v[76:79], a[44:47], v[188:191]
    v_add_u32 v234, 0x20000, v242
    v_mov_b32 v227, v243
    v_mfma_f32_16x16x32_bf16 v[188:191], v[72:75], a[32:35], v[188:191]
    v_mov_b32 v231, v251
    v_add_u32 v235, 0x20000, v243
    v_mfma_f32_16x16x32_bf16 v[156:159], v[72:75], a[28:31], v[156:159]
    buffer_load_dwordx4 a[92:95], v6, s[28:31], s44 offen offset:0 sc1
    v_mfma_f32_16x16x32_bf16 v[156:159], v[76:79], a[40:43], v[156:159]
    v_and_b32 v14, 15, v0
    v_lshlrev_b32 v14, 10, v14
    v_mfma_f32_16x16x32_bf16 v[124:127], v[76:79], a[36:39], v[124:127]
    v_mfma_f32_16x16x32_bf16 v[124:127], v[72:75], a[24:27], v[124:127]
    s_waitcnt vmcnt(12) lgkmcnt(0)
    v_mfma_f32_16x16x32_bf16 v[128:131], v[80:83], a[24:27], v[128:131]
    ds_read_b64_tr_b16 v[48:49], v248 offset:0
    ds_read_b64_tr_b16 v[50:51], v248 offset:2048
    v_lshl_add_u32 v14, v12, 4, v14
    v_mfma_f32_16x16x32_bf16 v[128:131], v[84:87], a[36:39], v[128:131]
    s_lshl_b32 s77, s84, 2
    ds_read_b64_tr_b16 v[52:53], v248 offset:8192
    ds_read_b64_tr_b16 v[54:55], v248 offset:10240
    s_and_b32 s40, s83, 3
    v_mfma_f32_16x16x32_bf16 v[160:163], v[84:87], a[40:43], v[160:163]
    s_lshl_b32 s44, s50, 12
    buffer_load_dwordx4 a[96:99], v4, s[28:31], s44 offen offset:0 sc1
    s_add_u32 s77, s77, s40
    v_mfma_f32_16x16x32_bf16 v[160:163], v[80:83], a[28:31], v[160:163]
    s_lshl_b32 s77, s77, 10
    ds_read_b64_tr_b16 v[56:57], v248 offset:16384
    ds_read_b64_tr_b16 v[58:59], v248 offset:18432
    s_add_u32 s77, s77, 131084
    v_mfma_f32_16x16x32_bf16 v[192:195], v[80:83], a[32:35], v[192:195]
    s_add_u32 s50, s50, 1
    ds_read_b64_tr_b16 v[60:61], v248 offset:24576
    ds_read_b64_tr_b16 v[62:63], v248 offset:26624
    s_mul_i32 s40, s86, 43
    v_mfma_f32_16x16x32_bf16 v[192:195], v[84:87], a[44:47], v[192:195]
    s_and_b32 s50, s50, 15
    buffer_load_dwordx4 a[100:103], v5, s[28:31], s44 offen offset:0 sc1
    s_lshr_b32 s40, s40, 7
    v_mfma_f32_16x16x32_bf16 v[196:199], v[92:95], a[44:47], v[196:199]
    s_lshl_b32 s78, s40, 12
    ds_read_b64_tr_b16 v[64:65], v249 offset:0
    ds_read_b64_tr_b16 v[66:67], v249 offset:2048
    s_lshl_b32 s40, s87, 7
    v_mfma_f32_16x16x32_bf16 v[196:199], v[88:91], a[32:35], v[196:199]
    s_branch L_over9
.p2align 12
L_stub9:
    s_setpc_b64 s[46:47]
L_over9:
    s_add_u32 s78, s78, s40
    ds_read_b64_tr_b16 v[68:69], v249 offset:8192
    ds_read_b64_tr_b16 v[70:71], v249 offset:10240
    s_add_u32 s78, s78, 131084
    v_mfma_f32_16x16x32_bf16 v[164:167], v[88:91], a[28:31], v[164:167]
    ds_read_b64_tr_b16 v[72:73], v249 offset:16384
    ds_read_b64_tr_b16 v[74:75], v249 offset:18432
    v_lshrrev_b32 v15, 1, v0
    v_mfma_f32_16x16x32_bf16 v[164:167], v[92:95], a[40:43], v[164:167]
    buffer_load_dwordx4 a[104:107], v6, s[28:31], s44 offen offset:0 sc1
    v_sub_u32 v15, 6, v15
    v_mfma_f32_16x16x32_bf16 v[132:135], v[92:95], a[36:39], v[132:135]
    ds_read_b64_tr_b16 v[76:77], v249 offset:24576
    ds_read_b64_tr_b16 v[78:79], v249 offset:26624
    v_lshrrev_b32 v16, 2, v0
    v_mfma_f32_16x16x32_bf16 v[132:135], v[88:91], a[24:27], v[132:135]
    v_lshlrev_b32 v2, 10, v0
    v_lshl_add_u32 v2, v16, 24, v2
    v_min_u32 v16, 1, v16
    v_mfma_f32_16x16x32_bf16 v[136:139], v[96:99], a[24:27], v[136:139]
    v_sub_u32 v16, 1, v16
    v_mul_u32_u24 v15, v15, v16
    v_lshlrev_b32 v16, 8, v15
    v_mfma_f32_16x16x32_bf16 v[136:139], v[100:103], a[36:39], v[136:139]
    s_lshl_b32 s44, s50, 12
    buffer_load_dwordx4 a[108:111], v4, s[28:31], s44 offen offset:0 sc1
    v_mfma_f32_16x16x32_bf16 v[168:171], v[100:103], a[40:43], v[168:171]
    v_mfma_f32_16x16x32_bf16 v[168:171], v[96:99], a[28:31], v[168:171]
    s_add_u32 s50, s50, 1
    v_mfma_f32_16x16x32_bf16 v[200:203], v[96:99], a[32:35], v[200:203]
    s_and_b32 s50, s50, 15
    buffer_load_dwordx4 a[112:115], v5, s[28:31], s44 offen offset:0 sc1
    v_mfma_f32_16x16x32_bf16 v[200:203], v[100:103], a[44:47], v[200:203]
    v_mfma_f32_16x16x32_bf16 v[204:207], v[108:111], a[44:47], v[204:207]
    v_mfma_f32_16x16x32_bf16 v[204:207], v[104:107], a[32:35], v[204:207]
    v_mfma_f32_16x16x32_bf16 v[172:175], v[104:107], a[28:31], v[172:175]
    buffer_load_dwordx4 a[116:119], v6, s[28:31], s44 offen offset:0 sc1
    v_mfma_f32_16x16x32_bf16 v[172:175], v[108:111], a[40:43], v[172:175]
    v_mfma_f32_16x16x32_bf16 v[140:143], v[108:111], a[36:39], v[140:143]
    v_mfma_f32_16x16x32_bf16 v[140:143], v[104:107], a[24:27], v[140:143]
    s_waitcnt vmcnt(6) lgkmcnt(0)
    v_mfma_f32_16x16x32_bf16 v[112:115], v[48:51], a[48:51], v[112:115]
    ds_read_b64_tr_b16 v[80:81], v252 offset:0
    ds_read_b64_tr_b16 v[82:83], v252 offset:2048
    v_mfma_f32_16x16x32_bf16 v[112:115], v[52:55], a[60:63], v[112:115]
    ds_read_b64_tr_b16 v[84:85], v252 offset:8192
    ds_read_b64_tr_b16 v[86:87], v252 offset:10240
    v_mfma_f32_16x16x32_bf16 v[112:115], v[56:59], a[72:75], v[112:115]
    s_lshl_b32 s44, s50, 12
    buffer_load_dwordx4 a[120:123], v4, s[28:31], s44 offen offset:0 sc1
    v_mfma_f32_16x16x32_bf16 v[112:115], v[60:63], a[84:87], v[112:115]
    v_mfma_f32_16x16x32_bf16 v[144:147], v[60:63], a[88:91], v[144:147]
    s_add_u32 s50, s50, 1
    ds_read_b64_tr_b16 v[88:89], v252 offset:16384
    ds_read_b64_tr_b16 v[90:91], v252 offset:18432
    v_mfma_f32_16x16x32_bf16 v[144:147], v[56:59], a[76:79], v[144:147]
    s_and_b32 s50, s50, 15
    buffer_load_dwordx4 a[124:127], v5, s[28:31], s44 offen offset:0 sc1
    v_mfma_f32_16x16x32_bf16 v[144:147], v[52:55], a[64:67], v[144:147]
    v_mfma_f32_16x16x32_bf16 v[144:147], v[48:51], a[52:55], v[144:147]
    ds_read_b64_tr_b16 v[92:93], v252 offset:24576
    ds_read_b64_tr_b16 v[94:95], v252 offset:26624
    v_mfma_f32_16x16x32_bf16 v[176:179], v[48:51], a[56:59], v[176:179]
    ds_read_b64_tr_b16 v[96:97], v253 offset:0
    ds_read_b64_tr_b16 v[98:99], v253 offset:2048
    v_mfma_f32_16x16x32_bf16 v[176:179], v[52:55], a[68:71], v[176:179]
    buffer_load_dwordx4 a[128:131], v6, s[28:31], s44 offen offset:0 sc1
    v_mfma_f32_16x16x32_bf16 v[176:179], v[56:59], a[80:83], v[176:179]
    v_mfma_f32_16x16x32_bf16 v[176:179], v[60:63], a[92:95], v[176:179]
    ds_read_b64_tr_b16 v[100:101], v253 offset:8192
    ds_read_b64_tr_b16 v[102:103], v253 offset:10240
    v_mfma_f32_16x16x32_bf16 v[180:183], v[76:79], a[92:95], v[180:183]
    ds_read_b64_tr_b16 v[104:105], v253 offset:16384
    ds_read_b64_tr_b16 v[106:107], v253 offset:18432
    v_mfma_f32_16x16x32_bf16 v[180:183], v[72:75], a[80:83], v[180:183]
    s_lshl_b32 s44, s50, 12
    buffer_load_dwordx4 a[132:135], v4, s[28:31], s44 offen offset:0 sc1
    v_mfma_f32_16x16x32_bf16 v[180:183], v[68:71], a[68:71], v[180:183]
    v_mfma_f32_16x16x32_bf16 v[180:183], v[64:67], a[56:59], v[180:183]
    s_add_u32 s50, s50, 1
    ds_read_b64_tr_b16 v[108:109], v253 offset:24576
    ds_read_b64_tr_b16 v[110:111], v253 offset:26624
    v_mfma_f32_16x16x32_bf16 v[148:151], v[64:67], a[52:55], v[148:151]
    s_and_b32 s50, s50, 15
    buffer_load_dwordx4 a[136:139], v5, s[28:31], s44 offen offset:0 sc1
    v_mfma_f32_16x16x32_bf16 v[148:151], v[68:71], a[64:67], v[148:151]
    v_mfma_f32_16x16x32_bf16 v[148:151], v[72:75], a[76:79], v[148:151]
    v_mfma_f32_16x16x32_bf16 v[148:151], v[76:79], a[88:91], v[148:151]
    v_mfma_f32_16x16x32_bf16 v[116:119], v[76:79], a[84:87], v[116:119]
    buffer_load_dwordx4 a[140:143], v6, s[28:31], s44 offen offset:0 sc1
    v_mfma_f32_16x16x32_bf16 v[116:119], v[72:75], a[72:75], v[116:119]
    v_mfma_f32_16x16x32_bf16 v[116:119], v[68:71], a[60:63], v[116:119]
    v_mfma_f32_16x16x32_bf16 v[116:119], v[64:67], a[48:51], v[116:119]
    s_waitcnt vmcnt(12) lgkmcnt(0)
    s_barrier
    v_mfma_f32_16x16x32_bf16 v[128:131], v[80:83], a[48:51], v[128:131]
    ds_read_b64_tr_b16 v[48:49], v248 offset:32768
    ds_read_b64_tr_b16 v[50:51], v248 offset:34816
    v_mfma_f32_16x16x32_bf16 v[128:131], v[84:87], a[60:63], v[128:131]
    ds_read_b64_tr_b16 v[52:53], v248 offset:40960
    ds_read_b64_tr_b16 v[54:55], v248 offset:43008
    v_mfma_f32_16x16x32_bf16 v[128:131], v[88:91], a[72:75], v[128:131]
    s_lshl_b32 s44, s50, 12
    buffer_load_dwordx4 a[144:147], v4, s[28:31], s44 offen offset:0 sc1
    v_mfma_f32_16x16x32_bf16 v[128:131], v[92:95], a[84:87], v[128:131]
    v_mfma_f32_16x16x32_bf16 v[160:163], v[92:95], a[88:91], v[160:163]
    s_add_u32 s50, s50, 1
    ds_read_b64_tr_b16 v[56:57], v248 offset:49152
    ds_read_b64_tr_b16 v[58:59], v248 offset:51200
    v_mfma_f32_16x16x32_bf16 v[160:163], v[88:91], a[76:79], v[160:163]
    s_and_b32 s50, s50, 15
    buffer_load_dwordx4 a[148:151], v5, s[28:31], s44 offen offset:0 sc1
    v_mfma_f32_16x16x32_bf16 v[160:163], v[84:87], a[64:67], v[160:163]
    v_mfma_f32_16x16x32_bf16 v[160:163], v[80:83], a[52:55], v[160:163]
    ds_read_b64_tr_b16 v[60:61], v248 offset:57344
    ds_read_b64_tr_b16 v[62:63], v248 offset:59392
    v_mfma_f32_16x16x32_bf16 v[192:195], v[80:83], a[56:59], v[192:195]
    ds_read_b64_tr_b16 v[64:65], v249 offset:32768
    ds_read_b64_tr_b16 v[66:67], v249 offset:34816
    v_mfma_f32_16x16x32_bf16 v[192:195], v[84:87], a[68:71], v[192:195]
    buffer_load_dwordx4 a[152:155], v6, s[28:31], s44 offen offset:0 sc1
    v_mfma_f32_16x16x32_bf16 v[192:195], v[88:91], a[80:83], v[192:195]
    v_mfma_f32_16x16x32_bf16 v[192:195], v[92:95], a[92:95], v[192:195]
    ds_read_b64_tr_b16 v[68:69], v249 offset:40960
    ds_read_b64_tr_b16 v[70:71], v249 offset:43008
    v_mfma_f32_16x16x32_bf16 v[196:199], v[108:111], a[92:95], v[196:199]
    ds_read_b64_tr_b16 v[72:73], v249 offset:49152
    ds_read_b64_tr_b16 v[74:75], v249 offset:51200
    v_mfma_f32_16x16x32_bf16 v[196:199], v[104:107], a[80:83], v[196:199]
    s_lshl_b32 s44, s50, 12
    buffer_load_dwordx4 a[156:159], v4, s[28:31], s44 offen offset:0 sc1
    v_mfma_f32_16x16x32_bf16 v[196:199], v[100:103], a[68:71], v[196:199]
    v_mfma_f32_16x16x32_bf16 v[196:199], v[96:99], a[56:59], v[196:199]
    s_add_u32 s50, s50, 1
    ds_read_b64_tr_b16 v[76:77], v249 offset:57344
    ds_read_b64_tr_b16 v[78:79], v249 offset:59392
    v_mfma_f32_16x16x32_bf16 v[164:167], v[96:99], a[52:55], v[164:167]
    s_and_b32 s50, s50, 15
    buffer_load_dwordx4 a[160:163], v5, s[28:31], s44 offen offset:0 sc1
    v_mfma_f32_16x16x32_bf16 v[164:167], v[100:103], a[64:67], v[164:167]
    v_mfma_f32_16x16x32_bf16 v[164:167], v[104:107], a[76:79], v[164:167]
    v_mfma_f32_16x16x32_bf16 v[164:167], v[108:111], a[88:91], v[164:167]
    v_mfma_f32_16x16x32_bf16 v[132:135], v[108:111], a[84:87], v[132:135]
    buffer_load_dwordx4 a[164:167], v6, s[28:31], s44 offen offset:0 sc1
    v_mfma_f32_16x16x32_bf16 v[132:135], v[104:107], a[72:75], v[132:135]
    v_mfma_f32_16x16x32_bf16 v[132:135], v[100:103], a[60:63], v[132:135]
    v_mfma_f32_16x16x32_bf16 v[132:135], v[96:99], a[48:51], v[132:135]
    s_waitcnt vmcnt(6) lgkmcnt(0)
    v_mfma_f32_16x16x32_bf16 v[112:115], v[48:51], a[96:99], v[112:115]
    ds_read_b64_tr_b16 v[80:81], v252 offset:32768
    ds_read_b64_tr_b16 v[82:83], v252 offset:34816
    v_mfma_f32_16x16x32_bf16 v[112:115], v[52:55], a[108:111], v[112:115]
    ds_read_b64_tr_b16 v[84:85], v252 offset:40960
    ds_read_b64_tr_b16 v[86:87], v252 offset:43008
    v_mfma_f32_16x16x32_bf16 v[112:115], v[56:59], a[120:123], v[112:115]
    s_lshl_b32 s44, s50, 12
    buffer_load_dwordx4 a[168:171], v4, s[28:31], s44 offen offset:0 sc1
    v_mfma_f32_16x16x32_bf16 v[112:115], v[60:63], a[132:135], v[112:115]
    v_mfma_f32_16x16x32_bf16 v[144:147], v[60:63], a[136:139], v[144:147]
    s_add_u32 s50, s50, 1
    ds_read_b64_tr_b16 v[88:89], v252 offset:49152
    ds_read_b64_tr_b16 v[90:91], v252 offset:51200
    v_mfma_f32_16x16x32_bf16 v[144:147], v[56:59], a[124:127], v[144:147]
    s_and_b32 s50, s50, 15
    buffer_load_dwordx4 a[172:175], v5, s[28:31], s44 offen offset:0 sc1
    v_mfma_f32_16x16x32_bf16 v[144:147], v[52:55], a[112:115], v[144:147]
    v_mfma_f32_16x16x32_bf16 v[144:147], v[48:51], a[100:103], v[144:147]
    ds_read_b64_tr_b16 v[92:93], v252 offset:57344
    ds_read_b64_tr_b16 v[94:95], v252 offset:59392
    v_mfma_f32_16x16x32_bf16 v[176:179], v[48:51], a[104:107], v[176:179]
    ds_read_b64_tr_b16 v[96:97], v253 offset:32768
    ds_read_b64_tr_b16 v[98:99], v253 offset:34816
    v_mfma_f32_16x16x32_bf16 v[176:179], v[52:55], a[116:119], v[176:179]
    buffer_load_dwordx4 a[176:179], v6, s[28:31], s44 offen offset:0 sc1
    v_mfma_f32_16x16x32_bf16 v[176:179], v[56:59], a[128:131], v[176:179]
    v_mfma_f32_16x16x32_bf16 v[176:179], v[60:63], a[140:143], v[176:179]
    ds_read_b64_tr_b16 v[100:101], v253 offset:40960
    ds_read_b64_tr_b16 v[102:103], v253 offset:43008
    v_mfma_f32_16x16x32_bf16 v[180:183], v[76:79], a[140:143], v[180:183]
    ds_read_b64_tr_b16 v[104:105], v253 offset:49152
    ds_read_b64_tr_b16 v[106:107], v253 offset:51200
    v_mfma_f32_16x16x32_bf16 v[180:183], v[72:75], a[128:131], v[180:183]
    s_lshl_b32 s44, s50, 12
    buffer_load_dwordx4 a[180:183], v4, s[28:31], s44 offen offset:0 sc1
    v_mfma_f32_16x16x32_bf16 v[180:183], v[68:71], a[116:119], v[180:183]
    v_mfma_f32_16x16x32_bf16 v[180:183], v[64:67], a[104:107], v[180:183]
    s_add_u32 s50, s50, 1
    ds_read_b64_tr_b16 v[108:109], v253 offset:57344
    ds_read_b64_tr_b16 v[110:111], v253 offset:59392
    v_mfma_f32_16x16x32_bf16 v[148:151], v[64:67], a[100:103], v[148:151]
    s_and_b32 s50, s50, 15
    buffer_load_dwordx4 a[184:187], v5, s[28:31], s44 offen offset:0 sc1
    v_mfma_f32_16x16x32_bf16 v[148:151], v[68:71], a[112:115], v[148:151]
    v_add_u32 v240, 0x20000, v240
    v_add_u32 v241, 0x20000, v241
    v_mfma_f32_16x16x32_bf16 v[148:151], v[72:75], a[124:127], v[148:151]
    v_add_u32 v242, 0x20000, v242
    v_add_u32 v243, 0x20000, v243
    v_mfma_f32_16x16x32_bf16 v[148:151], v[76:79], a[136:139], v[148:151]
    v_add_u32 v244, 0x20000, v244
    v_add_u32 v245, 0x20000, v245
    v_mfma_f32_16x16x32_bf16 v[116:119], v[76:79], a[132:135], v[116:119]
    buffer_load_dwordx4 a[188:191], v6, s[28:31], s44 offen offset:0 sc1
    v_mfma_f32_16x16x32_bf16 v[116:119], v[72:75], a[120:123], v[116:119]
    v_add_u32 v246, 0x20000, v246
    v_add_u32 v247, 0x20000, v247
    v_mfma_f32_16x16x32_bf16 v[116:119], v[68:71], a[108:111], v[116:119]
    v_mfma_f32_16x16x32_bf16 v[116:119], v[64:67], a[96:99], v[116:119]
    s_waitcnt vmcnt(12) lgkmcnt(0)
    s_barrier
    v_mfma_f32_16x16x32_bf16 v[128:131], v[80:83], a[96:99], v[128:131]
    ds_read_b64_tr_b16 v[48:49], v240 offset:0
    ds_read_b64_tr_b16 v[50:51], v240 offset:2048
    v_mfma_f32_16x16x32_bf16 v[128:131], v[84:87], a[108:111], v[128:131]
    s_add_u32 m0, s37, 0
    ds_read_b64_tr_b16 v[52:53], v240 offset:8192
    ds_read_b64_tr_b16 v[54:55], v240 offset:10240
    v_mfma_f32_16x16x32_bf16 v[128:131], v[88:91], a[120:123], v[128:131]
    s_add_u32 s43, s88, 0
    buffer_load_dwordx4 v44, s[24:27], s43 offen offset:0  lds
    v_mfma_f32_16x16x32_bf16 v[128:131], v[92:95], a[132:135], v[128:131]
    ds_read_b64_tr_b16 v[56:57], v240 offset:16384
    ds_read_b64_tr_b16 v[58:59], v240 offset:18432
    v_mfma_f32_16x16x32_bf16 v[160:163], v[92:95], a[136:139], v[160:163]
    buffer_load_dwordx4 v45, s[24:27], s43 offen offset:1024  lds
    v_mfma_f32_16x16x32_bf16 v[160:163], v[88:91], a[124:127], v[160:163]
    ds_read_b64_tr_b16 v[60:61], v240 offset:24576
    ds_read_b64_tr_b16 v[62:63], v240 offset:26624
    v_mfma_f32_16x16x32_bf16 v[160:163], v[84:87], a[112:115], v[160:163]
    ds_read_b64_tr_b16 v[64:65], v241 offset:0
    ds_read_b64_tr_b16 v[66:67], v241 offset:2048
    v_mfma_f32_16x16x32_bf16 v[160:163], v[80:83], a[100:103], v[160:163]
    buffer_load_dwordx4 v46, s[24:27], s43 offen offset:2048  lds
    v_mfma_f32_16x16x32_bf16 v[192:195], v[80:83], a[104:107], v[192:195]
    ds_read_b64_tr_b16 v[68:69], v241 offset:8192
    ds_read_b64_tr_b16 v[70:71], v241 offset:10240
    v_mfma_f32_16x16x32_bf16 v[192:195], v[84:87], a[116:119], v[192:195]
    ds_read_b64_tr_b16 v[72:73], v241 offset:16384
    ds_read_b64_tr_b16 v[74:75], v241 offset:18432
    v_mfma_f32_16x16x32_bf16 v[192:195], v[88:91], a[128:131], v[192:195]
    buffer_load_dwordx4 v47, s[24:27], s43 offen offset:3072  lds
    v_mfma_f32_16x16x32_bf16 v[192:195], v[92:95], a[140:143], v[192:195]
    ds_read_b64_tr_b16 v[76:77], v241 offset:24576
    ds_read_b64_tr_b16 v[78:79], v241 offset:26624
    v_mfma_f32_16x16x32_bf16 v[196:199], v[108:111], a[140:143], v[196:199]
    s_add_u32 m0, s37, 16384
    v_mfma_f32_16x16x32_bf16 v[196:199], v[104:107], a[128:131], v[196:199]
    s_add_u32 s43, s88, 262144
    buffer_load_dwordx4 v44, s[24:27], s43 offen offset:0  lds
    v_mfma_f32_16x16x32_bf16 v[196:199], v[100:103], a[116:119], v[196:199]
    v_mfma_f32_16x16x32_bf16 v[196:199], v[96:99], a[104:107], v[196:199]
    buffer_load_dwordx4 v45, s[24:27], s43 offen offset:1024  lds
    v_mfma_f32_16x16x32_bf16 v[164:167], v[96:99], a[100:103], v[164:167]
    v_mfma_f32_16x16x32_bf16 v[164:167], v[100:103], a[112:115], v[164:167]
    v_mfma_f32_16x16x32_bf16 v[164:167], v[104:107], a[124:127], v[164:167]
    buffer_load_dwordx4 v46, s[24:27], s43 offen offset:2048  lds
    v_mfma_f32_16x16x32_bf16 v[164:167], v[108:111], a[136:139], v[164:167]
    v_mfma_f32_16x16x32_bf16 v[132:135], v[108:111], a[132:135], v[132:135]
    v_mfma_f32_16x16x32_bf16 v[132:135], v[104:107], a[120:123], v[132:135]
    buffer_load_dwordx4 v47, s[24:27], s43 offen offset:3072  lds
    v_mfma_f32_16x16x32_bf16 v[132:135], v[100:103], a[108:111], v[132:135]
    v_mfma_f32_16x16x32_bf16 v[132:135], v[96:99], a[96:99], v[132:135]
    s_waitcnt vmcnt(8) lgkmcnt(0)
    s_barrier
    v_mfma_f32_16x16x32_bf16 v[112:115], v[48:51], a[144:147], v[112:115]
    ds_read_b64_tr_b16 v[80:81], v244 offset:0
    ds_read_b64_tr_b16 v[82:83], v244 offset:2048
    v_mfma_f32_16x16x32_bf16 v[112:115], v[52:55], a[156:159], v[112:115]
    s_add_u32 m0, s37, 32768
    ds_read_b64_tr_b16 v[84:85], v244 offset:8192
    ds_read_b64_tr_b16 v[86:87], v244 offset:10240
    v_mfma_f32_16x16x32_bf16 v[112:115], v[56:59], a[168:171], v[112:115]
    s_add_u32 s43, s88, 524288
    buffer_load_dwordx4 v44, s[24:27], s43 offen offset:0  lds
    v_mfma_f32_16x16x32_bf16 v[112:115], v[60:63], a[180:183], v[112:115]
    ds_read_b64_tr_b16 v[88:89], v244 offset:16384
    ds_read_b64_tr_b16 v[90:91], v244 offset:18432
    v_mfma_f32_16x16x32_bf16 v[144:147], v[60:63], a[184:187], v[144:147]
    buffer_load_dwordx4 v45, s[24:27], s43 offen offset:1024  lds
    v_mfma_f32_16x16x32_bf16 v[144:147], v[56:59], a[172:175], v[144:147]
    ds_read_b64_tr_b16 v[92:93], v244 offset:24576
    ds_read_b64_tr_b16 v[94:95], v244 offset:26624
    v_mfma_f32_16x16x32_bf16 v[144:147], v[52:55], a[160:163], v[144:147]
    ds_read_b64_tr_b16 v[96:97], v245 offset:0
    ds_read_b64_tr_b16 v[98:99], v245 offset:2048
    v_mfma_f32_16x16x32_bf16 v[144:147], v[48:51], a[148:151], v[144:147]
    buffer_load_dwordx4 v46, s[24:27], s43 offen offset:2048  lds
    v_mfma_f32_16x16x32_bf16 v[176:179], v[48:51], a[152:155], v[176:179]
    ds_read_b64_tr_b16 v[100:101], v245 offset:8192
    ds_read_b64_tr_b16 v[102:103], v245 offset:10240
    v_mfma_f32_16x16x32_bf16 v[176:179], v[52:55], a[164:167], v[176:179]
    ds_read_b64_tr_b16 v[104:105], v245 offset:16384
    ds_read_b64_tr_b16 v[106:107], v245 offset:18432
    v_mfma_f32_16x16x32_bf16 v[176:179], v[56:59], a[176:179], v[176:179]
    buffer_load_dwordx4 v47, s[24:27], s43 offen offset:3072  lds
    v_mfma_f32_16x16x32_bf16 v[176:179], v[60:63], a[188:191], v[176:179]
    ds_read_b64_tr_b16 v[108:109], v245 offset:24576
    ds_read_b64_tr_b16 v[110:111], v245 offset:26624
    v_mfma_f32_16x16x32_bf16 v[180:183], v[76:79], a[188:191], v[180:183]
    s_add_u32 m0, s37, 49152
    v_mfma_f32_16x16x32_bf16 v[180:183], v[72:75], a[176:179], v[180:183]
    s_add_u32 s43, s88, 786432
    buffer_load_dwordx4 v44, s[24:27], s43 offen offset:0  lds
    v_mfma_f32_16x16x32_bf16 v[180:183], v[68:71], a[164:167], v[180:183]
    v_mfma_f32_16x16x32_bf16 v[180:183], v[64:67], a[152:155], v[180:183]
    buffer_load_dwordx4 v45, s[24:27], s43 offen offset:1024  lds
    v_mfma_f32_16x16x32_bf16 v[148:151], v[64:67], a[148:151], v[148:151]
    v_mfma_f32_16x16x32_bf16 v[148:151], v[68:71], a[160:163], v[148:151]
    v_mfma_f32_16x16x32_bf16 v[148:151], v[72:75], a[172:175], v[148:151]
    buffer_load_dwordx4 v46, s[24:27], s43 offen offset:2048  lds
    v_mfma_f32_16x16x32_bf16 v[148:151], v[76:79], a[184:187], v[148:151]
    v_mfma_f32_16x16x32_bf16 v[116:119], v[76:79], a[180:183], v[116:119]
    v_mfma_f32_16x16x32_bf16 v[116:119], v[72:75], a[168:171], v[116:119]
    buffer_load_dwordx4 v47, s[24:27], s43 offen offset:3072  lds
    v_mfma_f32_16x16x32_bf16 v[116:119], v[68:71], a[156:159], v[116:119]
    v_mfma_f32_16x16x32_bf16 v[116:119], v[64:67], a[144:147], v[116:119]
    s_waitcnt vmcnt(16) lgkmcnt(0)
    v_mfma_f32_16x16x32_bf16 v[128:131], v[80:83], a[144:147], v[128:131]
    ds_read_b64_tr_b16 v[48:49], v250 offset:0
    v_mfma_f32_16x16x32_bf16 v[128:131], v[84:87], a[156:159], v[128:131]
    ds_read_b64_tr_b16 v[50:51], v250 offset:2048
    v_mfma_f32_16x16x32_bf16 v[128:131], v[88:91], a[168:171], v[128:131]
    ds_read_b64_tr_b16 v[52:53], v250 offset:8192
    v_mfma_f32_16x16x32_bf16 v[128:131], v[92:95], a[180:183], v[128:131]
    ds_read_b64_tr_b16 v[54:55], v250 offset:10240
    v_mfma_f32_16x16x32_bf16 v[160:163], v[92:95], a[184:187], v[160:163]
    ds_read_b64_tr_b16 v[56:57], v250 offset:16384
    v_mfma_f32_16x16x32_bf16 v[160:163], v[88:91], a[172:175], v[160:163]
    ds_read_b64_tr_b16 v[58:59], v250 offset:18432
    v_mfma_f32_16x16x32_bf16 v[160:163], v[84:87], a[160:163], v[160:163]
    ds_read_b64_tr_b16 v[60:61], v250 offset:24576
    v_mfma_f32_16x16x32_bf16 v[160:163], v[80:83], a[148:151], v[160:163]
    ds_read_b64_tr_b16 v[62:63], v250 offset:26624
    v_mfma_f32_16x16x32_bf16 v[192:195], v[80:83], a[152:155], v[192:195]
    ds_read_b64_tr_b16 v[64:65], v251 offset:0
    v_mfma_f32_16x16x32_bf16 v[192:195], v[84:87], a[164:167], v[192:195]
    ds_read_b64_tr_b16 v[66:67], v251 offset:2048
    v_mfma_f32_16x16x32_bf16 v[192:195], v[88:91], a[176:179], v[192:195]
    ds_read_b64_tr_b16 v[68:69], v251 offset:8192
    v_mfma_f32_16x16x32_bf16 v[192:195], v[92:95], a[188:191], v[192:195]
    ds_read_b64_tr_b16 v[70:71], v251 offset:10240
    v_mfma_f32_16x16x32_bf16 v[196:199], v[108:111], a[188:191], v[196:199]
    ds_read_b64_tr_b16 v[72:73], v251 offset:16384
    v_mfma_f32_16x16x32_bf16 v[196:199], v[104:107], a[176:179], v[196:199]
    ds_read_b64_tr_b16 v[74:75], v251 offset:18432
    v_mfma_f32_16x16x32_bf16 v[196:199], v[100:103], a[164:167], v[196:199]
    ds_read_b64_tr_b16 v[76:77], v251 offset:24576
    v_mfma_f32_16x16x32_bf16 v[196:199], v[96:99], a[152:155], v[196:199]
    ds_read_b64_tr_b16 v[78:79], v251 offset:26624
    v_mfma_f32_16x16x32_bf16 v[164:167], v[96:99], a[148:151], v[164:167]
    v_mfma_f32_16x16x32_bf16 v[164:167], v[100:103], a[160:163], v[164:167]
    v_mfma_f32_16x16x32_bf16 v[164:167], v[104:107], a[172:175], v[164:167]
    v_mfma_f32_16x16x32_bf16 v[164:167], v[108:111], a[184:187], v[164:167]
    v_mfma_f32_16x16x32_bf16 v[132:135], v[108:111], a[180:183], v[132:135]
    v_mfma_f32_16x16x32_bf16 v[132:135], v[104:107], a[168:171], v[132:135]
    v_mfma_f32_16x16x32_bf16 v[132:135], v[100:103], a[156:159], v[132:135]
    v_mfma_f32_16x16x32_bf16 v[132:135], v[96:99], a[144:147], v[132:135]
    s_waitcnt vmcnt(40) lgkmcnt(0)
    v_mfma_f32_16x16x32_bf16 v[120:123], v[48:51], a[48:51], v[120:123]
    ds_read_b64_tr_b16 v[80:81], v254 offset:0
    ds_read_b64_tr_b16 v[82:83], v254 offset:2048
    v_mfma_f32_16x16x32_bf16 v[120:123], v[52:55], a[60:63], v[120:123]
    ds_read_b64_tr_b16 v[84:85], v254 offset:8192
    ds_read_b64_tr_b16 v[86:87], v254 offset:10240
    v_mfma_f32_16x16x32_bf16 v[120:123], v[56:59], a[72:75], v[120:123]
    ds_read_b64_tr_b16 v[88:89], v254 offset:16384
    ds_read_b64_tr_b16 v[90:91], v254 offset:18432
    v_mfma_f32_16x16x32_bf16 v[120:123], v[60:63], a[84:87], v[120:123]
    ds_read_b64_tr_b16 v[92:93], v254 offset:24576
    ds_read_b64_tr_b16 v[94:95], v254 offset:26624
    v_mfma_f32_16x16x32_bf16 v[152:155], v[60:63], a[88:91], v[152:155]
    ds_read_b64_tr_b16 v[96:97], v255 offset:0
    ds_read_b64_tr_b16 v[98:99], v255 offset:2048
    v_mfma_f32_16x16x32_bf16 v[152:155], v[56:59], a[76:79], v[152:155]
    ds_read_b64_tr_b16 v[100:101], v255 offset:8192
    ds_read_b64_tr_b16 v[102:103], v255 offset:10240
    v_mfma_f32_16x16x32_bf16 v[152:155], v[52:55], a[64:67], v[152:155]
    ds_read_b64_tr_b16 v[104:105], v255 offset:16384
    ds_read_b64_tr_b16 v[106:107], v255 offset:18432
    v_mfma_f32_16x16x32_bf16 v[152:155], v[48:51], a[52:55], v[152:155]
    ds_read_b64_tr_b16 v[108:109], v255 offset:24576
    ds_read_b64_tr_b16 v[110:111], v255 offset:26624
    v_mfma_f32_16x16x32_bf16 v[184:187], v[48:51], a[56:59], v[184:187]
    v_mul_f32 v112, v112, v128
    v_mul_f32 v113, v113, v129
    v_mfma_f32_16x16x32_bf16 v[184:187], v[52:55], a[68:71], v[184:187]
    v_mul_f32 v114, v114, v130
    v_mul_f32 v115, v115, v131
    v_mfma_f32_16x16x32_bf16 v[184:187], v[56:59], a[80:83], v[184:187]
    v_mul_f32 v116, v116, v132
    v_mul_f32 v117, v117, v133
    v_mfma_f32_16x16x32_bf16 v[184:187], v[60:63], a[92:95], v[184:187]
    v_mul_f32 v118, v118, v134
    v_mul_f32 v119, v119, v135
    v_mfma_f32_16x16x32_bf16 v[188:191], v[76:79], a[92:95], v[188:191]
    v_cvt_pk_bf16_f32 v24, v112, v113
    v_cvt_pk_bf16_f32 v25, v114, v115
    v_mfma_f32_16x16x32_bf16 v[188:191], v[72:75], a[80:83], v[188:191]
    v_cvt_pk_bf16_f32 v26, v116, v117
    v_cvt_pk_bf16_f32 v27, v118, v119
    v_mfma_f32_16x16x32_bf16 v[188:191], v[68:71], a[68:71], v[188:191]
    buffer_store_dwordx4 v[24:27], v8, s[32:35], 0 offen sc1
    v_mfma_f32_16x16x32_bf16 v[188:191], v[64:67], a[56:59], v[188:191]
    v_mul_f32 v144, v144, v160
    v_mul_f32 v145, v145, v161
    v_mfma_f32_16x16x32_bf16 v[156:159], v[64:67], a[52:55], v[156:159]
    v_mul_f32 v146, v146, v162
    v_mul_f32 v147, v147, v163
    v_mfma_f32_16x16x32_bf16 v[156:159], v[68:71], a[64:67], v[156:159]
    v_mul_f32 v148, v148, v164
    v_mul_f32 v149, v149, v165
    v_mfma_f32_16x16x32_bf16 v[156:159], v[72:75], a[76:79], v[156:159]
    v_mul_f32 v150, v150, v166
    v_mul_f32 v151, v151, v167
    v_mfma_f32_16x16x32_bf16 v[156:159], v[76:79], a[88:91], v[156:159]
    v_cvt_pk_bf16_f32 v28, v144, v145
    v_cvt_pk_bf16_f32 v29, v146, v147
    v_mfma_f32_16x16x32_bf16 v[124:127], v[76:79], a[84:87], v[124:127]
    v_cvt_pk_bf16_f32 v30, v148, v149
    v_cvt_pk_bf16_f32 v31, v150, v151
    v_mfma_f32_16x16x32_bf16 v[124:127], v[72:75], a[72:75], v[124:127]
    buffer_store_dwordx4 v[28:31], v9, s[32:35], 0 offen sc1
    v_mfma_f32_16x16x32_bf16 v[124:127], v[68:71], a[60:63], v[124:127]
    v_mfma_f32_16x16x32_bf16 v[124:127], v[64:67], a[48:51], v[124:127]
    s_waitcnt vmcnt(42) lgkmcnt(0)
    s_barrier
    v_mfma_f32_16x16x32_bf16 v[136:139], v[80:83], a[48:51], v[136:139]
    ds_read_b64_tr_b16 v[48:49], v250 offset:32768
    ds_read_b64_tr_b16 v[50:51], v250 offset:34816
    v_mfma_f32_16x16x32_bf16 v[136:139], v[84:87], a[60:63], v[136:139]
    s_add_u32 m0, s37, 65536
    ds_read_b64_tr_b16 v[52:53], v250 offset:40960
    ds_read_b64_tr_b16 v[54:55], v250 offset:43008
    v_mfma_f32_16x16x32_bf16 v[136:139], v[88:91], a[72:75], v[136:139]
    s_add_u32 s43, s88, 1048576
    buffer_load_dwordx4 v44, s[24:27], s43 offen offset:0  lds
    v_mfma_f32_16x16x32_bf16 v[136:139], v[92:95], a[84:87], v[136:139]
    v_mfma_f32_16x16x32_bf16 v[168:171], v[92:95], a[88:91], v[168:171]
    ds_read_b64_tr_b16 v[56:57], v250 offset:49152
    ds_read_b64_tr_b16 v[58:59], v250 offset:51200
    v_mfma_f32_16x16x32_bf16 v[168:171], v[88:91], a[76:79], v[168:171]
    ds_read_b64_tr_b16 v[60:61], v250 offset:57344
    ds_read_b64_tr_b16 v[62:63], v250 offset:59392
    v_mfma_f32_16x16x32_bf16 v[168:171], v[84:87], a[64:67], v[168:171]
    ds_read_b64_tr_b16 v[64:65], v251 offset:32768
    ds_read_b64_tr_b16 v[66:67], v251 offset:34816
    v_mfma_f32_16x16x32_bf16 v[168:171], v[80:83], a[52:55], v[168:171]
    buffer_load_dwordx4 v45, s[24:27], s43 offen offset:1024  lds
    v_mfma_f32_16x16x32_bf16 v[200:203], v[80:83], a[56:59], v[200:203]
    v_mfma_f32_16x16x32_bf16 v[200:203], v[84:87], a[68:71], v[200:203]
    ds_read_b64_tr_b16 v[68:69], v251 offset:40960
    ds_read_b64_tr_b16 v[70:71], v251 offset:43008
    v_mfma_f32_16x16x32_bf16 v[200:203], v[88:91], a[80:83], v[200:203]
    ds_read_b64_tr_b16 v[72:73], v251 offset:49152
    ds_read_b64_tr_b16 v[74:75], v251 offset:51200
    v_mfma_f32_16x16x32_bf16 v[200:203], v[92:95], a[92:95], v[200:203]
    ds_read_b64_tr_b16 v[76:77], v251 offset:57344
    ds_read_b64_tr_b16 v[78:79], v251 offset:59392
    v_mfma_f32_16x16x32_bf16 v[204:207], v[108:111], a[92:95], v[204:207]
    v_mul_f32 v176, v176, v192
    v_mul_f32 v177, v177, v193
    v_mfma_f32_16x16x32_bf16 v[204:207], v[104:107], a[80:83], v[204:207]
    buffer_load_dwordx4 v46, s[24:27], s43 offen offset:2048  lds
    v_mfma_f32_16x16x32_bf16 v[204:207], v[100:103], a[68:71], v[204:207]
    v_mfma_f32_16x16x32_bf16 v[204:207], v[96:99], a[56:59], v[204:207]
    v_mul_f32 v178, v178, v194
    v_mul_f32 v179, v179, v195
    v_mfma_f32_16x16x32_bf16 v[172:175], v[96:99], a[52:55], v[172:175]
    v_mul_f32 v180, v180, v196
    v_mul_f32 v181, v181, v197
    v_mfma_f32_16x16x32_bf16 v[172:175], v[100:103], a[64:67], v[172:175]
    v_mul_f32 v182, v182, v198
    v_mul_f32 v183, v183, v199
    v_mfma_f32_16x16x32_bf16 v[172:175], v[104:107], a[76:79], v[172:175]
    buffer_load_dwordx4 v47, s[24:27], s43 offen offset:3072  lds
    v_mfma_f32_16x16x32_bf16 v[172:175], v[108:111], a[88:91], v[172:175]
    v_cvt_pk_bf16_f32 v32, v176, v177
    v_cvt_pk_bf16_f32 v33, v178, v179
    v_mfma_f32_16x16x32_bf16 v[140:143], v[108:111], a[84:87], v[140:143]
    v_cvt_pk_bf16_f32 v34, v180, v181
    v_cvt_pk_bf16_f32 v35, v182, v183
    v_mfma_f32_16x16x32_bf16 v[140:143], v[104:107], a[72:75], v[140:143]
    buffer_store_dwordx4 v[32:35], v10, s[32:35], 0 offen sc1
    v_mfma_f32_16x16x32_bf16 v[140:143], v[100:103], a[60:63], v[140:143]
    v_mfma_f32_16x16x32_bf16 v[140:143], v[96:99], a[48:51], v[140:143]
    s_waitcnt vmcnt(35) lgkmcnt(0)
    s_barrier
    v_mfma_f32_16x16x32_bf16 v[120:123], v[48:51], a[96:99], v[120:123]
    ds_read_b64_tr_b16 v[80:81], v254 offset:32768
    ds_read_b64_tr_b16 v[82:83], v254 offset:34816
    v_mfma_f32_16x16x32_bf16 v[120:123], v[52:55], a[108:111], v[120:123]
    s_add_u32 m0, s37, 81920
    ds_read_b64_tr_b16 v[84:85], v254 offset:40960
    ds_read_b64_tr_b16 v[86:87], v254 offset:43008
    v_mfma_f32_16x16x32_bf16 v[120:123], v[56:59], a[120:123], v[120:123]
    s_add_u32 s43, s88, 32768
    buffer_load_dwordx4 v44, s[24:27], s43 offen offset:0  lds
    v_mfma_f32_16x16x32_bf16 v[120:123], v[60:63], a[132:135], v[120:123]
    v_mfma_f32_16x16x32_bf16 v[152:155], v[60:63], a[136:139], v[152:155]
    ds_read_b64_tr_b16 v[88:89], v254 offset:49152
    ds_read_b64_tr_b16 v[90:91], v254 offset:51200
    v_mfma_f32_16x16x32_bf16 v[152:155], v[56:59], a[124:127], v[152:155]
    ds_read_b64_tr_b16 v[92:93], v254 offset:57344
    ds_read_b64_tr_b16 v[94:95], v254 offset:59392
    v_mfma_f32_16x16x32_bf16 v[152:155], v[52:55], a[112:115], v[152:155]
    ds_read_b64_tr_b16 v[96:97], v255 offset:32768
    ds_read_b64_tr_b16 v[98:99], v255 offset:34816
    v_mfma_f32_16x16x32_bf16 v[152:155], v[48:51], a[100:103], v[152:155]
    buffer_load_dwordx4 v45, s[24:27], s43 offen offset:1024  lds
    v_mfma_f32_16x16x32_bf16 v[184:187], v[48:51], a[104:107], v[184:187]
    v_mfma_f32_16x16x32_bf16 v[184:187], v[52:55], a[116:119], v[184:187]
    ds_read_b64_tr_b16 v[100:101], v255 offset:40960
    ds_read_b64_tr_b16 v[102:103], v255 offset:43008
    v_mfma_f32_16x16x32_bf16 v[184:187], v[56:59], a[128:131], v[184:187]
    ds_read_b64_tr_b16 v[104:105], v255 offset:49152
    ds_read_b64_tr_b16 v[106:107], v255 offset:51200
    v_mfma_f32_16x16x32_bf16 v[184:187], v[60:63], a[140:143], v[184:187]
    ds_read_b64_tr_b16 v[108:109], v255 offset:57344
    ds_read_b64_tr_b16 v[110:111], v255 offset:59392
    v_mfma_f32_16x16x32_bf16 v[188:191], v[76:79], a[140:143], v[188:191]
    v_mfma_f32_16x16x32_bf16 v[188:191], v[72:75], a[128:131], v[188:191]
    buffer_load_dwordx4 v46, s[24:27], s43 offen offset:2048  lds
    v_mfma_f32_16x16x32_bf16 v[188:191], v[68:71], a[116:119], v[188:191]
    v_mfma_f32_16x16x32_bf16 v[188:191], v[64:67], a[104:107], v[188:191]
    v_mfma_f32_16x16x32_bf16 v[156:159], v[64:67], a[100:103], v[156:159]
    v_mfma_f32_16x16x32_bf16 v[156:159], v[68:71], a[112:115], v[156:159]
    v_mfma_f32_16x16x32_bf16 v[156:159], v[72:75], a[124:127], v[156:159]
    buffer_load_dwordx4 v47, s[24:27], s43 offen offset:3072  lds
    v_mfma_f32_16x16x32_bf16 v[156:159], v[76:79], a[136:139], v[156:159]
    v_mfma_f32_16x16x32_bf16 v[124:127], v[76:79], a[132:135], v[124:127]
    v_mfma_f32_16x16x32_bf16 v[124:127], v[72:75], a[120:123], v[124:127]
    v_mfma_f32_16x16x32_bf16 v[124:127], v[68:71], a[108:111], v[124:127]
    v_mfma_f32_16x16x32_bf16 v[124:127], v[64:67], a[96:99], v[124:127]
    s_waitcnt vmcnt(39) lgkmcnt(0)
    v_lshlrev_b32 v3, 7, v0
    v_mov_b32 v1, 1
    s_waitcnt vmcnt(4)
    s_barrier
    s_cmp_lg_u32 s15, s82
    s_cbranch_scc1 L_sig6
    s_mov_b64 exec, 255
    buffer_atomic_add v1, v3, s[52:55], s77 offen sc1
    s_mov_b64 exec, -1
L_sig6:
    v_mfma_f32_16x16x32_bf16 v[136:139], v[80:83], a[96:99], v[136:139]
    ds_read_b64_tr_b16 v[48:49], v242 offset:0
    ds_read_b64_tr_b16 v[50:51], v242 offset:2048
    v_mfma_f32_16x16x32_bf16 v[136:139], v[84:87], a[108:111], v[136:139]
    s_branch L_over10
.p2align 12
L_stub10:
    s_setpc_b64 s[46:47]
L_over10:
    s_add_u32 m0, s37, 98304
    ds_read_b64_tr_b16 v[52:53], v242 offset:8192
    ds_read_b64_tr_b16 v[54:55], v242 offset:10240
    v_mfma_f32_16x16x32_bf16 v[136:139], v[88:91], a[120:123], v[136:139]
    s_add_u32 s43, s88, 294912
    buffer_load_dwordx4 v44, s[24:27], s43 offen offset:0  lds
    v_mfma_f32_16x16x32_bf16 v[136:139], v[92:95], a[132:135], v[136:139]
    v_mfma_f32_16x16x32_bf16 v[168:171], v[92:95], a[136:139], v[168:171]
    ds_read_b64_tr_b16 v[56:57], v242 offset:16384
    ds_read_b64_tr_b16 v[58:59], v242 offset:18432
    v_mfma_f32_16x16x32_bf16 v[168:171], v[88:91], a[124:127], v[168:171]
    ds_read_b64_tr_b16 v[60:61], v242 offset:24576
    ds_read_b64_tr_b16 v[62:63], v242 offset:26624
    v_mfma_f32_16x16x32_bf16 v[168:171], v[84:87], a[112:115], v[168:171]
    ds_read_b64_tr_b16 v[64:65], v243 offset:0
    ds_read_b64_tr_b16 v[66:67], v243 offset:2048
    v_mfma_f32_16x16x32_bf16 v[168:171], v[80:83], a[100:103], v[168:171]
    buffer_load_dwordx4 v45, s[24:27], s43 offen offset:1024  lds
    v_mfma_f32_16x16x32_bf16 v[200:203], v[80:83], a[104:107], v[200:203]
    v_mfma_f32_16x16x32_bf16 v[200:203], v[84:87], a[116:119], v[200:203]
    ds_read_b64_tr_b16 v[68:69], v243 offset:8192
    ds_read_b64_tr_b16 v[70:71], v243 offset:10240
    v_mfma_f32_16x16x32_bf16 v[200:203], v[88:91], a[128:131], v[200:203]
    ds_read_b64_tr_b16 v[72:73], v243 offset:16384
    ds_read_b64_tr_b16 v[74:75], v243 offset:18432
    v_mfma_f32_16x16x32_bf16 v[200:203], v[92:95], a[140:143], v[200:203]
    ds_read_b64_tr_b16 v[76:77], v243 offset:24576
    ds_read_b64_tr_b16 v[78:79], v243 offset:26624
    v_mfma_f32_16x16x32_bf16 v[204:207], v[108:111], a[140:143], v[204:207]
    v_mfma_f32_16x16x32_bf16 v[204:207], v[104:107], a[128:131], v[204:207]
    buffer_load_dwordx4 v46, s[24:27], s43 offen offset:2048  lds
    v_mfma_f32_16x16x32_bf16 v[204:207], v[100:103], a[116:119], v[204:207]
    v_mfma_f32_16x16x32_bf16 v[204:207], v[96:99], a[104:107], v[204:207]
    v_mfma_f32_16x16x32_bf16 v[172:175], v[96:99], a[100:103], v[172:175]
    v_mfma_f32_16x16x32_bf16 v[172:175], v[100:103], a[112:115], v[172:175]
    v_mfma_f32_16x16x32_bf16 v[172:175], v[104:107], a[124:127], v[172:175]
    buffer_load_dwordx4 v47, s[24:27], s43 offen offset:3072  lds
    v_mfma_f32_16x16x32_bf16 v[172:175], v[108:111], a[136:139], v[172:175]
    v_mfma_f32_16x16x32_bf16 v[140:143], v[108:111], a[132:135], v[140:143]
    v_mfma_f32_16x16x32_bf16 v[140:143], v[104:107], a[120:123], v[140:143]
    v_mfma_f32_16x16x32_bf16 v[140:143], v[100:103], a[108:111], v[140:143]
    v_mfma_f32_16x16x32_bf16 v[140:143], v[96:99], a[96:99], v[140:143]
    s_waitcnt vmcnt(31) lgkmcnt(0)
    s_barrier
    v_mfma_f32_16x16x32_bf16 v[120:123], v[48:51], a[144:147], v[120:123]
    ds_read_b64_tr_b16 v[80:81], v246 offset:0
    ds_read_b64_tr_b16 v[82:83], v246 offset:2048
    v_mfma_f32_16x16x32_bf16 v[120:123], v[52:55], a[156:159], v[120:123]
    s_add_u32 m0, s37, 114688
    ds_read_b64_tr_b16 v[84:85], v246 offset:8192
    ds_read_b64_tr_b16 v[86:87], v246 offset:10240
    v_mfma_f32_16x16x32_bf16 v[120:123], v[56:59], a[168:171], v[120:123]
    s_add_u32 s43, s88, 557056
    buffer_load_dwordx4 v44, s[24:27], s43 offen offset:0  lds
    v_mfma_f32_16x16x32_bf16 v[120:123], v[60:63], a[180:183], v[120:123]
    v_mfma_f32_16x16x32_bf16 v[152:155], v[60:63], a[184:187], v[152:155]
    ds_read_b64_tr_b16 v[88:89], v246 offset:16384
    ds_read_b64_tr_b16 v[90:91], v246 offset:18432
    v_mfma_f32_16x16x32_bf16 v[152:155], v[56:59], a[172:175], v[152:155]
    ds_read_b64_tr_b16 v[92:93], v246 offset:24576
    ds_read_b64_tr_b16 v[94:95], v246 offset:26624
    v_mfma_f32_16x16x32_bf16 v[152:155], v[52:55], a[160:163], v[152:155]
    ds_read_b64_tr_b16 v[96:97], v247 offset:0
    ds_read_b64_tr_b16 v[98:99], v247 offset:2048
    v_mfma_f32_16x16x32_bf16 v[152:155], v[48:51], a[148:151], v[152:155]
    buffer_load_dwordx4 v45, s[24:27], s43 offen offset:1024  lds
    v_mfma_f32_16x16x32_bf16 v[184:187], v[48:51], a[152:155], v[184:187]
    v_mfma_f32_16x16x32_bf16 v[184:187], v[52:55], a[164:167], v[184:187]
    ds_read_b64_tr_b16 v[100:101], v247 offset:8192
    ds_read_b64_tr_b16 v[102:103], v247 offset:10240
    v_mfma_f32_16x16x32_bf16 v[184:187], v[56:59], a[176:179], v[184:187]
    ds_read_b64_tr_b16 v[104:105], v247 offset:16384
    ds_read_b64_tr_b16 v[106:107], v247 offset:18432
    v_mfma_f32_16x16x32_bf16 v[184:187], v[60:63], a[188:191], v[184:187]
    ds_read_b64_tr_b16 v[108:109], v247 offset:24576
    ds_read_b64_tr_b16 v[110:111], v247 offset:26624
    v_mfma_f32_16x16x32_bf16 v[188:191], v[76:79], a[188:191], v[188:191]
    v_mfma_f32_16x16x32_bf16 v[188:191], v[72:75], a[176:179], v[188:191]
    buffer_load_dwordx4 v46, s[24:27], s43 offen offset:2048  lds
    v_mfma_f32_16x16x32_bf16 v[188:191], v[68:71], a[164:167], v[188:191]
    v_mfma_f32_16x16x32_bf16 v[188:191], v[64:67], a[152:155], v[188:191]
    v_mfma_f32_16x16x32_bf16 v[156:159], v[64:67], a[148:151], v[156:159]
    v_mfma_f32_16x16x32_bf16 v[156:159], v[68:71], a[160:163], v[156:159]
    v_mfma_f32_16x16x32_bf16 v[156:159], v[72:75], a[172:175], v[156:159]
    buffer_load_dwordx4 v47, s[24:27], s43 offen offset:3072  lds
    v_mfma_f32_16x16x32_bf16 v[156:159], v[76:79], a[184:187], v[156:159]
    v_mfma_f32_16x16x32_bf16 v[124:127], v[76:79], a[180:183], v[124:127]
    v_mfma_f32_16x16x32_bf16 v[124:127], v[72:75], a[168:171], v[124:127]
    v_mfma_f32_16x16x32_bf16 v[124:127], v[68:71], a[156:159], v[124:127]
    v_mfma_f32_16x16x32_bf16 v[124:127], v[64:67], a[144:147], v[124:127]
    s_waitcnt vmcnt(35) lgkmcnt(0)
    v_mfma_f32_16x16x32_bf16 v[136:139], v[80:83], a[144:147], v[136:139]
    v_mfma_f32_16x16x32_bf16 v[136:139], v[84:87], a[156:159], v[136:139]
    v_mfma_f32_16x16x32_bf16 v[136:139], v[88:91], a[168:171], v[136:139]
    v_mfma_f32_16x16x32_bf16 v[136:139], v[92:95], a[180:183], v[136:139]
    v_mfma_f32_16x16x32_bf16 v[168:171], v[80:83], a[148:151], v[168:171]
    v_mfma_f32_16x16x32_bf16 v[168:171], v[84:87], a[160:163], v[168:171]
    v_mfma_f32_16x16x32_bf16 v[168:171], v[88:91], a[172:175], v[168:171]
    v_mfma_f32_16x16x32_bf16 v[168:171], v[92:95], a[184:187], v[168:171]
    v_mfma_f32_16x16x32_bf16 v[200:203], v[80:83], a[152:155], v[200:203]
    v_mfma_f32_16x16x32_bf16 v[200:203], v[84:87], a[164:167], v[200:203]
    v_mfma_f32_16x16x32_bf16 v[200:203], v[88:91], a[176:179], v[200:203]
    v_mov_b32 v17, 0
    v_mfma_f32_16x16x32_bf16 v[200:203], v[92:95], a[188:191], v[200:203]
    buffer_atomic_add v17, v2, s[52:55], s78 offen sc0 sc1
    v_mfma_f32_16x16x32_bf16 v[140:143], v[96:99], a[144:147], v[140:143]
    v_mfma_f32_16x16x32_bf16 v[140:143], v[100:103], a[156:159], v[140:143]
    v_mfma_f32_16x16x32_bf16 v[140:143], v[104:107], a[168:171], v[140:143]
    v_mfma_f32_16x16x32_bf16 v[140:143], v[108:111], a[180:183], v[140:143]
    v_mfma_f32_16x16x32_bf16 v[172:175], v[96:99], a[148:151], v[172:175]
    v_mfma_f32_16x16x32_bf16 v[172:175], v[100:103], a[160:163], v[172:175]
    v_mfma_f32_16x16x32_bf16 v[172:175], v[104:107], a[172:175], v[172:175]
    v_mfma_f32_16x16x32_bf16 v[172:175], v[108:111], a[184:187], v[172:175]
    v_mfma_f32_16x16x32_bf16 v[204:207], v[96:99], a[152:155], v[204:207]
    v_mfma_f32_16x16x32_bf16 v[204:207], v[100:103], a[164:167], v[204:207]
    v_mfma_f32_16x16x32_bf16 v[204:207], v[104:107], a[176:179], v[204:207]
    v_mfma_f32_16x16x32_bf16 v[204:207], v[108:111], a[188:191], v[204:207]
    s_movk_i32 s44, 4096
    s_cmp_eq_u32 s83, 21
    s_cselect_b32 s34, 0, s34
    s_nop 3
    v_mul_f32 v120, v120, v136
    v_mul_f32 v121, v121, v137
    v_mul_f32 v122, v122, v138
    v_mul_f32 v123, v123, v139
    v_mul_f32 v124, v124, v140
    v_mul_f32 v125, v125, v141
    v_mul_f32 v126, v126, v142
    v_mul_f32 v127, v127, v143
    v_cvt_pk_bf16_f32 v136, v120, v121
    v_cvt_pk_bf16_f32 v137, v122, v123
    v_cvt_pk_bf16_f32 v138, v124, v125
    v_cvt_pk_bf16_f32 v139, v126, v127
    buffer_store_dwordx4 v[136:139], v8, s[32:35], s44 offen sc1
    v_mul_f32 v152, v152, v168
    v_mul_f32 v153, v153, v169
    v_mul_f32 v154, v154, v170
    v_mul_f32 v155, v155, v171
    v_mul_f32 v156, v156, v172
    v_mul_f32 v157, v157, v173
    v_mul_f32 v158, v158, v174
    v_mul_f32 v159, v159, v175
    v_cvt_pk_bf16_f32 v168, v152, v153
    v_cvt_pk_bf16_f32 v169, v154, v155
    v_cvt_pk_bf16_f32 v170, v156, v157
    v_cvt_pk_bf16_f32 v171, v158, v159
    buffer_store_dwordx4 v[168:171], v9, s[32:35], s44 offen sc1
    v_mul_f32 v184, v184, v200
    v_mul_f32 v185, v185, v201
    v_mul_f32 v186, v186, v202
    v_mul_f32 v187, v187, v203
    v_mul_f32 v188, v188, v204
    v_mul_f32 v189, v189, v205
    v_mul_f32 v190, v190, v206
    v_mul_f32 v191, v191, v207
    v_cvt_pk_bf16_f32 v200, v184, v185
    v_cvt_pk_bf16_f32 v201, v186, v187
    v_cvt_pk_bf16_f32 v202, v188, v189
    v_cvt_pk_bf16_f32 v203, v190, v191
    buffer_store_dwordx4 v[200:203], v10, s[32:35], s44 offen sc1
    ds_read_b64_tr_b16 v[48:49], v224 offset:0
    ds_read_b64_tr_b16 v[50:51], v224 offset:2048
    ds_read_b64_tr_b16 v[52:53], v224 offset:4096
    ds_read_b64_tr_b16 v[54:55], v224 offset:6144
    ds_read_b64_tr_b16 v[56:57], v224 offset:8192
    ds_read_b64_tr_b16 v[58:59], v224 offset:10240
    ds_read_b64_tr_b16 v[60:61], v224 offset:12288
    ds_read_b64_tr_b16 v[62:63], v224 offset:14336
    ds_read_b64_tr_b16 v[64:65], v225 offset:0
    ds_read_b64_tr_b16 v[66:67], v225 offset:2048
    ds_read_b64_tr_b16 v[68:69], v225 offset:4096
    ds_read_b64_tr_b16 v[70:71], v225 offset:6144
    ds_read_b64_tr_b16 v[72:73], v225 offset:8192
    ds_read_b64_tr_b16 v[74:75], v225 offset:10240
    ds_read_b64_tr_b16 v[76:77], v225 offset:12288
    ds_read_b64_tr_b16 v[78:79], v225 offset:14336
    ds_read_b64_tr_b16 v[80:81], v226 offset:0
    ds_read_b64_tr_b16 v[82:83], v226 offset:2048
    ds_read_b64_tr_b16 v[84:85], v226 offset:4096
    ds_read_b64_tr_b16 v[86:87], v226 offset:6144
    ds_read_b64_tr_b16 v[88:89], v226 offset:8192
    ds_read_b64_tr_b16 v[90:91], v226 offset:10240
    ds_read_b64_tr_b16 v[92:93], v226 offset:12288
    ds_read_b64_tr_b16 v[94:95], v226 offset:14336
    ds_read_b64_tr_b16 v[96:97], v227 offset:0
    ds_read_b64_tr_b16 v[98:99], v227 offset:2048
    ds_read_b64_tr_b16 v[100:101], v227 offset:4096
    ds_read_b64_tr_b16 v[102:103], v227 offset:6144
    ds_read_b64_tr_b16 v[104:105], v227 offset:8192
    ds_read_b64_tr_b16 v[106:107], v227 offset:10240
    ds_read_b64_tr_b16 v[108:109], v227 offset:12288
    ds_read_b64_tr_b16 v[110:111], v227 offset:14336
    s_mov_b32 s40, 0
    s_waitcnt vmcnt(3)
L_ap1_main_kernel:
    v_and_b32 v17, 0xff, v17
    v_cmp_gt_u32 vcc, v15, v17
    s_add_u32 s40, s40, 1
    s_cbranch_vccnz L_as1_main_kernel
L_ar1_main_kernel:
    s_mov_b32 s44, 0
    buffer_load_dwordx4 a[0:3], v20, s[16:19], s44 offen sc1
    s_mov_b32 s44, 8192
    buffer_load_dwordx4 a[4:7], v20, s[16:19], s44 offen sc1
    s_mov_b32 s44, 16384
    buffer_load_dwordx4 a[8:11], v20, s[16:19], s44 offen sc1
    s_mov_b32 s44, 24576
    buffer_load_dwordx4 a[12:15], v20, s[16:19], s44 offen sc1
    s_mov_b32 s44, 32768
    buffer_load_dwordx4 a[16:19], v20, s[16:19], s44 offen sc1
    s_mov_b32 s44, 40960
    buffer_load_dwordx4 a[20:23], v20, s[16:19], s44 offen sc1
    s_mov_b32 s44, 49152
    buffer_load_dwordx4 a[24:27], v20, s[16:19], s44 offen sc1
    s_mov_b32 s44, 57344
    buffer_load_dwordx4 a[28:31], v20, s[16:19], s44 offen sc1
    s_mov_b32 s44, 65536
    buffer_load_dwordx4 a[32:35], v20, s[16:19], s44 offen sc1
    s_mov_b32 s44, 73728
    buffer_load_dwordx4 a[36:39], v20, s[16:19], s44 offen sc1
    s_mov_b32 s44, 81920
    buffer_load_dwordx4 a[40:43], v20, s[16:19], s44 offen sc1
    s_mov_b32 s44, 90112
    buffer_load_dwordx4 a[44:47], v20, s[16:19], s44 offen sc1
    s_waitcnt lgkmcnt(0)
    v_lshlrev_b32 v3, 7, v0
    v_mov_b32 v1, 0x100
    s_waitcnt vmcnt(12)
    s_barrier
    s_cmp_lg_u32 s15, s82
    s_cbranch_scc1 L_sig7
    s_mov_b64 exec, 255
    buffer_atomic_add v1, v3, s[52:55], s77 offen sc1
    s_mov_b64 exec, -1
L_sig7:
    s_waitcnt vmcnt(8)
    s_waitcnt lgkmcnt(15)
    v_mfma_f32_16x16x32_bf16 v[176:179], v[48:51], a[0:3], 0
    ds_read_b64_tr_b16 v[112:113], v224 offset:16384
    ds_read_b64_tr_b16 v[114:115], v224 offset:18432
    s_mov_b32 s44, 98304
    buffer_load_dwordx4 a[48:51], v20, s[16:19], s44 offen sc1
    v_mfma_f32_16x16x32_bf16 v[176:179], v[52:55], a[4:7], v[176:179]
    ds_read_b64_tr_b16 v[116:117], v224 offset:20480
    ds_read_b64_tr_b16 v[118:119], v224 offset:22528
    v_mfma_f32_16x16x32_bf16 v[176:179], v[56:59], a[8:11], v[176:179]
    ds_read_b64_tr_b16 v[120:121], v224 offset:24576
    ds_read_b64_tr_b16 v[122:123], v224 offset:26624
    s_mov_b32 s44, 106496
    buffer_load_dwordx4 a[52:55], v20, s[16:19], s44 offen sc1
    v_mfma_f32_16x16x32_bf16 v[176:179], v[60:63], a[12:15], v[176:179]
    ds_read_b64_tr_b16 v[124:125], v224 offset:28672
    ds_read_b64_tr_b16 v[126:127], v224 offset:30720
    s_waitcnt lgkmcnt(15)
    v_mfma_f32_16x16x32_bf16 v[180:183], v[76:79], a[12:15], 0
    ds_read_b64_tr_b16 v[128:129], v225 offset:16384
    ds_read_b64_tr_b16 v[130:131], v225 offset:18432
    s_mov_b32 s44, 114688
    buffer_load_dwordx4 a[56:59], v20, s[16:19], s44 offen sc1
    v_mfma_f32_16x16x32_bf16 v[180:183], v[72:75], a[8:11], v[180:183]
    ds_read_b64_tr_b16 v[132:133], v225 offset:20480
    ds_read_b64_tr_b16 v[134:135], v225 offset:22528
    v_mfma_f32_16x16x32_bf16 v[180:183], v[68:71], a[4:7], v[180:183]
    ds_read_b64_tr_b16 v[136:137], v225 offset:24576
    ds_read_b64_tr_b16 v[138:139], v225 offset:26624
    s_mov_b32 s44, 122880
    buffer_load_dwordx4 a[60:63], v20, s[16:19], s44 offen sc1
    v_mfma_f32_16x16x32_bf16 v[180:183], v[64:67], a[0:3], v[180:183]
    ds_read_b64_tr_b16 v[140:141], v225 offset:28672
    ds_read_b64_tr_b16 v[142:143], v225 offset:30720
    s_waitcnt lgkmcnt(15)
    v_mfma_f32_16x16x32_bf16 v[184:187], v[80:83], a[0:3], 0
    ds_read_b64_tr_b16 v[144:145], v226 offset:16384
    ds_read_b64_tr_b16 v[146:147], v226 offset:18432
    s_mov_b32 s44, 131072
    buffer_load_dwordx4 a[64:67], v20, s[16:19], s44 offen sc1
    v_mfma_f32_16x16x32_bf16 v[184:187], v[84:87], a[4:7], v[184:187]
    ds_read_b64_tr_b16 v[148:149], v226 offset:20480
    ds_read_b64_tr_b16 v[150:151], v226 offset:22528
    v_mfma_f32_16x16x32_bf16 v[184:187], v[88:91], a[8:11], v[184:187]
    ds_read_b64_tr_b16 v[152:153], v226 offset:24576
    ds_read_b64_tr_b16 v[154:155], v226 offset:26624
    s_mov_b32 s44, 139264
    buffer_load_dwordx4 a[68:71], v20, s[16:19], s44 offen sc1
    v_mfma_f32_16x16x32_bf16 v[184:187], v[92:95], a[12:15], v[184:187]
    ds_read_b64_tr_b16 v[156:157], v226 offset:28672
    ds_read_b64_tr_b16 v[158:159], v226 offset:30720
    s_waitcnt lgkmcnt(15)
    v_mfma_f32_16x16x32_bf16 v[188:191], v[108:111], a[12:15], 0
    ds_read_b64_tr_b16 v[160:161], v227 offset:16384
    ds_read_b64_tr_b16 v[162:163], v227 offset:18432
    s_mov_b32 s44, 147456
    buffer_load_dwordx4 a[72:75], v20, s[16:19], s44 offen sc1
    v_mfma_f32_16x16x32_bf16 v[188:191], v[104:107], a[8:11], v[188:191]
    ds_read_b64_tr_b16 v[164:165], v227 offset:20480
    ds_read_b64_tr_b16 v[166:167], v227 offset:22528
    v_mfma_f32_16x16x32_bf16 v[188:191], v[100:103], a[4:7], v[188:191]
    ds_read_b64_tr_b16 v[168:169], v227 offset:24576
    ds_read_b64_tr_b16 v[170:171], v227 offset:26624
    s_mov_b32 s44, 155648
    buffer_load_dwordx4 a[76:79], v20, s[16:19], s44 offen sc1
    v_mfma_f32_16x16x32_bf16 v[188:191], v[96:99], a[0:3], v[188:191]
    ds_read_b64_tr_b16 v[172:173], v227 offset:28672
    ds_read_b64_tr_b16 v[174:175], v227 offset:30720
    s_waitcnt vmcnt(12)
    s_waitcnt lgkmcnt(15)
    v_mfma_f32_16x16x32_bf16 v[176:179], v[112:115], a[16:19], v[176:179]
    ds_read_b64_tr_b16 v[48:49], v224 offset:32768
    ds_read_b64_tr_b16 v[50:51], v224 offset:34816
    s_add_u32 m0, s37, 131072
    s_add_u32 s43, s88, 819200
    buffer_load_dwordx4 v44, s[24:27], s43 offen offset:0  lds
    v_mfma_f32_16x16x32_bf16 v[176:179], v[116:119], a[20:23], v[176:179]
    ds_read_b64_tr_b16 v[52:53], v224 offset:36864
    ds_read_b64_tr_b16 v[54:55], v224 offset:38912
    v_mfma_f32_16x16x32_bf16 v[176:179], v[120:123], a[24:27], v[176:179]
    ds_read_b64_tr_b16 v[56:57], v224 offset:40960
    ds_read_b64_tr_b16 v[58:59], v224 offset:43008
    buffer_load_dwordx4 v45, s[24:27], s43 offen offset:1024  lds
    v_mfma_f32_16x16x32_bf16 v[176:179], v[124:127], a[28:31], v[176:179]
    ds_read_b64_tr_b16 v[60:61], v224 offset:45056
    ds_read_b64_tr_b16 v[62:63], v224 offset:47104
    s_waitcnt lgkmcnt(15)
    v_mfma_f32_16x16x32_bf16 v[180:183], v[140:143], a[28:31], v[180:183]
    ds_read_b64_tr_b16 v[64:65], v225 offset:32768
    ds_read_b64_tr_b16 v[66:67], v225 offset:34816
    buffer_load_dwordx4 v46, s[24:27], s43 offen offset:2048  lds
    v_mfma_f32_16x16x32_bf16 v[180:183], v[136:139], a[24:27], v[180:183]
    ds_read_b64_tr_b16 v[68:69], v225 offset:36864
    ds_read_b64_tr_b16 v[70:71], v225 offset:38912
    v_mfma_f32_16x16x32_bf16 v[180:183], v[132:135], a[20:23], v[180:183]
    ds_read_b64_tr_b16 v[72:73], v225 offset:40960
    ds_read_b64_tr_b16 v[74:75], v225 offset:43008
    buffer_load_dwordx4 v47, s[24:27], s43 offen offset:3072  lds
    v_mfma_f32_16x16x32_bf16 v[180:183], v[128:131], a[16:19], v[180:183]
    ds_read_b64_tr_b16 v[76:77], v225 offset:45056
    ds_read_b64_tr_b16 v[78:79], v225 offset:47104
    s_waitcnt lgkmcnt(15)
    v_mfma_f32_16x16x32_bf16 v[184:187], v[144:147], a[16:19], v[184:187]
    ds_read_b64_tr_b16 v[80:81], v226 offset:32768
    ds_read_b64_tr_b16 v[82:83], v226 offset:34816
    s_add_u32 m0, s37, 147456
    s_add_u32 s43, s88, 1081344
    buffer_load_dwordx4 v44, s[24:27], s43 offen offset:0  lds
    v_mfma_f32_16x16x32_bf16 v[184:187], v[148:151], a[20:23], v[184:187]
    ds_read_b64_tr_b16 v[84:85], v226 offset:36864
    ds_read_b64_tr_b16 v[86:87], v226 offset:38912
    v_mfma_f32_16x16x32_bf16 v[184:187], v[152:155], a[24:27], v[184:187]
    ds_read_b64_tr_b16 v[88:89], v226 offset:40960
    ds_read_b64_tr_b16 v[90:91], v226 offset:43008
    buffer_load_dwordx4 v45, s[24:27], s43 offen offset:1024  lds
    v_mfma_f32_16x16x32_bf16 v[184:187], v[156:159], a[28:31], v[184:187]
    ds_read_b64_tr_b16 v[92:93], v226 offset:45056
    ds_read_b64_tr_b16 v[94:95], v226 offset:47104
    s_waitcnt lgkmcnt(15)
    v_mfma_f32_16x16x32_bf16 v[188:191], v[172:175], a[28:31], v[188:191]
    ds_read_b64_tr_b16 v[96:97], v227 offset:32768
    ds_read_b64_tr_b16 v[98:99], v227 offset:34816
    buffer_load_dwordx4 v46, s[24:27], s43 offen offset:2048  lds
    v_mfma_f32_16x16x32_bf16 v[188:191], v[168:171], a[24:27], v[188:191]
    ds_read_b64_tr_b16 v[100:101], v227 offset:36864
    ds_read_b64_tr_b16 v[102:103], v227 offset:38912
    v_mfma_f32_16x16x32_bf16 v[188:191], v[164:167], a[20:23], v[188:191]
    ds_read_b64_tr_b16 v[104:105], v227 offset:40960
    ds_read_b64_tr_b16 v[106:107], v227 offset:43008
    buffer_load_dwordx4 v47, s[24:27], s43 offen offset:3072  lds
    v_mfma_f32_16x16x32_bf16 v[188:191], v[160:163], a[16:19], v[188:191]
    ds_read_b64_tr_b16 v[108:109], v227 offset:45056
    ds_read_b64_tr_b16 v[110:111], v227 offset:47104
    s_waitcnt vmcnt(16)
    s_waitcnt lgkmcnt(15)
    v_mfma_f32_16x16x32_bf16 v[176:179], v[48:51], a[32:35], v[176:179]
    ds_read_b64_tr_b16 v[112:113], v224 offset:49152
    ds_read_b64_tr_b16 v[114:115], v224 offset:51200
    v_mov_b32 v17, 0
    buffer_atomic_add v17, v2, s[52:55], s78 offen sc0 sc1
    v_mfma_f32_16x16x32_bf16 v[176:179], v[52:55], a[36:39], v[176:179]
    ds_read_b64_tr_b16 v[116:117], v224 offset:53248
    ds_read_b64_tr_b16 v[118:119], v224 offset:55296
    v_mfma_f32_16x16x32_bf16 v[176:179], v[56:59], a[40:43], v[176:179]
    ds_read_b64_tr_b16 v[120:121], v224 offset:57344
    ds_read_b64_tr_b16 v[122:123], v224 offset:59392
    v_mfma_f32_16x16x32_bf16 v[176:179], v[60:63], a[44:47], v[176:179]
    ds_read_b64_tr_b16 v[124:125], v224 offset:61440
    ds_read_b64_tr_b16 v[126:127], v224 offset:63488
    s_add_u32 m0, s37, 0
    s_add_u32 s43, s80, 1310720
    buffer_load_dwordx4 v44, s[24:27], s43 offen offset:0  lds
    s_waitcnt lgkmcnt(15)
    v_mfma_f32_16x16x32_bf16 v[180:183], v[76:79], a[44:47], v[180:183]
    ds_read_b64_tr_b16 v[128:129], v225 offset:49152
    ds_read_b64_tr_b16 v[130:131], v225 offset:51200
    v_mfma_f32_16x16x32_bf16 v[180:183], v[72:75], a[40:43], v[180:183]
    ds_read_b64_tr_b16 v[132:133], v225 offset:53248
    ds_read_b64_tr_b16 v[134:135], v225 offset:55296
    v_mfma_f32_16x16x32_bf16 v[180:183], v[68:71], a[36:39], v[180:183]
    ds_read_b64_tr_b16 v[136:137], v225 offset:57344
    ds_read_b64_tr_b16 v[138:139], v225 offset:59392
    buffer_load_dwordx4 v45, s[24:27], s43 offen offset:1024  lds
    v_mfma_f32_16x16x32_bf16 v[180:183], v[64:67], a[32:35], v[180:183]
    ds_read_b64_tr_b16 v[140:141], v225 offset:61440
    ds_read_b64_tr_b16 v[142:143], v225 offset:63488
    s_waitcnt lgkmcnt(15)
    v_mfma_f32_16x16x32_bf16 v[184:187], v[80:83], a[32:35], v[184:187]
    ds_read_b64_tr_b16 v[144:145], v226 offset:49152
    ds_read_b64_tr_b16 v[146:147], v226 offset:51200
    v_mfma_f32_16x16x32_bf16 v[184:187], v[84:87], a[36:39], v[184:187]
    ds_read_b64_tr_b16 v[148:149], v226 offset:53248
    ds_read_b64_tr_b16 v[150:151], v226 offset:55296
    buffer_load_dwordx4 v46, s[24:27], s43 offen offset:2048  lds
    v_mfma_f32_16x16x32_bf16 v[184:187], v[88:91], a[40:43], v[184:187]
    ds_read_b64_tr_b16 v[152:153], v226 offset:57344
    ds_read_b64_tr_b16 v[154:155], v226 offset:59392
    v_mfma_f32_16x16x32_bf16 v[184:187], v[92:95], a[44:47], v[184:187]
    ds_read_b64_tr_b16 v[156:157], v226 offset:61440
    ds_read_b64_tr_b16 v[158:159], v226 offset:63488
    s_waitcnt lgkmcnt(15)
    v_mfma_f32_16x16x32_bf16 v[188:191], v[108:111], a[44:47], v[188:191]
    ds_read_b64_tr_b16 v[160:161], v227 offset:49152
    ds_read_b64_tr_b16 v[162:163], v227 offset:51200
    buffer_load_dwordx4 v47, s[24:27], s43 offen offset:3072  lds
    v_mfma_f32_16x16x32_bf16 v[188:191], v[104:107], a[40:43], v[188:191]
    ds_read_b64_tr_b16 v[164:165], v227 offset:53248
    ds_read_b64_tr_b16 v[166:167], v227 offset:55296
    v_mfma_f32_16x16x32_bf16 v[188:191], v[100:103], a[36:39], v[188:191]
    ds_read_b64_tr_b16 v[168:169], v227 offset:57344
    ds_read_b64_tr_b16 v[170:171], v227 offset:59392
    v_mfma_f32_16x16x32_bf16 v[188:191], v[96:99], a[32:35], v[188:191]
    ds_read_b64_tr_b16 v[172:173], v227 offset:61440
    ds_read_b64_tr_b16 v[174:175], v227 offset:63488
    s_waitcnt vmcnt(17)
    s_mov_b32 s40, 0
    s_waitcnt vmcnt(4)
L_ap2_main_kernel:
    v_cmp_gt_u32 vcc, v16, v17
    s_add_u32 s40, s40, 1
    s_cbranch_vccnz L_as2_main_kernel
L_ar2_main_kernel:
    s_waitcnt lgkmcnt(15)
    v_mfma_f32_16x16x32_bf16 v[176:179], v[112:115], a[48:51], v[176:179]
    ds_read_b64_tr_b16 v[48:49], v228 offset:0
    ds_read_b64_tr_b16 v[50:51], v228 offset:2048
    s_mov_b32 s44, 4096
    buffer_load_dwordx4 a[80:83], v20, s[16:19], s44 offen sc1
    v_mfma_f32_16x16x32_bf16 v[176:179], v[116:119], a[52:55], v[176:179]
    ds_read_b64_tr_b16 v[52:53], v228 offset:4096
    ds_read_b64_tr_b16 v[54:55], v228 offset:6144
    v_mfma_f32_16x16x32_bf16 v[176:179], v[120:123], a[56:59], v[176:179]
    ds_read_b64_tr_b16 v[56:57], v228 offset:8192
    ds_read_b64_tr_b16 v[58:59], v228 offset:10240
    s_mov_b32 s44, 12288
    buffer_load_dwordx4 a[84:87], v20, s[16:19], s44 offen sc1
    v_mfma_f32_16x16x32_bf16 v[176:179], v[124:127], a[60:63], v[176:179]
    ds_read_b64_tr_b16 v[60:61], v228 offset:12288
    ds_read_b64_tr_b16 v[62:63], v228 offset:14336
    s_waitcnt lgkmcnt(15)
    v_mfma_f32_16x16x32_bf16 v[180:183], v[140:143], a[60:63], v[180:183]
    ds_read_b64_tr_b16 v[64:65], v229 offset:0
    ds_read_b64_tr_b16 v[66:67], v229 offset:2048
    s_mov_b32 s44, 20480
    buffer_load_dwordx4 a[88:91], v20, s[16:19], s44 offen sc1
    v_mfma_f32_16x16x32_bf16 v[180:183], v[136:139], a[56:59], v[180:183]
    ds_read_b64_tr_b16 v[68:69], v229 offset:4096
    ds_read_b64_tr_b16 v[70:71], v229 offset:6144
    v_mfma_f32_16x16x32_bf16 v[180:183], v[132:135], a[52:55], v[180:183]
    ds_read_b64_tr_b16 v[72:73], v229 offset:8192
    ds_read_b64_tr_b16 v[74:75], v229 offset:10240
    s_mov_b32 s44, 28672
    buffer_load_dwordx4 a[92:95], v20, s[16:19], s44 offen sc1
    v_mfma_f32_16x16x32_bf16 v[180:183], v[128:131], a[48:51], v[180:183]
    ds_read_b64_tr_b16 v[76:77], v229 offset:12288
    ds_read_b64_tr_b16 v[78:79], v229 offset:14336
    s_waitcnt lgkmcnt(15)
    v_mfma_f32_16x16x32_bf16 v[184:187], v[144:147], a[48:51], v[184:187]
    ds_read_b64_tr_b16 v[80:81], v230 offset:0
    ds_read_b64_tr_b16 v[82:83], v230 offset:2048
    s_mov_b32 s44, 36864
    buffer_load_dwordx4 a[96:99], v20, s[16:19], s44 offen sc1
    v_mfma_f32_16x16x32_bf16 v[184:187], v[148:151], a[52:55], v[184:187]
    ds_read_b64_tr_b16 v[84:85], v230 offset:4096
    ds_read_b64_tr_b16 v[86:87], v230 offset:6144
    v_mfma_f32_16x16x32_bf16 v[184:187], v[152:155], a[56:59], v[184:187]
    ds_read_b64_tr_b16 v[88:89], v230 offset:8192
    ds_read_b64_tr_b16 v[90:91], v230 offset:10240
    s_mov_b32 s44, 45056
    buffer_load_dwordx4 a[100:103], v20, s[16:19], s44 offen sc1
    v_mfma_f32_16x16x32_bf16 v[184:187], v[156:159], a[60:63], v[184:187]
    ds_read_b64_tr_b16 v[92:93], v230 offset:12288
    ds_read_b64_tr_b16 v[94:95], v230 offset:14336
    s_waitcnt lgkmcnt(15)
    v_mfma_f32_16x16x32_bf16 v[188:191], v[172:175], a[60:63], v[188:191]
    ds_read_b64_tr_b16 v[96:97], v231 offset:0
    ds_read_b64_tr_b16 v[98:99], v231 offset:2048
    s_mov_b32 s44, 53248
    buffer_load_dwordx4 a[104:107], v20, s[16:19], s44 offen sc1
    v_mfma_f32_16x16x32_bf16 v[188:191], v[168:171], a[56:59], v[188:191]
    ds_read_b64_tr_b16 v[100:101], v231 offset:4096
    ds_read_b64_tr_b16 v[102:103], v231 offset:6144
    v_mfma_f32_16x16x32_bf16 v[188:191], v[164:167], a[52:55], v[188:191]
    ds_read_b64_tr_b16 v[104:105], v231 offset:8192
    ds_read_b64_tr_b16 v[106:107], v231 offset:10240
    s_mov_b32 s44, 61440
    buffer_load_dwordx4 a[108:111], v20, s[16:19], s44 offen sc1
    v_mfma_f32_16x16x32_bf16 v[188:191], v[160:163], a[48:51], v[188:191]
    ds_read_b64_tr_b16 v[108:109], v231 offset:12288
    ds_read_b64_tr_b16 v[110:111], v231 offset:14336
    s_waitcnt vmcnt(21)
    s_waitcnt lgkmcnt(15)
    v_mfma_f32_16x16x32_bf16 v[176:179], v[48:51], a[64:67], v[176:179]
    ds_read_b64_tr_b16 v[112:113], v228 offset:16384
    ds_read_b64_tr_b16 v[114:115], v228 offset:18432
    s_mov_b32 s44, 69632
    buffer_load_dwordx4 a[112:115], v20, s[16:19], s44 offen sc1
    v_mfma_f32_16x16x32_bf16 v[176:179], v[52:55], a[68:71], v[176:179]
    ds_read_b64_tr_b16 v[116:117], v228 offset:20480
    ds_read_b64_tr_b16 v[118:119], v228 offset:22528
    v_mfma_f32_16x16x32_bf16 v[176:179], v[56:59], a[72:75], v[176:179]
    ds_read_b64_tr_b16 v[120:121], v228 offset:24576
    ds_read_b64_tr_b16 v[122:123], v228 offset:26624
    s_mov_b32 s44, 77824
    buffer_load_dwordx4 a[116:119], v20, s[16:19], s44 offen sc1
    v_mfma_f32_16x16x32_bf16 v[176:179], v[60:63], a[76:79], v[176:179]
    ds_read_b64_tr_b16 v[124:125], v228 offset:28672
    ds_read_b64_tr_b16 v[126:127], v228 offset:30720
    s_waitcnt lgkmcnt(15)
    v_mfma_f32_16x16x32_bf16 v[180:183], v[76:79], a[76:79], v[180:183]
    ds_read_b64_tr_b16 v[128:129], v229 offset:16384
    ds_read_b64_tr_b16 v[130:131], v229 offset:18432
    s_mov_b32 s44, 86016
    buffer_load_dwordx4 a[120:123], v20, s[16:19], s44 offen sc1
    v_mfma_f32_16x16x32_bf16 v[180:183], v[72:75], a[72:75], v[180:183]
    ds_read_b64_tr_b16 v[132:133], v229 offset:20480
    ds_read_b64_tr_b16 v[134:135], v229 offset:22528
    v_mfma_f32_16x16x32_bf16 v[180:183], v[68:71], a[68:71], v[180:183]
    ds_read_b64_tr_b16 v[136:137], v229 offset:24576
    ds_read_b64_tr_b16 v[138:139], v229 offset:26624
    s_mov_b32 s44, 94208
    buffer_load_dwordx4 a[124:127], v20, s[16:19], s44 offen sc1
    v_mfma_f32_16x16x32_bf16 v[180:183], v[64:67], a[64:67], v[180:183]
    ds_read_b64_tr_b16 v[140:141], v229 offset:28672
    ds_read_b64_tr_b16 v[142:143], v229 offset:30720
    s_waitcnt lgkmcnt(15)
    v_mfma_f32_16x16x32_bf16 v[184:187], v[80:83], a[64:67], v[184:187]
    ds_read_b64_tr_b16 v[144:145], v230 offset:16384
    ds_read_b64_tr_b16 v[146:147], v230 offset:18432
    s_mov_b32 s44, 102400
    buffer_load_dwordx4 a[128:131], v20, s[16:19], s44 offen sc1
    v_mfma_f32_16x16x32_bf16 v[184:187], v[84:87], a[68:71], v[184:187]
    ds_read_b64_tr_b16 v[148:149], v230 offset:20480
    ds_read_b64_tr_b16 v[150:151], v230 offset:22528
    v_mfma_f32_16x16x32_bf16 v[184:187], v[88:91], a[72:75], v[184:187]
    s_branch L_over11
.p2align 12
L_stub11:
    s_setpc_b64 s[46:47]
L_over11:
    ds_read_b64_tr_b16 v[152:153], v230 offset:24576
    ds_read_b64_tr_b16 v[154:155], v230 offset:26624
    s_mov_b32 s44, 110592
    buffer_load_dwordx4 a[132:135], v20, s[16:19], s44 offen sc1
    v_mfma_f32_16x16x32_bf16 v[184:187], v[92:95], a[76:79], v[184:187]
    ds_read_b64_tr_b16 v[156:157], v230 offset:28672
    ds_read_b64_tr_b16 v[158:159], v230 offset:30720
    s_waitcnt lgkmcnt(15)
    v_mfma_f32_16x16x32_bf16 v[188:191], v[108:111], a[76:79], v[188:191]
    ds_read_b64_tr_b16 v[160:161], v231 offset:16384
    ds_read_b64_tr_b16 v[162:163], v231 offset:18432
    s_mov_b32 s44, 118784
    buffer_load_dwordx4 a[136:139], v20, s[16:19], s44 offen sc1
    v_mfma_f32_16x16x32_bf16 v[188:191], v[104:107], a[72:75], v[188:191]
    ds_read_b64_tr_b16 v[164:165], v231 offset:20480
    ds_read_b64_tr_b16 v[166:167], v231 offset:22528
    v_mfma_f32_16x16x32_bf16 v[188:191], v[100:103], a[68:71], v[188:191]
    ds_read_b64_tr_b16 v[168:169], v231 offset:24576
    ds_read_b64_tr_b16 v[170:171], v231 offset:26624
    s_mov_b32 s44, 126976
    buffer_load_dwordx4 a[140:143], v20, s[16:19], s44 offen sc1
    v_mfma_f32_16x16x32_bf16 v[188:191], v[96:99], a[64:67], v[188:191]
    ds_read_b64_tr_b16 v[172:173], v231 offset:28672
    ds_read_b64_tr_b16 v[174:175], v231 offset:30720
    s_waitcnt vmcnt(12)
    s_waitcnt lgkmcnt(15)
    v_mfma_f32_16x16x32_bf16 v[176:179], v[112:115], a[80:83], v[176:179]
    ds_read_b64_tr_b16 v[48:49], v228 offset:32768
    ds_read_b64_tr_b16 v[50:51], v228 offset:34816
    s_mov_b32 s44, 135168
    buffer_load_dwordx4 a[144:147], v20, s[16:19], s44 offen sc1
    v_mfma_f32_16x16x32_bf16 v[176:179], v[116:119], a[84:87], v[176:179]
    ds_read_b64_tr_b16 v[52:53], v228 offset:36864
    ds_read_b64_tr_b16 v[54:55], v228 offset:38912
    v_mfma_f32_16x16x32_bf16 v[176:179], v[120:123], a[88:91], v[176:179]
    ds_read_b64_tr_b16 v[56:57], v228 offset:40960
    ds_read_b64_tr_b16 v[58:59], v228 offset:43008
    v_mfma_f32_16x16x32_bf16 v[176:179], v[124:127], a[92:95], v[176:179]
    ds_read_b64_tr_b16 v[60:61], v228 offset:45056
    ds_read_b64_tr_b16 v[62:63], v228 offset:47104
    s_waitcnt lgkmcnt(15)
    v_mfma_f32_16x16x32_bf16 v[180:183], v[140:143], a[92:95], v[180:183]
    ds_read_b64_tr_b16 v[64:65], v229 offset:32768
    ds_read_b64_tr_b16 v[66:67], v229 offset:34816
    s_mov_b32 s44, 143360
    buffer_load_dwordx4 a[148:151], v20, s[16:19], s44 offen sc1
    v_mfma_f32_16x16x32_bf16 v[180:183], v[136:139], a[88:91], v[180:183]
    ds_read_b64_tr_b16 v[68:69], v229 offset:36864
    ds_read_b64_tr_b16 v[70:71], v229 offset:38912
    v_mfma_f32_16x16x32_bf16 v[180:183], v[132:135], a[84:87], v[180:183]
    ds_read_b64_tr_b16 v[72:73], v229 offset:40960
    ds_read_b64_tr_b16 v[74:75], v229 offset:43008
    v_mfma_f32_16x16x32_bf16 v[180:183], v[128:131], a[80:83], v[180:183]
    ds_read_b64_tr_b16 v[76:77], v229 offset:45056
    ds_read_b64_tr_b16 v[78:79], v229 offset:47104
    s_waitcnt lgkmcnt(15)
    v_mfma_f32_16x16x32_bf16 v[184:187], v[144:147], a[80:83], v[184:187]
    ds_read_b64_tr_b16 v[80:81], v230 offset:32768
    ds_read_b64_tr_b16 v[82:83], v230 offset:34816
    s_mov_b32 s44, 151552
    buffer_load_dwordx4 a[152:155], v20, s[16:19], s44 offen sc1
    v_mfma_f32_16x16x32_bf16 v[184:187], v[148:151], a[84:87], v[184:187]
    ds_read_b64_tr_b16 v[84:85], v230 offset:36864
    ds_read_b64_tr_b16 v[86:87], v230 offset:38912
    v_mfma_f32_16x16x32_bf16 v[184:187], v[152:155], a[88:91], v[184:187]
    ds_read_b64_tr_b16 v[88:89], v230 offset:40960
    ds_read_b64_tr_b16 v[90:91], v230 offset:43008
    v_mfma_f32_16x16x32_bf16 v[184:187], v[156:159], a[92:95], v[184:187]
    ds_read_b64_tr_b16 v[92:93], v230 offset:45056
    ds_read_b64_tr_b16 v[94:95], v230 offset:47104
    s_waitcnt lgkmcnt(15)
    v_mfma_f32_16x16x32_bf16 v[188:191], v[172:175], a[92:95], v[188:191]
    ds_read_b64_tr_b16 v[96:97], v231 offset:32768
    ds_read_b64_tr_b16 v[98:99], v231 offset:34816
    s_mov_b32 s44, 159744
    buffer_load_dwordx4 a[156:159], v20, s[16:19], s44 offen sc1
    v_mfma_f32_16x16x32_bf16 v[188:191], v[168:171], a[88:91], v[188:191]
    ds_read_b64_tr_b16 v[100:101], v231 offset:36864
    ds_read_b64_tr_b16 v[102:103], v231 offset:38912
    v_mfma_f32_16x16x32_bf16 v[188:191], v[164:167], a[84:87], v[188:191]
    ds_read_b64_tr_b16 v[104:105], v231 offset:40960
    ds_read_b64_tr_b16 v[106:107], v231 offset:43008
    v_mfma_f32_16x16x32_bf16 v[188:191], v[160:163], a[80:83], v[188:191]
    ds_read_b64_tr_b16 v[108:109], v231 offset:45056
    ds_read_b64_tr_b16 v[110:111], v231 offset:47104
    s_waitcnt vmcnt(12)
    s_waitcnt lgkmcnt(15)
    v_mfma_f32_16x16x32_bf16 v[176:179], v[48:51], a[96:99], v[176:179]
    ds_read_b64_tr_b16 v[112:113], v228 offset:49152
    ds_read_b64_tr_b16 v[114:115], v228 offset:51200
    s_mov_b32 s44, 163840
    buffer_load_dwordx4 a[160:163], v20, s[16:19], s44 offen sc1
    v_mfma_f32_16x16x32_bf16 v[176:179], v[52:55], a[100:103], v[176:179]
    ds_read_b64_tr_b16 v[116:117], v228 offset:53248
    ds_read_b64_tr_b16 v[118:119], v228 offset:55296
    v_mfma_f32_16x16x32_bf16 v[176:179], v[56:59], a[104:107], v[176:179]
    ds_read_b64_tr_b16 v[120:121], v228 offset:57344
    ds_read_b64_tr_b16 v[122:123], v228 offset:59392
    v_mfma_f32_16x16x32_bf16 v[176:179], v[60:63], a[108:111], v[176:179]
    ds_read_b64_tr_b16 v[124:125], v228 offset:61440
    ds_read_b64_tr_b16 v[126:127], v228 offset:63488
    s_waitcnt lgkmcnt(15)
    v_mfma_f32_16x16x32_bf16 v[180:183], v[76:79], a[108:111], v[180:183]
    ds_read_b64_tr_b16 v[128:129], v229 offset:49152
    ds_read_b64_tr_b16 v[130:131], v229 offset:51200
    v_mfma_f32_16x16x32_bf16 v[180:183], v[72:75], a[104:107], v[180:183]
    ds_read_b64_tr_b16 v[132:133], v229 offset:53248
    ds_read_b64_tr_b16 v[134:135], v229 offset:55296
    s_mov_b32 s44, 167936
    buffer_load_dwordx4 a[164:167], v20, s[16:19], s44 offen sc1
    v_mfma_f32_16x16x32_bf16 v[180:183], v[68:71], a[100:103], v[180:183]
    ds_read_b64_tr_b16 v[136:137], v229 offset:57344
    ds_read_b64_tr_b16 v[138:139], v229 offset:59392
    v_mfma_f32_16x16x32_bf16 v[180:183], v[64:67], a[96:99], v[180:183]
    ds_read_b64_tr_b16 v[140:141], v229 offset:61440
    ds_read_b64_tr_b16 v[142:143], v229 offset:63488
    s_waitcnt lgkmcnt(15)
    v_mfma_f32_16x16x32_bf16 v[184:187], v[80:83], a[96:99], v[184:187]
    ds_read_b64_tr_b16 v[144:145], v230 offset:49152
    ds_read_b64_tr_b16 v[146:147], v230 offset:51200
    v_mfma_f32_16x16x32_bf16 v[184:187], v[84:87], a[100:103], v[184:187]
    ds_read_b64_tr_b16 v[148:149], v230 offset:53248
    ds_read_b64_tr_b16 v[150:151], v230 offset:55296
    v_mfma_f32_16x16x32_bf16 v[184:187], v[88:91], a[104:107], v[184:187]
    ds_read_b64_tr_b16 v[152:153], v230 offset:57344
    ds_read_b64_tr_b16 v[154:155], v230 offset:59392
    s_mov_b32 s44, 172032
    buffer_load_dwordx4 a[168:171], v20, s[16:19], s44 offen sc1
    v_mfma_f32_16x16x32_bf16 v[184:187], v[92:95], a[108:111], v[184:187]
    ds_read_b64_tr_b16 v[156:157], v230 offset:61440
    ds_read_b64_tr_b16 v[158:159], v230 offset:63488
    s_waitcnt lgkmcnt(15)
    v_mfma_f32_16x16x32_bf16 v[188:191], v[108:111], a[108:111], v[188:191]
    ds_read_b64_tr_b16 v[160:161], v231 offset:49152
    ds_read_b64_tr_b16 v[162:163], v231 offset:51200
    v_mfma_f32_16x16x32_bf16 v[188:191], v[104:107], a[104:107], v[188:191]
    ds_read_b64_tr_b16 v[164:165], v231 offset:53248
    ds_read_b64_tr_b16 v[166:167], v231 offset:55296
    v_mfma_f32_16x16x32_bf16 v[188:191], v[100:103], a[100:103], v[188:191]
    ds_read_b64_tr_b16 v[168:169], v231 offset:57344
    ds_read_b64_tr_b16 v[170:171], v231 offset:59392
    v_mfma_f32_16x16x32_bf16 v[188:191], v[96:99], a[96:99], v[188:191]
    ds_read_b64_tr_b16 v[172:173], v231 offset:61440
    ds_read_b64_tr_b16 v[174:175], v231 offset:63488
    s_waitcnt vmcnt(11)
    s_barrier
    s_waitcnt lgkmcnt(15)
    v_mfma_f32_16x16x32_bf16 v[176:179], v[112:115], a[112:115], v[176:179]
    ds_read_b64_tr_b16 v[48:49], v232 offset:0
    ds_read_b64_tr_b16 v[50:51], v232 offset:2048
    v_mfma_f32_16x16x32_bf16 v[176:179], v[116:119], a[116:119], v[176:179]
    ds_read_b64_tr_b16 v[52:53], v232 offset:4096
    ds_read_b64_tr_b16 v[54:55], v232 offset:6144
    v_mfma_f32_16x16x32_bf16 v[176:179], v[120:123], a[120:123], v[176:179]
    ds_read_b64_tr_b16 v[56:57], v232 offset:8192
    ds_read_b64_tr_b16 v[58:59], v232 offset:10240
    v_mfma_f32_16x16x32_bf16 v[176:179], v[124:127], a[124:127], v[176:179]
    ds_read_b64_tr_b16 v[60:61], v232 offset:12288
    ds_read_b64_tr_b16 v[62:63], v232 offset:14336
    s_waitcnt lgkmcnt(15)
    v_mfma_f32_16x16x32_bf16 v[180:183], v[140:143], a[124:127], v[180:183]
    ds_read_b64_tr_b16 v[64:65], v233 offset:0
    ds_read_b64_tr_b16 v[66:67], v233 offset:2048
    v_mfma_f32_16x16x32_bf16 v[180:183], v[136:139], a[120:123], v[180:183]
    ds_read_b64_tr_b16 v[68:69], v233 offset:4096
    ds_read_b64_tr_b16 v[70:71], v233 offset:6144
    v_mfma_f32_16x16x32_bf16 v[180:183], v[132:135], a[116:119], v[180:183]
    ds_read_b64_tr_b16 v[72:73], v233 offset:8192
    ds_read_b64_tr_b16 v[74:75], v233 offset:10240
    v_mfma_f32_16x16x32_bf16 v[180:183], v[128:131], a[112:115], v[180:183]
    ds_read_b64_tr_b16 v[76:77], v233 offset:12288
    ds_read_b64_tr_b16 v[78:79], v233 offset:14336
    s_waitcnt lgkmcnt(15)
    v_mfma_f32_16x16x32_bf16 v[184:187], v[144:147], a[112:115], v[184:187]
    ds_read_b64_tr_b16 v[80:81], v234 offset:0
    ds_read_b64_tr_b16 v[82:83], v234 offset:2048
    v_mfma_f32_16x16x32_bf16 v[184:187], v[148:151], a[116:119], v[184:187]
    ds_read_b64_tr_b16 v[84:85], v234 offset:4096
    ds_read_b64_tr_b16 v[86:87], v234 offset:6144
    v_mfma_f32_16x16x32_bf16 v[184:187], v[152:155], a[120:123], v[184:187]
    ds_read_b64_tr_b16 v[88:89], v234 offset:8192
    ds_read_b64_tr_b16 v[90:91], v234 offset:10240
    v_mfma_f32_16x16x32_bf16 v[184:187], v[156:159], a[124:127], v[184:187]
    ds_read_b64_tr_b16 v[92:93], v234 offset:12288
    ds_read_b64_tr_b16 v[94:95], v234 offset:14336
    s_waitcnt lgkmcnt(15)
    v_mfma_f32_16x16x32_bf16 v[188:191], v[172:175], a[124:127], v[188:191]
    ds_read_b64_tr_b16 v[96:97], v235 offset:0
    ds_read_b64_tr_b16 v[98:99], v235 offset:2048
    v_mfma_f32_16x16x32_bf16 v[188:191], v[168:171], a[120:123], v[188:191]
    ds_read_b64_tr_b16 v[100:101], v235 offset:4096
    ds_read_b64_tr_b16 v[102:103], v235 offset:6144
    v_mfma_f32_16x16x32_bf16 v[188:191], v[164:167], a[116:119], v[188:191]
    ds_read_b64_tr_b16 v[104:105], v235 offset:8192
    ds_read_b64_tr_b16 v[106:107], v235 offset:10240
    v_mfma_f32_16x16x32_bf16 v[188:191], v[160:163], a[112:115], v[188:191]
    ds_read_b64_tr_b16 v[108:109], v235 offset:12288
    ds_read_b64_tr_b16 v[110:111], v235 offset:14336
    s_waitcnt vmcnt(7)
    s_waitcnt lgkmcnt(15)
    v_mfma_f32_16x16x32_bf16 v[176:179], v[48:51], a[128:131], v[176:179]
    ds_read_b64_tr_b16 v[112:113], v232 offset:16384
    ds_read_b64_tr_b16 v[114:115], v232 offset:18432
    s_movk_i32 s44, 4096
    buffer_load_dwordx4 v[4:7], v20, s[60:63], 0 offen sc1
    v_mfma_f32_16x16x32_bf16 v[176:179], v[52:55], a[132:135], v[176:179]
    ds_read_b64_tr_b16 v[116:117], v232 offset:20480
    ds_read_b64_tr_b16 v[118:119], v232 offset:22528
    v_mfma_f32_16x16x32_bf16 v[176:179], v[56:59], a[136:139], v[176:179]
    ds_read_b64_tr_b16 v[120:121], v232 offset:24576
    ds_read_b64_tr_b16 v[122:123], v232 offset:26624
    v_mfma_f32_16x16x32_bf16 v[176:179], v[60:63], a[140:143], v[176:179]
    ds_read_b64_tr_b16 v[124:125], v232 offset:28672
    ds_read_b64_tr_b16 v[126:127], v232 offset:30720
    s_waitcnt lgkmcnt(15)
    v_mfma_f32_16x16x32_bf16 v[180:183], v[76:79], a[140:143], v[180:183]
    ds_read_b64_tr_b16 v[128:129], v233 offset:16384
    ds_read_b64_tr_b16 v[130:131], v233 offset:18432
    v_mfma_f32_16x16x32_bf16 v[180:183], v[72:75], a[136:139], v[180:183]
    ds_read_b64_tr_b16 v[132:133], v233 offset:20480
    ds_read_b64_tr_b16 v[134:135], v233 offset:22528
    v_mfma_f32_16x16x32_bf16 v[180:183], v[68:71], a[132:135], v[180:183]
    ds_read_b64_tr_b16 v[136:137], v233 offset:24576
    ds_read_b64_tr_b16 v[138:139], v233 offset:26624
    v_mfma_f32_16x16x32_bf16 v[180:183], v[64:67], a[128:131], v[180:183]
    ds_read_b64_tr_b16 v[140:141], v233 offset:28672
    ds_read_b64_tr_b16 v[142:143], v233 offset:30720
    s_waitcnt lgkmcnt(15)
    v_mfma_f32_16x16x32_bf16 v[184:187], v[80:83], a[128:131], v[184:187]
    ds_read_b64_tr_b16 v[144:145], v234 offset:16384
    ds_read_b64_tr_b16 v[146:147], v234 offset:18432
    buffer_load_dwordx4 v[8:11], v20, s[60:63], s44 offen sc1
    v_mfma_f32_16x16x32_bf16 v[184:187], v[84:87], a[132:135], v[184:187]
    ds_read_b64_tr_b16 v[148:149], v234 offset:20480
    ds_read_b64_tr_b16 v[150:151], v234 offset:22528
    v_mfma_f32_16x16x32_bf16 v[184:187], v[88:91], a[136:139], v[184:187]
    ds_read_b64_tr_b16 v[152:153], v234 offset:24576
    ds_read_b64_tr_b16 v[154:155], v234 offset:26624
    v_mfma_f32_16x16x32_bf16 v[184:187], v[92:95], a[140:143], v[184:187]
    ds_read_b64_tr_b16 v[156:157], v234 offset:28672
    ds_read_b64_tr_b16 v[158:159], v234 offset:30720
    s_waitcnt lgkmcnt(15)
    v_mfma_f32_16x16x32_bf16 v[188:191], v[108:111], a[140:143], v[188:191]
    ds_read_b64_tr_b16 v[160:161], v235 offset:16384
    ds_read_b64_tr_b16 v[162:163], v235 offset:18432
    v_mfma_f32_16x16x32_bf16 v[188:191], v[104:107], a[136:139], v[188:191]
    ds_read_b64_tr_b16 v[164:165], v235 offset:20480
    ds_read_b64_tr_b16 v[166:167], v235 offset:22528
    v_mfma_f32_16x16x32_bf16 v[188:191], v[100:103], a[132:135], v[188:191]
    ds_read_b64_tr_b16 v[168:169], v235 offset:24576
    ds_read_b64_tr_b16 v[170:171], v235 offset:26624
    v_mfma_f32_16x16x32_bf16 v[188:191], v[96:99], a[128:131], v[188:191]
    ds_read_b64_tr_b16 v[172:173], v235 offset:28672
    ds_read_b64_tr_b16 v[174:175], v235 offset:30720
    s_waitcnt vmcnt(5)
    s_waitcnt lgkmcnt(15)
    v_mfma_f32_16x16x32_bf16 v[176:179], v[112:115], a[144:147], v[176:179]
    ds_read_b64_tr_b16 v[48:49], v224 offset:0
    v_mfma_f32_16x16x32_bf16 v[176:179], v[116:119], a[148:151], v[176:179]
    ds_read_b64_tr_b16 v[50:51], v224 offset:2048
    ds_read_b64_tr_b16 v[52:53], v224 offset:4096
    v_mfma_f32_16x16x32_bf16 v[176:179], v[120:123], a[152:155], v[176:179]
    ds_read_b64_tr_b16 v[54:55], v224 offset:6144
    v_mfma_f32_16x16x32_bf16 v[176:179], v[124:127], a[156:159], v[176:179]
    ds_read_b64_tr_b16 v[56:57], v224 offset:8192
    ds_read_b64_tr_b16 v[58:59], v224 offset:10240
    s_waitcnt lgkmcnt(15)
    v_mfma_f32_16x16x32_bf16 v[180:183], v[140:143], a[156:159], v[180:183]
    ds_read_b64_tr_b16 v[64:65], v225 offset:0
    v_mfma_f32_16x16x32_bf16 v[180:183], v[136:139], a[152:155], v[180:183]
    ds_read_b64_tr_b16 v[66:67], v225 offset:2048
    ds_read_b64_tr_b16 v[68:69], v225 offset:4096
    v_mfma_f32_16x16x32_bf16 v[180:183], v[132:135], a[148:151], v[180:183]
    ds_read_b64_tr_b16 v[70:71], v225 offset:6144
    v_mfma_f32_16x16x32_bf16 v[180:183], v[128:131], a[144:147], v[180:183]
    ds_read_b64_tr_b16 v[72:73], v225 offset:8192
    ds_read_b64_tr_b16 v[74:75], v225 offset:10240
    s_waitcnt lgkmcnt(15)
    v_mfma_f32_16x16x32_bf16 v[184:187], v[144:147], a[144:147], v[184:187]
    ds_read_b64_tr_b16 v[80:81], v226 offset:0
    v_mfma_f32_16x16x32_bf16 v[184:187], v[148:151], a[148:151], v[184:187]
    ds_read_b64_tr_b16 v[82:83], v226 offset:2048
    ds_read_b64_tr_b16 v[84:85], v226 offset:4096
    v_mfma_f32_16x16x32_bf16 v[184:187], v[152:155], a[152:155], v[184:187]
    ds_read_b64_tr_b16 v[86:87], v226 offset:6144
    v_mfma_f32_16x16x32_bf16 v[184:187], v[156:159], a[156:159], v[184:187]
    ds_read_b64_tr_b16 v[88:89], v226 offset:8192
    ds_read_b64_tr_b16 v[90:91], v226 offset:10240
    s_waitcnt lgkmcnt(15)
    v_mfma_f32_16x16x32_bf16 v[188:191], v[172:175], a[156:159], v[188:191]
    ds_read_b64_tr_b16 v[96:97], v227 offset:0
    v_mfma_f32_16x16x32_bf16 v[188:191], v[168:171], a[152:155], v[188:191]
    ds_read_b64_tr_b16 v[98:99], v227 offset:2048
    ds_read_b64_tr_b16 v[100:101], v227 offset:4096
    v_mfma_f32_16x16x32_bf16 v[188:191], v[164:167], a[148:151], v[188:191]
    ds_read_b64_tr_b16 v[102:103], v227 offset:6144
    v_mfma_f32_16x16x32_bf16 v[188:191], v[160:163], a[144:147], v[188:191]
    ds_read_b64_tr_b16 v[104:105], v227 offset:8192
    ds_read_b64_tr_b16 v[106:107], v227 offset:10240
    s_waitcnt vmcnt(2)
    s_waitcnt lgkmcnt(15)
    v_mfma_f32_16x16x32_bf16 v[176:179], v[48:51], a[160:163], v[176:179]
    s_waitcnt vmcnt(0)
    v_lshlrev_b32 v24, 16, v4
    v_and_b32 v25, 0xffff0000, v4
    v_lshlrev_b32 v26, 16, v5
    v_and_b32 v27, 0xffff0000, v5
    v_lshlrev_b32 v28, 16, v6
    v_and_b32 v29, 0xffff0000, v6
    v_lshlrev_b32 v30, 16, v7
    v_and_b32 v31, 0xffff0000, v7
    v_lshlrev_b32 v192, 16, v8
    v_and_b32 v193, 0xffff0000, v8
    v_lshlrev_b32 v194, 16, v9
    v_and_b32 v195, 0xffff0000, v9
    v_lshlrev_b32 v196, 16, v10
    v_and_b32 v197, 0xffff0000, v10
    v_lshlrev_b32 v198, 16, v11
    v_and_b32 v199, 0xffff0000, v11
    v_mfma_f32_16x16x32_bf16 v[176:179], v[52:55], a[164:167], v[176:179]
    v_mfma_f32_16x16x32_bf16 v[176:179], v[56:59], a[168:171], v[176:179]
    s_waitcnt lgkmcnt(12)
    v_mfma_f32_16x16x32_bf16 v[180:183], v[72:75], a[168:171], v[180:183]
    v_mfma_f32_16x16x32_bf16 v[180:183], v[68:71], a[164:167], v[180:183]
    v_mfma_f32_16x16x32_bf16 v[180:183], v[64:67], a[160:163], v[180:183]
    s_waitcnt lgkmcnt(6)
    v_mfma_f32_16x16x32_bf16 v[184:187], v[80:83], a[160:163], v[184:187]
    v_mfma_f32_16x16x32_bf16 v[184:187], v[84:87], a[164:167], v[184:187]
    v_mfma_f32_16x16x32_bf16 v[184:187], v[88:91], a[168:171], v[184:187]
    s_waitcnt lgkmcnt(0)
    v_mfma_f32_16x16x32_bf16 v[188:191], v[104:107], a[168:171], v[188:191]
    v_mfma_f32_16x16x32_bf16 v[188:191], v[100:103], a[164:167], v[188:191]
    v_mfma_f32_16x16x32_bf16 v[188:191], v[96:99], a[160:163], v[188:191]
    s_nop 4
    v_fmac_f32 v24, v208, v176
    v_fmac_f32 v25, v209, v177
    v_fmac_f32 v26, v210, v178
    v_fmac_f32 v27, v211, v179
    v_fmac_f32 v28, v212, v180
    v_fmac_f32 v29, v213, v181
    v_fmac_f32 v30, v214, v182
    v_fmac_f32 v31, v215, v183
    v_cvt_pk_bf16_f32 v4, v24, v25
    v_cvt_pk_bf16_f32 v5, v26, v27
    v_cvt_pk_bf16_f32 v6, v28, v29
    v_cvt_pk_bf16_f32 v7, v30, v31
    v_fmac_f32 v192, v216, v184
    v_fmac_f32 v193, v217, v185
    v_fmac_f32 v194, v218, v186
    v_fmac_f32 v195, v219, v187
    v_fmac_f32 v196, v220, v188
    v_fmac_f32 v197, v221, v189
    v_fmac_f32 v198, v222, v190
    v_fmac_f32 v199, v223, v191
    v_cvt_pk_bf16_f32 v8, v192, v193
    v_cvt_pk_bf16_f32 v9, v194, v195
    v_cvt_pk_bf16_f32 v10, v196, v197
    v_cvt_pk_bf16_f32 v11, v198, v199
    v_permlane32_swap_b32 v4, v6
    v_permlane32_swap_b32 v5, v7
    v_permlane32_swap_b32 v8, v10
    v_permlane32_swap_b32 v9, v11
    v_permlane16_swap_b32 v4, v6
    v_permlane16_swap_b32 v5, v7
    v_permlane16_swap_b32 v8, v10
    v_permlane16_swap_b32 v9, v11
    buffer_store_dwordx4 v[4:7], v14, s[20:23], 0 offen offset:0 sc1
    buffer_store_dwordx4 v[8:11], v14, s[20:23], 0 offen offset:64 sc1
L_end_main_kernel:
    s_endpgm
L_hot_end:
L_oslow_main_kernel:
    s_cmp_ge_u32 s40, 0x40000
    s_cbranch_scc1 L_oready_main_kernel
    buffer_load_dword v3, v2, s[52:55], s77 offen offset:32 sc1
    s_branch L_opoll_main_kernel
L_of2_main_kernel:
    buffer_store_dword v1, off, s[52:55], s40 offset:32 sc1
    s_branch L_of3_main_kernel
L_as1_main_kernel:
    s_cmp_ge_u32 s40, 0x40000
    s_cbranch_scc1 L_ar1_main_kernel
    v_mov_b32 v17, 0
    buffer_atomic_add v17, v2, s[52:55], s78 offen sc0 sc1
    s_waitcnt vmcnt(0)
    s_branch L_ap1_main_kernel
L_as2_main_kernel:
    s_cmp_ge_u32 s40, 0x40000
    s_cbranch_scc1 L_ar2_main_kernel
    v_mov_b32 v17, 0
    buffer_atomic_add v17, v2, s[52:55], s78 offen sc0 sc1
    s_waitcnt vmcnt(0)
    s_branch L_ap2_main_kernel
L_ofar_main_kernel:
    s_movk_i32 s42, 4096
    s_movk_i32 s43, 8192
    s_movk_i32 s44, 12288
    v_add_f32 v28, v224, v225
    v_add_f32 v30, v226, v227
    v_add_f32 v32, v228, v229
    v_add_f32 v34, v230, v231
    s_waitcnt lgkmcnt(0)
    v_mfma_f32_16x16x32_bf16 a[0:3], a[160:163], v[232:235], a[0:3]
    v_rcp_f32 v28, v28
    v_mfma_f32_16x16x32_bf16 a[0:3], a[192:195], v[192:195], a[0:3]
    v_rcp_f32 v30, v30
    v_mfma_f32_16x16x32_bf16 a[4:7], a[196:199], v[192:195], a[4:7]
    v_rcp_f32 v32, v32
    v_mfma_f32_16x16x32_bf16 a[4:7], a[164:167], v[232:235], a[4:7]
    v_rcp_f32 v34, v34
    v_mfma_f32_16x16x32_bf16 a[8:11], a[168:171], v[232:235], a[8:11]
    ds_read_b64_tr_b16 a[224:225], v4 offset:32768
    v_mfma_f32_16x16x32_bf16 a[8:11], a[200:203], v[192:195], a[8:11]
    ds_read_b64_tr_b16 a[226:227], v4 offset:36864
    v_mfma_f32_16x16x32_bf16 a[12:15], a[204:207], v[192:195], a[12:15]
    ds_read_b64_tr_b16 a[228:229], v4 offset:40960
    v_accvgpr_read_b32 v112, a0
    v_accvgpr_read_b32 v113, a1
    v_accvgpr_read_b32 v114, a2
    v_accvgpr_read_b32 v115, a3
    v_accvgpr_read_b32 v116, a4
    v_mfma_f32_16x16x32_bf16 a[12:15], a[172:175], v[232:235], a[12:15]
    ds_read_b64_tr_b16 a[230:231], v4 offset:45056
    v_accvgpr_read_b32 v117, a5
    v_accvgpr_read_b32 v118, a6
    v_accvgpr_read_b32 v119, a7
    v_mul_f32 v112, v112, v28
    v_mul_f32 v113, v113, v28
    v_mfma_f32_16x16x32_bf16 a[16:19], a[176:179], v[232:235], a[16:19]
    ds_read_b64_tr_b16 a[232:233], v4 offset:49152
    v_mul_f32 v114, v114, v28
    v_mul_f32 v115, v115, v28
    v_mul_f32 v116, v116, v28
    v_mul_f32 v117, v117, v28
    v_mul_f32 v118, v118, v28
    v_mfma_f32_16x16x32_bf16 a[16:19], a[208:211], v[192:195], a[16:19]
    ds_read_b64_tr_b16 a[234:235], v4 offset:53248
    v_mul_f32 v119, v119, v28
    v_cvt_pk_bf16_f32 v48, v112, v113
    v_cvt_pk_bf16_f32 v49, v114, v115
    v_cvt_pk_bf16_f32 v50, v116, v117
    v_cvt_pk_bf16_f32 v51, v118, v119
    v_mfma_f32_16x16x32_bf16 a[20:23], a[212:215], v[192:195], a[20:23]
    buffer_store_dwordx4 v[48:51], v20, s[32:35], 0 offen offset:0 sc1
    v_accvgpr_read_b32 v120, a8
    v_accvgpr_read_b32 v121, a9
    v_accvgpr_read_b32 v122, a10
    v_accvgpr_read_b32 v123, a11
    v_accvgpr_read_b32 v124, a12
    v_mfma_f32_16x16x32_bf16 a[20:23], a[180:183], v[232:235], a[20:23]
    ds_read_b64_tr_b16 a[236:237], v4 offset:57344
    v_accvgpr_read_b32 v125, a13
    v_accvgpr_read_b32 v126, a14
    v_accvgpr_read_b32 v127, a15
    v_mul_f32 v120, v120, v28
    v_mul_f32 v121, v121, v28
    v_mfma_f32_16x16x32_bf16 a[24:27], a[184:187], v[232:235], a[24:27]
    ds_read_b64_tr_b16 a[238:239], v4 offset:61440
    v_mul_f32 v122, v122, v28
    v_mul_f32 v123, v123, v28
    v_mul_f32 v124, v124, v28
    v_mul_f32 v125, v125, v28
    v_mul_f32 v126, v126, v28
    v_mfma_f32_16x16x32_bf16 a[24:27], a[216:219], v[192:195], a[24:27]
    ds_read_b64_tr_b16 a[240:241], v5 offset:32768
    v_mul_f32 v127, v127, v28
    v_cvt_pk_bf16_f32 v64, v120, v121
    v_cvt_pk_bf16_f32 v65, v122, v123
    v_cvt_pk_bf16_f32 v66, v124, v125
    v_cvt_pk_bf16_f32 v67, v126, v127
    v_mfma_f32_16x16x32_bf16 a[28:31], a[220:223], v[192:195], a[28:31]
    buffer_store_dwordx4 v[64:67], v20, s[32:35], s42 offen offset:0 sc1
    v_accvgpr_read_b32 v128, a16
    v_accvgpr_read_b32 v129, a17
    v_accvgpr_read_b32 v130, a18
    v_accvgpr_read_b32 v131, a19
    v_accvgpr_read_b32 v132, a20
    v_mfma_f32_16x16x32_bf16 a[28:31], a[188:191], v[232:235], a[28:31]
    ds_read_b64_tr_b16 a[242:243], v5 offset:36864
    v_accvgpr_read_b32 v133, a21
    v_accvgpr_read_b32 v134, a22
    v_accvgpr_read_b32 v135, a23
    v_mul_f32 v128, v128, v28
    v_mul_f32 v129, v129, v28
    v_mfma_f32_16x16x32_bf16 a[32:35], a[160:163], v[236:239], a[32:35]
    ds_read_b64_tr_b16 a[244:245], v5 offset:40960
    v_mul_f32 v130, v130, v28
    v_mul_f32 v131, v131, v28
    v_mul_f32 v132, v132, v28
    v_mul_f32 v133, v133, v28
    v_mul_f32 v134, v134, v28
    v_mfma_f32_16x16x32_bf16 a[32:35], a[192:195], v[196:199], a[32:35]
    ds_read_b64_tr_b16 a[246:247], v5 offset:45056
    v_mul_f32 v135, v135, v28
    v_cvt_pk_bf16_f32 v80, v128, v129
    v_cvt_pk_bf16_f32 v81, v130, v131
    v_cvt_pk_bf16_f32 v82, v132, v133
    v_cvt_pk_bf16_f32 v83, v134, v135
    v_mfma_f32_16x16x32_bf16 a[36:39], a[196:199], v[196:199], a[36:39]
    buffer_store_dwordx4 v[80:83], v20, s[32:35], s43 offen offset:0 sc1
    v_accvgpr_read_b32 v136, a24
    v_accvgpr_read_b32 v137, a25
    v_accvgpr_read_b32 v138, a26
    v_accvgpr_read_b32 v139, a27
    v_accvgpr_read_b32 v140, a28
    v_mfma_f32_16x16x32_bf16 a[36:39], a[164:167], v[236:239], a[36:39]
    ds_read_b64_tr_b16 a[248:249], v5 offset:49152
    v_accvgpr_read_b32 v141, a29
    v_accvgpr_read_b32 v142, a30
    v_accvgpr_read_b32 v143, a31
    v_mul_f32 v136, v136, v28
    v_mul_f32 v137, v137, v28
    v_mfma_f32_16x16x32_bf16 a[40:43], a[168:171], v[236:239], a[40:43]
    ds_read_b64_tr_b16 a[250:251], v5 offset:53248
    v_mul_f32 v138, v138, v28
    v_mul_f32 v139, v139, v28
    v_mul_f32 v140, v140, v28
    v_mul_f32 v141, v141, v28
    v_mul_f32 v142, v142, v28
    v_mfma_f32_16x16x32_bf16 a[40:43], a[200:203], v[196:199], a[40:43]
    ds_read_b64_tr_b16 a[252:253], v5 offset:57344
    v_mul_f32 v143, v143, v28
    v_cvt_pk_bf16_f32 v96, v136, v137
    v_cvt_pk_bf16_f32 v97, v138, v139
    v_cvt_pk_bf16_f32 v98, v140, v141
    v_cvt_pk_bf16_f32 v99, v142, v143
    v_mfma_f32_16x16x32_bf16 a[44:47], a[204:207], v[196:199], a[44:47]
    buffer_store_dwordx4 v[96:99], v20, s[32:35], s44 offen offset:0 sc1
    v_accvgpr_read_b32 v144, a32
    v_accvgpr_read_b32 v145, a33
    v_accvgpr_read_b32 v146, a34
    v_accvgpr_read_b32 v147, a35
    v_accvgpr_read_b32 v148, a36
    v_mfma_f32_16x16x32_bf16 a[44:47], a[172:175], v[236:239], a[44:47]
    ds_read_b64_tr_b16 a[254:255], v5 offset:61440
    v_accvgpr_read_b32 v149, a37
    v_accvgpr_read_b32 v150, a38
    v_accvgpr_read_b32 v151, a39
    v_mul_f32 v144, v144, v30
    v_mul_f32 v145, v145, v30
    v_mfma_f32_16x16x32_bf16 a[48:51], a[176:179], v[236:239], a[48:51]
    v_mul_f32 v146, v146, v30
    v_mul_f32 v147, v147, v30
    v_mul_f32 v148, v148, v30
    v_mul_f32 v149, v149, v30
    v_mul_f32 v150, v150, v30
    v_mfma_f32_16x16x32_bf16 a[48:51], a[208:211], v[196:199], a[48:51]
    v_mul_f32 v151, v151, v30
    v_cvt_pk_bf16_f32 v52, v144, v145
    v_cvt_pk_bf16_f32 v53, v146, v147
    v_cvt_pk_bf16_f32 v54, v148, v149
    v_cvt_pk_bf16_f32 v55, v150, v151
    v_mfma_f32_16x16x32_bf16 a[52:55], a[212:215], v[196:199], a[52:55]
    buffer_store_dwordx4 v[52:55], v20, s[32:35], 0 offen offset:1024 sc1
    v_accvgpr_read_b32 v152, a40
    v_accvgpr_read_b32 v153, a41
    v_accvgpr_read_b32 v154, a42
    v_accvgpr_read_b32 v155, a43
    v_accvgpr_read_b32 v156, a44
    v_mfma_f32_16x16x32_bf16 a[52:55], a[180:183], v[236:239], a[52:55]
    v_accvgpr_read_b32 v157, a45
    v_accvgpr_read_b32 v158, a46
    v_accvgpr_read_b32 v159, a47
    v_mul_f32 v152, v152, v30
    v_mul_f32 v153, v153, v30
    v_mfma_f32_16x16x32_bf16 a[56:59], a[184:187], v[236:239], a[56:59]
    v_mul_f32 v154, v154, v30
    v_mul_f32 v155, v155, v30
    v_mul_f32 v156, v156, v30
    v_mul_f32 v157, v157, v30
    v_mul_f32 v158, v158, v30
    v_mfma_f32_16x16x32_bf16 a[56:59], a[216:219], v[196:199], a[56:59]
    v_mul_f32 v159, v159, v30
    v_cvt_pk_bf16_f32 v68, v152, v153
    v_cvt_pk_bf16_f32 v69, v154, v155
    v_cvt_pk_bf16_f32 v70, v156, v157
    v_cvt_pk_bf16_f32 v71, v158, v159
    v_mfma_f32_16x16x32_bf16 a[60:63], a[220:223], v[196:199], a[60:63]
    buffer_store_dwordx4 v[68:71], v20, s[32:35], s42 offen offset:1024 sc1
    v_accvgpr_read_b32 v160, a48
    v_accvgpr_read_b32 v161, a49
    v_accvgpr_read_b32 v162, a50
    v_accvgpr_read_b32 v163, a51
    v_accvgpr_read_b32 v164, a52
    v_mfma_f32_16x16x32_bf16 a[60:63], a[188:191], v[236:239], a[60:63]
    v_accvgpr_read_b32 v165, a53
    v_accvgpr_read_b32 v166, a54
    v_accvgpr_read_b32 v167, a55
    v_mul_f32 v160, v160, v30
    v_mul_f32 v161, v161, v30
    v_mfma_f32_16x16x32_bf16 a[64:67], a[160:163], v[240:243], a[64:67]
    v_mul_f32 v162, v162, v30
    v_mul_f32 v163, v163, v30
    v_mul_f32 v164, v164, v30
    v_mul_f32 v165, v165, v30
    v_mul_f32 v166, v166, v30
    v_mfma_f32_16x16x32_bf16 a[64:67], a[192:195], v[200:203], a[64:67]
    v_mul_f32 v167, v167, v30
    v_cvt_pk_bf16_f32 v84, v160, v161
    v_cvt_pk_bf16_f32 v85, v162, v163
    v_cvt_pk_bf16_f32 v86, v164, v165
    v_cvt_pk_bf16_f32 v87, v166, v167
    v_mfma_f32_16x16x32_bf16 a[68:71], a[196:199], v[200:203], a[68:71]
    buffer_store_dwordx4 v[84:87], v20, s[32:35], s43 offen offset:1024 sc1
    v_accvgpr_read_b32 v168, a56
    v_accvgpr_read_b32 v169, a57
    v_accvgpr_read_b32 v170, a58
    v_accvgpr_read_b32 v171, a59
    v_accvgpr_read_b32 v172, a60
    v_mfma_f32_16x16x32_bf16 a[68:71], a[164:167], v[240:243], a[68:71]
    v_accvgpr_read_b32 v173, a61
    v_accvgpr_read_b32 v174, a62
    v_accvgpr_read_b32 v175, a63
    v_mul_f32 v168, v168, v30
    v_mul_f32 v169, v169, v30
    v_mfma_f32_16x16x32_bf16 a[72:75], a[168:171], v[240:243], a[72:75]
    v_mul_f32 v170, v170, v30
    v_mul_f32 v171, v171, v30
    v_mul_f32 v172, v172, v30
    v_mul_f32 v173, v173, v30
    v_mul_f32 v174, v174, v30
    v_mfma_f32_16x16x32_bf16 a[72:75], a[200:203], v[200:203], a[72:75]
    v_mul_f32 v175, v175, v30
    v_cvt_pk_bf16_f32 v100, v168, v169
    v_cvt_pk_bf16_f32 v101, v170, v171
    v_cvt_pk_bf16_f32 v102, v172, v173
    v_cvt_pk_bf16_f32 v103, v174, v175
    v_mfma_f32_16x16x32_bf16 a[76:79], a[204:207], v[200:203], a[76:79]
    buffer_store_dwordx4 v[100:103], v20, s[32:35], s44 offen offset:1024 sc1
    v_accvgpr_read_b32 v112, a64
    v_accvgpr_read_b32 v113, a65
    v_accvgpr_read_b32 v114, a66
    v_accvgpr_read_b32 v115, a67
    v_accvgpr_read_b32 v116, a68
    v_mfma_f32_16x16x32_bf16 a[76:79], a[172:175], v[240:243], a[76:79]
    v_accvgpr_read_b32 v117, a69
    v_accvgpr_read_b32 v118, a70
    v_accvgpr_read_b32 v119, a71
    v_mul_f32 v112, v112, v32
    v_mul_f32 v113, v113, v32
    v_mfma_f32_16x16x32_bf16 a[80:83], a[176:179], v[240:243], a[80:83]
    v_mul_f32 v114, v114, v32
    v_mul_f32 v115, v115, v32
    v_mul_f32 v116, v116, v32
    v_mul_f32 v117, v117, v32
    v_mul_f32 v118, v118, v32
    v_mfma_f32_16x16x32_bf16 a[80:83], a[208:211], v[200:203], a[80:83]
    v_mul_f32 v119, v119, v32
    v_cvt_pk_bf16_f32 v56, v112, v113
    v_cvt_pk_bf16_f32 v57, v114, v115
    v_cvt_pk_bf16_f32 v58, v116, v117
    v_cvt_pk_bf16_f32 v59, v118, v119
    v_mfma_f32_16x16x32_bf16 a[84:87], a[212:215], v[200:203], a[84:87]
    buffer_store_dwordx4 v[56:59], v20, s[32:35], 0 offen offset:2048 sc1
    v_accvgpr_read_b32 v120, a72
    v_accvgpr_read_b32 v121, a73
    v_accvgpr_read_b32 v122, a74
    v_accvgpr_read_b32 v123, a75
    v_accvgpr_read_b32 v124, a76
    v_mfma_f32_16x16x32_bf16 a[84:87], a[180:183], v[240:243], a[84:87]
    v_accvgpr_read_b32 v125, a77
    v_accvgpr_read_b32 v126, a78
    v_accvgpr_read_b32 v127, a79
    v_mul_f32 v120, v120, v32
    v_mul_f32 v121, v121, v32
    v_mfma_f32_16x16x32_bf16 a[88:91], a[184:187], v[240:243], a[88:91]
    v_mul_f32 v122, v122, v32
    v_mul_f32 v123, v123, v32
    v_mul_f32 v124, v124, v32
    v_mul_f32 v125, v125, v32
    v_mul_f32 v126, v126, v32
    v_mfma_f32_16x16x32_bf16 a[88:91], a[216:219], v[200:203], a[88:91]
    v_mul_f32 v127, v127, v32
    v_cvt_pk_bf16_f32 v72, v120, v121
    v_cvt_pk_bf16_f32 v73, v122, v123
    v_cvt_pk_bf16_f32 v74, v124, v125
    v_cvt_pk_bf16_f32 v75, v126, v127
    v_mfma_f32_16x16x32_bf16 a[92:95], a[220:223], v[200:203], a[92:95]
    buffer_store_dwordx4 v[72:75], v20, s[32:35], s42 offen offset:2048 sc1
    v_accvgpr_read_b32 v128, a80
    v_accvgpr_read_b32 v129, a81
    v_accvgpr_read_b32 v130, a82
    v_accvgpr_read_b32 v131, a83
    v_accvgpr_read_b32 v132, a84
    v_mfma_f32_16x16x32_bf16 a[92:95], a[188:191], v[240:243], a[92:95]
    v_accvgpr_read_b32 v133, a85
    v_accvgpr_read_b32 v134, a86
    v_accvgpr_read_b32 v135, a87
    v_mul_f32 v128, v128, v32
    v_mul_f32 v129, v129, v32
    v_mfma_f32_16x16x32_bf16 a[96:99], a[160:163], v[244:247], a[96:99]
    v_mul_f32 v130, v130, v32
    v_mul_f32 v131, v131, v32
    v_mul_f32 v132, v132, v32
    v_mul_f32 v133, v133, v32
    v_mul_f32 v134, v134, v32
    v_mfma_f32_16x16x32_bf16 a[96:99], a[192:195], v[204:207], a[96:99]
    v_mul_f32 v135, v135, v32
    v_cvt_pk_bf16_f32 v88, v128, v129
    v_cvt_pk_bf16_f32 v89, v130, v131
    v_cvt_pk_bf16_f32 v90, v132, v133
    v_cvt_pk_bf16_f32 v91, v134, v135
    v_mfma_f32_16x16x32_bf16 a[100:103], a[196:199], v[204:207], a[100:103]
    buffer_store_dwordx4 v[88:91], v20, s[32:35], s43 offen offset:2048 sc1
    v_accvgpr_read_b32 v136, a88
    v_accvgpr_read_b32 v137, a89
    v_accvgpr_read_b32 v138, a90
    v_accvgpr_read_b32 v139, a91
    v_accvgpr_read_b32 v140, a92
    v_mfma_f32_16x16x32_bf16 a[100:103], a[164:167], v[244:247], a[100:103]
    v_accvgpr_read_b32 v141, a93
    v_accvgpr_read_b32 v142, a94
    v_accvgpr_read_b32 v143, a95
    v_mul_f32 v136, v136, v32
    v_mul_f32 v137, v137, v32
    v_mfma_f32_16x16x32_bf16 a[104:107], a[168:171], v[244:247], a[104:107]
    v_mul_f32 v138, v138, v32
    v_mul_f32 v139, v139, v32
    v_mul_f32 v140, v140, v32
    v_mul_f32 v141, v141, v32
    v_mul_f32 v142, v142, v32
    v_mfma_f32_16x16x32_bf16 a[104:107], a[200:203], v[204:207], a[104:107]
    v_mul_f32 v143, v143, v32
    v_cvt_pk_bf16_f32 v104, v136, v137
    v_cvt_pk_bf16_f32 v105, v138, v139
    v_cvt_pk_bf16_f32 v106, v140, v141
    v_cvt_pk_bf16_f32 v107, v142, v143
    v_mfma_f32_16x16x32_bf16 a[108:111], a[204:207], v[204:207], a[108:111]
    buffer_store_dwordx4 v[104:107], v20, s[32:35], s44 offen offset:2048 sc1
    v_accvgpr_read_b32 v144, a96
    v_accvgpr_read_b32 v145, a97
    v_accvgpr_read_b32 v146, a98
    v_accvgpr_read_b32 v147, a99
    v_accvgpr_read_b32 v148, a100
    v_mfma_f32_16x16x32_bf16 a[108:111], a[172:175], v[244:247], a[108:111]
    v_accvgpr_read_b32 v149, a101
    v_accvgpr_read_b32 v150, a102
    v_accvgpr_read_b32 v151, a103
    v_mul_f32 v144, v144, v34
    v_mul_f32 v145, v145, v34
    v_mfma_f32_16x16x32_bf16 a[112:115], a[176:179], v[244:247], a[112:115]
    v_mul_f32 v146, v146, v34
    v_mul_f32 v147, v147, v34
    v_mul_f32 v148, v148, v34
    v_mul_f32 v149, v149, v34
    v_mul_f32 v150, v150, v34
    v_mfma_f32_16x16x32_bf16 a[112:115], a[208:211], v[204:207], a[112:115]
    v_mul_f32 v151, v151, v34
    v_cvt_pk_bf16_f32 v60, v144, v145
    v_cvt_pk_bf16_f32 v61, v146, v147
    v_cvt_pk_bf16_f32 v62, v148, v149
    v_cvt_pk_bf16_f32 v63, v150, v151
    v_mfma_f32_16x16x32_bf16 a[116:119], a[212:215], v[204:207], a[116:119]
    buffer_store_dwordx4 v[60:63], v20, s[32:35], 0 offen offset:3072 sc1
    v_accvgpr_read_b32 v152, a104
    v_accvgpr_read_b32 v153, a105
    v_accvgpr_read_b32 v154, a106
    v_accvgpr_read_b32 v155, a107
    v_accvgpr_read_b32 v156, a108
    v_mfma_f32_16x16x32_bf16 a[116:119], a[180:183], v[244:247], a[116:119]
    v_accvgpr_read_b32 v157, a109
    v_accvgpr_read_b32 v158, a110
    v_accvgpr_read_b32 v159, a111
    v_mul_f32 v152, v152, v34
    v_mul_f32 v153, v153, v34
    v_mfma_f32_16x16x32_bf16 a[120:123], a[184:187], v[244:247], a[120:123]
    v_mul_f32 v154, v154, v34
    v_mul_f32 v155, v155, v34
    v_mul_f32 v156, v156, v34
    v_mul_f32 v157, v157, v34
    v_mul_f32 v158, v158, v34
    v_mfma_f32_16x16x32_bf16 a[120:123], a[216:219], v[204:207], a[120:123]
    v_mul_f32 v159, v159, v34
    v_cvt_pk_bf16_f32 v76, v152, v153
    v_cvt_pk_bf16_f32 v77, v154, v155
    v_cvt_pk_bf16_f32 v78, v156, v157
    v_cvt_pk_bf16_f32 v79, v158, v159
    v_mfma_f32_16x16x32_bf16 a[124:127], a[220:223], v[204:207], a[124:127]
    buffer_store_dwordx4 v[76:79], v20, s[32:35], s42 offen offset:3072 sc1
    v_accvgpr_read_b32 v160, a112
    v_accvgpr_read_b32 v161, a113
    v_accvgpr_read_b32 v162, a114
    v_accvgpr_read_b32 v163, a115
    v_accvgpr_read_b32 v164, a116
    v_mfma_f32_16x16x32_bf16 a[124:127], a[188:191], v[244:247], a[124:127]
    v_accvgpr_read_b32 v165, a117
    v_accvgpr_read_b32 v166, a118
    v_accvgpr_read_b32 v167, a119
    v_mul_f32 v160, v160, v34
    v_mul_f32 v161, v161, v34
    v_mul_f32 v162, v162, v34
    v_mul_f32 v163, v163, v34
    v_mul_f32 v164, v164, v34
    v_mul_f32 v165, v165, v34
    v_mul_f32 v166, v166, v34
    v_mul_f32 v167, v167, v34
    v_cvt_pk_bf16_f32 v92, v160, v161
    v_cvt_pk_bf16_f32 v93, v162, v163
    v_cvt_pk_bf16_f32 v94, v164, v165
    v_cvt_pk_bf16_f32 v95, v166, v167
    v_accvgpr_read_b32 v168, a120
    v_accvgpr_read_b32 v169, a121
    v_accvgpr_read_b32 v170, a122
    v_accvgpr_read_b32 v171, a123
    buffer_store_dwordx4 v[92:95], v20, s[32:35], s43 offen offset:3072 sc1
    v_accvgpr_read_b32 v172, a124
    v_accvgpr_read_b32 v173, a125
    v_accvgpr_read_b32 v174, a126
    v_accvgpr_read_b32 v175, a127
    v_mul_f32 v168, v168, v34
    v_mul_f32 v169, v169, v34
    v_mul_f32 v170, v170, v34
    v_mul_f32 v171, v171, v34
    v_mul_f32 v172, v172, v34
    v_mul_f32 v173, v173, v34
    v_mul_f32 v174, v174, v34
    v_mul_f32 v175, v175, v34
    v_cvt_pk_bf16_f32 v108, v168, v169
    v_cvt_pk_bf16_f32 v109, v170, v171
    v_cvt_pk_bf16_f32 v110, v172, v173
    v_cvt_pk_bf16_f32 v111, v174, v175
    buffer_store_dwordx4 v[108:111], v20, s[32:35], s44 offen offset:3072 sc1
    s_branch L_oback_main_kernel
L_rare_p1:
    s_call_b64 s[46:47], L_raresub1_main_kernel
    s_branch L_back_p1
L_rare_p2:
    s_call_b64 s[46:47], L_raresub2_main_kernel
    s_branch L_back_p2
L_rare_p3:
    s_call_b64 s[46:47], L_raresub3_main_kernel
    s_branch L_back_p3
L_rare_l0:
    s_call_b64 s[46:47], L_raresub0_main_kernel
    s_branch L_back_l0
L_rare_l1:
    s_call_b64 s[46:47], L_raresub1_main_kernel
    s_branch L_back_l1
L_rare_l2:
    s_call_b64 s[46:47], L_raresub2_main_kernel
    s_branch L_back_l2
L_rare_l3:
    s_call_b64 s[46:47], L_raresub3_main_kernel
    s_branch L_back_l3
L_rare_e0:
    s_call_b64 s[46:47], L_raresub0_main_kernel
    s_branch L_back_e0
L_rare_e1:
    s_call_b64 s[46:47], L_raresub1_main_kernel
    s_branch L_back_e1
L_rare_e2:
    s_call_b64 s[46:47], L_raresub2_main_kernel
    s_branch L_back_e2
L_rare_e3:
    s_call_b64 s[46:47], L_raresub3_main_kernel
    s_branch L_back_e3
L_raresub0_main_kernel:
    s_nop 15
    v_mov_b32 v28, 0
    v_mov_b32 v29, 0
    v_mov_b32 v30, 0
    v_mov_b32 v31, 0
    v_mov_b32 v32, 0
    v_mov_b32 v33, 0
    v_mov_b32 v34, 0
    v_mov_b32 v35, 0
    s_nop 1
    v_smfmac_f32_16x16x64_bf16 v[28:31], v[24:27], v[176:183], v250
    v_smfmac_f32_16x16x64_bf16 v[32:35], v[24:27], v[184:191], v250
    s_nop 15
    v_sub_f32 v224, v224, v28
    v_sub_f32 v225, v225, v29
    v_sub_f32 v226, v226, v30
    v_sub_f32 v227, v227, v31
    v_sub_f32 v228, v228, v32
    v_sub_f32 v229, v229, v33
    v_sub_f32 v230, v230, v34
    v_sub_f32 v231, v231, v35
    v_max3_f32 v38, v112, v113, v114
    v_max3_f32 v38, v38, v115, v116
    v_max3_f32 v38, v38, v117, v118
    v_max_f32 v38, v38, v119
    v_mov_b32 v39, v38
    s_nop 1
    v_permlane16_swap_b32 v38, v39
    s_nop 1
    v_max_f32 v38, v38, v39
    v_mov_b32 v39, v38
    s_nop 1
    v_permlane32_swap_b32 v38, v39
    s_nop 1
    v_max_f32 v38, v38, v39
    v_ceil_f32 v38, v38
    v_add_f32 v38, 0x42200000, v38
    v_max_f32 v38, 0, v38
    v_exp_f32 v40, -v38
    v_sub_f32 v208, v208, v38
    v_sub_f32 v209, v209, v38
    v_sub_f32 v210, v210, v38
    v_sub_f32 v211, v211, v38
    v_sub_f32 v112, v112, v38
    v_sub_f32 v144, v144, v38
    v_sub_f32 v113, v113, v38
    v_sub_f32 v145, v145, v38
    v_sub_f32 v114, v114, v38
    v_sub_f32 v146, v146, v38
    v_sub_f32 v115, v115, v38
    v_sub_f32 v147, v147, v38
    v_sub_f32 v116, v116, v38
    v_sub_f32 v148, v148, v38
    v_sub_f32 v117, v117, v38
    v_sub_f32 v149, v149, v38
    v_sub_f32 v118, v118, v38
    v_sub_f32 v150, v150, v38
    v_sub_f32 v119, v119, v38
    v_sub_f32 v151, v151, v38
    v_mul_f32 v224, v224, v40
    v_mul_f32 v225, v225, v40
    v_accvgpr_read_b32 v39, a0
    v_mul_f32 v39, v39, v40
    v_accvgpr_write_b32 a0, v39
    v_accvgpr_read_b32 v39, a1
    v_mul_f32 v39, v39, v40
    v_accvgpr_write_b32 a1, v39
    v_accvgpr_read_b32 v39, a2
    v_mul_f32 v39, v39, v40
    v_accvgpr_write_b32 a2, v39
    v_accvgpr_read_b32 v39, a3
    v_mul_f32 v39, v39, v40
    v_accvgpr_write_b32 a3, v39
    v_accvgpr_read_b32 v39, a4
    v_mul_f32 v39, v39, v40
    v_accvgpr_write_b32 a4, v39
    v_accvgpr_read_b32 v39, a5
    v_mul_f32 v39, v39, v40
    v_accvgpr_write_b32 a5, v39
    v_accvgpr_read_b32 v39, a6
    v_mul_f32 v39, v39, v40
    v_accvgpr_write_b32 a6, v39
    v_accvgpr_read_b32 v39, a7
    v_mul_f32 v39, v39, v40
    v_accvgpr_write_b32 a7, v39
    v_accvgpr_read_b32 v39, a8
    v_mul_f32 v39, v39, v40
    v_accvgpr_write_b32 a8, v39
    v_accvgpr_read_b32 v39, a9
    v_mul_f32 v39, v39, v40
    v_accvgpr_write_b32 a9, v39
    v_accvgpr_read_b32 v39, a10
    v_mul_f32 v39, v39, v40
    v_accvgpr_write_b32 a10, v39
    v_accvgpr_read_b32 v39, a11
    v_mul_f32 v39, v39, v40
    v_accvgpr_write_b32 a11, v39
    v_accvgpr_read_b32 v39, a12
    v_mul_f32 v39, v39, v40
    v_accvgpr_write_b32 a12, v39
    v_accvgpr_read_b32 v39, a13
    v_mul_f32 v39, v39, v40
    v_accvgpr_write_b32 a13, v39
    v_accvgpr_read_b32 v39, a14
    v_mul_f32 v39, v39, v40
    v_accvgpr_write_b32 a14, v39
    v_accvgpr_read_b32 v39, a15
    v_mul_f32 v39, v39, v40
    v_accvgpr_write_b32 a15, v39
    v_accvgpr_read_b32 v39, a16
    v_mul_f32 v39, v39, v40
    v_accvgpr_write_b32 a16, v39
    v_accvgpr_read_b32 v39, a17
    v_mul_f32 v39, v39, v40
    v_accvgpr_write_b32 a17, v39
    v_accvgpr_read_b32 v39, a18
    v_mul_f32 v39, v39, v40
    v_accvgpr_write_b32 a18, v39
    v_accvgpr_read_b32 v39, a19
    v_mul_f32 v39, v39, v40
    v_accvgpr_write_b32 a19, v39
    v_accvgpr_read_b32 v39, a20
    v_mul_f32 v39, v39, v40
    v_accvgpr_write_b32 a20, v39
    v_accvgpr_read_b32 v39, a21
    v_mul_f32 v39, v39, v40
    v_accvgpr_write_b32 a21, v39
    v_accvgpr_read_b32 v39, a22
    v_mul_f32 v39, v39, v40
    v_accvgpr_write_b32 a22, v39
    v_accvgpr_read_b32 v39, a23
    v_mul_f32 v39, v39, v40
    v_accvgpr_write_b32 a23, v39
    v_accvgpr_read_b32 v39, a24
    v_mul_f32 v39, v39, v40
    v_accvgpr_write_b32 a24, v39
    v_accvgpr_read_b32 v39, a25
    v_mul_f32 v39, v39, v40
    v_accvgpr_write_b32 a25, v39
    v_accvgpr_read_b32 v39, a26
    v_mul_f32 v39, v39, v40
    v_accvgpr_write_b32 a26, v39
    v_accvgpr_read_b32 v39, a27
    v_mul_f32 v39, v39, v40
    v_accvgpr_write_b32 a27, v39
    v_accvgpr_read_b32 v39, a28
    v_mul_f32 v39, v39, v40
    v_accvgpr_write_b32 a28, v39
    v_accvgpr_read_b32 v39, a29
    v_mul_f32 v39, v39, v40
    v_accvgpr_write_b32 a29, v39
    v_accvgpr_read_b32 v39, a30
    v_mul_f32 v39, v39, v40
    v_accvgpr_write_b32 a30, v39
    v_accvgpr_read_b32 v39, a31
    v_mul_f32 v39, v39, v40
    v_accvgpr_write_b32 a31, v39
    v_lshlrev_b32 v39, 16, v232
    v_and_b32 v232, 0xffff0000, v232
    v_mul_f32 v39, v39, v40
    v_mul_f32 v232, v232, v40
    v_perm_b32 v232, v232, v39, s3
    v_lshlrev_b32 v39, 16, v233
    v_and_b32 v233, 0xffff0000, v233
    v_mul_f32 v39, v39, v40
    v_mul_f32 v233, v233, v40
    v_perm_b32 v233, v233, v39, s3
    v_lshlrev_b32 v39, 16, v234
    v_and_b32 v234, 0xffff0000, v234
    v_mul_f32 v39, v39, v40
    v_mul_f32 v234, v234, v40
    v_perm_b32 v234, v234, v39, s3
    v_lshlrev_b32 v39, 16, v235
    v_and_b32 v235, 0xffff0000, v235
    v_mul_f32 v39, v39, v40
    v_mul_f32 v235, v235, v40
    v_perm_b32 v235, v235, v39, s3
    v_lshlrev_b32 v39, 16, v192
    v_and_b32 v192, 0xffff0000, v192
    v_mul_f32 v39, v39, v40
    v_mul_f32 v192, v192, v40
    v_perm_b32 v192, v192, v39, s3
    v_lshlrev_b32 v39, 16, v193
    v_and_b32 v193, 0xffff0000, v193
    v_mul_f32 v39, v39, v40
    v_mul_f32 v193, v193, v40
    v_perm_b32 v193, v193, v39, s3
    v_lshlrev_b32 v39, 16, v194
    v_and_b32 v194, 0xffff0000, v194
    v_mul_f32 v39, v39, v40
    v_mul_f32 v194, v194, v40
    v_perm_b32 v194, v194, v39, s3
    v_lshlrev_b32 v39, 16, v195
    v_and_b32 v195, 0xffff0000, v195
    v_mul_f32 v39, v39, v40
    v_mul_f32 v195, v195, v40
    v_perm_b32 v195, v195, v39, s3
    v_exp_f32 v28, v112 clamp
    v_exp_f32 v29, v113 clamp
    v_exp_f32 v30, v114 clamp
    v_exp_f32 v31, v115 clamp
    v_exp_f32 v32, v116 clamp
    v_exp_f32 v33, v117 clamp
    v_exp_f32 v34, v118 clamp
    v_exp_f32 v35, v119 clamp
    s_nop 0
    v_perm_b32 v176, v29, v28, s3
    v_perm_b32 v177, v31, v30, s3
    v_perm_b32 v178, v33, v32, s3
    v_perm_b32 v179, v35, v34, s3
    v_max3_f32 v38, v120, v121, v122
    v_max3_f32 v38, v38, v123, v124
    v_max3_f32 v38, v38, v125, v126
    v_max_f32 v38, v38, v127
    v_mov_b32 v39, v38
    s_nop 1
    v_permlane16_swap_b32 v38, v39
    s_nop 1
    v_max_f32 v38, v38, v39
    v_mov_b32 v39, v38
    s_nop 1
    v_permlane32_swap_b32 v38, v39
    s_nop 1
    v_max_f32 v38, v38, v39
    v_ceil_f32 v38, v38
    v_add_f32 v38, 0x42200000, v38
    v_max_f32 v38, 0, v38
    v_exp_f32 v40, -v38
    v_sub_f32 v212, v212, v38
    v_sub_f32 v213, v213, v38
    v_sub_f32 v214, v214, v38
    v_sub_f32 v215, v215, v38
    v_sub_f32 v120, v120, v38
    v_sub_f32 v152, v152, v38
    v_sub_f32 v121, v121, v38
    v_sub_f32 v153, v153, v38
    v_sub_f32 v122, v122, v38
    v_sub_f32 v154, v154, v38
    v_sub_f32 v123, v123, v38
    v_sub_f32 v155, v155, v38
    v_sub_f32 v124, v124, v38
    v_sub_f32 v156, v156, v38
    v_sub_f32 v125, v125, v38
    v_sub_f32 v157, v157, v38
    v_sub_f32 v126, v126, v38
    v_sub_f32 v158, v158, v38
    v_sub_f32 v127, v127, v38
    v_sub_f32 v159, v159, v38
    v_mul_f32 v226, v226, v40
    v_mul_f32 v227, v227, v40
    v_accvgpr_read_b32 v39, a32
    v_mul_f32 v39, v39, v40
    v_accvgpr_write_b32 a32, v39
    v_accvgpr_read_b32 v39, a33
    v_mul_f32 v39, v39, v40
    v_accvgpr_write_b32 a33, v39
    v_accvgpr_read_b32 v39, a34
    v_mul_f32 v39, v39, v40
    v_accvgpr_write_b32 a34, v39
    v_accvgpr_read_b32 v39, a35
    v_mul_f32 v39, v39, v40
    v_accvgpr_write_b32 a35, v39
    v_accvgpr_read_b32 v39, a36
    v_mul_f32 v39, v39, v40
    v_accvgpr_write_b32 a36, v39
    v_accvgpr_read_b32 v39, a37
    v_mul_f32 v39, v39, v40
    v_accvgpr_write_b32 a37, v39
    v_accvgpr_read_b32 v39, a38
    v_mul_f32 v39, v39, v40
    v_accvgpr_write_b32 a38, v39
    v_accvgpr_read_b32 v39, a39
    v_mul_f32 v39, v39, v40
    v_accvgpr_write_b32 a39, v39
    v_accvgpr_read_b32 v39, a40
    v_mul_f32 v39, v39, v40
    v_accvgpr_write_b32 a40, v39
    v_accvgpr_read_b32 v39, a41
    v_mul_f32 v39, v39, v40
    v_accvgpr_write_b32 a41, v39
    v_accvgpr_read_b32 v39, a42
    v_mul_f32 v39, v39, v40
    v_accvgpr_write_b32 a42, v39
    v_accvgpr_read_b32 v39, a43
    v_mul_f32 v39, v39, v40
    v_accvgpr_write_b32 a43, v39
    v_accvgpr_read_b32 v39, a44
    v_mul_f32 v39, v39, v40
    v_accvgpr_write_b32 a44, v39
    v_accvgpr_read_b32 v39, a45
    v_mul_f32 v39, v39, v40
    v_accvgpr_write_b32 a45, v39
    v_accvgpr_read_b32 v39, a46
    v_mul_f32 v39, v39, v40
    v_accvgpr_write_b32 a46, v39
    v_accvgpr_read_b32 v39, a47
    v_mul_f32 v39, v39, v40
    v_accvgpr_write_b32 a47, v39
    v_accvgpr_read_b32 v39, a48
    v_mul_f32 v39, v39, v40
    v_accvgpr_write_b32 a48, v39
    v_accvgpr_read_b32 v39, a49
    v_mul_f32 v39, v39, v40
    v_accvgpr_write_b32 a49, v39
    v_accvgpr_read_b32 v39, a50
    v_mul_f32 v39, v39, v40
    v_accvgpr_write_b32 a50, v39
    v_accvgpr_read_b32 v39, a51
    v_mul_f32 v39, v39, v40
    v_accvgpr_write_b32 a51, v39
    v_accvgpr_read_b32 v39, a52
    v_mul_f32 v39, v39, v40
    v_accvgpr_write_b32 a52, v39
    v_accvgpr_read_b32 v39, a53
    v_mul_f32 v39, v39, v40
    v_accvgpr_write_b32 a53, v39
    v_accvgpr_read_b32 v39, a54
    v_mul_f32 v39, v39, v40
    v_accvgpr_write_b32 a54, v39
    v_accvgpr_read_b32 v39, a55
    v_mul_f32 v39, v39, v40
    v_accvgpr_write_b32 a55, v39
    v_accvgpr_read_b32 v39, a56
    v_mul_f32 v39, v39, v40
    v_accvgpr_write_b32 a56, v39
    v_accvgpr_read_b32 v39, a57
    v_mul_f32 v39, v39, v40
    v_accvgpr_write_b32 a57, v39
    v_accvgpr_read_b32 v39, a58
    v_mul_f32 v39, v39, v40
    v_accvgpr_write_b32 a58, v39
    v_accvgpr_read_b32 v39, a59
    v_mul_f32 v39, v39, v40
    v_accvgpr_write_b32 a59, v39
    v_accvgpr_read_b32 v39, a60
    v_mul_f32 v39, v39, v40
    v_accvgpr_write_b32 a60, v39
    v_accvgpr_read_b32 v39, a61
    v_mul_f32 v39, v39, v40
    v_accvgpr_write_b32 a61, v39
    v_accvgpr_read_b32 v39, a62
    v_mul_f32 v39, v39, v40
    v_accvgpr_write_b32 a62, v39
    v_accvgpr_read_b32 v39, a63
    v_mul_f32 v39, v39, v40
    v_accvgpr_write_b32 a63, v39
    v_lshlrev_b32 v39, 16, v236
    v_and_b32 v236, 0xffff0000, v236
    v_mul_f32 v39, v39, v40
    v_mul_f32 v236, v236, v40
    v_perm_b32 v236, v236, v39, s3
    v_lshlrev_b32 v39, 16, v237
    v_and_b32 v237, 0xffff0000, v237
    v_mul_f32 v39, v39, v40
    v_mul_f32 v237, v237, v40
    v_perm_b32 v237, v237, v39, s3
    v_lshlrev_b32 v39, 16, v238
    v_and_b32 v238, 0xffff0000, v238
    v_mul_f32 v39, v39, v40
    v_mul_f32 v238, v238, v40
    v_perm_b32 v238, v238, v39, s3
    v_lshlrev_b32 v39, 16, v239
    v_and_b32 v239, 0xffff0000, v239
    v_mul_f32 v39, v39, v40
    v_mul_f32 v239, v239, v40
    v_perm_b32 v239, v239, v39, s3
    v_lshlrev_b32 v39, 16, v196
    v_and_b32 v196, 0xffff0000, v196
    v_mul_f32 v39, v39, v40
    v_mul_f32 v196, v196, v40
    v_perm_b32 v196, v196, v39, s3
    v_lshlrev_b32 v39, 16, v197
    v_and_b32 v197, 0xffff0000, v197
    v_mul_f32 v39, v39, v40
    v_mul_f32 v197, v197, v40
    v_perm_b32 v197, v197, v39, s3
    v_lshlrev_b32 v39, 16, v198
    v_and_b32 v198, 0xffff0000, v198
    v_mul_f32 v39, v39, v40
    v_mul_f32 v198, v198, v40
    v_perm_b32 v198, v198, v39, s3
    v_lshlrev_b32 v39, 16, v199
    v_and_b32 v199, 0xffff0000, v199
    v_mul_f32 v39, v39, v40
    v_mul_f32 v199, v199, v40
    v_perm_b32 v199, v199, v39, s3
    v_exp_f32 v28, v120 clamp
    v_exp_f32 v29, v121 clamp
    v_exp_f32 v30, v122 clamp
    v_exp_f32 v31, v123 clamp
    v_exp_f32 v32, v124 clamp
    v_exp_f32 v33, v125 clamp
    v_exp_f32 v34, v126 clamp
    v_exp_f32 v35, v127 clamp
    s_nop 0
    v_perm_b32 v180, v29, v28, s3
    v_perm_b32 v181, v31, v30, s3
    v_perm_b32 v182, v33, v32, s3
    v_perm_b32 v183, v35, v34, s3
    v_max3_f32 v38, v128, v129, v130
    v_max3_f32 v38, v38, v131, v132
    v_max3_f32 v38, v38, v133, v134
    v_max_f32 v38, v38, v135
    v_mov_b32 v39, v38
    s_nop 1
    v_permlane16_swap_b32 v38, v39
    s_nop 1
    v_max_f32 v38, v38, v39
    v_mov_b32 v39, v38
    s_nop 1
    v_permlane32_swap_b32 v38, v39
    s_nop 1
    v_max_f32 v38, v38, v39
    v_ceil_f32 v38, v38
    v_add_f32 v38, 0x42200000, v38
    v_max_f32 v38, 0, v38
    v_exp_f32 v40, -v38
    v_sub_f32 v216, v216, v38
    v_sub_f32 v217, v217, v38
    v_sub_f32 v218, v218, v38
    v_sub_f32 v219, v219, v38
    v_sub_f32 v128, v128, v38
    v_sub_f32 v160, v160, v38
    v_sub_f32 v129, v129, v38
    v_sub_f32 v161, v161, v38
    v_sub_f32 v130, v130, v38
    v_sub_f32 v162, v162, v38
    v_sub_f32 v131, v131, v38
    v_sub_f32 v163, v163, v38
    v_sub_f32 v132, v132, v38
    v_sub_f32 v164, v164, v38
    v_sub_f32 v133, v133, v38
    v_sub_f32 v165, v165, v38
    v_sub_f32 v134, v134, v38
    v_sub_f32 v166, v166, v38
    v_sub_f32 v135, v135, v38
    v_sub_f32 v167, v167, v38
    v_mul_f32 v228, v228, v40
    v_mul_f32 v229, v229, v40
    v_accvgpr_read_b32 v39, a64
    v_mul_f32 v39, v39, v40
    v_accvgpr_write_b32 a64, v39
    v_accvgpr_read_b32 v39, a65
    v_mul_f32 v39, v39, v40
    v_accvgpr_write_b32 a65, v39
    v_accvgpr_read_b32 v39, a66
    v_mul_f32 v39, v39, v40
    v_accvgpr_write_b32 a66, v39
    v_accvgpr_read_b32 v39, a67
    v_mul_f32 v39, v39, v40
    v_accvgpr_write_b32 a67, v39
    v_accvgpr_read_b32 v39, a68
    v_mul_f32 v39, v39, v40
    v_accvgpr_write_b32 a68, v39
    v_accvgpr_read_b32 v39, a69
    v_mul_f32 v39, v39, v40
    v_accvgpr_write_b32 a69, v39
    v_accvgpr_read_b32 v39, a70
    v_mul_f32 v39, v39, v40
    v_accvgpr_write_b32 a70, v39
    v_accvgpr_read_b32 v39, a71
    v_mul_f32 v39, v39, v40
    v_accvgpr_write_b32 a71, v39
    v_accvgpr_read_b32 v39, a72
    v_mul_f32 v39, v39, v40
    v_accvgpr_write_b32 a72, v39
    v_accvgpr_read_b32 v39, a73
    v_mul_f32 v39, v39, v40
    v_accvgpr_write_b32 a73, v39
    v_accvgpr_read_b32 v39, a74
    v_mul_f32 v39, v39, v40
    v_accvgpr_write_b32 a74, v39
    v_accvgpr_read_b32 v39, a75
    v_mul_f32 v39, v39, v40
    v_accvgpr_write_b32 a75, v39
    v_accvgpr_read_b32 v39, a76
    v_mul_f32 v39, v39, v40
    v_accvgpr_write_b32 a76, v39
    v_accvgpr_read_b32 v39, a77
    v_mul_f32 v39, v39, v40
    v_accvgpr_write_b32 a77, v39
    v_accvgpr_read_b32 v39, a78
    v_mul_f32 v39, v39, v40
    v_accvgpr_write_b32 a78, v39
    v_accvgpr_read_b32 v39, a79
    v_mul_f32 v39, v39, v40
    v_accvgpr_write_b32 a79, v39
    v_accvgpr_read_b32 v39, a80
    v_mul_f32 v39, v39, v40
    v_accvgpr_write_b32 a80, v39
    v_accvgpr_read_b32 v39, a81
    v_mul_f32 v39, v39, v40
    v_accvgpr_write_b32 a81, v39
    v_accvgpr_read_b32 v39, a82
    v_mul_f32 v39, v39, v40
    v_accvgpr_write_b32 a82, v39
    v_accvgpr_read_b32 v39, a83
    v_mul_f32 v39, v39, v40
    v_accvgpr_write_b32 a83, v39
    v_accvgpr_read_b32 v39, a84
    v_mul_f32 v39, v39, v40
    v_accvgpr_write_b32 a84, v39
    v_accvgpr_read_b32 v39, a85
    v_mul_f32 v39, v39, v40
    v_accvgpr_write_b32 a85, v39
    v_accvgpr_read_b32 v39, a86
    v_mul_f32 v39, v39, v40
    v_accvgpr_write_b32 a86, v39
    v_accvgpr_read_b32 v39, a87
    v_mul_f32 v39, v39, v40
    v_accvgpr_write_b32 a87, v39
    v_accvgpr_read_b32 v39, a88
    v_mul_f32 v39, v39, v40
    v_accvgpr_write_b32 a88, v39
    v_accvgpr_read_b32 v39, a89
    v_mul_f32 v39, v39, v40
    v_accvgpr_write_b32 a89, v39
    v_accvgpr_read_b32 v39, a90
    v_mul_f32 v39, v39, v40
    v_accvgpr_write_b32 a90, v39
    v_accvgpr_read_b32 v39, a91
    v_mul_f32 v39, v39, v40
    v_accvgpr_write_b32 a91, v39
    v_accvgpr_read_b32 v39, a92
    v_mul_f32 v39, v39, v40
    v_accvgpr_write_b32 a92, v39
    v_accvgpr_read_b32 v39, a93
    v_mul_f32 v39, v39, v40
    v_accvgpr_write_b32 a93, v39
    v_accvgpr_read_b32 v39, a94
    v_mul_f32 v39, v39, v40
    v_accvgpr_write_b32 a94, v39
    v_accvgpr_read_b32 v39, a95
    v_mul_f32 v39, v39, v40
    v_accvgpr_write_b32 a95, v39
    v_lshlrev_b32 v39, 16, v240
    v_and_b32 v240, 0xffff0000, v240
    v_mul_f32 v39, v39, v40
    v_mul_f32 v240, v240, v40
    v_perm_b32 v240, v240, v39, s3
    v_lshlrev_b32 v39, 16, v241
    v_and_b32 v241, 0xffff0000, v241
    v_mul_f32 v39, v39, v40
    v_mul_f32 v241, v241, v40
    v_perm_b32 v241, v241, v39, s3
    v_lshlrev_b32 v39, 16, v242
    v_and_b32 v242, 0xffff0000, v242
    v_mul_f32 v39, v39, v40
    v_mul_f32 v242, v242, v40
    v_perm_b32 v242, v242, v39, s3
    v_lshlrev_b32 v39, 16, v243
    v_and_b32 v243, 0xffff0000, v243
    v_mul_f32 v39, v39, v40
    v_mul_f32 v243, v243, v40
    v_perm_b32 v243, v243, v39, s3
    v_lshlrev_b32 v39, 16, v200
    v_and_b32 v200, 0xffff0000, v200
    v_mul_f32 v39, v39, v40
    v_mul_f32 v200, v200, v40
    v_perm_b32 v200, v200, v39, s3
    v_lshlrev_b32 v39, 16, v201
    v_and_b32 v201, 0xffff0000, v201
    v_mul_f32 v39, v39, v40
    v_mul_f32 v201, v201, v40
    v_perm_b32 v201, v201, v39, s3
    v_lshlrev_b32 v39, 16, v202
    v_and_b32 v202, 0xffff0000, v202
    v_mul_f32 v39, v39, v40
    v_mul_f32 v202, v202, v40
    v_perm_b32 v202, v202, v39, s3
    v_lshlrev_b32 v39, 16, v203
    v_and_b32 v203, 0xffff0000, v203
    v_mul_f32 v39, v39, v40
    v_mul_f32 v203, v203, v40
    v_perm_b32 v203, v203, v39, s3
    v_exp_f32 v28, v128 clamp
    v_exp_f32 v29, v129 clamp
    v_exp_f32 v30, v130 clamp
    v_exp_f32 v31, v131 clamp
    v_exp_f32 v32, v132 clamp
    v_exp_f32 v33, v133 clamp
    v_exp_f32 v34, v134 clamp
    v_exp_f32 v35, v135 clamp
    s_nop 0
    v_perm_b32 v184, v29, v28, s3
    v_perm_b32 v185, v31, v30, s3
    v_perm_b32 v186, v33, v32, s3
    v_perm_b32 v187, v35, v34, s3
    v_max3_f32 v38, v136, v137, v138
    v_max3_f32 v38, v38, v139, v140
    v_max3_f32 v38, v38, v141, v142
    v_max_f32 v38, v38, v143
    v_mov_b32 v39, v38
    s_nop 1
    v_permlane16_swap_b32 v38, v39
    s_nop 1
    v_max_f32 v38, v38, v39
    v_mov_b32 v39, v38
    s_nop 1
    v_permlane32_swap_b32 v38, v39
    s_nop 1
    v_max_f32 v38, v38, v39
    v_ceil_f32 v38, v38
    v_add_f32 v38, 0x42200000, v38
    v_max_f32 v38, 0, v38
    v_exp_f32 v40, -v38
    v_sub_f32 v220, v220, v38
    v_sub_f32 v221, v221, v38
    v_sub_f32 v222, v222, v38
    v_sub_f32 v223, v223, v38
    v_sub_f32 v136, v136, v38
    v_sub_f32 v168, v168, v38
    v_sub_f32 v137, v137, v38
    v_sub_f32 v169, v169, v38
    v_sub_f32 v138, v138, v38
    v_sub_f32 v170, v170, v38
    v_sub_f32 v139, v139, v38
    v_sub_f32 v171, v171, v38
    v_sub_f32 v140, v140, v38
    v_sub_f32 v172, v172, v38
    v_sub_f32 v141, v141, v38
    v_sub_f32 v173, v173, v38
    v_sub_f32 v142, v142, v38
    v_sub_f32 v174, v174, v38
    v_sub_f32 v143, v143, v38
    v_sub_f32 v175, v175, v38
    v_mul_f32 v230, v230, v40
    v_mul_f32 v231, v231, v40
    v_accvgpr_read_b32 v39, a96
    v_mul_f32 v39, v39, v40
    v_accvgpr_write_b32 a96, v39
    v_accvgpr_read_b32 v39, a97
    v_mul_f32 v39, v39, v40
    v_accvgpr_write_b32 a97, v39
    v_accvgpr_read_b32 v39, a98
    v_mul_f32 v39, v39, v40
    v_accvgpr_write_b32 a98, v39
    v_accvgpr_read_b32 v39, a99
    v_mul_f32 v39, v39, v40
    v_accvgpr_write_b32 a99, v39
    v_accvgpr_read_b32 v39, a100
    v_mul_f32 v39, v39, v40
    v_accvgpr_write_b32 a100, v39
    v_accvgpr_read_b32 v39, a101
    v_mul_f32 v39, v39, v40
    v_accvgpr_write_b32 a101, v39
    v_accvgpr_read_b32 v39, a102
    v_mul_f32 v39, v39, v40
    v_accvgpr_write_b32 a102, v39
    v_accvgpr_read_b32 v39, a103
    v_mul_f32 v39, v39, v40
    v_accvgpr_write_b32 a103, v39
    v_accvgpr_read_b32 v39, a104
    v_mul_f32 v39, v39, v40
    v_accvgpr_write_b32 a104, v39
    v_accvgpr_read_b32 v39, a105
    v_mul_f32 v39, v39, v40
    v_accvgpr_write_b32 a105, v39
    v_accvgpr_read_b32 v39, a106
    v_mul_f32 v39, v39, v40
    v_accvgpr_write_b32 a106, v39
    v_accvgpr_read_b32 v39, a107
    v_mul_f32 v39, v39, v40
    v_accvgpr_write_b32 a107, v39
    v_accvgpr_read_b32 v39, a108
    v_mul_f32 v39, v39, v40
    v_accvgpr_write_b32 a108, v39
    v_accvgpr_read_b32 v39, a109
    v_mul_f32 v39, v39, v40
    v_accvgpr_write_b32 a109, v39
    v_accvgpr_read_b32 v39, a110
    v_mul_f32 v39, v39, v40
    v_accvgpr_write_b32 a110, v39
    v_accvgpr_read_b32 v39, a111
    v_mul_f32 v39, v39, v40
    v_accvgpr_write_b32 a111, v39
    v_accvgpr_read_b32 v39, a112
    v_mul_f32 v39, v39, v40
    v_accvgpr_write_b32 a112, v39
    v_accvgpr_read_b32 v39, a113
    v_mul_f32 v39, v39, v40
    v_accvgpr_write_b32 a113, v39
    v_accvgpr_read_b32 v39, a114
    v_mul_f32 v39, v39, v40
    v_accvgpr_write_b32 a114, v39
    v_accvgpr_read_b32 v39, a115
    v_mul_f32 v39, v39, v40
    v_accvgpr_write_b32 a115, v39
    v_accvgpr_read_b32 v39, a116
    v_mul_f32 v39, v39, v40
    v_accvgpr_write_b32 a116, v39
    v_accvgpr_read_b32 v39, a117
    v_mul_f32 v39, v39, v40
    v_accvgpr_write_b32 a117, v39
    v_accvgpr_read_b32 v39, a118
    v_mul_f32 v39, v39, v40
    v_accvgpr_write_b32 a118, v39
    v_accvgpr_read_b32 v39, a119
    v_mul_f32 v39, v39, v40
    v_accvgpr_write_b32 a119, v39
    v_accvgpr_read_b32 v39, a120
    v_mul_f32 v39, v39, v40
    v_accvgpr_write_b32 a120, v39
    v_accvgpr_read_b32 v39, a121
    v_mul_f32 v39, v39, v40
    v_accvgpr_write_b32 a121, v39
    v_accvgpr_read_b32 v39, a122
    v_mul_f32 v39, v39, v40
    v_accvgpr_write_b32 a122, v39
    v_accvgpr_read_b32 v39, a123
    v_mul_f32 v39, v39, v40
    v_accvgpr_write_b32 a123, v39
    v_accvgpr_read_b32 v39, a124
    v_mul_f32 v39, v39, v40
    v_accvgpr_write_b32 a124, v39
    v_accvgpr_read_b32 v39, a125
    v_mul_f32 v39, v39, v40
    v_accvgpr_write_b32 a125, v39
    v_accvgpr_read_b32 v39, a126
    v_mul_f32 v39, v39, v40
    v_accvgpr_write_b32 a126, v39
    v_accvgpr_read_b32 v39, a127
    v_mul_f32 v39, v39, v40
    v_accvgpr_write_b32 a127, v39
    v_lshlrev_b32 v39, 16, v244
    v_and_b32 v244, 0xffff0000, v244
    v_mul_f32 v39, v39, v40
    v_mul_f32 v244, v244, v40
    v_perm_b32 v244, v244, v39, s3
    v_lshlrev_b32 v39, 16, v245
    v_and_b32 v245, 0xffff0000, v245
    v_mul_f32 v39, v39, v40
    v_mul_f32 v245, v245, v40
    v_perm_b32 v245, v245, v39, s3
    v_lshlrev_b32 v39, 16, v246
    v_and_b32 v246, 0xffff0000, v246
    v_mul_f32 v39, v39, v40
    v_mul_f32 v246, v246, v40
    v_perm_b32 v246, v246, v39, s3
    v_lshlrev_b32 v39, 16, v247
    v_and_b32 v247, 0xffff0000, v247
    v_mul_f32 v39, v39, v40
    v_mul_f32 v247, v247, v40
    v_perm_b32 v247, v247, v39, s3
    v_lshlrev_b32 v39, 16, v204
    v_and_b32 v204, 0xffff0000, v204
    v_mul_f32 v39, v39, v40
    v_mul_f32 v204, v204, v40
    v_perm_b32 v204, v204, v39, s3
    v_lshlrev_b32 v39, 16, v205
    v_and_b32 v205, 0xffff0000, v205
    v_mul_f32 v39, v39, v40
    v_mul_f32 v205, v205, v40
    v_perm_b32 v205, v205, v39, s3
    v_lshlrev_b32 v39, 16, v206
    v_and_b32 v206, 0xffff0000, v206
    v_mul_f32 v39, v39, v40
    v_mul_f32 v206, v206, v40
    v_perm_b32 v206, v206, v39, s3
    v_lshlrev_b32 v39, 16, v207
    v_and_b32 v207, 0xffff0000, v207
    v_mul_f32 v39, v39, v40
    v_mul_f32 v207, v207, v40
    v_perm_b32 v207, v207, v39, s3
    v_exp_f32 v28, v136 clamp
    v_exp_f32 v29, v137 clamp
    v_exp_f32 v30, v138 clamp
    v_exp_f32 v31, v139 clamp
    v_exp_f32 v32, v140 clamp
    v_exp_f32 v33, v141 clamp
    v_exp_f32 v34, v142 clamp
    v_exp_f32 v35, v143 clamp
    s_nop 0
    v_perm_b32 v188, v29, v28, s3
    v_perm_b32 v189, v31, v30, s3
    v_perm_b32 v190, v33, v32, s3
    v_perm_b32 v191, v35, v34, s3
    s_nop 1
    v_smfmac_f32_16x16x64_bf16 v[224:227], v[24:27], v[176:183], v250
    v_smfmac_f32_16x16x64_bf16 v[228:231], v[24:27], v[184:191], v250
    s_nop 15
    s_setpc_b64 s[46:47]
L_raresub1_main_kernel:
    s_nop 15
    v_mov_b32 v28, 0
    v_mov_b32 v29, 0
    v_mov_b32 v30, 0
    v_mov_b32 v31, 0
    v_mov_b32 v32, 0
    v_mov_b32 v33, 0
    v_mov_b32 v34, 0
    v_mov_b32 v35, 0
    s_nop 1
    v_smfmac_f32_16x16x64_bf16 v[28:31], v[24:27], v[192:199], v250
    v_smfmac_f32_16x16x64_bf16 v[32:35], v[24:27], v[200:207], v250
    s_nop 15
    v_sub_f32 v224, v224, v28
    v_sub_f32 v225, v225, v29
    v_sub_f32 v226, v226, v30
    v_sub_f32 v227, v227, v31
    v_sub_f32 v228, v228, v32
    v_sub_f32 v229, v229, v33
    v_sub_f32 v230, v230, v34
    v_sub_f32 v231, v231, v35
    v_max3_f32 v38, v144, v145, v146
    v_max3_f32 v38, v38, v147, v148
    v_max3_f32 v38, v38, v149, v150
    v_max_f32 v38, v38, v151
    v_mov_b32 v39, v38
    s_nop 1
    v_permlane16_swap_b32 v38, v39
    s_nop 1
    v_max_f32 v38, v38, v39
    v_mov_b32 v39, v38
    s_nop 1
    v_permlane32_swap_b32 v38, v39
    s_nop 1
    v_max_f32 v38, v38, v39
    v_ceil_f32 v38, v38
    v_add_f32 v38, 0x42200000, v38
    v_max_f32 v38, 0, v38
    v_exp_f32 v40, -v38
    v_sub_f32 v208, v208, v38
    v_sub_f32 v209, v209, v38
    v_sub_f32 v210, v210, v38
    v_sub_f32 v211, v211, v38
    v_sub_f32 v144, v144, v38
    v_sub_f32 v112, v112, v38
    v_sub_f32 v145, v145, v38
    v_sub_f32 v113, v113, v38
    v_sub_f32 v146, v146, v38
    v_sub_f32 v114, v114, v38
    v_sub_f32 v147, v147, v38
    v_sub_f32 v115, v115, v38
    v_sub_f32 v148, v148, v38
    v_sub_f32 v116, v116, v38
    v_sub_f32 v149, v149, v38
    v_sub_f32 v117, v117, v38
    v_sub_f32 v150, v150, v38
    v_sub_f32 v118, v118, v38
    v_sub_f32 v151, v151, v38
    v_sub_f32 v119, v119, v38
    v_mul_f32 v224, v224, v40
    v_mul_f32 v225, v225, v40
    v_accvgpr_read_b32 v39, a0
    v_mul_f32 v39, v39, v40
    v_accvgpr_write_b32 a0, v39
    v_accvgpr_read_b32 v39, a1
    v_mul_f32 v39, v39, v40
    v_accvgpr_write_b32 a1, v39
    v_accvgpr_read_b32 v39, a2
    v_mul_f32 v39, v39, v40
    v_accvgpr_write_b32 a2, v39
    v_accvgpr_read_b32 v39, a3
    v_mul_f32 v39, v39, v40
    v_accvgpr_write_b32 a3, v39
    v_accvgpr_read_b32 v39, a4
    v_mul_f32 v39, v39, v40
    v_accvgpr_write_b32 a4, v39
    v_accvgpr_read_b32 v39, a5
    v_mul_f32 v39, v39, v40
    v_accvgpr_write_b32 a5, v39
    v_accvgpr_read_b32 v39, a6
    v_mul_f32 v39, v39, v40
    v_accvgpr_write_b32 a6, v39
    v_accvgpr_read_b32 v39, a7
    v_mul_f32 v39, v39, v40
    v_accvgpr_write_b32 a7, v39
    v_accvgpr_read_b32 v39, a8
    v_mul_f32 v39, v39, v40
    v_accvgpr_write_b32 a8, v39
    v_accvgpr_read_b32 v39, a9
    v_mul_f32 v39, v39, v40
    v_accvgpr_write_b32 a9, v39
    v_accvgpr_read_b32 v39, a10
    v_mul_f32 v39, v39, v40
    v_accvgpr_write_b32 a10, v39
    v_accvgpr_read_b32 v39, a11
    v_mul_f32 v39, v39, v40
    v_accvgpr_write_b32 a11, v39
    v_accvgpr_read_b32 v39, a12
    v_mul_f32 v39, v39, v40
    v_accvgpr_write_b32 a12, v39
    v_accvgpr_read_b32 v39, a13
    v_mul_f32 v39, v39, v40
    v_accvgpr_write_b32 a13, v39
    v_accvgpr_read_b32 v39, a14
    v_mul_f32 v39, v39, v40
    v_accvgpr_write_b32 a14, v39
    v_accvgpr_read_b32 v39, a15
    v_mul_f32 v39, v39, v40
    v_accvgpr_write_b32 a15, v39
    v_accvgpr_read_b32 v39, a16
    v_mul_f32 v39, v39, v40
    v_accvgpr_write_b32 a16, v39
    v_accvgpr_read_b32 v39, a17
    v_mul_f32 v39, v39, v40
    v_accvgpr_write_b32 a17, v39
    v_accvgpr_read_b32 v39, a18
    v_mul_f32 v39, v39, v40
    v_accvgpr_write_b32 a18, v39
    v_accvgpr_read_b32 v39, a19
    v_mul_f32 v39, v39, v40
    v_accvgpr_write_b32 a19, v39
    v_accvgpr_read_b32 v39, a20
    v_mul_f32 v39, v39, v40
    v_accvgpr_write_b32 a20, v39
    v_accvgpr_read_b32 v39, a21
    v_mul_f32 v39, v39, v40
    v_accvgpr_write_b32 a21, v39
    v_accvgpr_read_b32 v39, a22
    v_mul_f32 v39, v39, v40
    v_accvgpr_write_b32 a22, v39
    v_accvgpr_read_b32 v39, a23
    v_mul_f32 v39, v39, v40
    v_accvgpr_write_b32 a23, v39
    v_accvgpr_read_b32 v39, a24
    v_mul_f32 v39, v39, v40
    v_accvgpr_write_b32 a24, v39
    v_accvgpr_read_b32 v39, a25
    v_mul_f32 v39, v39, v40
    v_accvgpr_write_b32 a25, v39
    v_accvgpr_read_b32 v39, a26
    v_mul_f32 v39, v39, v40
    v_accvgpr_write_b32 a26, v39
    v_accvgpr_read_b32 v39, a27
    v_mul_f32 v39, v39, v40
    v_accvgpr_write_b32 a27, v39
    v_accvgpr_read_b32 v39, a28
    v_mul_f32 v39, v39, v40
    v_accvgpr_write_b32 a28, v39
    v_accvgpr_read_b32 v39, a29
    v_mul_f32 v39, v39, v40
    v_accvgpr_write_b32 a29, v39
    v_accvgpr_read_b32 v39, a30
    v_mul_f32 v39, v39, v40
    v_accvgpr_write_b32 a30, v39
    v_accvgpr_read_b32 v39, a31
    v_mul_f32 v39, v39, v40
    v_accvgpr_write_b32 a31, v39
    v_lshlrev_b32 v39, 16, v176
    v_and_b32 v176, 0xffff0000, v176
    v_mul_f32 v39, v39, v40
    v_mul_f32 v176, v176, v40
    v_perm_b32 v176, v176, v39, s3
    v_lshlrev_b32 v39, 16, v177
    v_and_b32 v177, 0xffff0000, v177
    v_mul_f32 v39, v39, v40
    v_mul_f32 v177, v177, v40
    v_perm_b32 v177, v177, v39, s3
    v_lshlrev_b32 v39, 16, v178
    v_and_b32 v178, 0xffff0000, v178
    v_mul_f32 v39, v39, v40
    v_mul_f32 v178, v178, v40
    v_perm_b32 v178, v178, v39, s3
    v_lshlrev_b32 v39, 16, v179
    v_and_b32 v179, 0xffff0000, v179
    v_mul_f32 v39, v39, v40
    v_mul_f32 v179, v179, v40
    v_perm_b32 v179, v179, v39, s3
    v_exp_f32 v28, v144 clamp
    v_exp_f32 v29, v145 clamp
    v_exp_f32 v30, v146 clamp
    v_exp_f32 v31, v147 clamp
    v_exp_f32 v32, v148 clamp
    v_exp_f32 v33, v149 clamp
    v_exp_f32 v34, v150 clamp
    v_exp_f32 v35, v151 clamp
    s_nop 0
    v_perm_b32 v192, v29, v28, s3
    v_perm_b32 v193, v31, v30, s3
    v_perm_b32 v194, v33, v32, s3
    v_perm_b32 v195, v35, v34, s3
    v_max3_f32 v38, v152, v153, v154
    v_max3_f32 v38, v38, v155, v156
    v_max3_f32 v38, v38, v157, v158
    v_max_f32 v38, v38, v159
    v_mov_b32 v39, v38
    s_nop 1
    v_permlane16_swap_b32 v38, v39
    s_nop 1
    v_max_f32 v38, v38, v39
    v_mov_b32 v39, v38
    s_nop 1
    v_permlane32_swap_b32 v38, v39
    s_nop 1
    v_max_f32 v38, v38, v39
    v_ceil_f32 v38, v38
    v_add_f32 v38, 0x42200000, v38
    v_max_f32 v38, 0, v38
    v_exp_f32 v40, -v38
    v_sub_f32 v212, v212, v38
    v_sub_f32 v213, v213, v38
    v_sub_f32 v214, v214, v38
    v_sub_f32 v215, v215, v38
    v_sub_f32 v152, v152, v38
    v_sub_f32 v120, v120, v38
    v_sub_f32 v153, v153, v38
    v_sub_f32 v121, v121, v38
    v_sub_f32 v154, v154, v38
    v_sub_f32 v122, v122, v38
    v_sub_f32 v155, v155, v38
    v_sub_f32 v123, v123, v38
    v_sub_f32 v156, v156, v38
    v_sub_f32 v124, v124, v38
    v_sub_f32 v157, v157, v38
    v_sub_f32 v125, v125, v38
    v_sub_f32 v158, v158, v38
    v_sub_f32 v126, v126, v38
    v_sub_f32 v159, v159, v38
    v_sub_f32 v127, v127, v38
    v_mul_f32 v226, v226, v40
    v_mul_f32 v227, v227, v40
    v_accvgpr_read_b32 v39, a32
    v_mul_f32 v39, v39, v40
    v_accvgpr_write_b32 a32, v39
    v_accvgpr_read_b32 v39, a33
    v_mul_f32 v39, v39, v40
    v_accvgpr_write_b32 a33, v39
    v_accvgpr_read_b32 v39, a34
    v_mul_f32 v39, v39, v40
    v_accvgpr_write_b32 a34, v39
    v_accvgpr_read_b32 v39, a35
    v_mul_f32 v39, v39, v40
    v_accvgpr_write_b32 a35, v39
    v_accvgpr_read_b32 v39, a36
    v_mul_f32 v39, v39, v40
    v_accvgpr_write_b32 a36, v39
    v_accvgpr_read_b32 v39, a37
    v_mul_f32 v39, v39, v40
    v_accvgpr_write_b32 a37, v39
    v_accvgpr_read_b32 v39, a38
    v_mul_f32 v39, v39, v40
    v_accvgpr_write_b32 a38, v39
    v_accvgpr_read_b32 v39, a39
    v_mul_f32 v39, v39, v40
    v_accvgpr_write_b32 a39, v39
    v_accvgpr_read_b32 v39, a40
    v_mul_f32 v39, v39, v40
    v_accvgpr_write_b32 a40, v39
    v_accvgpr_read_b32 v39, a41
    v_mul_f32 v39, v39, v40
    v_accvgpr_write_b32 a41, v39
    v_accvgpr_read_b32 v39, a42
    v_mul_f32 v39, v39, v40
    v_accvgpr_write_b32 a42, v39
    v_accvgpr_read_b32 v39, a43
    v_mul_f32 v39, v39, v40
    v_accvgpr_write_b32 a43, v39
    v_accvgpr_read_b32 v39, a44
    v_mul_f32 v39, v39, v40
    v_accvgpr_write_b32 a44, v39
    v_accvgpr_read_b32 v39, a45
    v_mul_f32 v39, v39, v40
    v_accvgpr_write_b32 a45, v39
    v_accvgpr_read_b32 v39, a46
    v_mul_f32 v39, v39, v40
    v_accvgpr_write_b32 a46, v39
    v_accvgpr_read_b32 v39, a47
    v_mul_f32 v39, v39, v40
    v_accvgpr_write_b32 a47, v39
    v_accvgpr_read_b32 v39, a48
    v_mul_f32 v39, v39, v40
    v_accvgpr_write_b32 a48, v39
    v_accvgpr_read_b32 v39, a49
    v_mul_f32 v39, v39, v40
    v_accvgpr_write_b32 a49, v39
    v_accvgpr_read_b32 v39, a50
    v_mul_f32 v39, v39, v40
    v_accvgpr_write_b32 a50, v39
    v_accvgpr_read_b32 v39, a51
    v_mul_f32 v39, v39, v40
    v_accvgpr_write_b32 a51, v39
    v_accvgpr_read_b32 v39, a52
    v_mul_f32 v39, v39, v40
    v_accvgpr_write_b32 a52, v39
    v_accvgpr_read_b32 v39, a53
    v_mul_f32 v39, v39, v40
    v_accvgpr_write_b32 a53, v39
    v_accvgpr_read_b32 v39, a54
    v_mul_f32 v39, v39, v40
    v_accvgpr_write_b32 a54, v39
    v_accvgpr_read_b32 v39, a55
    v_mul_f32 v39, v39, v40
    v_accvgpr_write_b32 a55, v39
    v_accvgpr_read_b32 v39, a56
    v_mul_f32 v39, v39, v40
    v_accvgpr_write_b32 a56, v39
    v_accvgpr_read_b32 v39, a57
    v_mul_f32 v39, v39, v40
    v_accvgpr_write_b32 a57, v39
    v_accvgpr_read_b32 v39, a58
    v_mul_f32 v39, v39, v40
    v_accvgpr_write_b32 a58, v39
    v_accvgpr_read_b32 v39, a59
    v_mul_f32 v39, v39, v40
    v_accvgpr_write_b32 a59, v39
    v_accvgpr_read_b32 v39, a60
    v_mul_f32 v39, v39, v40
    v_accvgpr_write_b32 a60, v39
    v_accvgpr_read_b32 v39, a61
    v_mul_f32 v39, v39, v40
    v_accvgpr_write_b32 a61, v39
    v_accvgpr_read_b32 v39, a62
    v_mul_f32 v39, v39, v40
    v_accvgpr_write_b32 a62, v39
    v_accvgpr_read_b32 v39, a63
    v_mul_f32 v39, v39, v40
    v_accvgpr_write_b32 a63, v39
    v_lshlrev_b32 v39, 16, v180
    v_and_b32 v180, 0xffff0000, v180
    v_mul_f32 v39, v39, v40
    v_mul_f32 v180, v180, v40
    v_perm_b32 v180, v180, v39, s3
    v_lshlrev_b32 v39, 16, v181
    v_and_b32 v181, 0xffff0000, v181
    v_mul_f32 v39, v39, v40
    v_mul_f32 v181, v181, v40
    v_perm_b32 v181, v181, v39, s3
    v_lshlrev_b32 v39, 16, v182
    v_and_b32 v182, 0xffff0000, v182
    v_mul_f32 v39, v39, v40
    v_mul_f32 v182, v182, v40
    v_perm_b32 v182, v182, v39, s3
    v_lshlrev_b32 v39, 16, v183
    v_and_b32 v183, 0xffff0000, v183
    v_mul_f32 v39, v39, v40
    v_mul_f32 v183, v183, v40
    v_perm_b32 v183, v183, v39, s3
    v_exp_f32 v28, v152 clamp
    v_exp_f32 v29, v153 clamp
    v_exp_f32 v30, v154 clamp
    v_exp_f32 v31, v155 clamp
    v_exp_f32 v32, v156 clamp
    v_exp_f32 v33, v157 clamp
    v_exp_f32 v34, v158 clamp
    v_exp_f32 v35, v159 clamp
    s_nop 0
    v_perm_b32 v196, v29, v28, s3
    v_perm_b32 v197, v31, v30, s3
    v_perm_b32 v198, v33, v32, s3
    v_perm_b32 v199, v35, v34, s3
    v_max3_f32 v38, v160, v161, v162
    v_max3_f32 v38, v38, v163, v164
    v_max3_f32 v38, v38, v165, v166
    v_max_f32 v38, v38, v167
    v_mov_b32 v39, v38
    s_nop 1
    v_permlane16_swap_b32 v38, v39
    s_nop 1
    v_max_f32 v38, v38, v39
    v_mov_b32 v39, v38
    s_nop 1
    v_permlane32_swap_b32 v38, v39
    s_nop 1
    v_max_f32 v38, v38, v39
    v_ceil_f32 v38, v38
    v_add_f32 v38, 0x42200000, v38
    v_max_f32 v38, 0, v38
    v_exp_f32 v40, -v38
    v_sub_f32 v216, v216, v38
    v_sub_f32 v217, v217, v38
    v_sub_f32 v218, v218, v38
    v_sub_f32 v219, v219, v38
    v_sub_f32 v160, v160, v38
    v_sub_f32 v128, v128, v38
    v_sub_f32 v161, v161, v38
    v_sub_f32 v129, v129, v38
    v_sub_f32 v162, v162, v38
    v_sub_f32 v130, v130, v38
    v_sub_f32 v163, v163, v38
    v_sub_f32 v131, v131, v38
    v_sub_f32 v164, v164, v38
    v_sub_f32 v132, v132, v38
    v_sub_f32 v165, v165, v38
    v_sub_f32 v133, v133, v38
    v_sub_f32 v166, v166, v38
    v_sub_f32 v134, v134, v38
    v_sub_f32 v167, v167, v38
    v_sub_f32 v135, v135, v38
    v_mul_f32 v228, v228, v40
    v_mul_f32 v229, v229, v40
    v_accvgpr_read_b32 v39, a64
    v_mul_f32 v39, v39, v40
    v_accvgpr_write_b32 a64, v39
    v_accvgpr_read_b32 v39, a65
    v_mul_f32 v39, v39, v40
    v_accvgpr_write_b32 a65, v39
    v_accvgpr_read_b32 v39, a66
    v_mul_f32 v39, v39, v40
    v_accvgpr_write_b32 a66, v39
    v_accvgpr_read_b32 v39, a67
    v_mul_f32 v39, v39, v40
    v_accvgpr_write_b32 a67, v39
    v_accvgpr_read_b32 v39, a68
    v_mul_f32 v39, v39, v40
    v_accvgpr_write_b32 a68, v39
    v_accvgpr_read_b32 v39, a69
    v_mul_f32 v39, v39, v40
    v_accvgpr_write_b32 a69, v39
    v_accvgpr_read_b32 v39, a70
    v_mul_f32 v39, v39, v40
    v_accvgpr_write_b32 a70, v39
    v_accvgpr_read_b32 v39, a71
    v_mul_f32 v39, v39, v40
    v_accvgpr_write_b32 a71, v39
    v_accvgpr_read_b32 v39, a72
    v_mul_f32 v39, v39, v40
    v_accvgpr_write_b32 a72, v39
    v_accvgpr_read_b32 v39, a73
    v_mul_f32 v39, v39, v40
    v_accvgpr_write_b32 a73, v39
    v_accvgpr_read_b32 v39, a74
    v_mul_f32 v39, v39, v40
    v_accvgpr_write_b32 a74, v39
    v_accvgpr_read_b32 v39, a75
    v_mul_f32 v39, v39, v40
    v_accvgpr_write_b32 a75, v39
    v_accvgpr_read_b32 v39, a76
    v_mul_f32 v39, v39, v40
    v_accvgpr_write_b32 a76, v39
    v_accvgpr_read_b32 v39, a77
    v_mul_f32 v39, v39, v40
    v_accvgpr_write_b32 a77, v39
    v_accvgpr_read_b32 v39, a78
    v_mul_f32 v39, v39, v40
    v_accvgpr_write_b32 a78, v39
    v_accvgpr_read_b32 v39, a79
    v_mul_f32 v39, v39, v40
    v_accvgpr_write_b32 a79, v39
    v_accvgpr_read_b32 v39, a80
    v_mul_f32 v39, v39, v40
    v_accvgpr_write_b32 a80, v39
    v_accvgpr_read_b32 v39, a81
    v_mul_f32 v39, v39, v40
    v_accvgpr_write_b32 a81, v39
    v_accvgpr_read_b32 v39, a82
    v_mul_f32 v39, v39, v40
    v_accvgpr_write_b32 a82, v39
    v_accvgpr_read_b32 v39, a83
    v_mul_f32 v39, v39, v40
    v_accvgpr_write_b32 a83, v39
    v_accvgpr_read_b32 v39, a84
    v_mul_f32 v39, v39, v40
    v_accvgpr_write_b32 a84, v39
    v_accvgpr_read_b32 v39, a85
    v_mul_f32 v39, v39, v40
    v_accvgpr_write_b32 a85, v39
    v_accvgpr_read_b32 v39, a86
    v_mul_f32 v39, v39, v40
    v_accvgpr_write_b32 a86, v39
    v_accvgpr_read_b32 v39, a87
    v_mul_f32 v39, v39, v40
    v_accvgpr_write_b32 a87, v39
    v_accvgpr_read_b32 v39, a88
    v_mul_f32 v39, v39, v40
    v_accvgpr_write_b32 a88, v39
    v_accvgpr_read_b32 v39, a89
    v_mul_f32 v39, v39, v40
    v_accvgpr_write_b32 a89, v39
    v_accvgpr_read_b32 v39, a90
    v_mul_f32 v39, v39, v40
    v_accvgpr_write_b32 a90, v39
    v_accvgpr_read_b32 v39, a91
    v_mul_f32 v39, v39, v40
    v_accvgpr_write_b32 a91, v39
    v_accvgpr_read_b32 v39, a92
    v_mul_f32 v39, v39, v40
    v_accvgpr_write_b32 a92, v39
    v_accvgpr_read_b32 v39, a93
    v_mul_f32 v39, v39, v40
    v_accvgpr_write_b32 a93, v39
    v_accvgpr_read_b32 v39, a94
    v_mul_f32 v39, v39, v40
    v_accvgpr_write_b32 a94, v39
    v_accvgpr_read_b32 v39, a95
    v_mul_f32 v39, v39, v40
    v_accvgpr_write_b32 a95, v39
    v_lshlrev_b32 v39, 16, v184
    v_and_b32 v184, 0xffff0000, v184
    v_mul_f32 v39, v39, v40
    v_mul_f32 v184, v184, v40
    v_perm_b32 v184, v184, v39, s3
    v_lshlrev_b32 v39, 16, v185
    v_and_b32 v185, 0xffff0000, v185
    v_mul_f32 v39, v39, v40
    v_mul_f32 v185, v185, v40
    v_perm_b32 v185, v185, v39, s3
    v_lshlrev_b32 v39, 16, v186
    v_and_b32 v186, 0xffff0000, v186
    v_mul_f32 v39, v39, v40
    v_mul_f32 v186, v186, v40
    v_perm_b32 v186, v186, v39, s3
    v_lshlrev_b32 v39, 16, v187
    v_and_b32 v187, 0xffff0000, v187
    v_mul_f32 v39, v39, v40
    v_mul_f32 v187, v187, v40
    v_perm_b32 v187, v187, v39, s3
    v_exp_f32 v28, v160 clamp
    v_exp_f32 v29, v161 clamp
    v_exp_f32 v30, v162 clamp
    v_exp_f32 v31, v163 clamp
    v_exp_f32 v32, v164 clamp
    v_exp_f32 v33, v165 clamp
    v_exp_f32 v34, v166 clamp
    v_exp_f32 v35, v167 clamp
    s_nop 0
    v_perm_b32 v200, v29, v28, s3
    v_perm_b32 v201, v31, v30, s3
    v_perm_b32 v202, v33, v32, s3
    v_perm_b32 v203, v35, v34, s3
    v_max3_f32 v38, v168, v169, v170
    v_max3_f32 v38, v38, v171, v172
    v_max3_f32 v38, v38, v173, v174
    v_max_f32 v38, v38, v175
    v_mov_b32 v39, v38
    s_nop 1
    v_permlane16_swap_b32 v38, v39
    s_nop 1
    v_max_f32 v38, v38, v39
    v_mov_b32 v39, v38
    s_nop 1
    v_permlane32_swap_b32 v38, v39
    s_nop 1
    v_max_f32 v38, v38, v39
    v_ceil_f32 v38, v38
    v_add_f32 v38, 0x42200000, v38
    v_max_f32 v38, 0, v38
    v_exp_f32 v40, -v38
    v_sub_f32 v220, v220, v38
    v_sub_f32 v221, v221, v38
    v_sub_f32 v222, v222, v38
    v_sub_f32 v223, v223, v38
    v_sub_f32 v168, v168, v38
    v_sub_f32 v136, v136, v38
    v_sub_f32 v169, v169, v38
    v_sub_f32 v137, v137, v38
    v_sub_f32 v170, v170, v38
    v_sub_f32 v138, v138, v38
    v_sub_f32 v171, v171, v38
    v_sub_f32 v139, v139, v38
    v_sub_f32 v172, v172, v38
    v_sub_f32 v140, v140, v38
    v_sub_f32 v173, v173, v38
    v_sub_f32 v141, v141, v38
    v_sub_f32 v174, v174, v38
    v_sub_f32 v142, v142, v38
    v_sub_f32 v175, v175, v38
    v_sub_f32 v143, v143, v38
    v_mul_f32 v230, v230, v40
    v_mul_f32 v231, v231, v40
    v_accvgpr_read_b32 v39, a96
    v_mul_f32 v39, v39, v40
    v_accvgpr_write_b32 a96, v39
    v_accvgpr_read_b32 v39, a97
    v_mul_f32 v39, v39, v40
    v_accvgpr_write_b32 a97, v39
    v_accvgpr_read_b32 v39, a98
    v_mul_f32 v39, v39, v40
    v_accvgpr_write_b32 a98, v39
    v_accvgpr_read_b32 v39, a99
    v_mul_f32 v39, v39, v40
    v_accvgpr_write_b32 a99, v39
    v_accvgpr_read_b32 v39, a100
    v_mul_f32 v39, v39, v40
    v_accvgpr_write_b32 a100, v39
    v_accvgpr_read_b32 v39, a101
    v_mul_f32 v39, v39, v40
    v_accvgpr_write_b32 a101, v39
    v_accvgpr_read_b32 v39, a102
    v_mul_f32 v39, v39, v40
    v_accvgpr_write_b32 a102, v39
    v_accvgpr_read_b32 v39, a103
    v_mul_f32 v39, v39, v40
    v_accvgpr_write_b32 a103, v39
    v_accvgpr_read_b32 v39, a104
    v_mul_f32 v39, v39, v40
    v_accvgpr_write_b32 a104, v39
    v_accvgpr_read_b32 v39, a105
    v_mul_f32 v39, v39, v40
    v_accvgpr_write_b32 a105, v39
    v_accvgpr_read_b32 v39, a106
    v_mul_f32 v39, v39, v40
    v_accvgpr_write_b32 a106, v39
    v_accvgpr_read_b32 v39, a107
    v_mul_f32 v39, v39, v40
    v_accvgpr_write_b32 a107, v39
    v_accvgpr_read_b32 v39, a108
    v_mul_f32 v39, v39, v40
    v_accvgpr_write_b32 a108, v39
    v_accvgpr_read_b32 v39, a109
    v_mul_f32 v39, v39, v40
    v_accvgpr_write_b32 a109, v39
    v_accvgpr_read_b32 v39, a110
    v_mul_f32 v39, v39, v40
    v_accvgpr_write_b32 a110, v39
    v_accvgpr_read_b32 v39, a111
    v_mul_f32 v39, v39, v40
    v_accvgpr_write_b32 a111, v39
    v_accvgpr_read_b32 v39, a112
    v_mul_f32 v39, v39, v40
    v_accvgpr_write_b32 a112, v39
    v_accvgpr_read_b32 v39, a113
    v_mul_f32 v39, v39, v40
    v_accvgpr_write_b32 a113, v39
    v_accvgpr_read_b32 v39, a114
    v_mul_f32 v39, v39, v40
    v_accvgpr_write_b32 a114, v39
    v_accvgpr_read_b32 v39, a115
    v_mul_f32 v39, v39, v40
    v_accvgpr_write_b32 a115, v39
    v_accvgpr_read_b32 v39, a116
    v_mul_f32 v39, v39, v40
    v_accvgpr_write_b32 a116, v39
    v_accvgpr_read_b32 v39, a117
    v_mul_f32 v39, v39, v40
    v_accvgpr_write_b32 a117, v39
    v_accvgpr_read_b32 v39, a118
    v_mul_f32 v39, v39, v40
    v_accvgpr_write_b32 a118, v39
    v_accvgpr_read_b32 v39, a119
    v_mul_f32 v39, v39, v40
    v_accvgpr_write_b32 a119, v39
    v_accvgpr_read_b32 v39, a120
    v_mul_f32 v39, v39, v40
    v_accvgpr_write_b32 a120, v39
    v_accvgpr_read_b32 v39, a121
    v_mul_f32 v39, v39, v40
    v_accvgpr_write_b32 a121, v39
    v_accvgpr_read_b32 v39, a122
    v_mul_f32 v39, v39, v40
    v_accvgpr_write_b32 a122, v39
    v_accvgpr_read_b32 v39, a123
    v_mul_f32 v39, v39, v40
    v_accvgpr_write_b32 a123, v39
    v_accvgpr_read_b32 v39, a124
    v_mul_f32 v39, v39, v40
    v_accvgpr_write_b32 a124, v39
    v_accvgpr_read_b32 v39, a125
    v_mul_f32 v39, v39, v40
    v_accvgpr_write_b32 a125, v39
    v_accvgpr_read_b32 v39, a126
    v_mul_f32 v39, v39, v40
    v_accvgpr_write_b32 a126, v39
    v_accvgpr_read_b32 v39, a127
    v_mul_f32 v39, v39, v40
    v_accvgpr_write_b32 a127, v39
    v_lshlrev_b32 v39, 16, v188
    v_and_b32 v188, 0xffff0000, v188
    v_mul_f32 v39, v39, v40
    v_mul_f32 v188, v188, v40
    v_perm_b32 v188, v188, v39, s3
    v_lshlrev_b32 v39, 16, v189
    v_and_b32 v189, 0xffff0000, v189
    v_mul_f32 v39, v39, v40
    v_mul_f32 v189, v189, v40
    v_perm_b32 v189, v189, v39, s3
    v_lshlrev_b32 v39, 16, v190
    v_and_b32 v190, 0xffff0000, v190
    v_mul_f32 v39, v39, v40
    v_mul_f32 v190, v190, v40
    v_perm_b32 v190, v190, v39, s3
    v_lshlrev_b32 v39, 16, v191
    v_and_b32 v191, 0xffff0000, v191
    v_mul_f32 v39, v39, v40
    v_mul_f32 v191, v191, v40
    v_perm_b32 v191, v191, v39, s3
    v_exp_f32 v28, v168 clamp
    v_exp_f32 v29, v169 clamp
    v_exp_f32 v30, v170 clamp
    v_exp_f32 v31, v171 clamp
    v_exp_f32 v32, v172 clamp
    v_exp_f32 v33, v173 clamp
    v_exp_f32 v34, v174 clamp
    v_exp_f32 v35, v175 clamp
    s_nop 0
    v_perm_b32 v204, v29, v28, s3
    v_perm_b32 v205, v31, v30, s3
    v_perm_b32 v206, v33, v32, s3
    v_perm_b32 v207, v35, v34, s3
    s_nop 1
    v_smfmac_f32_16x16x64_bf16 v[224:227], v[24:27], v[192:199], v250
    v_smfmac_f32_16x16x64_bf16 v[228:231], v[24:27], v[200:207], v250
    s_nop 15
    s_setpc_b64 s[46:47]
L_raresub2_main_kernel:
    s_nop 15
    v_mov_b32 v28, 0
    v_mov_b32 v29, 0
    v_mov_b32 v30, 0
    v_mov_b32 v31, 0
    v_mov_b32 v32, 0
    v_mov_b32 v33, 0
    v_mov_b32 v34, 0
    v_mov_b32 v35, 0
    s_nop 1
    v_smfmac_f32_16x16x64_bf16 v[28:31], v[24:27], v[232:239], v250
    v_smfmac_f32_16x16x64_bf16 v[32:35], v[24:27], v[240:247], v250
    s_nop 15
    v_sub_f32 v224, v224, v28
    v_sub_f32 v225, v225, v29
    v_sub_f32 v226, v226, v30
    v_sub_f32 v227, v227, v31
    v_sub_f32 v228, v228, v32
    v_sub_f32 v229, v229, v33
    v_sub_f32 v230, v230, v34
    v_sub_f32 v231, v231, v35
    v_max3_f32 v38, v112, v113, v114
    v_max3_f32 v38, v38, v115, v116
    v_max3_f32 v38, v38, v117, v118
    v_max_f32 v38, v38, v119
    v_mov_b32 v39, v38
    s_nop 1
    v_permlane16_swap_b32 v38, v39
    s_nop 1
    v_max_f32 v38, v38, v39
    v_mov_b32 v39, v38
    s_nop 1
    v_permlane32_swap_b32 v38, v39
    s_nop 1
    v_max_f32 v38, v38, v39
    v_ceil_f32 v38, v38
    v_add_f32 v38, 0x42200000, v38
    v_max_f32 v38, 0, v38
    v_exp_f32 v40, -v38
    v_sub_f32 v208, v208, v38
    v_sub_f32 v209, v209, v38
    v_sub_f32 v210, v210, v38
    v_sub_f32 v211, v211, v38
    v_sub_f32 v112, v112, v38
    v_sub_f32 v144, v144, v38
    v_sub_f32 v113, v113, v38
    v_sub_f32 v145, v145, v38
    v_sub_f32 v114, v114, v38
    v_sub_f32 v146, v146, v38
    v_sub_f32 v115, v115, v38
    v_sub_f32 v147, v147, v38
    v_sub_f32 v116, v116, v38
    v_sub_f32 v148, v148, v38
    v_sub_f32 v117, v117, v38
    v_sub_f32 v149, v149, v38
    v_sub_f32 v118, v118, v38
    v_sub_f32 v150, v150, v38
    v_sub_f32 v119, v119, v38
    v_sub_f32 v151, v151, v38
    v_mul_f32 v224, v224, v40
    v_mul_f32 v225, v225, v40
    v_accvgpr_read_b32 v39, a0
    v_mul_f32 v39, v39, v40
    v_accvgpr_write_b32 a0, v39
    v_accvgpr_read_b32 v39, a1
    v_mul_f32 v39, v39, v40
    v_accvgpr_write_b32 a1, v39
    v_accvgpr_read_b32 v39, a2
    v_mul_f32 v39, v39, v40
    v_accvgpr_write_b32 a2, v39
    v_accvgpr_read_b32 v39, a3
    v_mul_f32 v39, v39, v40
    v_accvgpr_write_b32 a3, v39
    v_accvgpr_read_b32 v39, a4
    v_mul_f32 v39, v39, v40
    v_accvgpr_write_b32 a4, v39
    v_accvgpr_read_b32 v39, a5
    v_mul_f32 v39, v39, v40
    v_accvgpr_write_b32 a5, v39
    v_accvgpr_read_b32 v39, a6
    v_mul_f32 v39, v39, v40
    v_accvgpr_write_b32 a6, v39
    v_accvgpr_read_b32 v39, a7
    v_mul_f32 v39, v39, v40
    v_accvgpr_write_b32 a7, v39
    v_accvgpr_read_b32 v39, a8
    v_mul_f32 v39, v39, v40
    v_accvgpr_write_b32 a8, v39
    v_accvgpr_read_b32 v39, a9
    v_mul_f32 v39, v39, v40
    v_accvgpr_write_b32 a9, v39
    v_accvgpr_read_b32 v39, a10
    v_mul_f32 v39, v39, v40
    v_accvgpr_write_b32 a10, v39
    v_accvgpr_read_b32 v39, a11
    v_mul_f32 v39, v39, v40
    v_accvgpr_write_b32 a11, v39
    v_accvgpr_read_b32 v39, a12
    v_mul_f32 v39, v39, v40
    v_accvgpr_write_b32 a12, v39
    v_accvgpr_read_b32 v39, a13
    v_mul_f32 v39, v39, v40
    v_accvgpr_write_b32 a13, v39
    v_accvgpr_read_b32 v39, a14
    v_mul_f32 v39, v39, v40
    v_accvgpr_write_b32 a14, v39
    v_accvgpr_read_b32 v39, a15
    v_mul_f32 v39, v39, v40
    v_accvgpr_write_b32 a15, v39
    v_accvgpr_read_b32 v39, a16
    v_mul_f32 v39, v39, v40
    v_accvgpr_write_b32 a16, v39
    v_accvgpr_read_b32 v39, a17
    v_mul_f32 v39, v39, v40
    v_accvgpr_write_b32 a17, v39
    v_accvgpr_read_b32 v39, a18
    v_mul_f32 v39, v39, v40
    v_accvgpr_write_b32 a18, v39
    v_accvgpr_read_b32 v39, a19
    v_mul_f32 v39, v39, v40
    v_accvgpr_write_b32 a19, v39
    v_accvgpr_read_b32 v39, a20
    v_mul_f32 v39, v39, v40
    v_accvgpr_write_b32 a20, v39
    v_accvgpr_read_b32 v39, a21
    v_mul_f32 v39, v39, v40
    v_accvgpr_write_b32 a21, v39
    v_accvgpr_read_b32 v39, a22
    v_mul_f32 v39, v39, v40
    v_accvgpr_write_b32 a22, v39
    v_accvgpr_read_b32 v39, a23
    v_mul_f32 v39, v39, v40
    v_accvgpr_write_b32 a23, v39
    v_accvgpr_read_b32 v39, a24
    v_mul_f32 v39, v39, v40
    v_accvgpr_write_b32 a24, v39
    v_accvgpr_read_b32 v39, a25
    v_mul_f32 v39, v39, v40
    v_accvgpr_write_b32 a25, v39
    v_accvgpr_read_b32 v39, a26
    v_mul_f32 v39, v39, v40
    v_accvgpr_write_b32 a26, v39
    v_accvgpr_read_b32 v39, a27
    v_mul_f32 v39, v39, v40
    v_accvgpr_write_b32 a27, v39
    v_accvgpr_read_b32 v39, a28
    v_mul_f32 v39, v39, v40
    v_accvgpr_write_b32 a28, v39
    v_accvgpr_read_b32 v39, a29
    v_mul_f32 v39, v39, v40
    v_accvgpr_write_b32 a29, v39
    v_accvgpr_read_b32 v39, a30
    v_mul_f32 v39, v39, v40
    v_accvgpr_write_b32 a30, v39
    v_accvgpr_read_b32 v39, a31
    v_mul_f32 v39, v39, v40
    v_accvgpr_write_b32 a31, v39
    v_lshlrev_b32 v39, 16, v176
    v_and_b32 v176, 0xffff0000, v176
    v_mul_f32 v39, v39, v40
    v_mul_f32 v176, v176, v40
    v_perm_b32 v176, v176, v39, s3
    v_lshlrev_b32 v39, 16, v177
    v_and_b32 v177, 0xffff0000, v177
    v_mul_f32 v39, v39, v40
    v_mul_f32 v177, v177, v40
    v_perm_b32 v177, v177, v39, s3
    v_lshlrev_b32 v39, 16, v178
    v_and_b32 v178, 0xffff0000, v178
    v_mul_f32 v39, v39, v40
    v_mul_f32 v178, v178, v40
    v_perm_b32 v178, v178, v39, s3
    v_lshlrev_b32 v39, 16, v179
    v_and_b32 v179, 0xffff0000, v179
    v_mul_f32 v39, v39, v40
    v_mul_f32 v179, v179, v40
    v_perm_b32 v179, v179, v39, s3
    v_lshlrev_b32 v39, 16, v192
    v_and_b32 v192, 0xffff0000, v192
    v_mul_f32 v39, v39, v40
    v_mul_f32 v192, v192, v40
    v_perm_b32 v192, v192, v39, s3
    v_lshlrev_b32 v39, 16, v193
    v_and_b32 v193, 0xffff0000, v193
    v_mul_f32 v39, v39, v40
    v_mul_f32 v193, v193, v40
    v_perm_b32 v193, v193, v39, s3
    v_lshlrev_b32 v39, 16, v194
    v_and_b32 v194, 0xffff0000, v194
    v_mul_f32 v39, v39, v40
    v_mul_f32 v194, v194, v40
    v_perm_b32 v194, v194, v39, s3
    v_lshlrev_b32 v39, 16, v195
    v_and_b32 v195, 0xffff0000, v195
    v_mul_f32 v39, v39, v40
    v_mul_f32 v195, v195, v40
    v_perm_b32 v195, v195, v39, s3
    v_exp_f32 v28, v112 clamp
    v_exp_f32 v29, v113 clamp
    v_exp_f32 v30, v114 clamp
    v_exp_f32 v31, v115 clamp
    v_exp_f32 v32, v116 clamp
    v_exp_f32 v33, v117 clamp
    v_exp_f32 v34, v118 clamp
    v_exp_f32 v35, v119 clamp
    s_nop 0
    v_perm_b32 v232, v29, v28, s3
    v_perm_b32 v233, v31, v30, s3
    v_perm_b32 v234, v33, v32, s3
    v_perm_b32 v235, v35, v34, s3
    v_max3_f32 v38, v120, v121, v122
    v_max3_f32 v38, v38, v123, v124
    v_max3_f32 v38, v38, v125, v126
    v_max_f32 v38, v38, v127
    v_mov_b32 v39, v38
    s_nop 1
    v_permlane16_swap_b32 v38, v39
    s_nop 1
    v_max_f32 v38, v38, v39
    v_mov_b32 v39, v38
    s_nop 1
    v_permlane32_swap_b32 v38, v39
    s_nop 1
    v_max_f32 v38, v38, v39
    v_ceil_f32 v38, v38
    v_add_f32 v38, 0x42200000, v38
    v_max_f32 v38, 0, v38
    v_exp_f32 v40, -v38
    v_sub_f32 v212, v212, v38
    v_sub_f32 v213, v213, v38
    v_sub_f32 v214, v214, v38
    v_sub_f32 v215, v215, v38
    v_sub_f32 v120, v120, v38
    v_sub_f32 v152, v152, v38
    v_sub_f32 v121, v121, v38
    v_sub_f32 v153, v153, v38
    v_sub_f32 v122, v122, v38
    v_sub_f32 v154, v154, v38
    v_sub_f32 v123, v123, v38
    v_sub_f32 v155, v155, v38
    v_sub_f32 v124, v124, v38
    v_sub_f32 v156, v156, v38
    v_sub_f32 v125, v125, v38
    v_sub_f32 v157, v157, v38
    v_sub_f32 v126, v126, v38
    v_sub_f32 v158, v158, v38
    v_sub_f32 v127, v127, v38
    v_sub_f32 v159, v159, v38
    v_mul_f32 v226, v226, v40
    v_mul_f32 v227, v227, v40
    v_accvgpr_read_b32 v39, a32
    v_mul_f32 v39, v39, v40
    v_accvgpr_write_b32 a32, v39
    v_accvgpr_read_b32 v39, a33
    v_mul_f32 v39, v39, v40
    v_accvgpr_write_b32 a33, v39
    v_accvgpr_read_b32 v39, a34
    v_mul_f32 v39, v39, v40
    v_accvgpr_write_b32 a34, v39
    v_accvgpr_read_b32 v39, a35
    v_mul_f32 v39, v39, v40
    v_accvgpr_write_b32 a35, v39
    v_accvgpr_read_b32 v39, a36
    v_mul_f32 v39, v39, v40
    v_accvgpr_write_b32 a36, v39
    v_accvgpr_read_b32 v39, a37
    v_mul_f32 v39, v39, v40
    v_accvgpr_write_b32 a37, v39
    v_accvgpr_read_b32 v39, a38
    v_mul_f32 v39, v39, v40
    v_accvgpr_write_b32 a38, v39
    v_accvgpr_read_b32 v39, a39
    v_mul_f32 v39, v39, v40
    v_accvgpr_write_b32 a39, v39
    v_accvgpr_read_b32 v39, a40
    v_mul_f32 v39, v39, v40
    v_accvgpr_write_b32 a40, v39
    v_accvgpr_read_b32 v39, a41
    v_mul_f32 v39, v39, v40
    v_accvgpr_write_b32 a41, v39
    v_accvgpr_read_b32 v39, a42
    v_mul_f32 v39, v39, v40
    v_accvgpr_write_b32 a42, v39
    v_accvgpr_read_b32 v39, a43
    v_mul_f32 v39, v39, v40
    v_accvgpr_write_b32 a43, v39
    v_accvgpr_read_b32 v39, a44
    v_mul_f32 v39, v39, v40
    v_accvgpr_write_b32 a44, v39
    v_accvgpr_read_b32 v39, a45
    v_mul_f32 v39, v39, v40
    v_accvgpr_write_b32 a45, v39
    v_accvgpr_read_b32 v39, a46
    v_mul_f32 v39, v39, v40
    v_accvgpr_write_b32 a46, v39
    v_accvgpr_read_b32 v39, a47
    v_mul_f32 v39, v39, v40
    v_accvgpr_write_b32 a47, v39
    v_accvgpr_read_b32 v39, a48
    v_mul_f32 v39, v39, v40
    v_accvgpr_write_b32 a48, v39
    v_accvgpr_read_b32 v39, a49
    v_mul_f32 v39, v39, v40
    v_accvgpr_write_b32 a49, v39
    v_accvgpr_read_b32 v39, a50
    v_mul_f32 v39, v39, v40
    v_accvgpr_write_b32 a50, v39
    v_accvgpr_read_b32 v39, a51
    v_mul_f32 v39, v39, v40
    v_accvgpr_write_b32 a51, v39
    v_accvgpr_read_b32 v39, a52
    v_mul_f32 v39, v39, v40
    v_accvgpr_write_b32 a52, v39
    v_accvgpr_read_b32 v39, a53
    v_mul_f32 v39, v39, v40
    v_accvgpr_write_b32 a53, v39
    v_accvgpr_read_b32 v39, a54
    v_mul_f32 v39, v39, v40
    v_accvgpr_write_b32 a54, v39
    v_accvgpr_read_b32 v39, a55
    v_mul_f32 v39, v39, v40
    v_accvgpr_write_b32 a55, v39
    v_accvgpr_read_b32 v39, a56
    v_mul_f32 v39, v39, v40
    v_accvgpr_write_b32 a56, v39
    v_accvgpr_read_b32 v39, a57
    v_mul_f32 v39, v39, v40
    v_accvgpr_write_b32 a57, v39
    v_accvgpr_read_b32 v39, a58
    v_mul_f32 v39, v39, v40
    v_accvgpr_write_b32 a58, v39
    v_accvgpr_read_b32 v39, a59
    v_mul_f32 v39, v39, v40
    v_accvgpr_write_b32 a59, v39
    v_accvgpr_read_b32 v39, a60
    v_mul_f32 v39, v39, v40
    v_accvgpr_write_b32 a60, v39
    v_accvgpr_read_b32 v39, a61
    v_mul_f32 v39, v39, v40
    v_accvgpr_write_b32 a61, v39
    v_accvgpr_read_b32 v39, a62
    v_mul_f32 v39, v39, v40
    v_accvgpr_write_b32 a62, v39
    v_accvgpr_read_b32 v39, a63
    v_mul_f32 v39, v39, v40
    v_accvgpr_write_b32 a63, v39
    v_lshlrev_b32 v39, 16, v180
    v_and_b32 v180, 0xffff0000, v180
    v_mul_f32 v39, v39, v40
    v_mul_f32 v180, v180, v40
    v_perm_b32 v180, v180, v39, s3
    v_lshlrev_b32 v39, 16, v181
    v_and_b32 v181, 0xffff0000, v181
    v_mul_f32 v39, v39, v40
    v_mul_f32 v181, v181, v40
    v_perm_b32 v181, v181, v39, s3
    v_lshlrev_b32 v39, 16, v182
    v_and_b32 v182, 0xffff0000, v182
    v_mul_f32 v39, v39, v40
    v_mul_f32 v182, v182, v40
    v_perm_b32 v182, v182, v39, s3
    v_lshlrev_b32 v39, 16, v183
    v_and_b32 v183, 0xffff0000, v183
    v_mul_f32 v39, v39, v40
    v_mul_f32 v183, v183, v40
    v_perm_b32 v183, v183, v39, s3
    v_lshlrev_b32 v39, 16, v196
    v_and_b32 v196, 0xffff0000, v196
    v_mul_f32 v39, v39, v40
    v_mul_f32 v196, v196, v40
    v_perm_b32 v196, v196, v39, s3
    v_lshlrev_b32 v39, 16, v197
    v_and_b32 v197, 0xffff0000, v197
    v_mul_f32 v39, v39, v40
    v_mul_f32 v197, v197, v40
    v_perm_b32 v197, v197, v39, s3
    v_lshlrev_b32 v39, 16, v198
    v_and_b32 v198, 0xffff0000, v198
    v_mul_f32 v39, v39, v40
    v_mul_f32 v198, v198, v40
    v_perm_b32 v198, v198, v39, s3
    v_lshlrev_b32 v39, 16, v199
    v_and_b32 v199, 0xffff0000, v199
    v_mul_f32 v39, v39, v40
    v_mul_f32 v199, v199, v40
    v_perm_b32 v199, v199, v39, s3
    v_exp_f32 v28, v120 clamp
    v_exp_f32 v29, v121 clamp
    v_exp_f32 v30, v122 clamp
    v_exp_f32 v31, v123 clamp
    v_exp_f32 v32, v124 clamp
    v_exp_f32 v33, v125 clamp
    v_exp_f32 v34, v126 clamp
    v_exp_f32 v35, v127 clamp
    s_nop 0
    v_perm_b32 v236, v29, v28, s3
    v_perm_b32 v237, v31, v30, s3
    v_perm_b32 v238, v33, v32, s3
    v_perm_b32 v239, v35, v34, s3
    v_max3_f32 v38, v128, v129, v130
    v_max3_f32 v38, v38, v131, v132
    v_max3_f32 v38, v38, v133, v134
    v_max_f32 v38, v38, v135
    v_mov_b32 v39, v38
    s_nop 1
    v_permlane16_swap_b32 v38, v39
    s_nop 1
    v_max_f32 v38, v38, v39
    v_mov_b32 v39, v38
    s_nop 1
    v_permlane32_swap_b32 v38, v39
    s_nop 1
    v_max_f32 v38, v38, v39
    v_ceil_f32 v38, v38
    v_add_f32 v38, 0x42200000, v38
    v_max_f32 v38, 0, v38
    v_exp_f32 v40, -v38
    v_sub_f32 v216, v216, v38
    v_sub_f32 v217, v217, v38
    v_sub_f32 v218, v218, v38
    v_sub_f32 v219, v219, v38
    v_sub_f32 v128, v128, v38
    v_sub_f32 v160, v160, v38
    v_sub_f32 v129, v129, v38
    v_sub_f32 v161, v161, v38
    v_sub_f32 v130, v130, v38
    v_sub_f32 v162, v162, v38
    v_sub_f32 v131, v131, v38
    v_sub_f32 v163, v163, v38
    v_sub_f32 v132, v132, v38
    v_sub_f32 v164, v164, v38
    v_sub_f32 v133, v133, v38
    v_sub_f32 v165, v165, v38
    v_sub_f32 v134, v134, v38
    v_sub_f32 v166, v166, v38
    v_sub_f32 v135, v135, v38
    v_sub_f32 v167, v167, v38
    v_mul_f32 v228, v228, v40
    v_mul_f32 v229, v229, v40
    v_accvgpr_read_b32 v39, a64
    v_mul_f32 v39, v39, v40
    v_accvgpr_write_b32 a64, v39
    v_accvgpr_read_b32 v39, a65
    v_mul_f32 v39, v39, v40
    v_accvgpr_write_b32 a65, v39
    v_accvgpr_read_b32 v39, a66
    v_mul_f32 v39, v39, v40
    v_accvgpr_write_b32 a66, v39
    v_accvgpr_read_b32 v39, a67
    v_mul_f32 v39, v39, v40
    v_accvgpr_write_b32 a67, v39
    v_accvgpr_read_b32 v39, a68
    v_mul_f32 v39, v39, v40
    v_accvgpr_write_b32 a68, v39
    v_accvgpr_read_b32 v39, a69
    v_mul_f32 v39, v39, v40
    v_accvgpr_write_b32 a69, v39
    v_accvgpr_read_b32 v39, a70
    v_mul_f32 v39, v39, v40
    v_accvgpr_write_b32 a70, v39
    v_accvgpr_read_b32 v39, a71
    v_mul_f32 v39, v39, v40
    v_accvgpr_write_b32 a71, v39
    v_accvgpr_read_b32 v39, a72
    v_mul_f32 v39, v39, v40
    v_accvgpr_write_b32 a72, v39
    v_accvgpr_read_b32 v39, a73
    v_mul_f32 v39, v39, v40
    v_accvgpr_write_b32 a73, v39
    v_accvgpr_read_b32 v39, a74
    v_mul_f32 v39, v39, v40
    v_accvgpr_write_b32 a74, v39
    v_accvgpr_read_b32 v39, a75
    v_mul_f32 v39, v39, v40
    v_accvgpr_write_b32 a75, v39
    v_accvgpr_read_b32 v39, a76
    v_mul_f32 v39, v39, v40
    v_accvgpr_write_b32 a76, v39
    v_accvgpr_read_b32 v39, a77
    v_mul_f32 v39, v39, v40
    v_accvgpr_write_b32 a77, v39
    v_accvgpr_read_b32 v39, a78
    v_mul_f32 v39, v39, v40
    v_accvgpr_write_b32 a78, v39
    v_accvgpr_read_b32 v39, a79
    v_mul_f32 v39, v39, v40
    v_accvgpr_write_b32 a79, v39
    v_accvgpr_read_b32 v39, a80
    v_mul_f32 v39, v39, v40
    v_accvgpr_write_b32 a80, v39
    v_accvgpr_read_b32 v39, a81
    v_mul_f32 v39, v39, v40
    v_accvgpr_write_b32 a81, v39
    v_accvgpr_read_b32 v39, a82
    v_mul_f32 v39, v39, v40
    v_accvgpr_write_b32 a82, v39
    v_accvgpr_read_b32 v39, a83
    v_mul_f32 v39, v39, v40
    v_accvgpr_write_b32 a83, v39
    v_accvgpr_read_b32 v39, a84
    v_mul_f32 v39, v39, v40
    v_accvgpr_write_b32 a84, v39
    v_accvgpr_read_b32 v39, a85
    v_mul_f32 v39, v39, v40
    v_accvgpr_write_b32 a85, v39
    v_accvgpr_read_b32 v39, a86
    v_mul_f32 v39, v39, v40
    v_accvgpr_write_b32 a86, v39
    v_accvgpr_read_b32 v39, a87
    v_mul_f32 v39, v39, v40
    v_accvgpr_write_b32 a87, v39
    v_accvgpr_read_b32 v39, a88
    v_mul_f32 v39, v39, v40
    v_accvgpr_write_b32 a88, v39
    v_accvgpr_read_b32 v39, a89
    v_mul_f32 v39, v39, v40
    v_accvgpr_write_b32 a89, v39
    v_accvgpr_read_b32 v39, a90
    v_mul_f32 v39, v39, v40
    v_accvgpr_write_b32 a90, v39
    v_accvgpr_read_b32 v39, a91
    v_mul_f32 v39, v39, v40
    v_accvgpr_write_b32 a91, v39
    v_accvgpr_read_b32 v39, a92
    v_mul_f32 v39, v39, v40
    v_accvgpr_write_b32 a92, v39
    v_accvgpr_read_b32 v39, a93
    v_mul_f32 v39, v39, v40
    v_accvgpr_write_b32 a93, v39
    v_accvgpr_read_b32 v39, a94
    v_mul_f32 v39, v39, v40
    v_accvgpr_write_b32 a94, v39
    v_accvgpr_read_b32 v39, a95
    v_mul_f32 v39, v39, v40
    v_accvgpr_write_b32 a95, v39
    v_lshlrev_b32 v39, 16, v184
    v_and_b32 v184, 0xffff0000, v184
    v_mul_f32 v39, v39, v40
    v_mul_f32 v184, v184, v40
    v_perm_b32 v184, v184, v39, s3
    v_lshlrev_b32 v39, 16, v185
    v_and_b32 v185, 0xffff0000, v185
    v_mul_f32 v39, v39, v40
    v_mul_f32 v185, v185, v40
    v_perm_b32 v185, v185, v39, s3
    v_lshlrev_b32 v39, 16, v186
    v_and_b32 v186, 0xffff0000, v186
    v_mul_f32 v39, v39, v40
    v_mul_f32 v186, v186, v40
    v_perm_b32 v186, v186, v39, s3
    v_lshlrev_b32 v39, 16, v187
    v_and_b32 v187, 0xffff0000, v187
    v_mul_f32 v39, v39, v40
    v_mul_f32 v187, v187, v40
    v_perm_b32 v187, v187, v39, s3
    v_lshlrev_b32 v39, 16, v200
    v_and_b32 v200, 0xffff0000, v200
    v_mul_f32 v39, v39, v40
    v_mul_f32 v200, v200, v40
    v_perm_b32 v200, v200, v39, s3
    v_lshlrev_b32 v39, 16, v201
    v_and_b32 v201, 0xffff0000, v201
    v_mul_f32 v39, v39, v40
    v_mul_f32 v201, v201, v40
    v_perm_b32 v201, v201, v39, s3
    v_lshlrev_b32 v39, 16, v202
    v_and_b32 v202, 0xffff0000, v202
    v_mul_f32 v39, v39, v40
    v_mul_f32 v202, v202, v40
    v_perm_b32 v202, v202, v39, s3
    v_lshlrev_b32 v39, 16, v203
    v_and_b32 v203, 0xffff0000, v203
    v_mul_f32 v39, v39, v40
    v_mul_f32 v203, v203, v40
    v_perm_b32 v203, v203, v39, s3
    v_exp_f32 v28, v128 clamp
    v_exp_f32 v29, v129 clamp
    v_exp_f32 v30, v130 clamp
    v_exp_f32 v31, v131 clamp
    v_exp_f32 v32, v132 clamp
    v_exp_f32 v33, v133 clamp
    v_exp_f32 v34, v134 clamp
    v_exp_f32 v35, v135 clamp
    s_nop 0
    v_perm_b32 v240, v29, v28, s3
    v_perm_b32 v241, v31, v30, s3
    v_perm_b32 v242, v33, v32, s3
    v_perm_b32 v243, v35, v34, s3
    v_max3_f32 v38, v136, v137, v138
    v_max3_f32 v38, v38, v139, v140
    v_max3_f32 v38, v38, v141, v142
    v_max_f32 v38, v38, v143
    v_mov_b32 v39, v38
    s_nop 1
    v_permlane16_swap_b32 v38, v39
    s_nop 1
    v_max_f32 v38, v38, v39
    v_mov_b32 v39, v38
    s_nop 1
    v_permlane32_swap_b32 v38, v39
    s_nop 1
    v_max_f32 v38, v38, v39
    v_ceil_f32 v38, v38
    v_add_f32 v38, 0x42200000, v38
    v_max_f32 v38, 0, v38
    v_exp_f32 v40, -v38
    v_sub_f32 v220, v220, v38
    v_sub_f32 v221, v221, v38
    v_sub_f32 v222, v222, v38
    v_sub_f32 v223, v223, v38
    v_sub_f32 v136, v136, v38
    v_sub_f32 v168, v168, v38
    v_sub_f32 v137, v137, v38
    v_sub_f32 v169, v169, v38
    v_sub_f32 v138, v138, v38
    v_sub_f32 v170, v170, v38
    v_sub_f32 v139, v139, v38
    v_sub_f32 v171, v171, v38
    v_sub_f32 v140, v140, v38
    v_sub_f32 v172, v172, v38
    v_sub_f32 v141, v141, v38
    v_sub_f32 v173, v173, v38
    v_sub_f32 v142, v142, v38
    v_sub_f32 v174, v174, v38
    v_sub_f32 v143, v143, v38
    v_sub_f32 v175, v175, v38
    v_mul_f32 v230, v230, v40
    v_mul_f32 v231, v231, v40
    v_accvgpr_read_b32 v39, a96
    v_mul_f32 v39, v39, v40
    v_accvgpr_write_b32 a96, v39
    v_accvgpr_read_b32 v39, a97
    v_mul_f32 v39, v39, v40
    v_accvgpr_write_b32 a97, v39
    v_accvgpr_read_b32 v39, a98
    v_mul_f32 v39, v39, v40
    v_accvgpr_write_b32 a98, v39
    v_accvgpr_read_b32 v39, a99
    v_mul_f32 v39, v39, v40
    v_accvgpr_write_b32 a99, v39
    v_accvgpr_read_b32 v39, a100
    v_mul_f32 v39, v39, v40
    v_accvgpr_write_b32 a100, v39
    v_accvgpr_read_b32 v39, a101
    v_mul_f32 v39, v39, v40
    v_accvgpr_write_b32 a101, v39
    v_accvgpr_read_b32 v39, a102
    v_mul_f32 v39, v39, v40
    v_accvgpr_write_b32 a102, v39
    v_accvgpr_read_b32 v39, a103
    v_mul_f32 v39, v39, v40
    v_accvgpr_write_b32 a103, v39
    v_accvgpr_read_b32 v39, a104
    v_mul_f32 v39, v39, v40
    v_accvgpr_write_b32 a104, v39
    v_accvgpr_read_b32 v39, a105
    v_mul_f32 v39, v39, v40
    v_accvgpr_write_b32 a105, v39
    v_accvgpr_read_b32 v39, a106
    v_mul_f32 v39, v39, v40
    v_accvgpr_write_b32 a106, v39
    v_accvgpr_read_b32 v39, a107
    v_mul_f32 v39, v39, v40
    v_accvgpr_write_b32 a107, v39
    v_accvgpr_read_b32 v39, a108
    v_mul_f32 v39, v39, v40
    v_accvgpr_write_b32 a108, v39
    v_accvgpr_read_b32 v39, a109
    v_mul_f32 v39, v39, v40
    v_accvgpr_write_b32 a109, v39
    v_accvgpr_read_b32 v39, a110
    v_mul_f32 v39, v39, v40
    v_accvgpr_write_b32 a110, v39
    v_accvgpr_read_b32 v39, a111
    v_mul_f32 v39, v39, v40
    v_accvgpr_write_b32 a111, v39
    v_accvgpr_read_b32 v39, a112
    v_mul_f32 v39, v39, v40
    v_accvgpr_write_b32 a112, v39
    v_accvgpr_read_b32 v39, a113
    v_mul_f32 v39, v39, v40
    v_accvgpr_write_b32 a113, v39
    v_accvgpr_read_b32 v39, a114
    v_mul_f32 v39, v39, v40
    v_accvgpr_write_b32 a114, v39
    v_accvgpr_read_b32 v39, a115
    v_mul_f32 v39, v39, v40
    v_accvgpr_write_b32 a115, v39
    v_accvgpr_read_b32 v39, a116
    v_mul_f32 v39, v39, v40
    v_accvgpr_write_b32 a116, v39
    v_accvgpr_read_b32 v39, a117
    v_mul_f32 v39, v39, v40
    v_accvgpr_write_b32 a117, v39
    v_accvgpr_read_b32 v39, a118
    v_mul_f32 v39, v39, v40
    v_accvgpr_write_b32 a118, v39
    v_accvgpr_read_b32 v39, a119
    v_mul_f32 v39, v39, v40
    v_accvgpr_write_b32 a119, v39
    v_accvgpr_read_b32 v39, a120
    v_mul_f32 v39, v39, v40
    v_accvgpr_write_b32 a120, v39
    v_accvgpr_read_b32 v39, a121
    v_mul_f32 v39, v39, v40
    v_accvgpr_write_b32 a121, v39
    v_accvgpr_read_b32 v39, a122
    v_mul_f32 v39, v39, v40
    v_accvgpr_write_b32 a122, v39
    v_accvgpr_read_b32 v39, a123
    v_mul_f32 v39, v39, v40
    v_accvgpr_write_b32 a123, v39
    v_accvgpr_read_b32 v39, a124
    v_mul_f32 v39, v39, v40
    v_accvgpr_write_b32 a124, v39
    v_accvgpr_read_b32 v39, a125
    v_mul_f32 v39, v39, v40
    v_accvgpr_write_b32 a125, v39
    v_accvgpr_read_b32 v39, a126
    v_mul_f32 v39, v39, v40
    v_accvgpr_write_b32 a126, v39
    v_accvgpr_read_b32 v39, a127
    v_mul_f32 v39, v39, v40
    v_accvgpr_write_b32 a127, v39
    v_lshlrev_b32 v39, 16, v188
    v_and_b32 v188, 0xffff0000, v188
    v_mul_f32 v39, v39, v40
    v_mul_f32 v188, v188, v40
    v_perm_b32 v188, v188, v39, s3
    v_lshlrev_b32 v39, 16, v189
    v_and_b32 v189, 0xffff0000, v189
    v_mul_f32 v39, v39, v40
    v_mul_f32 v189, v189, v40
    v_perm_b32 v189, v189, v39, s3
    v_lshlrev_b32 v39, 16, v190
    v_and_b32 v190, 0xffff0000, v190
    v_mul_f32 v39, v39, v40
    v_mul_f32 v190, v190, v40
    v_perm_b32 v190, v190, v39, s3
    v_lshlrev_b32 v39, 16, v191
    v_and_b32 v191, 0xffff0000, v191
    v_mul_f32 v39, v39, v40
    v_mul_f32 v191, v191, v40
    v_perm_b32 v191, v191, v39, s3
    v_lshlrev_b32 v39, 16, v204
    v_and_b32 v204, 0xffff0000, v204
    v_mul_f32 v39, v39, v40
    v_mul_f32 v204, v204, v40
    v_perm_b32 v204, v204, v39, s3
    v_lshlrev_b32 v39, 16, v205
    v_and_b32 v205, 0xffff0000, v205
    v_mul_f32 v39, v39, v40
    v_mul_f32 v205, v205, v40
    v_perm_b32 v205, v205, v39, s3
    v_lshlrev_b32 v39, 16, v206
    v_and_b32 v206, 0xffff0000, v206
    v_mul_f32 v39, v39, v40
    v_mul_f32 v206, v206, v40
    v_perm_b32 v206, v206, v39, s3
    v_lshlrev_b32 v39, 16, v207
    v_and_b32 v207, 0xffff0000, v207
    v_mul_f32 v39, v39, v40
    v_mul_f32 v207, v207, v40
    v_perm_b32 v207, v207, v39, s3
    v_exp_f32 v28, v136 clamp
    v_exp_f32 v29, v137 clamp
    v_exp_f32 v30, v138 clamp
    v_exp_f32 v31, v139 clamp
    v_exp_f32 v32, v140 clamp
    v_exp_f32 v33, v141 clamp
    v_exp_f32 v34, v142 clamp
    v_exp_f32 v35, v143 clamp
    s_nop 0
    v_perm_b32 v244, v29, v28, s3
    v_perm_b32 v245, v31, v30, s3
    v_perm_b32 v246, v33, v32, s3
    v_perm_b32 v247, v35, v34, s3
    s_nop 1
    v_smfmac_f32_16x16x64_bf16 v[224:227], v[24:27], v[232:239], v250
    v_smfmac_f32_16x16x64_bf16 v[228:231], v[24:27], v[240:247], v250
    s_nop 15
    s_setpc_b64 s[46:47]
L_raresub3_main_kernel:
    s_nop 15
    v_mov_b32 v28, 0
    v_mov_b32 v29, 0
    v_mov_b32 v30, 0
    v_mov_b32 v31, 0
    v_mov_b32 v32, 0
    v_mov_b32 v33, 0
    v_mov_b32 v34, 0
    v_mov_b32 v35, 0
    s_nop 1
    v_smfmac_f32_16x16x64_bf16 v[28:31], v[24:27], v[192:199], v250
    v_smfmac_f32_16x16x64_bf16 v[32:35], v[24:27], v[200:207], v250
    s_nop 15
    v_sub_f32 v224, v224, v28
    v_sub_f32 v225, v225, v29
    v_sub_f32 v226, v226, v30
    v_sub_f32 v227, v227, v31
    v_sub_f32 v228, v228, v32
    v_sub_f32 v229, v229, v33
    v_sub_f32 v230, v230, v34
    v_sub_f32 v231, v231, v35
    v_max3_f32 v38, v144, v145, v146
    v_max3_f32 v38, v38, v147, v148
    v_max3_f32 v38, v38, v149, v150
    v_max_f32 v38, v38, v151
    v_mov_b32 v39, v38
    s_nop 1
    v_permlane16_swap_b32 v38, v39
    s_nop 1
    v_max_f32 v38, v38, v39
    v_mov_b32 v39, v38
    s_nop 1
    v_permlane32_swap_b32 v38, v39
    s_nop 1
    v_max_f32 v38, v38, v39
    v_ceil_f32 v38, v38
    v_add_f32 v38, 0x42200000, v38
    v_max_f32 v38, 0, v38
    v_exp_f32 v40, -v38
    v_sub_f32 v208, v208, v38
    v_sub_f32 v209, v209, v38
    v_sub_f32 v210, v210, v38
    v_sub_f32 v211, v211, v38
    v_sub_f32 v144, v144, v38
    v_sub_f32 v112, v112, v38
    v_sub_f32 v145, v145, v38
    v_sub_f32 v113, v113, v38
    v_sub_f32 v146, v146, v38
    v_sub_f32 v114, v114, v38
    v_sub_f32 v147, v147, v38
    v_sub_f32 v115, v115, v38
    v_sub_f32 v148, v148, v38
    v_sub_f32 v116, v116, v38
    v_sub_f32 v149, v149, v38
    v_sub_f32 v117, v117, v38
    v_sub_f32 v150, v150, v38
    v_sub_f32 v118, v118, v38
    v_sub_f32 v151, v151, v38
    v_sub_f32 v119, v119, v38
    v_mul_f32 v224, v224, v40
    v_mul_f32 v225, v225, v40
    v_accvgpr_read_b32 v39, a0
    v_mul_f32 v39, v39, v40
    v_accvgpr_write_b32 a0, v39
    v_accvgpr_read_b32 v39, a1
    v_mul_f32 v39, v39, v40
    v_accvgpr_write_b32 a1, v39
    v_accvgpr_read_b32 v39, a2
    v_mul_f32 v39, v39, v40
    v_accvgpr_write_b32 a2, v39
    v_accvgpr_read_b32 v39, a3
    v_mul_f32 v39, v39, v40
    v_accvgpr_write_b32 a3, v39
    v_accvgpr_read_b32 v39, a4
    v_mul_f32 v39, v39, v40
    v_accvgpr_write_b32 a4, v39
    v_accvgpr_read_b32 v39, a5
    v_mul_f32 v39, v39, v40
    v_accvgpr_write_b32 a5, v39
    v_accvgpr_read_b32 v39, a6
    v_mul_f32 v39, v39, v40
    v_accvgpr_write_b32 a6, v39
    v_accvgpr_read_b32 v39, a7
    v_mul_f32 v39, v39, v40
    v_accvgpr_write_b32 a7, v39
    v_accvgpr_read_b32 v39, a8
    v_mul_f32 v39, v39, v40
    v_accvgpr_write_b32 a8, v39
    v_accvgpr_read_b32 v39, a9
    v_mul_f32 v39, v39, v40
    v_accvgpr_write_b32 a9, v39
    v_accvgpr_read_b32 v39, a10
    v_mul_f32 v39, v39, v40
    v_accvgpr_write_b32 a10, v39
    v_accvgpr_read_b32 v39, a11
    v_mul_f32 v39, v39, v40
    v_accvgpr_write_b32 a11, v39
    v_accvgpr_read_b32 v39, a12
    v_mul_f32 v39, v39, v40
    v_accvgpr_write_b32 a12, v39
    v_accvgpr_read_b32 v39, a13
    v_mul_f32 v39, v39, v40
    v_accvgpr_write_b32 a13, v39
    v_accvgpr_read_b32 v39, a14
    v_mul_f32 v39, v39, v40
    v_accvgpr_write_b32 a14, v39
    v_accvgpr_read_b32 v39, a15
    v_mul_f32 v39, v39, v40
    v_accvgpr_write_b32 a15, v39
    v_accvgpr_read_b32 v39, a16
    v_mul_f32 v39, v39, v40
    v_accvgpr_write_b32 a16, v39
    v_accvgpr_read_b32 v39, a17
    v_mul_f32 v39, v39, v40
    v_accvgpr_write_b32 a17, v39
    v_accvgpr_read_b32 v39, a18
    v_mul_f32 v39, v39, v40
    v_accvgpr_write_b32 a18, v39
    v_accvgpr_read_b32 v39, a19
    v_mul_f32 v39, v39, v40
    v_accvgpr_write_b32 a19, v39
    v_accvgpr_read_b32 v39, a20
    v_mul_f32 v39, v39, v40
    v_accvgpr_write_b32 a20, v39
    v_accvgpr_read_b32 v39, a21
    v_mul_f32 v39, v39, v40
    v_accvgpr_write_b32 a21, v39
    v_accvgpr_read_b32 v39, a22
    v_mul_f32 v39, v39, v40
    v_accvgpr_write_b32 a22, v39
    v_accvgpr_read_b32 v39, a23
    v_mul_f32 v39, v39, v40
    v_accvgpr_write_b32 a23, v39
    v_accvgpr_read_b32 v39, a24
    v_mul_f32 v39, v39, v40
    v_accvgpr_write_b32 a24, v39
    v_accvgpr_read_b32 v39, a25
    v_mul_f32 v39, v39, v40
    v_accvgpr_write_b32 a25, v39
    v_accvgpr_read_b32 v39, a26
    v_mul_f32 v39, v39, v40
    v_accvgpr_write_b32 a26, v39
    v_accvgpr_read_b32 v39, a27
    v_mul_f32 v39, v39, v40
    v_accvgpr_write_b32 a27, v39
    v_accvgpr_read_b32 v39, a28
    v_mul_f32 v39, v39, v40
    v_accvgpr_write_b32 a28, v39
    v_accvgpr_read_b32 v39, a29
    v_mul_f32 v39, v39, v40
    v_accvgpr_write_b32 a29, v39
    v_accvgpr_read_b32 v39, a30
    v_mul_f32 v39, v39, v40
    v_accvgpr_write_b32 a30, v39
    v_accvgpr_read_b32 v39, a31
    v_mul_f32 v39, v39, v40
    v_accvgpr_write_b32 a31, v39
    v_lshlrev_b32 v39, 16, v232
    v_and_b32 v232, 0xffff0000, v232
    v_mul_f32 v39, v39, v40
    v_mul_f32 v232, v232, v40
    v_perm_b32 v232, v232, v39, s3
    v_lshlrev_b32 v39, 16, v233
    v_and_b32 v233, 0xffff0000, v233
    v_mul_f32 v39, v39, v40
    v_mul_f32 v233, v233, v40
    v_perm_b32 v233, v233, v39, s3
    v_lshlrev_b32 v39, 16, v234
    v_and_b32 v234, 0xffff0000, v234
    v_mul_f32 v39, v39, v40
    v_mul_f32 v234, v234, v40
    v_perm_b32 v234, v234, v39, s3
    v_lshlrev_b32 v39, 16, v235
    v_and_b32 v235, 0xffff0000, v235
    v_mul_f32 v39, v39, v40
    v_mul_f32 v235, v235, v40
    v_perm_b32 v235, v235, v39, s3
    v_exp_f32 v28, v144 clamp
    v_exp_f32 v29, v145 clamp
    v_exp_f32 v30, v146 clamp
    v_exp_f32 v31, v147 clamp
    v_exp_f32 v32, v148 clamp
    v_exp_f32 v33, v149 clamp
    v_exp_f32 v34, v150 clamp
    v_exp_f32 v35, v151 clamp
    s_nop 0
    v_perm_b32 v192, v29, v28, s3
    v_perm_b32 v193, v31, v30, s3
    v_perm_b32 v194, v33, v32, s3
    v_perm_b32 v195, v35, v34, s3
    v_max3_f32 v38, v152, v153, v154
    v_max3_f32 v38, v38, v155, v156
    v_max3_f32 v38, v38, v157, v158
    v_max_f32 v38, v38, v159
    v_mov_b32 v39, v38
    s_nop 1
    v_permlane16_swap_b32 v38, v39
    s_nop 1
    v_max_f32 v38, v38, v39
    v_mov_b32 v39, v38
    s_nop 1
    v_permlane32_swap_b32 v38, v39
    s_nop 1
    v_max_f32 v38, v38, v39
    v_ceil_f32 v38, v38
    v_add_f32 v38, 0x42200000, v38
    v_max_f32 v38, 0, v38
    v_exp_f32 v40, -v38
    v_sub_f32 v212, v212, v38
    v_sub_f32 v213, v213, v38
    v_sub_f32 v214, v214, v38
    v_sub_f32 v215, v215, v38
    v_sub_f32 v152, v152, v38
    v_sub_f32 v120, v120, v38
    v_sub_f32 v153, v153, v38
    v_sub_f32 v121, v121, v38
    v_sub_f32 v154, v154, v38
    v_sub_f32 v122, v122, v38
    v_sub_f32 v155, v155, v38
    v_sub_f32 v123, v123, v38
    v_sub_f32 v156, v156, v38
    v_sub_f32 v124, v124, v38
    v_sub_f32 v157, v157, v38
    v_sub_f32 v125, v125, v38
    v_sub_f32 v158, v158, v38
    v_sub_f32 v126, v126, v38
    v_sub_f32 v159, v159, v38
    v_sub_f32 v127, v127, v38
    v_mul_f32 v226, v226, v40
    v_mul_f32 v227, v227, v40
    v_accvgpr_read_b32 v39, a32
    v_mul_f32 v39, v39, v40
    v_accvgpr_write_b32 a32, v39
    v_accvgpr_read_b32 v39, a33
    v_mul_f32 v39, v39, v40
    v_accvgpr_write_b32 a33, v39
    v_accvgpr_read_b32 v39, a34
    v_mul_f32 v39, v39, v40
    v_accvgpr_write_b32 a34, v39
    v_accvgpr_read_b32 v39, a35
    v_mul_f32 v39, v39, v40
    v_accvgpr_write_b32 a35, v39
    v_accvgpr_read_b32 v39, a36
    v_mul_f32 v39, v39, v40
    v_accvgpr_write_b32 a36, v39
    v_accvgpr_read_b32 v39, a37
    v_mul_f32 v39, v39, v40
    v_accvgpr_write_b32 a37, v39
    v_accvgpr_read_b32 v39, a38
    v_mul_f32 v39, v39, v40
    v_accvgpr_write_b32 a38, v39
    v_accvgpr_read_b32 v39, a39
    v_mul_f32 v39, v39, v40
    v_accvgpr_write_b32 a39, v39
    v_accvgpr_read_b32 v39, a40
    v_mul_f32 v39, v39, v40
    v_accvgpr_write_b32 a40, v39
    v_accvgpr_read_b32 v39, a41
    v_mul_f32 v39, v39, v40
    v_accvgpr_write_b32 a41, v39
    v_accvgpr_read_b32 v39, a42
    v_mul_f32 v39, v39, v40
    v_accvgpr_write_b32 a42, v39
    v_accvgpr_read_b32 v39, a43
    v_mul_f32 v39, v39, v40
    v_accvgpr_write_b32 a43, v39
    v_accvgpr_read_b32 v39, a44
    v_mul_f32 v39, v39, v40
    v_accvgpr_write_b32 a44, v39
    v_accvgpr_read_b32 v39, a45
    v_mul_f32 v39, v39, v40
    v_accvgpr_write_b32 a45, v39
    v_accvgpr_read_b32 v39, a46
    v_mul_f32 v39, v39, v40
    v_accvgpr_write_b32 a46, v39
    v_accvgpr_read_b32 v39, a47
    v_mul_f32 v39, v39, v40
    v_accvgpr_write_b32 a47, v39
    v_accvgpr_read_b32 v39, a48
    v_mul_f32 v39, v39, v40
    v_accvgpr_write_b32 a48, v39
    v_accvgpr_read_b32 v39, a49
    v_mul_f32 v39, v39, v40
    v_accvgpr_write_b32 a49, v39
    v_accvgpr_read_b32 v39, a50
    v_mul_f32 v39, v39, v40
    v_accvgpr_write_b32 a50, v39
    v_accvgpr_read_b32 v39, a51
    v_mul_f32 v39, v39, v40
    v_accvgpr_write_b32 a51, v39
    v_accvgpr_read_b32 v39, a52
    v_mul_f32 v39, v39, v40
    v_accvgpr_write_b32 a52, v39
    v_accvgpr_read_b32 v39, a53
    v_mul_f32 v39, v39, v40
    v_accvgpr_write_b32 a53, v39
    v_accvgpr_read_b32 v39, a54
    v_mul_f32 v39, v39, v40
    v_accvgpr_write_b32 a54, v39
    v_accvgpr_read_b32 v39, a55
    v_mul_f32 v39, v39, v40
    v_accvgpr_write_b32 a55, v39
    v_accvgpr_read_b32 v39, a56
    v_mul_f32 v39, v39, v40
    v_accvgpr_write_b32 a56, v39
    v_accvgpr_read_b32 v39, a57
    v_mul_f32 v39, v39, v40
    v_accvgpr_write_b32 a57, v39
    v_accvgpr_read_b32 v39, a58
    v_mul_f32 v39, v39, v40
    v_accvgpr_write_b32 a58, v39
    v_accvgpr_read_b32 v39, a59
    v_mul_f32 v39, v39, v40
    v_accvgpr_write_b32 a59, v39
    v_accvgpr_read_b32 v39, a60
    v_mul_f32 v39, v39, v40
    v_accvgpr_write_b32 a60, v39
    v_accvgpr_read_b32 v39, a61
    v_mul_f32 v39, v39, v40
    v_accvgpr_write_b32 a61, v39
    v_accvgpr_read_b32 v39, a62
    v_mul_f32 v39, v39, v40
    v_accvgpr_write_b32 a62, v39
    v_accvgpr_read_b32 v39, a63
    v_mul_f32 v39, v39, v40
    v_accvgpr_write_b32 a63, v39
    v_lshlrev_b32 v39, 16, v236
    v_and_b32 v236, 0xffff0000, v236
    v_mul_f32 v39, v39, v40
    v_mul_f32 v236, v236, v40
    v_perm_b32 v236, v236, v39, s3
    v_lshlrev_b32 v39, 16, v237
    v_and_b32 v237, 0xffff0000, v237
    v_mul_f32 v39, v39, v40
    v_mul_f32 v237, v237, v40
    v_perm_b32 v237, v237, v39, s3
    v_lshlrev_b32 v39, 16, v238
    v_and_b32 v238, 0xffff0000, v238
    v_mul_f32 v39, v39, v40
    v_mul_f32 v238, v238, v40
    v_perm_b32 v238, v238, v39, s3
    v_lshlrev_b32 v39, 16, v239
    v_and_b32 v239, 0xffff0000, v239
    v_mul_f32 v39, v39, v40
    v_mul_f32 v239, v239, v40
    v_perm_b32 v239, v239, v39, s3
    v_exp_f32 v28, v152 clamp
    v_exp_f32 v29, v153 clamp
    v_exp_f32 v30, v154 clamp
    v_exp_f32 v31, v155 clamp
    v_exp_f32 v32, v156 clamp
    v_exp_f32 v33, v157 clamp
    v_exp_f32 v34, v158 clamp
    v_exp_f32 v35, v159 clamp
    s_nop 0
    v_perm_b32 v196, v29, v28, s3
    v_perm_b32 v197, v31, v30, s3
    v_perm_b32 v198, v33, v32, s3
    v_perm_b32 v199, v35, v34, s3
    v_max3_f32 v38, v160, v161, v162
    v_max3_f32 v38, v38, v163, v164
    v_max3_f32 v38, v38, v165, v166
    v_max_f32 v38, v38, v167
    v_mov_b32 v39, v38
    s_nop 1
    v_permlane16_swap_b32 v38, v39
    s_nop 1
    v_max_f32 v38, v38, v39
    v_mov_b32 v39, v38
    s_nop 1
    v_permlane32_swap_b32 v38, v39
    s_nop 1
    v_max_f32 v38, v38, v39
    v_ceil_f32 v38, v38
    v_add_f32 v38, 0x42200000, v38
    v_max_f32 v38, 0, v38
    v_exp_f32 v40, -v38
    v_sub_f32 v216, v216, v38
    v_sub_f32 v217, v217, v38
    v_sub_f32 v218, v218, v38
    v_sub_f32 v219, v219, v38
    v_sub_f32 v160, v160, v38
    v_sub_f32 v128, v128, v38
    v_sub_f32 v161, v161, v38
    v_sub_f32 v129, v129, v38
    v_sub_f32 v162, v162, v38
    v_sub_f32 v130, v130, v38
    v_sub_f32 v163, v163, v38
    v_sub_f32 v131, v131, v38
    v_sub_f32 v164, v164, v38
    v_sub_f32 v132, v132, v38
    v_sub_f32 v165, v165, v38
    v_sub_f32 v133, v133, v38
    v_sub_f32 v166, v166, v38
    v_sub_f32 v134, v134, v38
    v_sub_f32 v167, v167, v38
    v_sub_f32 v135, v135, v38
    v_mul_f32 v228, v228, v40
    v_mul_f32 v229, v229, v40
    v_accvgpr_read_b32 v39, a64
    v_mul_f32 v39, v39, v40
    v_accvgpr_write_b32 a64, v39
    v_accvgpr_read_b32 v39, a65
    v_mul_f32 v39, v39, v40
    v_accvgpr_write_b32 a65, v39
    v_accvgpr_read_b32 v39, a66
    v_mul_f32 v39, v39, v40
    v_accvgpr_write_b32 a66, v39
    v_accvgpr_read_b32 v39, a67
    v_mul_f32 v39, v39, v40
    v_accvgpr_write_b32 a67, v39
    v_accvgpr_read_b32 v39, a68
    v_mul_f32 v39, v39, v40
    v_accvgpr_write_b32 a68, v39
    v_accvgpr_read_b32 v39, a69
    v_mul_f32 v39, v39, v40
    v_accvgpr_write_b32 a69, v39
    v_accvgpr_read_b32 v39, a70
    v_mul_f32 v39, v39, v40
    v_accvgpr_write_b32 a70, v39
    v_accvgpr_read_b32 v39, a71
    v_mul_f32 v39, v39, v40
    v_accvgpr_write_b32 a71, v39
    v_accvgpr_read_b32 v39, a72
    v_mul_f32 v39, v39, v40
    v_accvgpr_write_b32 a72, v39
    v_accvgpr_read_b32 v39, a73
    v_mul_f32 v39, v39, v40
    v_accvgpr_write_b32 a73, v39
    v_accvgpr_read_b32 v39, a74
    v_mul_f32 v39, v39, v40
    v_accvgpr_write_b32 a74, v39
    v_accvgpr_read_b32 v39, a75
    v_mul_f32 v39, v39, v40
    v_accvgpr_write_b32 a75, v39
    v_accvgpr_read_b32 v39, a76
    v_mul_f32 v39, v39, v40
    v_accvgpr_write_b32 a76, v39
    v_accvgpr_read_b32 v39, a77
    v_mul_f32 v39, v39, v40
    v_accvgpr_write_b32 a77, v39
    v_accvgpr_read_b32 v39, a78
    v_mul_f32 v39, v39, v40
    v_accvgpr_write_b32 a78, v39
    v_accvgpr_read_b32 v39, a79
    v_mul_f32 v39, v39, v40
    v_accvgpr_write_b32 a79, v39
    v_accvgpr_read_b32 v39, a80
    v_mul_f32 v39, v39, v40
    v_accvgpr_write_b32 a80, v39
    v_accvgpr_read_b32 v39, a81
    v_mul_f32 v39, v39, v40
    v_accvgpr_write_b32 a81, v39
    v_accvgpr_read_b32 v39, a82
    v_mul_f32 v39, v39, v40
    v_accvgpr_write_b32 a82, v39
    v_accvgpr_read_b32 v39, a83
    v_mul_f32 v39, v39, v40
    v_accvgpr_write_b32 a83, v39
    v_accvgpr_read_b32 v39, a84
    v_mul_f32 v39, v39, v40
    v_accvgpr_write_b32 a84, v39
    v_accvgpr_read_b32 v39, a85
    v_mul_f32 v39, v39, v40
    v_accvgpr_write_b32 a85, v39
    v_accvgpr_read_b32 v39, a86
    v_mul_f32 v39, v39, v40
    v_accvgpr_write_b32 a86, v39
    v_accvgpr_read_b32 v39, a87
    v_mul_f32 v39, v39, v40
    v_accvgpr_write_b32 a87, v39
    v_accvgpr_read_b32 v39, a88
    v_mul_f32 v39, v39, v40
    v_accvgpr_write_b32 a88, v39
    v_accvgpr_read_b32 v39, a89
    v_mul_f32 v39, v39, v40
    v_accvgpr_write_b32 a89, v39
    v_accvgpr_read_b32 v39, a90
    v_mul_f32 v39, v39, v40
    v_accvgpr_write_b32 a90, v39
    v_accvgpr_read_b32 v39, a91
    v_mul_f32 v39, v39, v40
    v_accvgpr_write_b32 a91, v39
    v_accvgpr_read_b32 v39, a92
    v_mul_f32 v39, v39, v40
    v_accvgpr_write_b32 a92, v39
    v_accvgpr_read_b32 v39, a93
    v_mul_f32 v39, v39, v40
    v_accvgpr_write_b32 a93, v39
    v_accvgpr_read_b32 v39, a94
    v_mul_f32 v39, v39, v40
    v_accvgpr_write_b32 a94, v39
    v_accvgpr_read_b32 v39, a95
    v_mul_f32 v39, v39, v40
    v_accvgpr_write_b32 a95, v39
    v_lshlrev_b32 v39, 16, v240
    v_and_b32 v240, 0xffff0000, v240
    v_mul_f32 v39, v39, v40
    v_mul_f32 v240, v240, v40
    v_perm_b32 v240, v240, v39, s3
    v_lshlrev_b32 v39, 16, v241
    v_and_b32 v241, 0xffff0000, v241
    v_mul_f32 v39, v39, v40
    v_mul_f32 v241, v241, v40
    v_perm_b32 v241, v241, v39, s3
    v_lshlrev_b32 v39, 16, v242
    v_and_b32 v242, 0xffff0000, v242
    v_mul_f32 v39, v39, v40
    v_mul_f32 v242, v242, v40
    v_perm_b32 v242, v242, v39, s3
    v_lshlrev_b32 v39, 16, v243
    v_and_b32 v243, 0xffff0000, v243
    v_mul_f32 v39, v39, v40
    v_mul_f32 v243, v243, v40
    v_perm_b32 v243, v243, v39, s3
    v_exp_f32 v28, v160 clamp
    v_exp_f32 v29, v161 clamp
    v_exp_f32 v30, v162 clamp
    v_exp_f32 v31, v163 clamp
    v_exp_f32 v32, v164 clamp
    v_exp_f32 v33, v165 clamp
    v_exp_f32 v34, v166 clamp
    v_exp_f32 v35, v167 clamp
    s_nop 0
    v_perm_b32 v200, v29, v28, s3
    v_perm_b32 v201, v31, v30, s3
    v_perm_b32 v202, v33, v32, s3
    v_perm_b32 v203, v35, v34, s3
    v_max3_f32 v38, v168, v169, v170
    v_max3_f32 v38, v38, v171, v172
    v_max3_f32 v38, v38, v173, v174
    v_max_f32 v38, v38, v175
    v_mov_b32 v39, v38
    s_nop 1
    v_permlane16_swap_b32 v38, v39
    s_nop 1
    v_max_f32 v38, v38, v39
    v_mov_b32 v39, v38
    s_nop 1
    v_permlane32_swap_b32 v38, v39
    s_nop 1
    v_max_f32 v38, v38, v39
    v_ceil_f32 v38, v38
    v_add_f32 v38, 0x42200000, v38
    v_max_f32 v38, 0, v38
    v_exp_f32 v40, -v38
    v_sub_f32 v220, v220, v38
    v_sub_f32 v221, v221, v38
    v_sub_f32 v222, v222, v38
    v_sub_f32 v223, v223, v38
    v_sub_f32 v168, v168, v38
    v_sub_f32 v136, v136, v38
    v_sub_f32 v169, v169, v38
    v_sub_f32 v137, v137, v38
    v_sub_f32 v170, v170, v38
    v_sub_f32 v138, v138, v38
    v_sub_f32 v171, v171, v38
    v_sub_f32 v139, v139, v38
    v_sub_f32 v172, v172, v38
    v_sub_f32 v140, v140, v38
    v_sub_f32 v173, v173, v38
    v_sub_f32 v141, v141, v38
    v_sub_f32 v174, v174, v38
    v_sub_f32 v142, v142, v38
    v_sub_f32 v175, v175, v38
    v_sub_f32 v143, v143, v38
    v_mul_f32 v230, v230, v40
    v_mul_f32 v231, v231, v40
    v_accvgpr_read_b32 v39, a96
    v_mul_f32 v39, v39, v40
    v_accvgpr_write_b32 a96, v39
    v_accvgpr_read_b32 v39, a97
    v_mul_f32 v39, v39, v40
    v_accvgpr_write_b32 a97, v39
    v_accvgpr_read_b32 v39, a98
    v_mul_f32 v39, v39, v40
    v_accvgpr_write_b32 a98, v39
    v_accvgpr_read_b32 v39, a99
    v_mul_f32 v39, v39, v40
    v_accvgpr_write_b32 a99, v39
    v_accvgpr_read_b32 v39, a100
    v_mul_f32 v39, v39, v40
    v_accvgpr_write_b32 a100, v39
    v_accvgpr_read_b32 v39, a101
    v_mul_f32 v39, v39, v40
    v_accvgpr_write_b32 a101, v39
    v_accvgpr_read_b32 v39, a102
    v_mul_f32 v39, v39, v40
    v_accvgpr_write_b32 a102, v39
    v_accvgpr_read_b32 v39, a103
    v_mul_f32 v39, v39, v40
    v_accvgpr_write_b32 a103, v39
    v_accvgpr_read_b32 v39, a104
    v_mul_f32 v39, v39, v40
    v_accvgpr_write_b32 a104, v39
    v_accvgpr_read_b32 v39, a105
    v_mul_f32 v39, v39, v40
    v_accvgpr_write_b32 a105, v39
    v_accvgpr_read_b32 v39, a106
    v_mul_f32 v39, v39, v40
    v_accvgpr_write_b32 a106, v39
    v_accvgpr_read_b32 v39, a107
    v_mul_f32 v39, v39, v40
    v_accvgpr_write_b32 a107, v39
    v_accvgpr_read_b32 v39, a108
    v_mul_f32 v39, v39, v40
    v_accvgpr_write_b32 a108, v39
    v_accvgpr_read_b32 v39, a109
    v_mul_f32 v39, v39, v40
    v_accvgpr_write_b32 a109, v39
    v_accvgpr_read_b32 v39, a110
    v_mul_f32 v39, v39, v40
    v_accvgpr_write_b32 a110, v39
    v_accvgpr_read_b32 v39, a111
    v_mul_f32 v39, v39, v40
    v_accvgpr_write_b32 a111, v39
    v_accvgpr_read_b32 v39, a112
    v_mul_f32 v39, v39, v40
    v_accvgpr_write_b32 a112, v39
    v_accvgpr_read_b32 v39, a113
    v_mul_f32 v39, v39, v40
    v_accvgpr_write_b32 a113, v39
    v_accvgpr_read_b32 v39, a114
    v_mul_f32 v39, v39, v40
    v_accvgpr_write_b32 a114, v39
    v_accvgpr_read_b32 v39, a115
    v_mul_f32 v39, v39, v40
    v_accvgpr_write_b32 a115, v39
    v_accvgpr_read_b32 v39, a116
    v_mul_f32 v39, v39, v40
    v_accvgpr_write_b32 a116, v39
    v_accvgpr_read_b32 v39, a117
    v_mul_f32 v39, v39, v40
    v_accvgpr_write_b32 a117, v39
    v_accvgpr_read_b32 v39, a118
    v_mul_f32 v39, v39, v40
    v_accvgpr_write_b32 a118, v39
    v_accvgpr_read_b32 v39, a119
    v_mul_f32 v39, v39, v40
    v_accvgpr_write_b32 a119, v39
    v_accvgpr_read_b32 v39, a120
    v_mul_f32 v39, v39, v40
    v_accvgpr_write_b32 a120, v39
    v_accvgpr_read_b32 v39, a121
    v_mul_f32 v39, v39, v40
    v_accvgpr_write_b32 a121, v39
    v_accvgpr_read_b32 v39, a122
    v_mul_f32 v39, v39, v40
    v_accvgpr_write_b32 a122, v39
    v_accvgpr_read_b32 v39, a123
    v_mul_f32 v39, v39, v40
    v_accvgpr_write_b32 a123, v39
    v_accvgpr_read_b32 v39, a124
    v_mul_f32 v39, v39, v40
    v_accvgpr_write_b32 a124, v39
    v_accvgpr_read_b32 v39, a125
    v_mul_f32 v39, v39, v40
    v_accvgpr_write_b32 a125, v39
    v_accvgpr_read_b32 v39, a126
    v_mul_f32 v39, v39, v40
    v_accvgpr_write_b32 a126, v39
    v_accvgpr_read_b32 v39, a127
    v_mul_f32 v39, v39, v40
    v_accvgpr_write_b32 a127, v39
    v_lshlrev_b32 v39, 16, v244
    v_and_b32 v244, 0xffff0000, v244
    v_mul_f32 v39, v39, v40
    v_mul_f32 v244, v244, v40
    v_perm_b32 v244, v244, v39, s3
    v_lshlrev_b32 v39, 16, v245
    v_and_b32 v245, 0xffff0000, v245
    v_mul_f32 v39, v39, v40
    v_mul_f32 v245, v245, v40
    v_perm_b32 v245, v245, v39, s3
    v_lshlrev_b32 v39, 16, v246
    v_and_b32 v246, 0xffff0000, v246
    v_mul_f32 v39, v39, v40
    v_mul_f32 v246, v246, v40
    v_perm_b32 v246, v246, v39, s3
    v_lshlrev_b32 v39, 16, v247
    v_and_b32 v247, 0xffff0000, v247
    v_mul_f32 v39, v39, v40
    v_mul_f32 v247, v247, v40
    v_perm_b32 v247, v247, v39, s3
    v_exp_f32 v28, v168 clamp
    v_exp_f32 v29, v169 clamp
    v_exp_f32 v30, v170 clamp
    v_exp_f32 v31, v171 clamp
    v_exp_f32 v32, v172 clamp
    v_exp_f32 v33, v173 clamp
    v_exp_f32 v34, v174 clamp
    v_exp_f32 v35, v175 clamp
    s_nop 0
    v_perm_b32 v204, v29, v28, s3
    v_perm_b32 v205, v31, v30, s3
    v_perm_b32 v206, v33, v32, s3
    v_perm_b32 v207, v35, v34, s3
    s_nop 1
    v_smfmac_f32_16x16x64_bf16 v[224:227], v[24:27], v[192:199], v250
    v_smfmac_f32_16x16x64_bf16 v[228:231], v[24:27], v[200:207], v250
    s_nop 15
    s_setpc_b64 s[46:47]
.section .rodata,"a"
.p2align 6
.amdhsa_kernel adaLN_cond__gqa_block_cached__glu_gated_bilinear__prompt_kernel
  .amdhsa_next_free_vgpr 512
  .amdhsa_next_free_sgpr 102
  .amdhsa_accum_offset 256
  .amdhsa_group_segment_fixed_size 0
  .amdhsa_kernarg_size 112
  .amdhsa_user_sgpr_count 2
  .amdhsa_user_sgpr_kernarg_segment_ptr 1
  .amdhsa_system_sgpr_workgroup_id_x 1
.end_amdhsa_kernel
```
